```python
import torch

def _softmax(x, axis=-1):
    return torch.softmax(x, dim=axis)

def _gelu(x):
    return torch.nn.functional.gelu(x, approximate='tanh')

def _silu(x):
    return torch.nn.functional.silu(x)

def _sigmoid(x):
    return torch.sigmoid(x)

def _layernorm(x, axis=-1, eps=1e-05):
    m = x.mean(dim=axis, keepdim=True)
    v = x.var(dim=axis, keepdim=True, unbiased=False)
    return (x - m) / torch.sqrt(v + eps)

def _scatter_add(tgt, idx, src, axis=0):
    return tgt.clone().index_add_(axis, idx, src)

def _segment_sum(src, seg, n):
    out = torch.zeros((n,) + src.shape[1:], dtype=src.dtype)
    return out.index_add_(0, seg, src)

def _pad(x, pw):
    flat = tuple((v for pair in reversed(pw) for v in pair))
    return torch.nn.functional.pad(x, flat)
kernel_name = 'adaLN_cond__memory_aug_recurrent_mem_tr__mixer_channel_mlp__prompt'

def setup_inputs():

    _w = lambda a: (lambda t: t.to(torch.bfloat16) if t.is_floating_point() else t)(torch.as_tensor(a))

    def _A_setup():
        B, S, Dm = (1, 2048, 640)
        H, Dh = (32, 192)
        M, seg = (8, 32)
        seg = min(seg, S)
        S = S // seg * seg
        return {'x': _w((lambda *s: torch.randn(*s, dtype=torch.bfloat16) * 0.05)(B, S, Dm)), 'mem0': _w((lambda *s: torch.randn(*s, dtype=torch.bfloat16) * 0.4)(B, M, Dm)), 'Wq': _w((lambda *s: torch.randn(*s, dtype=torch.bfloat16) * 1.6)(Dm, H, Dh) * Dm ** (-0.5)), 'Wk': _w((lambda *s: torch.randn(*s, dtype=torch.bfloat16) * 1.6)(Dm, H, Dh) * Dm ** (-0.5)), 'Wv': _w((lambda *s: torch.randn(*s, dtype=torch.bfloat16) * 0.4)(Dm, H, Dh) * Dm ** (-0.5)), 'Wo': _w((lambda *s: torch.randn(*s, dtype=torch.bfloat16) * 0.4)(H, Dh, Dm) * (H * Dh) ** (-0.5)), 'seg_len': seg}
    _A_in = _A_setup()

    def _B_setup():
        B, S, D, F = (1, 2048, 640, 1536)
        return {'x': _w((lambda *s: torch.randn(*s, dtype=torch.bfloat16) * 0.05)(B, S, D)), 'w1': _w((lambda *s: torch.randn(*s, dtype=torch.bfloat16) * 1.6)(D, F) * D ** (-0.5)), 'b1': _w((lambda *s: torch.randn(*s, dtype=torch.bfloat16) * 0.4)(F)), 'w2': _w((lambda *s: torch.randn(*s, dtype=torch.bfloat16) * 0.1)(F, D) * F ** (-0.5)), 'b2': _w((lambda *s: torch.randn(*s, dtype=torch.bfloat16) * 0.1)(D))}
    _B_in = _B_setup()
    return {'A_x': _A_in['x'], 'A_mem0': _A_in['mem0'], 'A_Wq': _A_in['Wq'], 'A_Wk': _A_in['Wk'], 'A_Wv': _A_in['Wv'], 'A_Wo': _A_in['Wo'], 'A_seg_len': _A_in['seg_len'], 'B_x': _B_in['x'], 'B_w1': _B_in['w1'], 'B_b1': _B_in['b1'], 'B_w2': _B_in['w2'], 'B_b2': _B_in['b2'], 'c': _w((lambda *s: torch.randn(*s, dtype=torch.bfloat16) * 0.1)(1, 640) * 8.0), 'w_mod': _w((lambda *s: torch.randn(*s, dtype=torch.bfloat16) * 0.1)(640, 6 * 640) * 640 ** (-0.5) * 8.0)}

def reference(A_x, A_mem0, A_Wq, A_Wk, A_Wv, A_Wo, A_seg_len, B_x, B_w1, B_b1, B_w2, B_b2, c, w_mod):

    def _A_ref(x, mem0, Wq, Wk, Wv, Wo, seg_len):
        B, S, Dm = x.shape
        H, Dh = (Wq.shape[1], Wq.shape[2])
        M = mem0.shape[1]
        scale = Dh ** (-0.5)
        n_seg = S // seg_len
        L = M + seg_len
        idx = torch.arange(L)
        mask = (idx[:, None] < M) | (idx[:, None] >= idx[None, :])
        mem = mem0
        outs = []
        for s in range(n_seg):
            xs = x[:, s * seg_len:(s + 1) * seg_len, :].clone()
            h = torch.concatenate([mem, xs], axis=1)
            q = torch.einsum('btd,dhe->bhte', h, Wq)
            k = torch.einsum('btd,dhe->bhte', h, Wk)
            v = torch.einsum('btd,dhe->bhte', h, Wv)
            scores = torch.einsum('bhqe,bhke->bhqk', q, k) * scale
            scores = torch.where(mask[None, None], scores, -1000000000.0)
            p = _softmax(scores, axis=-1)
            o = torch.einsum('bhqk,bhke->bhqe', p, v)
            o = torch.einsum('bhte,hed->btd', o, Wo)
            mem = o[:, :M, :].clone()
            outs.append(o[:, M:, :])
        return torch.concatenate(outs, axis=1)

    def _B_ref(x, w1, b1, w2, b2):
        y = _layernorm(x, axis=-1)
        h = _gelu(torch.einsum('bsd,df->bsf', y, w1) + b1)
        return torch.einsum('bsf,fd->bsd', h, w2) + b2
    x = A_x
    mod = (_silu(c) @ w_mod).reshape(c.shape[0], 6, 1, -1)
    sa, ca, ga, sb, cb, gb = (mod[:, 0].clone(), mod[:, 1].clone(), mod[:, 2].clone(), mod[:, 3].clone(), mod[:, 4].clone(), mod[:, 5].clone())
    h = _layernorm(x, axis=-1) * (1 + ca) + sa
    x = x + ga * _A_ref(h, A_mem0, A_Wq, A_Wk, A_Wv, A_Wo, A_seg_len)
    h = _layernorm(x, axis=-1) * (1 + cb) + sb
    x = x + gb * _B_ref(h, B_w1, B_b1, B_w2, B_b2)
    return x
```

```asm
; @launch kernel=adaLN_cond__memory_aug_recurrent_mem_tr__mixer_channel_mlp__prompt_kernel grid=(256,1,1) block=(256,1,1) lds=163840
.amdgcn_target "amdgcn-amd-amdhsa--gfx950"

.text
.globl adaLN_cond__memory_aug_recurrent_mem_tr__mixer_channel_mlp__prompt_kernel
.p2align 8
.type adaLN_cond__memory_aug_recurrent_mem_tr__mixer_channel_mlp__prompt_kernel,@function
adaLN_cond__memory_aug_recurrent_mem_tr__mixer_channel_mlp__prompt_kernel:
    s_mov_b32 s3, 255
    s_branch .Lmega
.p2align 8
.Lmega:
    s_cmp_ge_u32 s2, 256
    s_cbranch_scc1 .Lend
    s_load_dwordx2 s[4:5], s[0:1], 128
    s_load_dwordx4 s[8:11], s[0:1], 112
    v_lshrrev_b32 v2, 6, v0
    v_and_b32 v1, 63, v0
    s_mov_b32 s14, 0
    s_mov_b32 s94, 0
    v_readfirstlane_b32 s12, v2
    s_getreg_b32 s15, hwreg(HW_REG_XCC_ID)
    s_and_b32 s15, s15, 7
    s_waitcnt lgkmcnt(0)
    s_mov_b32 s6, s10
    s_mov_b32 s7, s11
    s_add_u32 s4, s4, 0x1fffff
    s_addc_u32 s5, s5, 0
    s_and_b32 s4, s4, 0xffe00000
    s_add_u32 s10, s4, 260046848
    s_addc_u32 s11, s5, 0
    s_cmp_ge_u32 s2, 8
    s_cbranch_scc1 .dsk_1
    s_lshl_b32 s16, s12, 15
    s_lshl_b32 s17, s2, 17
    s_add_u32 s16, s16, s17
    s_add_u32 s16, s16, 4201984
    v_lshlrev_b32 v2, 13, v1
    v_add_u32 v2, s16, v2
    v_mov_b32 v3, 0
    s_mov_b64 exec, 15
    global_store_dword v2, v3, s[4:5] sc1
    s_mov_b64 exec, 1
    s_mov_b32 s20, 0x7fffffff
    s_mov_b32 s21, 0x7fffffff
    s_waitcnt vmcnt(0)
    s_memtime s[22:23]
    s_waitcnt lgkmcnt(0)
    global_load_dword v3, v2, s[4:5] sc1
    s_waitcnt vmcnt(0)
    s_memtime s[24:25]
    v_add_u32 v2, 8192, v2
    s_waitcnt lgkmcnt(0)
    s_sub_u32 s24, s24, s22
    s_min_u32 s20, s20, s24
    s_memtime s[22:23]
    s_waitcnt lgkmcnt(0)
    global_load_dword v3, v2, s[4:5] sc1
    s_waitcnt vmcnt(0)
    s_memtime s[24:25]
    v_add_u32 v2, 8192, v2
    s_waitcnt lgkmcnt(0)
    s_sub_u32 s24, s24, s22
    s_min_u32 s21, s21, s24
    s_memtime s[22:23]
    s_waitcnt lgkmcnt(0)
    global_load_dword v3, v2, s[4:5] sc1
    s_waitcnt vmcnt(0)
    s_memtime s[24:25]
    v_add_u32 v2, 8192, v2
    s_waitcnt lgkmcnt(0)
    s_sub_u32 s24, s24, s22
    s_min_u32 s20, s20, s24
    s_memtime s[22:23]
    s_waitcnt lgkmcnt(0)
    global_load_dword v3, v2, s[4:5] sc1
    s_waitcnt vmcnt(0)
    s_memtime s[24:25]
    v_add_u32 v2, 8192, v2
    s_waitcnt lgkmcnt(0)
    s_sub_u32 s24, s24, s22
    s_min_u32 s21, s21, s24
    s_lshl_b32 s16, s12, 3
    v_mov_b32 v2, s16
    v_mov_b32 v4, s20
    v_mov_b32 v5, s21
    ds_write_b64 v2, v[4:5] offset:64
    s_mov_b64 exec, -1
    s_waitcnt lgkmcnt(0)
    s_barrier
    v_mov_b32 v2, 0
    ds_read_b128 v[4:7], v2 offset:64
    ds_read_b128 v[8:11], v2 offset:80
    s_waitcnt lgkmcnt(0)
    v_min3_u32 v4, v4, v6, v8
    v_min3_u32 v5, v5, v7, v9
    v_min_u32 v4, v4, v10
    v_min_u32 v5, v5, v11
    s_nop 0
    v_readfirstlane_b32 s20, v4
    v_readfirstlane_b32 s21, v5
    s_lshr_b32 s22, s15, 2
    s_nop 2
    s_cmp_lt_u32 s21, s20
    s_cselect_b32 s23, 1, 0
    s_xor_b32 s23, s23, s22
    s_xor_b32 s23, s23, 0
    s_lshl_b32 s23, s23, 8
    s_add_u32 s23, s23, 1
    s_cmp_lg_u32 s12, 0
    s_cbranch_scc1 .dsk_1
    v_mov_b32 v2, 72
    v_mov_b32 v3, s23
    s_mov_b64 exec, 1
    global_atomic_add v2, v3, s[6:7] sc1
    s_mov_b64 exec, -1
.dsk_1:
    s_cmp_lg_u32 s12, 0
    s_cbranch_scc1 .Ltk_wait
    s_lshl_b32 s16, s15, 2
    v_mov_b32 v2, s16
    v_mov_b32 v3, 1
    s_mov_b64 exec, 1
    global_atomic_add v4, v2, v3, s[6:7] sc0 sc1
    s_waitcnt vmcnt(0)
    s_mov_b64 exec, -1
    v_readfirstlane_b32 s13, v4
    s_nop 3
    s_cmp_lt_u32 s13, 32
    s_cbranch_scc1 .Ltk_ok
    v_and_b32 v2, 7, v1
    v_lshlrev_b32 v2, 2, v2
.Ltk_ov:
    global_load_dword v4, v2, s[6:7] sc0 sc1
    s_waitcnt vmcnt(0)
    s_mov_b32 s16, 0
    v_readlane_b32 s20, v4, 0
    s_nop 3
    s_add_u32 s16, s16, s20
    v_readlane_b32 s21, v4, 1
    s_nop 3
    s_add_u32 s16, s16, s21
    v_readlane_b32 s22, v4, 2
    s_nop 3
    s_add_u32 s16, s16, s22
    v_readlane_b32 s23, v4, 3
    s_nop 3
    s_add_u32 s16, s16, s23
    v_readlane_b32 s24, v4, 4
    s_nop 3
    s_add_u32 s16, s16, s24
    v_readlane_b32 s25, v4, 5
    s_nop 3
    s_add_u32 s16, s16, s25
    v_readlane_b32 s26, v4, 6
    s_nop 3
    s_add_u32 s16, s16, s26
    v_readlane_b32 s27, v4, 7
    s_nop 3
    s_add_u32 s16, s16, s27
    s_add_u32 s14, s14, 1
    s_cmp_gt_u32 s14, 400000
    s_cbranch_scc1 .Lend
    s_cmp_lt_u32 s16, 256
    s_cbranch_scc1 .Ltk_ov
    v_mov_b32 v2, 32
    s_mov_b64 exec, 1
    global_atomic_add v4, v2, v3, s[6:7] sc0 sc1
    s_waitcnt vmcnt(0)
    s_mov_b64 exec, -1
    v_readfirstlane_b32 s16, v4
    s_nop 3
    s_min_u32 s17, s20, 32
    s_mov_b32 s15, 0
    s_add_u32 s13, s17, s16
    s_cmp_lt_u32 s13, 32
    s_cbranch_scc1 .Ltk_ok
    s_sub_u32 s16, s13, 32
    s_min_u32 s17, s21, 32
    s_mov_b32 s15, 1
    s_add_u32 s13, s17, s16
    s_cmp_lt_u32 s13, 32
    s_cbranch_scc1 .Ltk_ok
    s_sub_u32 s16, s13, 32
    s_min_u32 s17, s22, 32
    s_mov_b32 s15, 2
    s_add_u32 s13, s17, s16
    s_cmp_lt_u32 s13, 32
    s_cbranch_scc1 .Ltk_ok
    s_sub_u32 s16, s13, 32
    s_min_u32 s17, s23, 32
    s_mov_b32 s15, 3
    s_add_u32 s13, s17, s16
    s_cmp_lt_u32 s13, 32
    s_cbranch_scc1 .Ltk_ok
    s_sub_u32 s16, s13, 32
    s_min_u32 s17, s24, 32
    s_mov_b32 s15, 4
    s_add_u32 s13, s17, s16
    s_cmp_lt_u32 s13, 32
    s_cbranch_scc1 .Ltk_ok
    s_sub_u32 s16, s13, 32
    s_min_u32 s17, s25, 32
    s_mov_b32 s15, 5
    s_add_u32 s13, s17, s16
    s_cmp_lt_u32 s13, 32
    s_cbranch_scc1 .Ltk_ok
    s_sub_u32 s16, s13, 32
    s_min_u32 s17, s26, 32
    s_mov_b32 s15, 6
    s_add_u32 s13, s17, s16
    s_cmp_lt_u32 s13, 32
    s_cbranch_scc1 .Ltk_ok
    s_sub_u32 s16, s13, 32
    s_min_u32 s17, s27, 32
    s_mov_b32 s15, 7
    s_add_u32 s13, s17, s16
    s_cmp_lt_u32 s13, 32
    s_cbranch_scc1 .Ltk_ok
    s_sub_u32 s16, s13, 32
    s_branch .Lend
.Ltk_ok:
    s_lshl_b32 s16, s15, 8
    s_or_b32 s16, s16, s13
    v_mov_b32 v2, 0
    v_mov_b32 v3, s16
    ds_write_b32 v2, v3
    s_waitcnt lgkmcnt(0)
.Ltk_wait:
    s_barrier
    v_mov_b32 v2, 0
    ds_read_b32 v3, v2
    s_waitcnt lgkmcnt(0)
    v_readfirstlane_b32 s16, v3
    s_barrier
    s_lshr_b32 s15, s16, 8
    s_and_b32 s15, s15, 7
    s_and_b32 s13, s16, 31
    s_mov_b32 s89, 0
    s_cmp_ge_u32 s15, 4
    s_cbranch_scc1 .Lpl_o
    s_cmp_ge_u32 s13, 26
    s_cbranch_scc1 .Lpl_q
    s_cmp_lt_u32 s13, 10
    s_cbranch_scc1 .Lpl_c
    s_lshl_b32 s16, s15, 4
    s_add_u32 s13, s13, s16
    s_sub_u32 s13, s13, 10
    s_mov_b32 s96, s13
    s_bitcmp1_b32 s3, 3
    s_cbranch_scc0 .Lend
    s_bitcmp1_b32 s13, 0
    s_cbranch_scc1 .Lrole_V
    s_branch .Lrole_S
.Lpl_c:
    s_mul_i32 s88, s15, 10
    s_add_u32 s88, s88, s13
    s_cmp_ge_u32 s13, 5
    s_cbranch_scc1 .Lpl_c2
    s_mul_i32 s16, s15, 5
    s_add_u32 s13, s13, s16
    s_branch .Lpl_b
.Lpl_c2:
    s_mov_b32 s96, 255
    s_bitcmp1_b32 s3, 3
    s_cbranch_scc0 .Lend
    s_add_u32 s13, s88, 64
    s_branch .Lrole_C
.Lpl_q:
    s_mul_i32 s16, s15, 6
    s_add_u32 s13, s13, s16
    s_sub_u32 s13, s13, 26
    s_mov_b32 s15, 0
    s_branch .Lrole_A
.Lpl_o:
    s_sub_u32 s16, s15, 4
    s_add_u32 s17, s13, 19
    s_cmp_lt_u32 s13, 6
    s_cbranch_scc1 .Lpl_r
    s_sub_u32 s17, s13, 6
    s_cmp_lt_u32 s13, 17
    s_cbranch_scc1 .Lpl_r
    s_add_u32 s17, s13, 8
    s_cmp_lt_u32 s13, 23
    s_cbranch_scc1 .Lpl_r
    s_sub_u32 s17, s13, 12
    s_cmp_lt_u32 s13, 31
    s_cbranch_scc1 .Lpl_r
    s_mov_b32 s17, 31
    .Lpl_r:
    s_mov_b32 s13, s17
    s_cmp_ge_u32 s13, 11
    s_cbranch_scc1 .Lpl_a
    s_mov_b32 s17, s13
    s_add_u32 s13, s16, 44
    s_cmp_eq_u32 s17, 8
    s_cbranch_scc1 .Lpl_b
    s_lshl_b32 s13, s16, 1
    s_add_u32 s13, s13, s17
    s_add_u32 s13, s13, 39
    s_cmp_gt_u32 s17, 8
    s_cbranch_scc1 .Lpl_b
    s_lshl_b32 s13, s16, 3
    s_add_u32 s13, s13, s17
    s_add_u32 s13, s13, 20
    s_cmp_lt_u32 s16, 3
    s_cbranch_scc1 .Lpl_b
    s_add_u32 s13, s17, 56
    s_branch .Lpl_b
.Lpl_a:
    s_cmp_eq_u32 s13, 31
    s_cbranch_scc1 .Lend
    s_sub_u32 s17, s13, 11
    s_lshl_b32 s13, s16, 3
    s_add_u32 s13, s13, s17
    s_mov_b32 s15, 3
    s_cmp_lt_u32 s17, 8
    s_cbranch_scc1 .Lrole_A
    s_sub_u32 s90, s17, 8
    s_sub_u32 s89, s16, 1
    s_cmp_eq_u32 s16, 0
    s_cselect_b32 s89, 3, s89
    s_cmp_ge_u32 s90, 8
    s_cselect_b32 s89, 0, s89
    s_mul_i32 s13, s16, 6
    s_add_u32 s13, s13, s90
    s_mov_b32 s15, 2
    s_cmp_lt_u32 s90, 6
    s_cbranch_scc1 .Lrole_A
    s_sub_u32 s13, s13, 6
    s_mov_b32 s15, 1
    s_branch .Lrole_A
.Lpl_b:
    s_add_u32 s96, s13, 64
.Lrole_B:
    s_load_dwordx4 s[20:23], s[0:1], 96
    s_load_dwordx2 s[18:19], s[0:1], 0
    v_lshrrev_b32 v4, 4, v0
    s_lshl_b32 s15, s13, 5
    v_add_u32 v5, s15, v4
    v_mul_u32_u24 v5, 1280, v5
    v_and_b32 v6, 15, v1
    v_lshlrev_b32 v6, 4, v6
    v_add_u32 v5, v5, v6
    s_waitcnt lgkmcnt(0)
    global_load_dwordx4 v[200:203], v5, s[18:19] offset:0
    global_load_dwordx4 v[204:207], v5, s[18:19] offset:256
    global_load_dwordx4 v[208:211], v5, s[18:19] offset:512
    global_load_dwordx4 v[212:215], v5, s[18:19] offset:768
    global_load_dwordx4 v[216:219], v5, s[18:19] offset:1024
    v_add_u32 v5, 20480, v5
    global_load_dwordx4 v[220:223], v5, s[18:19] offset:0
    global_load_dwordx4 v[224:227], v5, s[18:19] offset:256
    global_load_dwordx4 v[228:231], v5, s[18:19] offset:512
    global_load_dwordx4 v[232:235], v5, s[18:19] offset:768
    global_load_dwordx4 v[236:239], v5, s[18:19] offset:1024
    v_mov_b32 v4, -1
    v_mov_b32 v5, -1
    v_mov_b32 v6, -1
    v_mov_b32 v7, -1
    s_mul_i32 s15, s13, 12288
    v_lshlrev_b32 v2, 4, v0
    v_add_u32 v2, s15, v2
    v_add_u32 v3, 1048576, v2
    global_store_dwordx4 v2, v[4:7], s[4:5] sc1
    global_store_dwordx4 v3, v[4:7], s[4:5] sc1
    v_add_u32 v2, 4096, v2
    v_add_u32 v3, 4096, v3
    global_store_dwordx4 v2, v[4:7], s[4:5] sc1
    global_store_dwordx4 v3, v[4:7], s[4:5] sc1
    v_add_u32 v2, 4096, v2
    v_add_u32 v3, 4096, v3
    global_store_dwordx4 v2, v[4:7], s[4:5] sc1
    global_store_dwordx4 v3, v[4:7], s[4:5] sc1
    s_lshl_b32 s15, s13, 10
    v_lshlrev_b32 v2, 2, v0
    v_add_u32 v2, s15, v2
    v_mov_b32 v3, 0
    global_store_dword v2, v3, s[10:11] sc1
    s_mul_i32 s16, s13, 3277
    s_lshr_b32 s16, s16, 16
    s_mul_i32 s17, s16, 20
    s_sub_u32 s17, s13, s17
    s_mul_i32 s24, s16, 224
    s_mul_i32 s25, s16, 5120
    s_cmp_ge_u32 s13, 60
    s_cbranch_scc1 .Lmp_donea
    v_and_b32 v8, 7, v0
    v_lshrrev_b32 v9, 3, v0
    v_add_u32 v9, s24, v9
    v_lshlrev_b32 v8, 4, v8
    s_lshl_b32 s15, s17, 7
    v_add_u32 v8, s15, v8
    v_min_u32 v4, 639, v9
    v_lshlrev_b32 v5, 1, v4
    v_mul_u32_u24 v4, 7680, v4
    v_add_u32 v4, v4, v8
    global_load_ushort v140, v5, s[20:21]
    global_load_dwordx4 v[48:51], v4, s[22:23]
    v_cmp_gt_u32 vcc, 640, v9
    v_add_u32 v9, 32, v9
    s_nop 0
    v_cndmask_b32 v180, 0, 1.0, vcc
    v_min_u32 v4, 639, v9
    v_lshlrev_b32 v5, 1, v4
    v_mul_u32_u24 v4, 7680, v4
    v_add_u32 v4, v4, v8
    global_load_ushort v141, v5, s[20:21]
    global_load_dwordx4 v[52:55], v4, s[22:23]
    v_cmp_gt_u32 vcc, 640, v9
    v_add_u32 v9, 32, v9
    s_nop 0
    v_cndmask_b32 v181, 0, 1.0, vcc
    v_min_u32 v4, 639, v9
    v_lshlrev_b32 v5, 1, v4
    v_mul_u32_u24 v4, 7680, v4
    v_add_u32 v4, v4, v8
    global_load_ushort v142, v5, s[20:21]
    global_load_dwordx4 v[56:59], v4, s[22:23]
    v_cmp_gt_u32 vcc, 640, v9
    v_add_u32 v9, 32, v9
    s_nop 0
    v_cndmask_b32 v182, 0, 1.0, vcc
    v_min_u32 v4, 639, v9
    v_lshlrev_b32 v5, 1, v4
    v_mul_u32_u24 v4, 7680, v4
    v_add_u32 v4, v4, v8
    global_load_ushort v143, v5, s[20:21]
    global_load_dwordx4 v[60:63], v4, s[22:23]
    v_cmp_gt_u32 vcc, 640, v9
    v_add_u32 v9, 32, v9
    s_nop 0
    v_cndmask_b32 v183, 0, 1.0, vcc
    v_min_u32 v4, 639, v9
    v_lshlrev_b32 v5, 1, v4
    v_mul_u32_u24 v4, 7680, v4
    v_add_u32 v4, v4, v8
    global_load_ushort v144, v5, s[20:21]
    global_load_dwordx4 v[64:67], v4, s[22:23]
    v_cmp_gt_u32 vcc, 640, v9
    v_add_u32 v9, 32, v9
    s_nop 0
    v_cndmask_b32 v184, 0, 1.0, vcc
    v_min_u32 v4, 639, v9
    v_lshlrev_b32 v5, 1, v4
    v_mul_u32_u24 v4, 7680, v4
    v_add_u32 v4, v4, v8
    global_load_ushort v145, v5, s[20:21]
    global_load_dwordx4 v[68:71], v4, s[22:23]
    v_cmp_gt_u32 vcc, 640, v9
    v_add_u32 v9, 32, v9
    s_nop 0
    v_cndmask_b32 v185, 0, 1.0, vcc
    v_min_u32 v4, 639, v9
    v_lshlrev_b32 v5, 1, v4
    v_mul_u32_u24 v4, 7680, v4
    v_add_u32 v4, v4, v8
    global_load_ushort v146, v5, s[20:21]
    global_load_dwordx4 v[72:75], v4, s[22:23]
    v_cmp_gt_u32 vcc, 640, v9
    v_add_u32 v9, 32, v9
    s_nop 0
    v_cndmask_b32 v186, 0, 1.0, vcc
    v_mov_b32 v32, 0
    v_mov_b32 v33, 0
    v_mov_b32 v34, 0
    v_mov_b32 v35, 0
    v_mov_b32 v36, 0
    v_mov_b32 v37, 0
    v_mov_b32 v38, 0
    v_mov_b32 v39, 0
    s_waitcnt vmcnt(12)
    v_lshlrev_b32 v140, 16, v140
    v_mul_f32 v10, 0xbfb8aa3b, v140
    v_exp_f32 v10, v10
    v_mul_f32 v140, v140, v180
    v_add_f32 v10, 1.0, v10
    v_rcp_f32 v10, v10
    s_nop 0
    v_mul_f32 v10, v10, v140
    v_lshlrev_b32 v6, 16, v48
    v_and_b32 v7, 0xffff0000, v48
    v_fmac_f32 v32, v10, v6
    v_fmac_f32 v33, v10, v7
    v_lshlrev_b32 v6, 16, v49
    v_and_b32 v7, 0xffff0000, v49
    v_fmac_f32 v34, v10, v6
    v_fmac_f32 v35, v10, v7
    v_lshlrev_b32 v6, 16, v50
    v_and_b32 v7, 0xffff0000, v50
    v_fmac_f32 v36, v10, v6
    v_fmac_f32 v37, v10, v7
    v_lshlrev_b32 v6, 16, v51
    v_and_b32 v7, 0xffff0000, v51
    v_fmac_f32 v38, v10, v6
    v_fmac_f32 v39, v10, v7
    s_waitcnt vmcnt(10)
    v_lshlrev_b32 v141, 16, v141
    v_mul_f32 v10, 0xbfb8aa3b, v141
    v_exp_f32 v10, v10
    v_mul_f32 v141, v141, v181
    v_add_f32 v10, 1.0, v10
    v_rcp_f32 v10, v10
    s_nop 0
    v_mul_f32 v10, v10, v141
    v_lshlrev_b32 v6, 16, v52
    v_and_b32 v7, 0xffff0000, v52
    v_fmac_f32 v32, v10, v6
    v_fmac_f32 v33, v10, v7
    v_lshlrev_b32 v6, 16, v53
    v_and_b32 v7, 0xffff0000, v53
    v_fmac_f32 v34, v10, v6
    v_fmac_f32 v35, v10, v7
    v_lshlrev_b32 v6, 16, v54
    v_and_b32 v7, 0xffff0000, v54
    v_fmac_f32 v36, v10, v6
    v_fmac_f32 v37, v10, v7
    v_lshlrev_b32 v6, 16, v55
    v_and_b32 v7, 0xffff0000, v55
    v_fmac_f32 v38, v10, v6
    v_fmac_f32 v39, v10, v7
    s_waitcnt vmcnt(8)
    v_lshlrev_b32 v142, 16, v142
    v_mul_f32 v10, 0xbfb8aa3b, v142
    v_exp_f32 v10, v10
    v_mul_f32 v142, v142, v182
    v_add_f32 v10, 1.0, v10
    v_rcp_f32 v10, v10
    s_nop 0
    v_mul_f32 v10, v10, v142
    v_lshlrev_b32 v6, 16, v56
    v_and_b32 v7, 0xffff0000, v56
    v_fmac_f32 v32, v10, v6
    v_fmac_f32 v33, v10, v7
    v_lshlrev_b32 v6, 16, v57
    v_and_b32 v7, 0xffff0000, v57
    v_fmac_f32 v34, v10, v6
    v_fmac_f32 v35, v10, v7
    v_lshlrev_b32 v6, 16, v58
    v_and_b32 v7, 0xffff0000, v58
    v_fmac_f32 v36, v10, v6
    v_fmac_f32 v37, v10, v7
    v_lshlrev_b32 v6, 16, v59
    v_and_b32 v7, 0xffff0000, v59
    v_fmac_f32 v38, v10, v6
    v_fmac_f32 v39, v10, v7
    s_waitcnt vmcnt(6)
    v_lshlrev_b32 v143, 16, v143
    v_mul_f32 v10, 0xbfb8aa3b, v143
    v_exp_f32 v10, v10
    v_mul_f32 v143, v143, v183
    v_add_f32 v10, 1.0, v10
    v_rcp_f32 v10, v10
    s_nop 0
    v_mul_f32 v10, v10, v143
    v_lshlrev_b32 v6, 16, v60
    v_and_b32 v7, 0xffff0000, v60
    v_fmac_f32 v32, v10, v6
    v_fmac_f32 v33, v10, v7
    v_lshlrev_b32 v6, 16, v61
    v_and_b32 v7, 0xffff0000, v61
    v_fmac_f32 v34, v10, v6
    v_fmac_f32 v35, v10, v7
    v_lshlrev_b32 v6, 16, v62
    v_and_b32 v7, 0xffff0000, v62
    v_fmac_f32 v36, v10, v6
    v_fmac_f32 v37, v10, v7
    v_lshlrev_b32 v6, 16, v63
    v_and_b32 v7, 0xffff0000, v63
    v_fmac_f32 v38, v10, v6
    v_fmac_f32 v39, v10, v7
    s_waitcnt vmcnt(4)
    v_lshlrev_b32 v144, 16, v144
    v_mul_f32 v10, 0xbfb8aa3b, v144
    v_exp_f32 v10, v10
    v_mul_f32 v144, v144, v184
    v_add_f32 v10, 1.0, v10
    v_rcp_f32 v10, v10
    s_nop 0
    v_mul_f32 v10, v10, v144
    v_lshlrev_b32 v6, 16, v64
    v_and_b32 v7, 0xffff0000, v64
    v_fmac_f32 v32, v10, v6
    v_fmac_f32 v33, v10, v7
    v_lshlrev_b32 v6, 16, v65
    v_and_b32 v7, 0xffff0000, v65
    v_fmac_f32 v34, v10, v6
    v_fmac_f32 v35, v10, v7
    v_lshlrev_b32 v6, 16, v66
    v_and_b32 v7, 0xffff0000, v66
    v_fmac_f32 v36, v10, v6
    v_fmac_f32 v37, v10, v7
    v_lshlrev_b32 v6, 16, v67
    v_and_b32 v7, 0xffff0000, v67
    v_fmac_f32 v38, v10, v6
    v_fmac_f32 v39, v10, v7
    s_waitcnt vmcnt(2)
    v_lshlrev_b32 v145, 16, v145
    v_mul_f32 v10, 0xbfb8aa3b, v145
    v_exp_f32 v10, v10
    v_mul_f32 v145, v145, v185
    v_add_f32 v10, 1.0, v10
    v_rcp_f32 v10, v10
    s_nop 0
    v_mul_f32 v10, v10, v145
    v_lshlrev_b32 v6, 16, v68
    v_and_b32 v7, 0xffff0000, v68
    v_fmac_f32 v32, v10, v6
    v_fmac_f32 v33, v10, v7
    v_lshlrev_b32 v6, 16, v69
    v_and_b32 v7, 0xffff0000, v69
    v_fmac_f32 v34, v10, v6
    v_fmac_f32 v35, v10, v7
    v_lshlrev_b32 v6, 16, v70
    v_and_b32 v7, 0xffff0000, v70
    v_fmac_f32 v36, v10, v6
    v_fmac_f32 v37, v10, v7
    v_lshlrev_b32 v6, 16, v71
    v_and_b32 v7, 0xffff0000, v71
    v_fmac_f32 v38, v10, v6
    v_fmac_f32 v39, v10, v7
    s_waitcnt vmcnt(0)
    v_lshlrev_b32 v146, 16, v146
    v_mul_f32 v10, 0xbfb8aa3b, v146
    v_exp_f32 v10, v10
    v_mul_f32 v146, v146, v186
    v_add_f32 v10, 1.0, v10
    v_rcp_f32 v10, v10
    s_nop 0
    v_mul_f32 v10, v10, v146
    v_lshlrev_b32 v6, 16, v72
    v_and_b32 v7, 0xffff0000, v72
    v_fmac_f32 v32, v10, v6
    v_fmac_f32 v33, v10, v7
    v_lshlrev_b32 v6, 16, v73
    v_and_b32 v7, 0xffff0000, v73
    v_fmac_f32 v34, v10, v6
    v_fmac_f32 v35, v10, v7
    v_lshlrev_b32 v6, 16, v74
    v_and_b32 v7, 0xffff0000, v74
    v_fmac_f32 v36, v10, v6
    v_fmac_f32 v37, v10, v7
    v_lshlrev_b32 v6, 16, v75
    v_and_b32 v7, 0xffff0000, v75
    v_fmac_f32 v38, v10, v6
    v_fmac_f32 v39, v10, v7
    v_lshlrev_b32 v9, 5, v0
    ds_write_b128 v9, v[32:35]
    ds_write_b128 v9, v[36:39] offset:16
    s_waitcnt lgkmcnt(0)
    s_barrier
    v_lshlrev_b32 v3, 2, v1
    s_lshl_b32 s15, s12, 11
    v_add_u32 v3, s15, v3
    ds_read_b32 v16, v3 offset:0
    ds_read_b32 v17, v3 offset:256
    ds_read_b32 v18, v3 offset:512
    ds_read_b32 v19, v3 offset:768
    ds_read_b32 v20, v3 offset:1024
    ds_read_b32 v21, v3 offset:1280
    ds_read_b32 v22, v3 offset:1536
    ds_read_b32 v23, v3 offset:1792
    s_waitcnt lgkmcnt(0)
    v_add_f32 v16, v16, v17
    v_add_f32 v16, v16, v18
    v_add_f32 v16, v16, v19
    v_add_f32 v16, v16, v20
    v_add_f32 v16, v16, v21
    v_add_f32 v16, v16, v22
    v_add_f32 v16, v16, v23
    v_lshlrev_b32 v3, 2, v0
    ds_write_b32 v3, v16 offset:8192
    s_waitcnt lgkmcnt(0)
    s_barrier
    s_cmp_lg_u32 s12, 0
    s_cbranch_scc1 .Lmp_donea
    ds_read_b32 v16, v3 offset:8192
    ds_read_b32 v17, v3 offset:8448
    ds_read_b32 v18, v3 offset:8704
    ds_read_b32 v19, v3 offset:8960
    s_waitcnt lgkmcnt(0)
    v_add_f32 v16, v16, v17
    v_add_f32 v18, v18, v19
    v_add_f32 v16, v16, v18
    s_lshl_b32 s15, s17, 8
    s_add_u32 s15, s15, s25
    s_add_u32 s15, s15, 258998272
    v_add_u32 v3, s15, v3
    global_store_dword v3, v16, s[4:5] sc1
.Lmp_donea:
    s_waitcnt vmcnt(0)
    s_barrier
    s_cmp_lg_u32 s12, 0
    s_cbranch_scc1 .Lar_wa
    v_mov_b32 v2, 64
    v_mov_b32 v3, 1
    s_mov_b64 exec, 1
    global_atomic_add v4, v2, v3, s[6:7] sc0 sc1
    s_waitcnt vmcnt(0)
    v_cmp_eq_u32 vcc, 63, v4
    v_mov_b32 v2, 128
    v_mov_b32 v3, 64
    s_and_b64 exec, exec, vcc
    s_cbranch_execz .Lar_xa
    global_store_dword v2, v3, s[6:7] sc0 sc1
.Lar_xa:
    s_mov_b64 exec, -1
.Lar_wa:
    v_mov_b32 v2, 128
.iw_2:
    global_load_dword v3, v2, s[6:7] sc0 sc1
    s_waitcnt vmcnt(0)
    v_readfirstlane_b32 s15, v3
    s_nop 3
    s_cmp_ge_u32 s15, 64
    s_cbranch_scc1 .iwd_3
    s_sleep 4
    s_add_u32 s14, s14, 1
    s_cmp_gt_u32 s14, 400000
    s_cbranch_scc1 .Lend
    s_branch .iw_2
.iwd_3:
    v_lshlrev_b32 v2, 4, v0
    v_add_u32 v3, 258998272, v2
    global_load_dwordx4 v[4:7], v3, s[4:5] sc1
    v_add_u32 v3, 5120, v3
    global_load_dwordx4 v[8:11], v3, s[4:5] sc1
    v_add_u32 v3, 5120, v3
    global_load_dwordx4 v[12:15], v3, s[4:5] sc1
    s_waitcnt vmcnt(0)
    v_add_f32 v4, v4, v8
    v_add_f32 v4, v4, v12
    v_add_f32 v5, v5, v9
    v_add_f32 v5, v5, v13
    v_add_f32 v6, v6, v10
    v_add_f32 v6, v6, v14
    v_add_f32 v7, v7, v11
    v_add_f32 v7, v7, v15
    v_add_u32 v2, 0, v2
    ds_write_b128 v2, v[4:7]
    v_lshlrev_b32 v2, 4, v0
    v_add_u32 v2, 4096, v2
    v_add_u32 v3, 258998272, v2
    v_cmp_gt_u32 vcc, 64, v0
    s_and_saveexec_b64 s[16:17], vcc
    s_cbranch_execz .m2l_4
    global_load_dwordx4 v[4:7], v3, s[4:5] sc1
    v_add_u32 v3, 5120, v3
    global_load_dwordx4 v[8:11], v3, s[4:5] sc1
    v_add_u32 v3, 5120, v3
    global_load_dwordx4 v[12:15], v3, s[4:5] sc1
    s_waitcnt vmcnt(0)
    v_add_f32 v4, v4, v8
    v_add_f32 v4, v4, v12
    v_add_f32 v5, v5, v9
    v_add_f32 v5, v5, v13
    v_add_f32 v6, v6, v10
    v_add_f32 v6, v6, v14
    v_add_f32 v7, v7, v11
    v_add_f32 v7, v7, v15
    v_add_u32 v2, 0, v2
    ds_write_b128 v2, v[4:7]
.m2l_4:
    s_mov_b64 exec, -1
    s_waitcnt lgkmcnt(0)
    s_barrier
    v_and_b32 v2, 15, v1
    v_lshlrev_b32 v3, 5, v2
    ds_read_b128 v[64:67], v3 offset:0
    ds_read_b128 v[68:71], v3 offset:16
    ds_read_b128 v[104:107], v3 offset:2560
    ds_read_b128 v[108:111], v3 offset:2576
    ds_read_b128 v[72:75], v3 offset:512
    ds_read_b128 v[76:79], v3 offset:528
    ds_read_b128 v[112:115], v3 offset:3072
    ds_read_b128 v[116:119], v3 offset:3088
    ds_read_b128 v[80:83], v3 offset:1024
    ds_read_b128 v[84:87], v3 offset:1040
    ds_read_b128 v[120:123], v3 offset:3584
    ds_read_b128 v[124:127], v3 offset:3600
    ds_read_b128 v[88:91], v3 offset:1536
    ds_read_b128 v[92:95], v3 offset:1552
    ds_read_b128 v[128:131], v3 offset:4096
    ds_read_b128 v[132:135], v3 offset:4112
    ds_read_b128 v[96:99], v3 offset:2048
    ds_read_b128 v[100:103], v3 offset:2064
    ds_read_b128 v[136:139], v3 offset:4608
    ds_read_b128 v[140:143], v3 offset:4624
    v_lshrrev_b32 v4, 4, v1
    s_lshl_b32 s15, s12, 2
    v_add_u32 v4, s15, v4
    s_lshl_b32 s15, s13, 5
    v_add_u32 v5, s15, v4
    v_mul_u32_u24 v5, 1280, v5
    v_lshlrev_b32 v6, 4, v2
    v_add_u32 v5, v5, v6
    v_lshrrev_b32 v6, 2, v2
    v_lshlrev_b32 v6, 10, v6
    v_and_b32 v7, 3, v2
    v_lshlrev_b32 v7, 8, v7
    v_add_u32 v6, v6, v7
    v_lshlrev_b32 v7, 4, v4
    v_add_u32 v6, v6, v7
    s_mul_i32 s15, s13, 40960
    s_add_u32 s15, s15, 239075328
    v_add_u32 v6, s15, v6
    s_waitcnt lgkmcnt(0)
    v_add_f32 v104, 1.0, v104
    v_add_f32 v105, 1.0, v105
    v_add_f32 v106, 1.0, v106
    v_add_f32 v107, 1.0, v107
    v_add_f32 v108, 1.0, v108
    v_add_f32 v109, 1.0, v109
    v_add_f32 v110, 1.0, v110
    v_add_f32 v111, 1.0, v111
    v_add_f32 v112, 1.0, v112
    v_add_f32 v113, 1.0, v113
    v_add_f32 v114, 1.0, v114
    v_add_f32 v115, 1.0, v115
    v_add_f32 v116, 1.0, v116
    v_add_f32 v117, 1.0, v117
    v_add_f32 v118, 1.0, v118
    v_add_f32 v119, 1.0, v119
    v_add_f32 v120, 1.0, v120
    v_add_f32 v121, 1.0, v121
    v_add_f32 v122, 1.0, v122
    v_add_f32 v123, 1.0, v123
    v_add_f32 v124, 1.0, v124
    v_add_f32 v125, 1.0, v125
    v_add_f32 v126, 1.0, v126
    v_add_f32 v127, 1.0, v127
    v_add_f32 v128, 1.0, v128
    v_add_f32 v129, 1.0, v129
    v_add_f32 v130, 1.0, v130
    v_add_f32 v131, 1.0, v131
    v_add_f32 v132, 1.0, v132
    v_add_f32 v133, 1.0, v133
    v_add_f32 v134, 1.0, v134
    v_add_f32 v135, 1.0, v135
    v_add_f32 v136, 1.0, v136
    v_add_f32 v137, 1.0, v137
    v_add_f32 v138, 1.0, v138
    v_add_f32 v139, 1.0, v139
    v_add_f32 v140, 1.0, v140
    v_add_f32 v141, 1.0, v141
    v_add_f32 v142, 1.0, v142
    v_add_f32 v143, 1.0, v143
    v_lshlrev_b32 v16, 16, v200
    v_and_b32 v17, 0xffff0000, v200
    v_lshlrev_b32 v18, 16, v201
    v_and_b32 v19, 0xffff0000, v201
    v_lshlrev_b32 v20, 16, v202
    v_and_b32 v21, 0xffff0000, v202
    v_lshlrev_b32 v22, 16, v203
    v_and_b32 v23, 0xffff0000, v203
    v_lshlrev_b32 v24, 16, v204
    v_and_b32 v25, 0xffff0000, v204
    v_lshlrev_b32 v26, 16, v205
    v_and_b32 v27, 0xffff0000, v205
    v_lshlrev_b32 v28, 16, v206
    v_and_b32 v29, 0xffff0000, v206
    v_lshlrev_b32 v30, 16, v207
    v_and_b32 v31, 0xffff0000, v207
    v_lshlrev_b32 v32, 16, v208
    v_and_b32 v33, 0xffff0000, v208
    v_lshlrev_b32 v34, 16, v209
    v_and_b32 v35, 0xffff0000, v209
    v_lshlrev_b32 v36, 16, v210
    v_and_b32 v37, 0xffff0000, v210
    v_lshlrev_b32 v38, 16, v211
    v_and_b32 v39, 0xffff0000, v211
    v_lshlrev_b32 v40, 16, v212
    v_and_b32 v41, 0xffff0000, v212
    v_lshlrev_b32 v42, 16, v213
    v_and_b32 v43, 0xffff0000, v213
    v_lshlrev_b32 v44, 16, v214
    v_and_b32 v45, 0xffff0000, v214
    v_lshlrev_b32 v46, 16, v215
    v_and_b32 v47, 0xffff0000, v215
    v_lshlrev_b32 v48, 16, v216
    v_and_b32 v49, 0xffff0000, v216
    v_lshlrev_b32 v50, 16, v217
    v_and_b32 v51, 0xffff0000, v217
    v_lshlrev_b32 v52, 16, v218
    v_and_b32 v53, 0xffff0000, v218
    v_lshlrev_b32 v54, 16, v219
    v_and_b32 v55, 0xffff0000, v219
    v_pk_add_f32 v[8:9], v[16:17], v[18:19]
    v_pk_add_f32 v[8:9], v[8:9], v[20:21]
    v_pk_add_f32 v[8:9], v[8:9], v[22:23]
    v_pk_add_f32 v[8:9], v[8:9], v[24:25]
    v_pk_add_f32 v[8:9], v[8:9], v[26:27]
    v_pk_add_f32 v[8:9], v[8:9], v[28:29]
    v_pk_add_f32 v[8:9], v[8:9], v[30:31]
    v_pk_add_f32 v[8:9], v[8:9], v[32:33]
    v_pk_add_f32 v[8:9], v[8:9], v[34:35]
    v_pk_add_f32 v[8:9], v[8:9], v[36:37]
    v_pk_add_f32 v[8:9], v[8:9], v[38:39]
    v_pk_add_f32 v[8:9], v[8:9], v[40:41]
    v_pk_add_f32 v[8:9], v[8:9], v[42:43]
    v_pk_add_f32 v[8:9], v[8:9], v[44:45]
    v_pk_add_f32 v[8:9], v[8:9], v[46:47]
    v_pk_add_f32 v[8:9], v[8:9], v[48:49]
    v_pk_add_f32 v[8:9], v[8:9], v[50:51]
    v_pk_add_f32 v[8:9], v[8:9], v[52:53]
    v_pk_add_f32 v[8:9], v[8:9], v[54:55]
    v_add_f32 v8, v8, v9
    s_nop 1
    v_add_f32_dpp v8, v8, v8 row_ror:8 row_mask:0xf bank_mask:0xf
    s_nop 1
    v_add_f32_dpp v8, v8, v8 row_ror:4 row_mask:0xf bank_mask:0xf
    s_nop 1
    v_add_f32_dpp v8, v8, v8 row_ror:2 row_mask:0xf bank_mask:0xf
    s_nop 1
    v_add_f32_dpp v8, v8, v8 row_ror:1 row_mask:0xf bank_mask:0xf
    v_mul_f32 v8, 0xbacccccd, v8
    v_mov_b32 v9, v8
    v_pk_add_f32 v[16:17], v[16:17], v[8:9]
    v_pk_add_f32 v[18:19], v[18:19], v[8:9]
    v_pk_add_f32 v[20:21], v[20:21], v[8:9]
    v_pk_add_f32 v[22:23], v[22:23], v[8:9]
    v_pk_add_f32 v[24:25], v[24:25], v[8:9]
    v_pk_add_f32 v[26:27], v[26:27], v[8:9]
    v_pk_add_f32 v[28:29], v[28:29], v[8:9]
    v_pk_add_f32 v[30:31], v[30:31], v[8:9]
    v_pk_add_f32 v[32:33], v[32:33], v[8:9]
    v_pk_add_f32 v[34:35], v[34:35], v[8:9]
    v_pk_add_f32 v[36:37], v[36:37], v[8:9]
    v_pk_add_f32 v[38:39], v[38:39], v[8:9]
    v_pk_add_f32 v[40:41], v[40:41], v[8:9]
    v_pk_add_f32 v[42:43], v[42:43], v[8:9]
    v_pk_add_f32 v[44:45], v[44:45], v[8:9]
    v_pk_add_f32 v[46:47], v[46:47], v[8:9]
    v_pk_add_f32 v[48:49], v[48:49], v[8:9]
    v_pk_add_f32 v[50:51], v[50:51], v[8:9]
    v_pk_add_f32 v[52:53], v[52:53], v[8:9]
    v_pk_add_f32 v[54:55], v[54:55], v[8:9]
    v_pk_mul_f32 v[10:11], v[16:17], v[16:17]
    v_pk_fma_f32 v[10:11], v[18:19], v[18:19], v[10:11]
    v_pk_fma_f32 v[10:11], v[20:21], v[20:21], v[10:11]
    v_pk_fma_f32 v[10:11], v[22:23], v[22:23], v[10:11]
    v_pk_fma_f32 v[10:11], v[24:25], v[24:25], v[10:11]
    v_pk_fma_f32 v[10:11], v[26:27], v[26:27], v[10:11]
    v_pk_fma_f32 v[10:11], v[28:29], v[28:29], v[10:11]
    v_pk_fma_f32 v[10:11], v[30:31], v[30:31], v[10:11]
    v_pk_fma_f32 v[10:11], v[32:33], v[32:33], v[10:11]
    v_pk_fma_f32 v[10:11], v[34:35], v[34:35], v[10:11]
    v_pk_fma_f32 v[10:11], v[36:37], v[36:37], v[10:11]
    v_pk_fma_f32 v[10:11], v[38:39], v[38:39], v[10:11]
    v_pk_fma_f32 v[10:11], v[40:41], v[40:41], v[10:11]
    v_pk_fma_f32 v[10:11], v[42:43], v[42:43], v[10:11]
    v_pk_fma_f32 v[10:11], v[44:45], v[44:45], v[10:11]
    v_pk_fma_f32 v[10:11], v[46:47], v[46:47], v[10:11]
    v_pk_fma_f32 v[10:11], v[48:49], v[48:49], v[10:11]
    v_pk_fma_f32 v[10:11], v[50:51], v[50:51], v[10:11]
    v_pk_fma_f32 v[10:11], v[52:53], v[52:53], v[10:11]
    v_pk_fma_f32 v[10:11], v[54:55], v[54:55], v[10:11]
    v_add_f32 v9, v10, v11
    s_nop 1
    v_add_f32_dpp v9, v9, v9 row_ror:8 row_mask:0xf bank_mask:0xf
    s_nop 1
    v_add_f32_dpp v9, v9, v9 row_ror:4 row_mask:0xf bank_mask:0xf
    s_nop 1
    v_add_f32_dpp v9, v9, v9 row_ror:2 row_mask:0xf bank_mask:0xf
    s_nop 1
    v_add_f32_dpp v9, v9, v9 row_ror:1 row_mask:0xf bank_mask:0xf
    v_mov_b32 v10, 0x3727c5ac
    v_fmac_f32 v10, 0x3acccccd, v9
    v_rsq_f32 v10, v10
    s_nop 0
    v_mov_b32 v11, v10
    v_pk_mul_f32 v[16:17], v[16:17], v[10:11]
    v_pk_mul_f32 v[18:19], v[18:19], v[10:11]
    v_pk_mul_f32 v[20:21], v[20:21], v[10:11]
    v_pk_mul_f32 v[22:23], v[22:23], v[10:11]
    v_pk_mul_f32 v[24:25], v[24:25], v[10:11]
    v_pk_mul_f32 v[26:27], v[26:27], v[10:11]
    v_pk_mul_f32 v[28:29], v[28:29], v[10:11]
    v_pk_mul_f32 v[30:31], v[30:31], v[10:11]
    v_pk_mul_f32 v[32:33], v[32:33], v[10:11]
    v_pk_mul_f32 v[34:35], v[34:35], v[10:11]
    v_pk_mul_f32 v[36:37], v[36:37], v[10:11]
    v_pk_mul_f32 v[38:39], v[38:39], v[10:11]
    v_pk_mul_f32 v[40:41], v[40:41], v[10:11]
    v_pk_mul_f32 v[42:43], v[42:43], v[10:11]
    v_pk_mul_f32 v[44:45], v[44:45], v[10:11]
    v_pk_mul_f32 v[46:47], v[46:47], v[10:11]
    v_pk_mul_f32 v[48:49], v[48:49], v[10:11]
    v_pk_mul_f32 v[50:51], v[50:51], v[10:11]
    v_pk_mul_f32 v[52:53], v[52:53], v[10:11]
    v_pk_mul_f32 v[54:55], v[54:55], v[10:11]
    v_pk_fma_f32 v[16:17], v[16:17], v[104:105], v[64:65]
    v_pk_fma_f32 v[18:19], v[18:19], v[106:107], v[66:67]
    v_pk_fma_f32 v[20:21], v[20:21], v[108:109], v[68:69]
    v_pk_fma_f32 v[22:23], v[22:23], v[110:111], v[70:71]
    v_pk_fma_f32 v[24:25], v[24:25], v[112:113], v[72:73]
    v_pk_fma_f32 v[26:27], v[26:27], v[114:115], v[74:75]
    v_pk_fma_f32 v[28:29], v[28:29], v[116:117], v[76:77]
    v_pk_fma_f32 v[30:31], v[30:31], v[118:119], v[78:79]
    v_pk_fma_f32 v[32:33], v[32:33], v[120:121], v[80:81]
    v_pk_fma_f32 v[34:35], v[34:35], v[122:123], v[82:83]
    v_pk_fma_f32 v[36:37], v[36:37], v[124:125], v[84:85]
    v_pk_fma_f32 v[38:39], v[38:39], v[126:127], v[86:87]
    v_pk_fma_f32 v[40:41], v[40:41], v[128:129], v[88:89]
    v_pk_fma_f32 v[42:43], v[42:43], v[130:131], v[90:91]
    v_pk_fma_f32 v[44:45], v[44:45], v[132:133], v[92:93]
    v_pk_fma_f32 v[46:47], v[46:47], v[134:135], v[94:95]
    v_pk_fma_f32 v[48:49], v[48:49], v[136:137], v[96:97]
    v_pk_fma_f32 v[50:51], v[50:51], v[138:139], v[98:99]
    v_pk_fma_f32 v[52:53], v[52:53], v[140:141], v[100:101]
    v_pk_fma_f32 v[54:55], v[54:55], v[142:143], v[102:103]
    v_cvt_pk_bf16_f32 v144, v16, v17
    v_cvt_pk_bf16_f32 v145, v18, v19
    v_cvt_pk_bf16_f32 v146, v20, v21
    v_cvt_pk_bf16_f32 v147, v22, v23
    v_cvt_pk_bf16_f32 v148, v24, v25
    v_cvt_pk_bf16_f32 v149, v26, v27
    v_cvt_pk_bf16_f32 v150, v28, v29
    v_cvt_pk_bf16_f32 v151, v30, v31
    v_cvt_pk_bf16_f32 v152, v32, v33
    v_cvt_pk_bf16_f32 v153, v34, v35
    v_cvt_pk_bf16_f32 v154, v36, v37
    v_cvt_pk_bf16_f32 v155, v38, v39
    v_cvt_pk_bf16_f32 v156, v40, v41
    v_cvt_pk_bf16_f32 v157, v42, v43
    v_cvt_pk_bf16_f32 v158, v44, v45
    v_cvt_pk_bf16_f32 v159, v46, v47
    v_cvt_pk_bf16_f32 v160, v48, v49
    v_cvt_pk_bf16_f32 v161, v50, v51
    v_cvt_pk_bf16_f32 v162, v52, v53
    v_cvt_pk_bf16_f32 v163, v54, v55
    global_store_dwordx4 v6, v[144:147], s[4:5] sc1
    v_add_u32 v6, 4096, v6
    global_store_dwordx4 v6, v[148:151], s[4:5] sc1
    v_add_u32 v6, 4096, v6
    global_store_dwordx4 v6, v[152:155], s[4:5] sc1
    v_add_u32 v6, 4096, v6
    global_store_dwordx4 v6, v[156:159], s[4:5] sc1
    v_add_u32 v6, 4096, v6
    global_store_dwordx4 v6, v[160:163], s[4:5] sc1
    v_add_u32 v6, 4096, v6
    v_lshlrev_b32 v16, 16, v220
    v_and_b32 v17, 0xffff0000, v220
    v_lshlrev_b32 v18, 16, v221
    v_and_b32 v19, 0xffff0000, v221
    v_lshlrev_b32 v20, 16, v222
    v_and_b32 v21, 0xffff0000, v222
    v_lshlrev_b32 v22, 16, v223
    v_and_b32 v23, 0xffff0000, v223
    v_lshlrev_b32 v24, 16, v224
    v_and_b32 v25, 0xffff0000, v224
    v_lshlrev_b32 v26, 16, v225
    v_and_b32 v27, 0xffff0000, v225
    v_lshlrev_b32 v28, 16, v226
    v_and_b32 v29, 0xffff0000, v226
    v_lshlrev_b32 v30, 16, v227
    v_and_b32 v31, 0xffff0000, v227
    v_lshlrev_b32 v32, 16, v228
    v_and_b32 v33, 0xffff0000, v228
    v_lshlrev_b32 v34, 16, v229
    v_and_b32 v35, 0xffff0000, v229
    v_lshlrev_b32 v36, 16, v230
    v_and_b32 v37, 0xffff0000, v230
    v_lshlrev_b32 v38, 16, v231
    v_and_b32 v39, 0xffff0000, v231
    v_lshlrev_b32 v40, 16, v232
    v_and_b32 v41, 0xffff0000, v232
    v_lshlrev_b32 v42, 16, v233
    v_and_b32 v43, 0xffff0000, v233
    v_lshlrev_b32 v44, 16, v234
    v_and_b32 v45, 0xffff0000, v234
    v_lshlrev_b32 v46, 16, v235
    v_and_b32 v47, 0xffff0000, v235
    v_lshlrev_b32 v48, 16, v236
    v_and_b32 v49, 0xffff0000, v236
    v_lshlrev_b32 v50, 16, v237
    v_and_b32 v51, 0xffff0000, v237
    v_lshlrev_b32 v52, 16, v238
    v_and_b32 v53, 0xffff0000, v238
    v_lshlrev_b32 v54, 16, v239
    v_and_b32 v55, 0xffff0000, v239
    v_pk_add_f32 v[8:9], v[16:17], v[18:19]
    v_pk_add_f32 v[8:9], v[8:9], v[20:21]
    v_pk_add_f32 v[8:9], v[8:9], v[22:23]
    v_pk_add_f32 v[8:9], v[8:9], v[24:25]
    v_pk_add_f32 v[8:9], v[8:9], v[26:27]
    v_pk_add_f32 v[8:9], v[8:9], v[28:29]
    v_pk_add_f32 v[8:9], v[8:9], v[30:31]
    v_pk_add_f32 v[8:9], v[8:9], v[32:33]
    v_pk_add_f32 v[8:9], v[8:9], v[34:35]
    v_pk_add_f32 v[8:9], v[8:9], v[36:37]
    v_pk_add_f32 v[8:9], v[8:9], v[38:39]
    v_pk_add_f32 v[8:9], v[8:9], v[40:41]
    v_pk_add_f32 v[8:9], v[8:9], v[42:43]
    v_pk_add_f32 v[8:9], v[8:9], v[44:45]
    v_pk_add_f32 v[8:9], v[8:9], v[46:47]
    v_pk_add_f32 v[8:9], v[8:9], v[48:49]
    v_pk_add_f32 v[8:9], v[8:9], v[50:51]
    v_pk_add_f32 v[8:9], v[8:9], v[52:53]
    v_pk_add_f32 v[8:9], v[8:9], v[54:55]
    v_add_f32 v8, v8, v9
    s_nop 1
    v_add_f32_dpp v8, v8, v8 row_ror:8 row_mask:0xf bank_mask:0xf
    s_nop 1
    v_add_f32_dpp v8, v8, v8 row_ror:4 row_mask:0xf bank_mask:0xf
    s_nop 1
    v_add_f32_dpp v8, v8, v8 row_ror:2 row_mask:0xf bank_mask:0xf
    s_nop 1
    v_add_f32_dpp v8, v8, v8 row_ror:1 row_mask:0xf bank_mask:0xf
    v_mul_f32 v8, 0xbacccccd, v8
    v_mov_b32 v9, v8
    v_pk_add_f32 v[16:17], v[16:17], v[8:9]
    v_pk_add_f32 v[18:19], v[18:19], v[8:9]
    v_pk_add_f32 v[20:21], v[20:21], v[8:9]
    v_pk_add_f32 v[22:23], v[22:23], v[8:9]
    v_pk_add_f32 v[24:25], v[24:25], v[8:9]
    v_pk_add_f32 v[26:27], v[26:27], v[8:9]
    v_pk_add_f32 v[28:29], v[28:29], v[8:9]
    v_pk_add_f32 v[30:31], v[30:31], v[8:9]
    v_pk_add_f32 v[32:33], v[32:33], v[8:9]
    v_pk_add_f32 v[34:35], v[34:35], v[8:9]
    v_pk_add_f32 v[36:37], v[36:37], v[8:9]
    v_pk_add_f32 v[38:39], v[38:39], v[8:9]
    v_pk_add_f32 v[40:41], v[40:41], v[8:9]
    v_pk_add_f32 v[42:43], v[42:43], v[8:9]
    v_pk_add_f32 v[44:45], v[44:45], v[8:9]
    v_pk_add_f32 v[46:47], v[46:47], v[8:9]
    v_pk_add_f32 v[48:49], v[48:49], v[8:9]
    v_pk_add_f32 v[50:51], v[50:51], v[8:9]
    v_pk_add_f32 v[52:53], v[52:53], v[8:9]
    v_pk_add_f32 v[54:55], v[54:55], v[8:9]
    v_pk_mul_f32 v[10:11], v[16:17], v[16:17]
    v_pk_fma_f32 v[10:11], v[18:19], v[18:19], v[10:11]
    v_pk_fma_f32 v[10:11], v[20:21], v[20:21], v[10:11]
    v_pk_fma_f32 v[10:11], v[22:23], v[22:23], v[10:11]
    v_pk_fma_f32 v[10:11], v[24:25], v[24:25], v[10:11]
    v_pk_fma_f32 v[10:11], v[26:27], v[26:27], v[10:11]
    v_pk_fma_f32 v[10:11], v[28:29], v[28:29], v[10:11]
    v_pk_fma_f32 v[10:11], v[30:31], v[30:31], v[10:11]
    v_pk_fma_f32 v[10:11], v[32:33], v[32:33], v[10:11]
    v_pk_fma_f32 v[10:11], v[34:35], v[34:35], v[10:11]
    v_pk_fma_f32 v[10:11], v[36:37], v[36:37], v[10:11]
    v_pk_fma_f32 v[10:11], v[38:39], v[38:39], v[10:11]
    v_pk_fma_f32 v[10:11], v[40:41], v[40:41], v[10:11]
    v_pk_fma_f32 v[10:11], v[42:43], v[42:43], v[10:11]
    v_pk_fma_f32 v[10:11], v[44:45], v[44:45], v[10:11]
    v_pk_fma_f32 v[10:11], v[46:47], v[46:47], v[10:11]
    v_pk_fma_f32 v[10:11], v[48:49], v[48:49], v[10:11]
    v_pk_fma_f32 v[10:11], v[50:51], v[50:51], v[10:11]
    v_pk_fma_f32 v[10:11], v[52:53], v[52:53], v[10:11]
    v_pk_fma_f32 v[10:11], v[54:55], v[54:55], v[10:11]
    v_add_f32 v9, v10, v11
    s_nop 1
    v_add_f32_dpp v9, v9, v9 row_ror:8 row_mask:0xf bank_mask:0xf
    s_nop 1
    v_add_f32_dpp v9, v9, v9 row_ror:4 row_mask:0xf bank_mask:0xf
    s_nop 1
    v_add_f32_dpp v9, v9, v9 row_ror:2 row_mask:0xf bank_mask:0xf
    s_nop 1
    v_add_f32_dpp v9, v9, v9 row_ror:1 row_mask:0xf bank_mask:0xf
    v_mov_b32 v10, 0x3727c5ac
    v_fmac_f32 v10, 0x3acccccd, v9
    v_rsq_f32 v10, v10
    s_nop 0
    v_mov_b32 v11, v10
    v_pk_mul_f32 v[16:17], v[16:17], v[10:11]
    v_pk_mul_f32 v[18:19], v[18:19], v[10:11]
    v_pk_mul_f32 v[20:21], v[20:21], v[10:11]
    v_pk_mul_f32 v[22:23], v[22:23], v[10:11]
    v_pk_mul_f32 v[24:25], v[24:25], v[10:11]
    v_pk_mul_f32 v[26:27], v[26:27], v[10:11]
    v_pk_mul_f32 v[28:29], v[28:29], v[10:11]
    v_pk_mul_f32 v[30:31], v[30:31], v[10:11]
    v_pk_mul_f32 v[32:33], v[32:33], v[10:11]
    v_pk_mul_f32 v[34:35], v[34:35], v[10:11]
    v_pk_mul_f32 v[36:37], v[36:37], v[10:11]
    v_pk_mul_f32 v[38:39], v[38:39], v[10:11]
    v_pk_mul_f32 v[40:41], v[40:41], v[10:11]
    v_pk_mul_f32 v[42:43], v[42:43], v[10:11]
    v_pk_mul_f32 v[44:45], v[44:45], v[10:11]
    v_pk_mul_f32 v[46:47], v[46:47], v[10:11]
    v_pk_mul_f32 v[48:49], v[48:49], v[10:11]
    v_pk_mul_f32 v[50:51], v[50:51], v[10:11]
    v_pk_mul_f32 v[52:53], v[52:53], v[10:11]
    v_pk_mul_f32 v[54:55], v[54:55], v[10:11]
    v_pk_fma_f32 v[16:17], v[16:17], v[104:105], v[64:65]
    v_pk_fma_f32 v[18:19], v[18:19], v[106:107], v[66:67]
    v_pk_fma_f32 v[20:21], v[20:21], v[108:109], v[68:69]
    v_pk_fma_f32 v[22:23], v[22:23], v[110:111], v[70:71]
    v_pk_fma_f32 v[24:25], v[24:25], v[112:113], v[72:73]
    v_pk_fma_f32 v[26:27], v[26:27], v[114:115], v[74:75]
    v_pk_fma_f32 v[28:29], v[28:29], v[116:117], v[76:77]
    v_pk_fma_f32 v[30:31], v[30:31], v[118:119], v[78:79]
    v_pk_fma_f32 v[32:33], v[32:33], v[120:121], v[80:81]
    v_pk_fma_f32 v[34:35], v[34:35], v[122:123], v[82:83]
    v_pk_fma_f32 v[36:37], v[36:37], v[124:125], v[84:85]
    v_pk_fma_f32 v[38:39], v[38:39], v[126:127], v[86:87]
    v_pk_fma_f32 v[40:41], v[40:41], v[128:129], v[88:89]
    v_pk_fma_f32 v[42:43], v[42:43], v[130:131], v[90:91]
    v_pk_fma_f32 v[44:45], v[44:45], v[132:133], v[92:93]
    v_pk_fma_f32 v[46:47], v[46:47], v[134:135], v[94:95]
    v_pk_fma_f32 v[48:49], v[48:49], v[136:137], v[96:97]
    v_pk_fma_f32 v[50:51], v[50:51], v[138:139], v[98:99]
    v_pk_fma_f32 v[52:53], v[52:53], v[140:141], v[100:101]
    v_pk_fma_f32 v[54:55], v[54:55], v[142:143], v[102:103]
    v_cvt_pk_bf16_f32 v164, v16, v17
    v_cvt_pk_bf16_f32 v165, v18, v19
    v_cvt_pk_bf16_f32 v166, v20, v21
    v_cvt_pk_bf16_f32 v167, v22, v23
    v_cvt_pk_bf16_f32 v168, v24, v25
    v_cvt_pk_bf16_f32 v169, v26, v27
    v_cvt_pk_bf16_f32 v170, v28, v29
    v_cvt_pk_bf16_f32 v171, v30, v31
    v_cvt_pk_bf16_f32 v172, v32, v33
    v_cvt_pk_bf16_f32 v173, v34, v35
    v_cvt_pk_bf16_f32 v174, v36, v37
    v_cvt_pk_bf16_f32 v175, v38, v39
    v_cvt_pk_bf16_f32 v176, v40, v41
    v_cvt_pk_bf16_f32 v177, v42, v43
    v_cvt_pk_bf16_f32 v178, v44, v45
    v_cvt_pk_bf16_f32 v179, v46, v47
    v_cvt_pk_bf16_f32 v180, v48, v49
    v_cvt_pk_bf16_f32 v181, v50, v51
    v_cvt_pk_bf16_f32 v182, v52, v53
    v_cvt_pk_bf16_f32 v183, v54, v55
    global_store_dwordx4 v6, v[164:167], s[4:5] sc1
    v_add_u32 v6, 4096, v6
    global_store_dwordx4 v6, v[168:171], s[4:5] sc1
    v_add_u32 v6, 4096, v6
    global_store_dwordx4 v6, v[172:175], s[4:5] sc1
    v_add_u32 v6, 4096, v6
    global_store_dwordx4 v6, v[176:179], s[4:5] sc1
    v_add_u32 v6, 4096, v6
    global_store_dwordx4 v6, v[180:183], s[4:5] sc1
    v_add_u32 v6, 4096, v6
    s_waitcnt vmcnt(0)
    s_barrier
    s_lshl_b32 s15, s13, 7
    s_add_u32 s15, s15, 0
    s_mov_b32 s16, 1
    s_cmp_lg_u32 s12, 0
    s_cbranch_scc1 .pub_5
    v_mov_b32 v2, s15
    v_mov_b32 v3, s16
    s_mov_b64 exec, 1
    global_store_dword v2, v3, s[10:11] sc1
    s_mov_b64 exec, -1
.pub_5:
    s_barrier
    s_mov_b32 s26, s13
    s_sub_u32 s13, s13, 8
    s_add_u32 s17, s13, 20
    s_mov_b32 s24, 0
    s_mov_b32 s25, 10240
    s_cmp_ge_u32 s13, 40
    s_cbranch_scc1 .Lmp_doneb
    v_and_b32 v8, 7, v0
    v_lshrrev_b32 v9, 3, v0
    v_add_u32 v9, s24, v9
    v_lshlrev_b32 v8, 4, v8
    s_lshl_b32 s15, s17, 7
    v_add_u32 v8, s15, v8
    v_min_u32 v4, 639, v9
    v_lshlrev_b32 v5, 1, v4
    v_mul_u32_u24 v4, 7680, v4
    v_add_u32 v4, v4, v8
    global_load_ushort v140, v5, s[20:21]
    global_load_dwordx4 v[48:51], v4, s[22:23]
    v_cmp_gt_u32 vcc, 640, v9
    v_add_u32 v9, 32, v9
    s_nop 0
    v_cndmask_b32 v180, 0, 1.0, vcc
    v_min_u32 v4, 639, v9
    v_lshlrev_b32 v5, 1, v4
    v_mul_u32_u24 v4, 7680, v4
    v_add_u32 v4, v4, v8
    global_load_ushort v141, v5, s[20:21]
    global_load_dwordx4 v[52:55], v4, s[22:23]
    v_cmp_gt_u32 vcc, 640, v9
    v_add_u32 v9, 32, v9
    s_nop 0
    v_cndmask_b32 v181, 0, 1.0, vcc
    v_min_u32 v4, 639, v9
    v_lshlrev_b32 v5, 1, v4
    v_mul_u32_u24 v4, 7680, v4
    v_add_u32 v4, v4, v8
    global_load_ushort v142, v5, s[20:21]
    global_load_dwordx4 v[56:59], v4, s[22:23]
    v_cmp_gt_u32 vcc, 640, v9
    v_add_u32 v9, 32, v9
    s_nop 0
    v_cndmask_b32 v182, 0, 1.0, vcc
    v_min_u32 v4, 639, v9
    v_lshlrev_b32 v5, 1, v4
    v_mul_u32_u24 v4, 7680, v4
    v_add_u32 v4, v4, v8
    global_load_ushort v143, v5, s[20:21]
    global_load_dwordx4 v[60:63], v4, s[22:23]
    v_cmp_gt_u32 vcc, 640, v9
    v_add_u32 v9, 32, v9
    s_nop 0
    v_cndmask_b32 v183, 0, 1.0, vcc
    v_min_u32 v4, 639, v9
    v_lshlrev_b32 v5, 1, v4
    v_mul_u32_u24 v4, 7680, v4
    v_add_u32 v4, v4, v8
    global_load_ushort v144, v5, s[20:21]
    global_load_dwordx4 v[64:67], v4, s[22:23]
    v_cmp_gt_u32 vcc, 640, v9
    v_add_u32 v9, 32, v9
    s_nop 0
    v_cndmask_b32 v184, 0, 1.0, vcc
    v_min_u32 v4, 639, v9
    v_lshlrev_b32 v5, 1, v4
    v_mul_u32_u24 v4, 7680, v4
    v_add_u32 v4, v4, v8
    global_load_ushort v145, v5, s[20:21]
    global_load_dwordx4 v[68:71], v4, s[22:23]
    v_cmp_gt_u32 vcc, 640, v9
    v_add_u32 v9, 32, v9
    s_nop 0
    v_cndmask_b32 v185, 0, 1.0, vcc
    v_min_u32 v4, 639, v9
    v_lshlrev_b32 v5, 1, v4
    v_mul_u32_u24 v4, 7680, v4
    v_add_u32 v4, v4, v8
    global_load_ushort v146, v5, s[20:21]
    global_load_dwordx4 v[72:75], v4, s[22:23]
    v_cmp_gt_u32 vcc, 640, v9
    v_add_u32 v9, 32, v9
    s_nop 0
    v_cndmask_b32 v186, 0, 1.0, vcc
    v_min_u32 v4, 639, v9
    v_lshlrev_b32 v5, 1, v4
    v_mul_u32_u24 v4, 7680, v4
    v_add_u32 v4, v4, v8
    global_load_ushort v147, v5, s[20:21]
    global_load_dwordx4 v[76:79], v4, s[22:23]
    v_cmp_gt_u32 vcc, 640, v9
    v_add_u32 v9, 32, v9
    s_nop 0
    v_cndmask_b32 v187, 0, 1.0, vcc
    v_min_u32 v4, 639, v9
    v_lshlrev_b32 v5, 1, v4
    v_mul_u32_u24 v4, 7680, v4
    v_add_u32 v4, v4, v8
    global_load_ushort v148, v5, s[20:21]
    global_load_dwordx4 v[80:83], v4, s[22:23]
    v_cmp_gt_u32 vcc, 640, v9
    v_add_u32 v9, 32, v9
    s_nop 0
    v_cndmask_b32 v188, 0, 1.0, vcc
    v_min_u32 v4, 639, v9
    v_lshlrev_b32 v5, 1, v4
    v_mul_u32_u24 v4, 7680, v4
    v_add_u32 v4, v4, v8
    global_load_ushort v149, v5, s[20:21]
    global_load_dwordx4 v[84:87], v4, s[22:23]
    v_cmp_gt_u32 vcc, 640, v9
    v_add_u32 v9, 32, v9
    s_nop 0
    v_cndmask_b32 v189, 0, 1.0, vcc
    v_min_u32 v4, 639, v9
    v_lshlrev_b32 v5, 1, v4
    v_mul_u32_u24 v4, 7680, v4
    v_add_u32 v4, v4, v8
    global_load_ushort v150, v5, s[20:21]
    global_load_dwordx4 v[88:91], v4, s[22:23]
    v_cmp_gt_u32 vcc, 640, v9
    v_add_u32 v9, 32, v9
    s_nop 0
    v_cndmask_b32 v190, 0, 1.0, vcc
    v_min_u32 v4, 639, v9
    v_lshlrev_b32 v5, 1, v4
    v_mul_u32_u24 v4, 7680, v4
    v_add_u32 v4, v4, v8
    global_load_ushort v151, v5, s[20:21]
    global_load_dwordx4 v[92:95], v4, s[22:23]
    v_cmp_gt_u32 vcc, 640, v9
    v_add_u32 v9, 32, v9
    s_nop 0
    v_cndmask_b32 v191, 0, 1.0, vcc
    v_min_u32 v4, 639, v9
    v_lshlrev_b32 v5, 1, v4
    v_mul_u32_u24 v4, 7680, v4
    v_add_u32 v4, v4, v8
    global_load_ushort v152, v5, s[20:21]
    global_load_dwordx4 v[96:99], v4, s[22:23]
    v_cmp_gt_u32 vcc, 640, v9
    v_add_u32 v9, 32, v9
    s_nop 0
    v_cndmask_b32 v192, 0, 1.0, vcc
    v_min_u32 v4, 639, v9
    v_lshlrev_b32 v5, 1, v4
    v_mul_u32_u24 v4, 7680, v4
    v_add_u32 v4, v4, v8
    global_load_ushort v153, v5, s[20:21]
    global_load_dwordx4 v[100:103], v4, s[22:23]
    v_cmp_gt_u32 vcc, 640, v9
    v_add_u32 v9, 32, v9
    s_nop 0
    v_cndmask_b32 v193, 0, 1.0, vcc
    v_min_u32 v4, 639, v9
    v_lshlrev_b32 v5, 1, v4
    v_mul_u32_u24 v4, 7680, v4
    v_add_u32 v4, v4, v8
    global_load_ushort v154, v5, s[20:21]
    global_load_dwordx4 v[104:107], v4, s[22:23]
    v_cmp_gt_u32 vcc, 640, v9
    v_add_u32 v9, 32, v9
    s_nop 0
    v_cndmask_b32 v194, 0, 1.0, vcc
    v_min_u32 v4, 639, v9
    v_lshlrev_b32 v5, 1, v4
    v_mul_u32_u24 v4, 7680, v4
    v_add_u32 v4, v4, v8
    global_load_ushort v155, v5, s[20:21]
    global_load_dwordx4 v[108:111], v4, s[22:23]
    v_cmp_gt_u32 vcc, 640, v9
    v_add_u32 v9, 32, v9
    s_nop 0
    v_cndmask_b32 v195, 0, 1.0, vcc
    v_min_u32 v4, 639, v9
    v_lshlrev_b32 v5, 1, v4
    v_mul_u32_u24 v4, 7680, v4
    v_add_u32 v4, v4, v8
    global_load_ushort v156, v5, s[20:21]
    global_load_dwordx4 v[112:115], v4, s[22:23]
    v_cmp_gt_u32 vcc, 640, v9
    v_add_u32 v9, 32, v9
    s_nop 0
    v_cndmask_b32 v196, 0, 1.0, vcc
    v_min_u32 v4, 639, v9
    v_lshlrev_b32 v5, 1, v4
    v_mul_u32_u24 v4, 7680, v4
    v_add_u32 v4, v4, v8
    global_load_ushort v157, v5, s[20:21]
    global_load_dwordx4 v[116:119], v4, s[22:23]
    v_cmp_gt_u32 vcc, 640, v9
    v_add_u32 v9, 32, v9
    s_nop 0
    v_cndmask_b32 v197, 0, 1.0, vcc
    v_min_u32 v4, 639, v9
    v_lshlrev_b32 v5, 1, v4
    v_mul_u32_u24 v4, 7680, v4
    v_add_u32 v4, v4, v8
    global_load_ushort v158, v5, s[20:21]
    global_load_dwordx4 v[120:123], v4, s[22:23]
    v_cmp_gt_u32 vcc, 640, v9
    v_add_u32 v9, 32, v9
    s_nop 0
    v_cndmask_b32 v198, 0, 1.0, vcc
    v_min_u32 v4, 639, v9
    v_lshlrev_b32 v5, 1, v4
    v_mul_u32_u24 v4, 7680, v4
    v_add_u32 v4, v4, v8
    global_load_ushort v159, v5, s[20:21]
    global_load_dwordx4 v[124:127], v4, s[22:23]
    v_cmp_gt_u32 vcc, 640, v9
    v_add_u32 v9, 32, v9
    s_nop 0
    v_cndmask_b32 v199, 0, 1.0, vcc
    v_mov_b32 v32, 0
    v_mov_b32 v33, 0
    v_mov_b32 v34, 0
    v_mov_b32 v35, 0
    v_mov_b32 v36, 0
    v_mov_b32 v37, 0
    v_mov_b32 v38, 0
    v_mov_b32 v39, 0
    s_waitcnt vmcnt(38)
    v_lshlrev_b32 v140, 16, v140
    v_mul_f32 v10, 0xbfb8aa3b, v140
    v_exp_f32 v10, v10
    v_mul_f32 v140, v140, v180
    v_add_f32 v10, 1.0, v10
    v_rcp_f32 v10, v10
    s_nop 0
    v_mul_f32 v10, v10, v140
    v_lshlrev_b32 v6, 16, v48
    v_and_b32 v7, 0xffff0000, v48
    v_fmac_f32 v32, v10, v6
    v_fmac_f32 v33, v10, v7
    v_lshlrev_b32 v6, 16, v49
    v_and_b32 v7, 0xffff0000, v49
    v_fmac_f32 v34, v10, v6
    v_fmac_f32 v35, v10, v7
    v_lshlrev_b32 v6, 16, v50
    v_and_b32 v7, 0xffff0000, v50
    v_fmac_f32 v36, v10, v6
    v_fmac_f32 v37, v10, v7
    v_lshlrev_b32 v6, 16, v51
    v_and_b32 v7, 0xffff0000, v51
    v_fmac_f32 v38, v10, v6
    v_fmac_f32 v39, v10, v7
    s_waitcnt vmcnt(36)
    v_lshlrev_b32 v141, 16, v141
    v_mul_f32 v10, 0xbfb8aa3b, v141
    v_exp_f32 v10, v10
    v_mul_f32 v141, v141, v181
    v_add_f32 v10, 1.0, v10
    v_rcp_f32 v10, v10
    s_nop 0
    v_mul_f32 v10, v10, v141
    v_lshlrev_b32 v6, 16, v52
    v_and_b32 v7, 0xffff0000, v52
    v_fmac_f32 v32, v10, v6
    v_fmac_f32 v33, v10, v7
    v_lshlrev_b32 v6, 16, v53
    v_and_b32 v7, 0xffff0000, v53
    v_fmac_f32 v34, v10, v6
    v_fmac_f32 v35, v10, v7
    v_lshlrev_b32 v6, 16, v54
    v_and_b32 v7, 0xffff0000, v54
    v_fmac_f32 v36, v10, v6
    v_fmac_f32 v37, v10, v7
    v_lshlrev_b32 v6, 16, v55
    v_and_b32 v7, 0xffff0000, v55
    v_fmac_f32 v38, v10, v6
    v_fmac_f32 v39, v10, v7
    s_waitcnt vmcnt(34)
    v_lshlrev_b32 v142, 16, v142
    v_mul_f32 v10, 0xbfb8aa3b, v142
    v_exp_f32 v10, v10
    v_mul_f32 v142, v142, v182
    v_add_f32 v10, 1.0, v10
    v_rcp_f32 v10, v10
    s_nop 0
    v_mul_f32 v10, v10, v142
    v_lshlrev_b32 v6, 16, v56
    v_and_b32 v7, 0xffff0000, v56
    v_fmac_f32 v32, v10, v6
    v_fmac_f32 v33, v10, v7
    v_lshlrev_b32 v6, 16, v57
    v_and_b32 v7, 0xffff0000, v57
    v_fmac_f32 v34, v10, v6
    v_fmac_f32 v35, v10, v7
    v_lshlrev_b32 v6, 16, v58
    v_and_b32 v7, 0xffff0000, v58
    v_fmac_f32 v36, v10, v6
    v_fmac_f32 v37, v10, v7
    v_lshlrev_b32 v6, 16, v59
    v_and_b32 v7, 0xffff0000, v59
    v_fmac_f32 v38, v10, v6
    v_fmac_f32 v39, v10, v7
    s_waitcnt vmcnt(32)
    v_lshlrev_b32 v143, 16, v143
    v_mul_f32 v10, 0xbfb8aa3b, v143
    v_exp_f32 v10, v10
    v_mul_f32 v143, v143, v183
    v_add_f32 v10, 1.0, v10
    v_rcp_f32 v10, v10
    s_nop 0
    v_mul_f32 v10, v10, v143
    v_lshlrev_b32 v6, 16, v60
    v_and_b32 v7, 0xffff0000, v60
    v_fmac_f32 v32, v10, v6
    v_fmac_f32 v33, v10, v7
    v_lshlrev_b32 v6, 16, v61
    v_and_b32 v7, 0xffff0000, v61
    v_fmac_f32 v34, v10, v6
    v_fmac_f32 v35, v10, v7
    v_lshlrev_b32 v6, 16, v62
    v_and_b32 v7, 0xffff0000, v62
    v_fmac_f32 v36, v10, v6
    v_fmac_f32 v37, v10, v7
    v_lshlrev_b32 v6, 16, v63
    v_and_b32 v7, 0xffff0000, v63
    v_fmac_f32 v38, v10, v6
    v_fmac_f32 v39, v10, v7
    s_waitcnt vmcnt(30)
    v_lshlrev_b32 v144, 16, v144
    v_mul_f32 v10, 0xbfb8aa3b, v144
    v_exp_f32 v10, v10
    v_mul_f32 v144, v144, v184
    v_add_f32 v10, 1.0, v10
    v_rcp_f32 v10, v10
    s_nop 0
    v_mul_f32 v10, v10, v144
    v_lshlrev_b32 v6, 16, v64
    v_and_b32 v7, 0xffff0000, v64
    v_fmac_f32 v32, v10, v6
    v_fmac_f32 v33, v10, v7
    v_lshlrev_b32 v6, 16, v65
    v_and_b32 v7, 0xffff0000, v65
    v_fmac_f32 v34, v10, v6
    v_fmac_f32 v35, v10, v7
    v_lshlrev_b32 v6, 16, v66
    v_and_b32 v7, 0xffff0000, v66
    v_fmac_f32 v36, v10, v6
    v_fmac_f32 v37, v10, v7
    v_lshlrev_b32 v6, 16, v67
    v_and_b32 v7, 0xffff0000, v67
    v_fmac_f32 v38, v10, v6
    v_fmac_f32 v39, v10, v7
    s_waitcnt vmcnt(28)
    v_lshlrev_b32 v145, 16, v145
    v_mul_f32 v10, 0xbfb8aa3b, v145
    v_exp_f32 v10, v10
    v_mul_f32 v145, v145, v185
    v_add_f32 v10, 1.0, v10
    v_rcp_f32 v10, v10
    s_nop 0
    v_mul_f32 v10, v10, v145
    v_lshlrev_b32 v6, 16, v68
    v_and_b32 v7, 0xffff0000, v68
    v_fmac_f32 v32, v10, v6
    v_fmac_f32 v33, v10, v7
    v_lshlrev_b32 v6, 16, v69
    v_and_b32 v7, 0xffff0000, v69
    v_fmac_f32 v34, v10, v6
    v_fmac_f32 v35, v10, v7
    v_lshlrev_b32 v6, 16, v70
    v_and_b32 v7, 0xffff0000, v70
    v_fmac_f32 v36, v10, v6
    v_fmac_f32 v37, v10, v7
    v_lshlrev_b32 v6, 16, v71
    v_and_b32 v7, 0xffff0000, v71
    v_fmac_f32 v38, v10, v6
    v_fmac_f32 v39, v10, v7
    s_waitcnt vmcnt(26)
    v_lshlrev_b32 v146, 16, v146
    v_mul_f32 v10, 0xbfb8aa3b, v146
    v_exp_f32 v10, v10
    v_mul_f32 v146, v146, v186
    v_add_f32 v10, 1.0, v10
    v_rcp_f32 v10, v10
    s_nop 0
    v_mul_f32 v10, v10, v146
    v_lshlrev_b32 v6, 16, v72
    v_and_b32 v7, 0xffff0000, v72
    v_fmac_f32 v32, v10, v6
    v_fmac_f32 v33, v10, v7
    v_lshlrev_b32 v6, 16, v73
    v_and_b32 v7, 0xffff0000, v73
    v_fmac_f32 v34, v10, v6
    v_fmac_f32 v35, v10, v7
    v_lshlrev_b32 v6, 16, v74
    v_and_b32 v7, 0xffff0000, v74
    v_fmac_f32 v36, v10, v6
    v_fmac_f32 v37, v10, v7
    v_lshlrev_b32 v6, 16, v75
    v_and_b32 v7, 0xffff0000, v75
    v_fmac_f32 v38, v10, v6
    v_fmac_f32 v39, v10, v7
    s_waitcnt vmcnt(24)
    v_lshlrev_b32 v147, 16, v147
    v_mul_f32 v10, 0xbfb8aa3b, v147
    v_exp_f32 v10, v10
    v_mul_f32 v147, v147, v187
    v_add_f32 v10, 1.0, v10
    v_rcp_f32 v10, v10
    s_nop 0
    v_mul_f32 v10, v10, v147
    v_lshlrev_b32 v6, 16, v76
    v_and_b32 v7, 0xffff0000, v76
    v_fmac_f32 v32, v10, v6
    v_fmac_f32 v33, v10, v7
    v_lshlrev_b32 v6, 16, v77
    v_and_b32 v7, 0xffff0000, v77
    v_fmac_f32 v34, v10, v6
    v_fmac_f32 v35, v10, v7
    v_lshlrev_b32 v6, 16, v78
    v_and_b32 v7, 0xffff0000, v78
    v_fmac_f32 v36, v10, v6
    v_fmac_f32 v37, v10, v7
    v_lshlrev_b32 v6, 16, v79
    v_and_b32 v7, 0xffff0000, v79
    v_fmac_f32 v38, v10, v6
    v_fmac_f32 v39, v10, v7
    s_waitcnt vmcnt(22)
    v_lshlrev_b32 v148, 16, v148
    v_mul_f32 v10, 0xbfb8aa3b, v148
    v_exp_f32 v10, v10
    v_mul_f32 v148, v148, v188
    v_add_f32 v10, 1.0, v10
    v_rcp_f32 v10, v10
    s_nop 0
    v_mul_f32 v10, v10, v148
    v_lshlrev_b32 v6, 16, v80
    v_and_b32 v7, 0xffff0000, v80
    v_fmac_f32 v32, v10, v6
    v_fmac_f32 v33, v10, v7
    v_lshlrev_b32 v6, 16, v81
    v_and_b32 v7, 0xffff0000, v81
    v_fmac_f32 v34, v10, v6
    v_fmac_f32 v35, v10, v7
    v_lshlrev_b32 v6, 16, v82
    v_and_b32 v7, 0xffff0000, v82
    v_fmac_f32 v36, v10, v6
    v_fmac_f32 v37, v10, v7
    v_lshlrev_b32 v6, 16, v83
    v_and_b32 v7, 0xffff0000, v83
    v_fmac_f32 v38, v10, v6
    v_fmac_f32 v39, v10, v7
    s_waitcnt vmcnt(20)
    v_lshlrev_b32 v149, 16, v149
    v_mul_f32 v10, 0xbfb8aa3b, v149
    v_exp_f32 v10, v10
    v_mul_f32 v149, v149, v189
    v_add_f32 v10, 1.0, v10
    v_rcp_f32 v10, v10
    s_nop 0
    v_mul_f32 v10, v10, v149
    v_lshlrev_b32 v6, 16, v84
    v_and_b32 v7, 0xffff0000, v84
    v_fmac_f32 v32, v10, v6
    v_fmac_f32 v33, v10, v7
    v_lshlrev_b32 v6, 16, v85
    v_and_b32 v7, 0xffff0000, v85
    v_fmac_f32 v34, v10, v6
    v_fmac_f32 v35, v10, v7
    v_lshlrev_b32 v6, 16, v86
    v_and_b32 v7, 0xffff0000, v86
    v_fmac_f32 v36, v10, v6
    v_fmac_f32 v37, v10, v7
    v_lshlrev_b32 v6, 16, v87
    v_and_b32 v7, 0xffff0000, v87
    v_fmac_f32 v38, v10, v6
    v_fmac_f32 v39, v10, v7
    s_waitcnt vmcnt(18)
    v_lshlrev_b32 v150, 16, v150
    v_mul_f32 v10, 0xbfb8aa3b, v150
    v_exp_f32 v10, v10
    v_mul_f32 v150, v150, v190
    v_add_f32 v10, 1.0, v10
    v_rcp_f32 v10, v10
    s_nop 0
    v_mul_f32 v10, v10, v150
    v_lshlrev_b32 v6, 16, v88
    v_and_b32 v7, 0xffff0000, v88
    v_fmac_f32 v32, v10, v6
    v_fmac_f32 v33, v10, v7
    v_lshlrev_b32 v6, 16, v89
    v_and_b32 v7, 0xffff0000, v89
    v_fmac_f32 v34, v10, v6
    v_fmac_f32 v35, v10, v7
    v_lshlrev_b32 v6, 16, v90
    v_and_b32 v7, 0xffff0000, v90
    v_fmac_f32 v36, v10, v6
    v_fmac_f32 v37, v10, v7
    v_lshlrev_b32 v6, 16, v91
    v_and_b32 v7, 0xffff0000, v91
    v_fmac_f32 v38, v10, v6
    v_fmac_f32 v39, v10, v7
    s_waitcnt vmcnt(16)
    v_lshlrev_b32 v151, 16, v151
    v_mul_f32 v10, 0xbfb8aa3b, v151
    v_exp_f32 v10, v10
    v_mul_f32 v151, v151, v191
    v_add_f32 v10, 1.0, v10
    v_rcp_f32 v10, v10
    s_nop 0
    v_mul_f32 v10, v10, v151
    v_lshlrev_b32 v6, 16, v92
    v_and_b32 v7, 0xffff0000, v92
    v_fmac_f32 v32, v10, v6
    v_fmac_f32 v33, v10, v7
    v_lshlrev_b32 v6, 16, v93
    v_and_b32 v7, 0xffff0000, v93
    v_fmac_f32 v34, v10, v6
    v_fmac_f32 v35, v10, v7
    v_lshlrev_b32 v6, 16, v94
    v_and_b32 v7, 0xffff0000, v94
    v_fmac_f32 v36, v10, v6
    v_fmac_f32 v37, v10, v7
    v_lshlrev_b32 v6, 16, v95
    v_and_b32 v7, 0xffff0000, v95
    v_fmac_f32 v38, v10, v6
    v_fmac_f32 v39, v10, v7
    s_waitcnt vmcnt(14)
    v_lshlrev_b32 v152, 16, v152
    v_mul_f32 v10, 0xbfb8aa3b, v152
    v_exp_f32 v10, v10
    v_mul_f32 v152, v152, v192
    v_add_f32 v10, 1.0, v10
    v_rcp_f32 v10, v10
    s_nop 0
    v_mul_f32 v10, v10, v152
    v_lshlrev_b32 v6, 16, v96
    v_and_b32 v7, 0xffff0000, v96
    v_fmac_f32 v32, v10, v6
    v_fmac_f32 v33, v10, v7
    v_lshlrev_b32 v6, 16, v97
    v_and_b32 v7, 0xffff0000, v97
    v_fmac_f32 v34, v10, v6
    v_fmac_f32 v35, v10, v7
    v_lshlrev_b32 v6, 16, v98
    v_and_b32 v7, 0xffff0000, v98
    v_fmac_f32 v36, v10, v6
    v_fmac_f32 v37, v10, v7
    v_lshlrev_b32 v6, 16, v99
    v_and_b32 v7, 0xffff0000, v99
    v_fmac_f32 v38, v10, v6
    v_fmac_f32 v39, v10, v7
    s_waitcnt vmcnt(12)
    v_lshlrev_b32 v153, 16, v153
    v_mul_f32 v10, 0xbfb8aa3b, v153
    v_exp_f32 v10, v10
    v_mul_f32 v153, v153, v193
    v_add_f32 v10, 1.0, v10
    v_rcp_f32 v10, v10
    s_nop 0
    v_mul_f32 v10, v10, v153
    v_lshlrev_b32 v6, 16, v100
    v_and_b32 v7, 0xffff0000, v100
    v_fmac_f32 v32, v10, v6
    v_fmac_f32 v33, v10, v7
    v_lshlrev_b32 v6, 16, v101
    v_and_b32 v7, 0xffff0000, v101
    v_fmac_f32 v34, v10, v6
    v_fmac_f32 v35, v10, v7
    v_lshlrev_b32 v6, 16, v102
    v_and_b32 v7, 0xffff0000, v102
    v_fmac_f32 v36, v10, v6
    v_fmac_f32 v37, v10, v7
    v_lshlrev_b32 v6, 16, v103
    v_and_b32 v7, 0xffff0000, v103
    v_fmac_f32 v38, v10, v6
    v_fmac_f32 v39, v10, v7
    s_waitcnt vmcnt(10)
    v_lshlrev_b32 v154, 16, v154
    v_mul_f32 v10, 0xbfb8aa3b, v154
    v_exp_f32 v10, v10
    v_mul_f32 v154, v154, v194
    v_add_f32 v10, 1.0, v10
    v_rcp_f32 v10, v10
    s_nop 0
    v_mul_f32 v10, v10, v154
    v_lshlrev_b32 v6, 16, v104
    v_and_b32 v7, 0xffff0000, v104
    v_fmac_f32 v32, v10, v6
    v_fmac_f32 v33, v10, v7
    v_lshlrev_b32 v6, 16, v105
    v_and_b32 v7, 0xffff0000, v105
    v_fmac_f32 v34, v10, v6
    v_fmac_f32 v35, v10, v7
    v_lshlrev_b32 v6, 16, v106
    v_and_b32 v7, 0xffff0000, v106
    v_fmac_f32 v36, v10, v6
    v_fmac_f32 v37, v10, v7
    v_lshlrev_b32 v6, 16, v107
    v_and_b32 v7, 0xffff0000, v107
    v_fmac_f32 v38, v10, v6
    v_fmac_f32 v39, v10, v7
    s_waitcnt vmcnt(8)
    v_lshlrev_b32 v155, 16, v155
    v_mul_f32 v10, 0xbfb8aa3b, v155
    v_exp_f32 v10, v10
    v_mul_f32 v155, v155, v195
    v_add_f32 v10, 1.0, v10
    v_rcp_f32 v10, v10
    s_nop 0
    v_mul_f32 v10, v10, v155
    v_lshlrev_b32 v6, 16, v108
    v_and_b32 v7, 0xffff0000, v108
    v_fmac_f32 v32, v10, v6
    v_fmac_f32 v33, v10, v7
    v_lshlrev_b32 v6, 16, v109
    v_and_b32 v7, 0xffff0000, v109
    v_fmac_f32 v34, v10, v6
    v_fmac_f32 v35, v10, v7
    v_lshlrev_b32 v6, 16, v110
    v_and_b32 v7, 0xffff0000, v110
    v_fmac_f32 v36, v10, v6
    v_fmac_f32 v37, v10, v7
    v_lshlrev_b32 v6, 16, v111
    v_and_b32 v7, 0xffff0000, v111
    v_fmac_f32 v38, v10, v6
    v_fmac_f32 v39, v10, v7
    s_waitcnt vmcnt(6)
    v_lshlrev_b32 v156, 16, v156
    v_mul_f32 v10, 0xbfb8aa3b, v156
    v_exp_f32 v10, v10
    v_mul_f32 v156, v156, v196
    v_add_f32 v10, 1.0, v10
    v_rcp_f32 v10, v10
    s_nop 0
    v_mul_f32 v10, v10, v156
    v_lshlrev_b32 v6, 16, v112
    v_and_b32 v7, 0xffff0000, v112
    v_fmac_f32 v32, v10, v6
    v_fmac_f32 v33, v10, v7
    v_lshlrev_b32 v6, 16, v113
    v_and_b32 v7, 0xffff0000, v113
    v_fmac_f32 v34, v10, v6
    v_fmac_f32 v35, v10, v7
    v_lshlrev_b32 v6, 16, v114
    v_and_b32 v7, 0xffff0000, v114
    v_fmac_f32 v36, v10, v6
    v_fmac_f32 v37, v10, v7
    v_lshlrev_b32 v6, 16, v115
    v_and_b32 v7, 0xffff0000, v115
    v_fmac_f32 v38, v10, v6
    v_fmac_f32 v39, v10, v7
    s_waitcnt vmcnt(4)
    v_lshlrev_b32 v157, 16, v157
    v_mul_f32 v10, 0xbfb8aa3b, v157
    v_exp_f32 v10, v10
    v_mul_f32 v157, v157, v197
    v_add_f32 v10, 1.0, v10
    v_rcp_f32 v10, v10
    s_nop 0
    v_mul_f32 v10, v10, v157
    v_lshlrev_b32 v6, 16, v116
    v_and_b32 v7, 0xffff0000, v116
    v_fmac_f32 v32, v10, v6
    v_fmac_f32 v33, v10, v7
    v_lshlrev_b32 v6, 16, v117
    v_and_b32 v7, 0xffff0000, v117
    v_fmac_f32 v34, v10, v6
    v_fmac_f32 v35, v10, v7
    v_lshlrev_b32 v6, 16, v118
    v_and_b32 v7, 0xffff0000, v118
    v_fmac_f32 v36, v10, v6
    v_fmac_f32 v37, v10, v7
    v_lshlrev_b32 v6, 16, v119
    v_and_b32 v7, 0xffff0000, v119
    v_fmac_f32 v38, v10, v6
    v_fmac_f32 v39, v10, v7
    s_waitcnt vmcnt(2)
    v_lshlrev_b32 v158, 16, v158
    v_mul_f32 v10, 0xbfb8aa3b, v158
    v_exp_f32 v10, v10
    v_mul_f32 v158, v158, v198
    v_add_f32 v10, 1.0, v10
    v_rcp_f32 v10, v10
    s_nop 0
    v_mul_f32 v10, v10, v158
    v_lshlrev_b32 v6, 16, v120
    v_and_b32 v7, 0xffff0000, v120
    v_fmac_f32 v32, v10, v6
    v_fmac_f32 v33, v10, v7
    v_lshlrev_b32 v6, 16, v121
    v_and_b32 v7, 0xffff0000, v121
    v_fmac_f32 v34, v10, v6
    v_fmac_f32 v35, v10, v7
    v_lshlrev_b32 v6, 16, v122
    v_and_b32 v7, 0xffff0000, v122
    v_fmac_f32 v36, v10, v6
    v_fmac_f32 v37, v10, v7
    v_lshlrev_b32 v6, 16, v123
    v_and_b32 v7, 0xffff0000, v123
    v_fmac_f32 v38, v10, v6
    v_fmac_f32 v39, v10, v7
    s_waitcnt vmcnt(0)
    v_lshlrev_b32 v159, 16, v159
    v_mul_f32 v10, 0xbfb8aa3b, v159
    v_exp_f32 v10, v10
    v_mul_f32 v159, v159, v199
    v_add_f32 v10, 1.0, v10
    v_rcp_f32 v10, v10
    s_nop 0
    v_mul_f32 v10, v10, v159
    v_lshlrev_b32 v6, 16, v124
    v_and_b32 v7, 0xffff0000, v124
    v_fmac_f32 v32, v10, v6
    v_fmac_f32 v33, v10, v7
    v_lshlrev_b32 v6, 16, v125
    v_and_b32 v7, 0xffff0000, v125
    v_fmac_f32 v34, v10, v6
    v_fmac_f32 v35, v10, v7
    v_lshlrev_b32 v6, 16, v126
    v_and_b32 v7, 0xffff0000, v126
    v_fmac_f32 v36, v10, v6
    v_fmac_f32 v37, v10, v7
    v_lshlrev_b32 v6, 16, v127
    v_and_b32 v7, 0xffff0000, v127
    v_fmac_f32 v38, v10, v6
    v_fmac_f32 v39, v10, v7
    v_lshlrev_b32 v9, 5, v0
    ds_write_b128 v9, v[32:35]
    ds_write_b128 v9, v[36:39] offset:16
    s_waitcnt lgkmcnt(0)
    s_barrier
    v_lshlrev_b32 v3, 2, v1
    s_lshl_b32 s15, s12, 11
    v_add_u32 v3, s15, v3
    ds_read_b32 v16, v3 offset:0
    ds_read_b32 v17, v3 offset:256
    ds_read_b32 v18, v3 offset:512
    ds_read_b32 v19, v3 offset:768
    ds_read_b32 v20, v3 offset:1024
    ds_read_b32 v21, v3 offset:1280
    ds_read_b32 v22, v3 offset:1536
    ds_read_b32 v23, v3 offset:1792
    s_waitcnt lgkmcnt(0)
    v_add_f32 v16, v16, v17
    v_add_f32 v16, v16, v18
    v_add_f32 v16, v16, v19
    v_add_f32 v16, v16, v20
    v_add_f32 v16, v16, v21
    v_add_f32 v16, v16, v22
    v_add_f32 v16, v16, v23
    v_lshlrev_b32 v3, 2, v0
    ds_write_b32 v3, v16 offset:8192
    s_waitcnt lgkmcnt(0)
    s_barrier
    s_cmp_lg_u32 s12, 0
    s_cbranch_scc1 .Lmp_doneb
    ds_read_b32 v16, v3 offset:8192
    ds_read_b32 v17, v3 offset:8448
    ds_read_b32 v18, v3 offset:8704
    ds_read_b32 v19, v3 offset:8960
    s_waitcnt lgkmcnt(0)
    v_add_f32 v16, v16, v17
    v_add_f32 v18, v18, v19
    v_add_f32 v16, v16, v18
    s_lshl_b32 s15, s17, 8
    s_add_u32 s15, s15, s25
    s_add_u32 s15, s15, 258998272
    v_add_u32 v3, s15, v3
    global_store_dword v3, v16, s[4:5] sc1
.Lmp_doneb:
    s_mov_b32 s13, s26
    s_waitcnt vmcnt(0)
    s_barrier
    s_cmp_lg_u32 s12, 0
    s_cbranch_scc1 .Lar_wb
    v_mov_b32 v2, 68
    v_mov_b32 v3, 1
    s_mov_b64 exec, 1
    global_atomic_add v4, v2, v3, s[6:7] sc0 sc1
    s_waitcnt vmcnt(0)
    v_cmp_eq_u32 vcc, 63, v4
    v_mov_b32 v2, 160
    v_mov_b32 v3, 64
    s_and_b64 exec, exec, vcc
    s_cbranch_execz .Lar_xb
    global_store_dword v2, v3, s[6:7] sc0 sc1
.Lar_xb:
    s_mov_b64 exec, -1
.Lar_wb:
.LB_after_h1:
    s_barrier
    s_cmp_ge_u32 s13, 20
    s_cbranch_scc1 .Lr_nc
    s_add_u32 s13, s88, 64
    s_bitcmp1_b32 s3, 3
    s_cbranch_scc0 .Lend
    s_branch .Lrole_C
.Lr_nc:
    s_sub_u32 s13, s13, 20
    s_cmp_lt_u32 s13, 24
    s_cbranch_scc1 .Lr_b1
    s_cmp_lt_u32 s13, 28
    s_cbranch_scc1 .Lr_ln
    s_cmp_lt_u32 s13, 36
    s_cbranch_scc1 .Lr_m1
    s_bitcmp1_b32 s3, 7
    s_cbranch_scc0 .Lend
    s_sub_u32 s13, s13, 36
    s_mov_b32 s38, 0
.Lr_m2h:
    s_bitcmp1_b32 s3, 7
    s_cbranch_scc0 .Lend
    s_load_dwordx4 s[16:19], s[0:1], 80
    s_and_b32 s20, s13, 7
    s_mul_i32 s20, s20, 80
    s_waitcnt lgkmcnt(0)
    s_mov_b32 s44, s18
    s_mov_b32 s45, s19
    s_mul_i32 s15, s12, 491520
    s_lshl_b32 s22, s20, 1
    s_add_u32 s15, s15, s22
    s_add_u32 s24, s16, s15
    s_addc_u32 s25, s17, 0
    v_lshrrev_b32 v2, 3, v1
    v_mul_u32_u24 v3, 1280, v2
    v_lshrrev_b32 v4, 1, v2
    v_and_b32 v4, 3, v4
    v_lshlrev_b32 v4, 1, v4
    v_and_b32 v5, 7, v1
    v_xor_b32 v4, v4, v5
    v_lshlrev_b32 v4, 4, v4
    v_add_u32 v4, v4, v3
    s_lshl_b32 s30, s12, 15
    v_lshrrev_b32 v12, 5, v1
    v_lshlrev_b32 v13, 11, v12
    v_bfe_u32 v12, v1, 2, 3
    v_lshlrev_b32 v14, 7, v12
    v_add_u32 v13, v13, v14
    v_and_b32 v14, 3, v1
    v_lshlrev_b32 v14, 3, v14
    v_add_u32 v13, v13, v14
    v_add_u32 v13, s30, v13
    v_lshrrev_b32 v12, 1, v12
    v_xor_b32 v14, 0, v12
    v_lshlrev_b32 v14, 5, v14
    v_add_u32 v8, v13, v14
    v_xor_b32 v14, 1, v12
    v_lshlrev_b32 v14, 5, v14
    v_add_u32 v9, v13, v14
    v_xor_b32 v14, 2, v12
    v_lshlrev_b32 v14, 5, v14
    v_add_u32 v10, v13, v14
    v_xor_b32 v14, 3, v12
    v_lshlrev_b32 v14, 5, v14
    v_add_u32 v11, v13, v14
    s_add_u32 m0, s30, 0
    s_nop 0
    global_load_lds_dwordx4 v4, s[24:25] offset:0
    s_add_u32 m0, s30, 992
    s_nop 0
    global_load_lds_dwordx4 v4, s[24:25] offset:32
    s_add_u32 s24, s24, 10240
    s_addc_u32 s25, s25, 0
    s_add_u32 m0, s30, 2048
    s_nop 0
    global_load_lds_dwordx4 v4, s[24:25] offset:0
    s_add_u32 m0, s30, 3040
    s_nop 0
    global_load_lds_dwordx4 v4, s[24:25] offset:32
    s_add_u32 s24, s24, 10240
    s_addc_u32 s25, s25, 0
    s_add_u32 m0, s30, 4096
    s_nop 0
    global_load_lds_dwordx4 v4, s[24:25] offset:0
    s_add_u32 m0, s30, 5088
    s_nop 0
    global_load_lds_dwordx4 v4, s[24:25] offset:32
    s_add_u32 s24, s24, 10240
    s_addc_u32 s25, s25, 0
    s_add_u32 m0, s30, 6144
    s_nop 0
    global_load_lds_dwordx4 v4, s[24:25] offset:0
    s_add_u32 m0, s30, 7136
    s_nop 0
    global_load_lds_dwordx4 v4, s[24:25] offset:32
    s_add_u32 s24, s24, 10240
    s_addc_u32 s25, s25, 0
    s_add_u32 m0, s30, 8192
    s_nop 0
    global_load_lds_dwordx4 v4, s[24:25] offset:0
    s_add_u32 m0, s30, 9184
    s_nop 0
    global_load_lds_dwordx4 v4, s[24:25] offset:32
    s_add_u32 s24, s24, 10240
    s_addc_u32 s25, s25, 0
    s_add_u32 m0, s30, 10240
    s_nop 0
    global_load_lds_dwordx4 v4, s[24:25] offset:0
    s_add_u32 m0, s30, 11232
    s_nop 0
    global_load_lds_dwordx4 v4, s[24:25] offset:32
    s_add_u32 s24, s24, 10240
    s_addc_u32 s25, s25, 0
    s_add_u32 m0, s30, 12288
    s_nop 0
    global_load_lds_dwordx4 v4, s[24:25] offset:0
    s_add_u32 m0, s30, 13280
    s_nop 0
    global_load_lds_dwordx4 v4, s[24:25] offset:32
    s_add_u32 s24, s24, 10240
    s_addc_u32 s25, s25, 0
    s_add_u32 m0, s30, 14336
    s_nop 0
    global_load_lds_dwordx4 v4, s[24:25] offset:0
    s_add_u32 m0, s30, 15328
    s_nop 0
    global_load_lds_dwordx4 v4, s[24:25] offset:32
    s_add_u32 s24, s24, 10240
    s_addc_u32 s25, s25, 0
    s_add_u32 m0, s30, 16384
    s_nop 0
    global_load_lds_dwordx4 v4, s[24:25] offset:0
    s_add_u32 m0, s30, 17376
    s_nop 0
    global_load_lds_dwordx4 v4, s[24:25] offset:32
    s_add_u32 s24, s24, 10240
    s_addc_u32 s25, s25, 0
    s_add_u32 m0, s30, 18432
    s_nop 0
    global_load_lds_dwordx4 v4, s[24:25] offset:0
    s_add_u32 m0, s30, 19424
    s_nop 0
    global_load_lds_dwordx4 v4, s[24:25] offset:32
    s_add_u32 s24, s24, 10240
    s_addc_u32 s25, s25, 0
    s_add_u32 m0, s30, 20480
    s_nop 0
    global_load_lds_dwordx4 v4, s[24:25] offset:0
    s_add_u32 m0, s30, 21472
    s_nop 0
    global_load_lds_dwordx4 v4, s[24:25] offset:32
    s_add_u32 s24, s24, 10240
    s_addc_u32 s25, s25, 0
    s_add_u32 m0, s30, 22528
    s_nop 0
    global_load_lds_dwordx4 v4, s[24:25] offset:0
    s_add_u32 m0, s30, 23520
    s_nop 0
    global_load_lds_dwordx4 v4, s[24:25] offset:32
    s_add_u32 s24, s24, 10240
    s_addc_u32 s25, s25, 0
    s_waitcnt vmcnt(16)
    s_add_u32 m0, s30, 24576
    s_nop 0
    global_load_lds_dwordx4 v4, s[24:25] offset:0
    s_add_u32 m0, s30, 25568
    s_nop 0
    global_load_lds_dwordx4 v4, s[24:25] offset:32
    s_add_u32 s24, s24, 10240
    s_addc_u32 s25, s25, 0
    s_add_u32 m0, s30, 26624
    s_nop 0
    global_load_lds_dwordx4 v4, s[24:25] offset:0
    s_add_u32 m0, s30, 27616
    s_nop 0
    global_load_lds_dwordx4 v4, s[24:25] offset:32
    s_add_u32 s24, s24, 10240
    s_addc_u32 s25, s25, 0
    s_add_u32 m0, s30, 28672
    s_nop 0
    global_load_lds_dwordx4 v4, s[24:25] offset:0
    s_add_u32 m0, s30, 29664
    s_nop 0
    global_load_lds_dwordx4 v4, s[24:25] offset:32
    s_add_u32 s24, s24, 10240
    s_addc_u32 s25, s25, 0
    s_add_u32 m0, s30, 30720
    s_nop 0
    global_load_lds_dwordx4 v4, s[24:25] offset:0
    s_add_u32 m0, s30, 31712
    s_nop 0
    global_load_lds_dwordx4 v4, s[24:25] offset:32
    s_add_u32 s24, s24, 10240
    s_addc_u32 s25, s25, 0
    ds_read_b64_tr_b16 a[0:1], v8 offset:0
    ds_read_b64_tr_b16 a[4:5], v9 offset:0
    ds_read_b64_tr_b16 a[8:9], v10 offset:0
    ds_read_b64_tr_b16 a[12:13], v11 offset:0
    ds_read_b64_tr_b16 a[16:17], v11 offset:1024
    ds_read_b64_tr_b16 a[2:3], v8 offset:4096
    ds_read_b64_tr_b16 a[6:7], v9 offset:4096
    ds_read_b64_tr_b16 a[10:11], v10 offset:4096
    ds_read_b64_tr_b16 a[14:15], v11 offset:4096
    ds_read_b64_tr_b16 a[18:19], v11 offset:5120
    s_waitcnt lgkmcnt(0)
    s_waitcnt vmcnt(16)
    s_add_u32 m0, s30, 0
    s_nop 0
    global_load_lds_dwordx4 v4, s[24:25] offset:0
    s_add_u32 m0, s30, 992
    s_nop 0
    global_load_lds_dwordx4 v4, s[24:25] offset:32
    s_add_u32 s24, s24, 10240
    s_addc_u32 s25, s25, 0
    s_add_u32 m0, s30, 2048
    s_nop 0
    global_load_lds_dwordx4 v4, s[24:25] offset:0
    s_add_u32 m0, s30, 3040
    s_nop 0
    global_load_lds_dwordx4 v4, s[24:25] offset:32
    s_add_u32 s24, s24, 10240
    s_addc_u32 s25, s25, 0
    s_add_u32 m0, s30, 4096
    s_nop 0
    global_load_lds_dwordx4 v4, s[24:25] offset:0
    s_add_u32 m0, s30, 5088
    s_nop 0
    global_load_lds_dwordx4 v4, s[24:25] offset:32
    s_add_u32 s24, s24, 10240
    s_addc_u32 s25, s25, 0
    s_add_u32 m0, s30, 6144
    s_nop 0
    global_load_lds_dwordx4 v4, s[24:25] offset:0
    s_add_u32 m0, s30, 7136
    s_nop 0
    global_load_lds_dwordx4 v4, s[24:25] offset:32
    s_add_u32 s24, s24, 10240
    s_addc_u32 s25, s25, 0
    ds_read_b64_tr_b16 a[80:81], v8 offset:8192
    ds_read_b64_tr_b16 a[84:85], v9 offset:8192
    ds_read_b64_tr_b16 a[88:89], v10 offset:8192
    ds_read_b64_tr_b16 a[92:93], v11 offset:8192
    ds_read_b64_tr_b16 a[96:97], v11 offset:9216
    ds_read_b64_tr_b16 a[20:21], v8 offset:12288
    ds_read_b64_tr_b16 a[24:25], v9 offset:12288
    ds_read_b64_tr_b16 a[28:29], v10 offset:12288
    ds_read_b64_tr_b16 a[32:33], v11 offset:12288
    ds_read_b64_tr_b16 a[36:37], v11 offset:13312
    s_waitcnt lgkmcnt(0)
    s_waitcnt vmcnt(16)
    s_add_u32 m0, s30, 8192
    s_nop 0
    global_load_lds_dwordx4 v4, s[24:25] offset:0
    s_add_u32 m0, s30, 9184
    s_nop 0
    global_load_lds_dwordx4 v4, s[24:25] offset:32
    s_add_u32 s24, s24, 10240
    s_addc_u32 s25, s25, 0
    s_add_u32 m0, s30, 10240
    s_nop 0
    global_load_lds_dwordx4 v4, s[24:25] offset:0
    s_add_u32 m0, s30, 11232
    s_nop 0
    global_load_lds_dwordx4 v4, s[24:25] offset:32
    s_add_u32 s24, s24, 10240
    s_addc_u32 s25, s25, 0
    s_add_u32 m0, s30, 12288
    s_nop 0
    global_load_lds_dwordx4 v4, s[24:25] offset:0
    s_add_u32 m0, s30, 13280
    s_nop 0
    global_load_lds_dwordx4 v4, s[24:25] offset:32
    s_add_u32 s24, s24, 10240
    s_addc_u32 s25, s25, 0
    s_add_u32 m0, s30, 14336
    s_nop 0
    global_load_lds_dwordx4 v4, s[24:25] offset:0
    s_add_u32 m0, s30, 15328
    s_nop 0
    global_load_lds_dwordx4 v4, s[24:25] offset:32
    s_add_u32 s24, s24, 10240
    s_addc_u32 s25, s25, 0
    ds_read_b64_tr_b16 a[22:23], v8 offset:16384
    ds_read_b64_tr_b16 a[26:27], v9 offset:16384
    ds_read_b64_tr_b16 a[30:31], v10 offset:16384
    ds_read_b64_tr_b16 a[34:35], v11 offset:16384
    ds_read_b64_tr_b16 a[38:39], v11 offset:17408
    ds_read_b64_tr_b16 a[82:83], v8 offset:20480
    ds_read_b64_tr_b16 a[86:87], v9 offset:20480
    ds_read_b64_tr_b16 a[90:91], v10 offset:20480
    ds_read_b64_tr_b16 a[94:95], v11 offset:20480
    ds_read_b64_tr_b16 a[98:99], v11 offset:21504
    s_waitcnt lgkmcnt(0)
    s_waitcnt vmcnt(16)
    s_add_u32 m0, s30, 16384
    s_nop 0
    global_load_lds_dwordx4 v4, s[24:25] offset:0
    s_add_u32 m0, s30, 17376
    s_nop 0
    global_load_lds_dwordx4 v4, s[24:25] offset:32
    s_add_u32 s24, s24, 10240
    s_addc_u32 s25, s25, 0
    s_add_u32 m0, s30, 18432
    s_nop 0
    global_load_lds_dwordx4 v4, s[24:25] offset:0
    s_add_u32 m0, s30, 19424
    s_nop 0
    global_load_lds_dwordx4 v4, s[24:25] offset:32
    s_add_u32 s24, s24, 10240
    s_addc_u32 s25, s25, 0
    s_add_u32 m0, s30, 20480
    s_nop 0
    global_load_lds_dwordx4 v4, s[24:25] offset:0
    s_add_u32 m0, s30, 21472
    s_nop 0
    global_load_lds_dwordx4 v4, s[24:25] offset:32
    s_add_u32 s24, s24, 10240
    s_addc_u32 s25, s25, 0
    s_add_u32 m0, s30, 22528
    s_nop 0
    global_load_lds_dwordx4 v4, s[24:25] offset:0
    s_add_u32 m0, s30, 23520
    s_nop 0
    global_load_lds_dwordx4 v4, s[24:25] offset:32
    s_add_u32 s24, s24, 10240
    s_addc_u32 s25, s25, 0
    ds_read_b64_tr_b16 a[40:41], v8 offset:24576
    ds_read_b64_tr_b16 a[44:45], v9 offset:24576
    ds_read_b64_tr_b16 a[48:49], v10 offset:24576
    ds_read_b64_tr_b16 a[52:53], v11 offset:24576
    ds_read_b64_tr_b16 a[56:57], v11 offset:25600
    ds_read_b64_tr_b16 a[42:43], v8 offset:28672
    ds_read_b64_tr_b16 a[46:47], v9 offset:28672
    ds_read_b64_tr_b16 a[50:51], v10 offset:28672
    ds_read_b64_tr_b16 a[54:55], v11 offset:28672
    ds_read_b64_tr_b16 a[58:59], v11 offset:29696
    s_waitcnt lgkmcnt(0)
    s_waitcnt vmcnt(16)
    s_add_u32 m0, s30, 24576
    s_nop 0
    global_load_lds_dwordx4 v4, s[24:25] offset:0
    s_add_u32 m0, s30, 25568
    s_nop 0
    global_load_lds_dwordx4 v4, s[24:25] offset:32
    s_add_u32 s24, s24, 10240
    s_addc_u32 s25, s25, 0
    s_add_u32 m0, s30, 26624
    s_nop 0
    global_load_lds_dwordx4 v4, s[24:25] offset:0
    s_add_u32 m0, s30, 27616
    s_nop 0
    global_load_lds_dwordx4 v4, s[24:25] offset:32
    s_add_u32 s24, s24, 10240
    s_addc_u32 s25, s25, 0
    s_add_u32 m0, s30, 28672
    s_nop 0
    global_load_lds_dwordx4 v4, s[24:25] offset:0
    s_add_u32 m0, s30, 29664
    s_nop 0
    global_load_lds_dwordx4 v4, s[24:25] offset:32
    s_add_u32 s24, s24, 10240
    s_addc_u32 s25, s25, 0
    s_add_u32 m0, s30, 30720
    s_nop 0
    global_load_lds_dwordx4 v4, s[24:25] offset:0
    s_add_u32 m0, s30, 31712
    s_nop 0
    global_load_lds_dwordx4 v4, s[24:25] offset:32
    s_add_u32 s24, s24, 10240
    s_addc_u32 s25, s25, 0
    ds_read_b64_tr_b16 a[100:101], v8 offset:0
    ds_read_b64_tr_b16 a[104:105], v9 offset:0
    ds_read_b64_tr_b16 a[108:109], v10 offset:0
    ds_read_b64_tr_b16 a[112:113], v11 offset:0
    ds_read_b64_tr_b16 a[116:117], v11 offset:1024
    ds_read_b64_tr_b16 a[60:61], v8 offset:4096
    ds_read_b64_tr_b16 a[64:65], v9 offset:4096
    ds_read_b64_tr_b16 a[68:69], v10 offset:4096
    ds_read_b64_tr_b16 a[72:73], v11 offset:4096
    ds_read_b64_tr_b16 a[76:77], v11 offset:5120
    s_waitcnt lgkmcnt(0)
    s_waitcnt vmcnt(16)
    s_add_u32 m0, s30, 0
    s_nop 0
    global_load_lds_dwordx4 v4, s[24:25] offset:0
    s_add_u32 m0, s30, 992
    s_nop 0
    global_load_lds_dwordx4 v4, s[24:25] offset:32
    s_add_u32 s24, s24, 10240
    s_addc_u32 s25, s25, 0
    s_add_u32 m0, s30, 2048
    s_nop 0
    global_load_lds_dwordx4 v4, s[24:25] offset:0
    s_add_u32 m0, s30, 3040
    s_nop 0
    global_load_lds_dwordx4 v4, s[24:25] offset:32
    s_add_u32 s24, s24, 10240
    s_addc_u32 s25, s25, 0
    s_add_u32 m0, s30, 4096
    s_nop 0
    global_load_lds_dwordx4 v4, s[24:25] offset:0
    s_add_u32 m0, s30, 5088
    s_nop 0
    global_load_lds_dwordx4 v4, s[24:25] offset:32
    s_add_u32 s24, s24, 10240
    s_addc_u32 s25, s25, 0
    s_add_u32 m0, s30, 6144
    s_nop 0
    global_load_lds_dwordx4 v4, s[24:25] offset:0
    s_add_u32 m0, s30, 7136
    s_nop 0
    global_load_lds_dwordx4 v4, s[24:25] offset:32
    s_add_u32 s24, s24, 10240
    s_addc_u32 s25, s25, 0
    ds_read_b64_tr_b16 a[62:63], v8 offset:8192
    ds_read_b64_tr_b16 a[66:67], v9 offset:8192
    ds_read_b64_tr_b16 a[70:71], v10 offset:8192
    ds_read_b64_tr_b16 a[74:75], v11 offset:8192
    ds_read_b64_tr_b16 a[78:79], v11 offset:9216
    ds_read_b64_tr_b16 a[102:103], v8 offset:12288
    ds_read_b64_tr_b16 a[106:107], v9 offset:12288
    ds_read_b64_tr_b16 a[110:111], v10 offset:12288
    ds_read_b64_tr_b16 a[114:115], v11 offset:12288
    ds_read_b64_tr_b16 a[118:119], v11 offset:13312
    s_waitcnt lgkmcnt(0)
    s_waitcnt vmcnt(16)
    s_add_u32 m0, s30, 8192
    s_nop 0
    global_load_lds_dwordx4 v4, s[24:25] offset:0
    s_add_u32 m0, s30, 9184
    s_nop 0
    global_load_lds_dwordx4 v4, s[24:25] offset:32
    s_add_u32 s24, s24, 10240
    s_addc_u32 s25, s25, 0
    s_add_u32 m0, s30, 10240
    s_nop 0
    global_load_lds_dwordx4 v4, s[24:25] offset:0
    s_add_u32 m0, s30, 11232
    s_nop 0
    global_load_lds_dwordx4 v4, s[24:25] offset:32
    s_add_u32 s24, s24, 10240
    s_addc_u32 s25, s25, 0
    s_add_u32 m0, s30, 12288
    s_nop 0
    global_load_lds_dwordx4 v4, s[24:25] offset:0
    s_add_u32 m0, s30, 13280
    s_nop 0
    global_load_lds_dwordx4 v4, s[24:25] offset:32
    s_add_u32 s24, s24, 10240
    s_addc_u32 s25, s25, 0
    s_add_u32 m0, s30, 14336
    s_nop 0
    global_load_lds_dwordx4 v4, s[24:25] offset:0
    s_add_u32 m0, s30, 15328
    s_nop 0
    global_load_lds_dwordx4 v4, s[24:25] offset:32
    s_add_u32 s24, s24, 10240
    s_addc_u32 s25, s25, 0
    ds_read_b64_tr_b16 a[120:121], v8 offset:16384
    ds_read_b64_tr_b16 a[124:125], v9 offset:16384
    ds_read_b64_tr_b16 a[128:129], v10 offset:16384
    ds_read_b64_tr_b16 a[132:133], v11 offset:16384
    ds_read_b64_tr_b16 a[136:137], v11 offset:17408
    ds_read_b64_tr_b16 a[122:123], v8 offset:20480
    ds_read_b64_tr_b16 a[126:127], v9 offset:20480
    ds_read_b64_tr_b16 a[130:131], v10 offset:20480
    ds_read_b64_tr_b16 a[134:135], v11 offset:20480
    ds_read_b64_tr_b16 a[138:139], v11 offset:21504
    s_waitcnt lgkmcnt(0)
    s_waitcnt vmcnt(16)
    s_add_u32 m0, s30, 16384
    s_nop 0
    global_load_lds_dwordx4 v4, s[24:25] offset:0
    s_add_u32 m0, s30, 17376
    s_nop 0
    global_load_lds_dwordx4 v4, s[24:25] offset:32
    s_add_u32 s24, s24, 10240
    s_addc_u32 s25, s25, 0
    s_add_u32 m0, s30, 18432
    s_nop 0
    global_load_lds_dwordx4 v4, s[24:25] offset:0
    s_add_u32 m0, s30, 19424
    s_nop 0
    global_load_lds_dwordx4 v4, s[24:25] offset:32
    s_add_u32 s24, s24, 10240
    s_addc_u32 s25, s25, 0
    s_add_u32 m0, s30, 20480
    s_nop 0
    global_load_lds_dwordx4 v4, s[24:25] offset:0
    s_add_u32 m0, s30, 21472
    s_nop 0
    global_load_lds_dwordx4 v4, s[24:25] offset:32
    s_add_u32 s24, s24, 10240
    s_addc_u32 s25, s25, 0
    s_add_u32 m0, s30, 22528
    s_nop 0
    global_load_lds_dwordx4 v4, s[24:25] offset:0
    s_add_u32 m0, s30, 23520
    s_nop 0
    global_load_lds_dwordx4 v4, s[24:25] offset:32
    s_add_u32 s24, s24, 10240
    s_addc_u32 s25, s25, 0
    ds_read_b64_tr_b16 a[200:201], v8 offset:24576
    ds_read_b64_tr_b16 a[204:205], v9 offset:24576
    ds_read_b64_tr_b16 a[208:209], v10 offset:24576
    ds_read_b64_tr_b16 a[212:213], v11 offset:24576
    ds_read_b64_tr_b16 a[216:217], v11 offset:25600
    ds_read_b64_tr_b16 a[140:141], v8 offset:28672
    ds_read_b64_tr_b16 a[144:145], v9 offset:28672
    ds_read_b64_tr_b16 a[148:149], v10 offset:28672
    ds_read_b64_tr_b16 a[152:153], v11 offset:28672
    ds_read_b64_tr_b16 a[156:157], v11 offset:29696
    s_waitcnt lgkmcnt(0)
    s_waitcnt vmcnt(16)
    s_add_u32 m0, s30, 24576
    s_nop 0
    global_load_lds_dwordx4 v4, s[24:25] offset:0
    s_add_u32 m0, s30, 25568
    s_nop 0
    global_load_lds_dwordx4 v4, s[24:25] offset:32
    s_add_u32 s24, s24, 10240
    s_addc_u32 s25, s25, 0
    s_add_u32 m0, s30, 26624
    s_nop 0
    global_load_lds_dwordx4 v4, s[24:25] offset:0
    s_add_u32 m0, s30, 27616
    s_nop 0
    global_load_lds_dwordx4 v4, s[24:25] offset:32
    s_add_u32 s24, s24, 10240
    s_addc_u32 s25, s25, 0
    s_add_u32 m0, s30, 28672
    s_nop 0
    global_load_lds_dwordx4 v4, s[24:25] offset:0
    s_add_u32 m0, s30, 29664
    s_nop 0
    global_load_lds_dwordx4 v4, s[24:25] offset:32
    s_add_u32 s24, s24, 10240
    s_addc_u32 s25, s25, 0
    s_add_u32 m0, s30, 30720
    s_nop 0
    global_load_lds_dwordx4 v4, s[24:25] offset:0
    s_add_u32 m0, s30, 31712
    s_nop 0
    global_load_lds_dwordx4 v4, s[24:25] offset:32
    s_add_u32 s24, s24, 10240
    s_addc_u32 s25, s25, 0
    ds_read_b64_tr_b16 a[142:143], v8 offset:0
    ds_read_b64_tr_b16 a[146:147], v9 offset:0
    ds_read_b64_tr_b16 a[150:151], v10 offset:0
    ds_read_b64_tr_b16 a[154:155], v11 offset:0
    ds_read_b64_tr_b16 a[158:159], v11 offset:1024
    ds_read_b64_tr_b16 a[202:203], v8 offset:4096
    ds_read_b64_tr_b16 a[206:207], v9 offset:4096
    ds_read_b64_tr_b16 a[210:211], v10 offset:4096
    ds_read_b64_tr_b16 a[214:215], v11 offset:4096
    ds_read_b64_tr_b16 a[218:219], v11 offset:5120
    s_waitcnt lgkmcnt(0)
    s_waitcnt vmcnt(16)
    ds_read_b64_tr_b16 a[160:161], v8 offset:8192
    ds_read_b64_tr_b16 a[164:165], v9 offset:8192
    ds_read_b64_tr_b16 a[168:169], v10 offset:8192
    ds_read_b64_tr_b16 a[172:173], v11 offset:8192
    ds_read_b64_tr_b16 a[176:177], v11 offset:9216
    ds_read_b64_tr_b16 a[162:163], v8 offset:12288
    ds_read_b64_tr_b16 a[166:167], v9 offset:12288
    ds_read_b64_tr_b16 a[170:171], v10 offset:12288
    ds_read_b64_tr_b16 a[174:175], v11 offset:12288
    ds_read_b64_tr_b16 a[178:179], v11 offset:13312
    s_waitcnt lgkmcnt(0)
    s_waitcnt vmcnt(8)
    ds_read_b64_tr_b16 a[220:221], v8 offset:16384
    ds_read_b64_tr_b16 a[224:225], v9 offset:16384
    ds_read_b64_tr_b16 a[228:229], v10 offset:16384
    ds_read_b64_tr_b16 a[232:233], v11 offset:16384
    ds_read_b64_tr_b16 a[236:237], v11 offset:17408
    ds_read_b64_tr_b16 a[180:181], v8 offset:20480
    ds_read_b64_tr_b16 a[184:185], v9 offset:20480
    ds_read_b64_tr_b16 a[188:189], v10 offset:20480
    ds_read_b64_tr_b16 a[192:193], v11 offset:20480
    ds_read_b64_tr_b16 a[196:197], v11 offset:21504
    s_waitcnt lgkmcnt(0)
    s_waitcnt vmcnt(0)
    ds_read_b64_tr_b16 a[182:183], v8 offset:24576
    ds_read_b64_tr_b16 a[186:187], v9 offset:24576
    ds_read_b64_tr_b16 a[190:191], v10 offset:24576
    ds_read_b64_tr_b16 a[194:195], v11 offset:24576
    ds_read_b64_tr_b16 a[198:199], v11 offset:25600
    ds_read_b64_tr_b16 a[222:223], v8 offset:28672
    ds_read_b64_tr_b16 a[226:227], v9 offset:28672
    ds_read_b64_tr_b16 a[230:231], v10 offset:28672
    ds_read_b64_tr_b16 a[234:235], v11 offset:28672
    ds_read_b64_tr_b16 a[238:239], v11 offset:29696
    s_waitcnt lgkmcnt(0)
    s_barrier
    v_mov_b32 v2, 160
.iw_6:
    global_load_dword v3, v2, s[6:7] sc0 sc1
    s_waitcnt vmcnt(0)
    v_readfirstlane_b32 s15, v3
    s_nop 3
    s_cmp_ge_u32 s15, 64
    s_cbranch_scc1 .iwd_7
    s_sleep 4
    s_add_u32 s14, s14, 1
    s_cmp_gt_u32 s14, 400000
    s_cbranch_scc1 .Lend
    s_branch .iw_6
.iwd_7:
    v_lshlrev_b32 v2, 4, v0
    v_add_u32 v3, 259021312, v2
    v_cmp_gt_u32 vcc, 160, v0
    s_and_saveexec_b64 s[16:17], vcc
    s_cbranch_execz .m2l_8
    global_load_dwordx4 v[4:7], v3, s[4:5] sc1
    s_waitcnt vmcnt(0)
    v_add_u32 v2, 131072, v2
    ds_write_b128 v2, v[4:7]
.m2l_8:
    s_mov_b64 exec, -1
    s_waitcnt lgkmcnt(0)
    s_barrier
    v_lshrrev_b32 v2, 4, v1
    v_lshlrev_b32 v2, 4, v2
    v_and_b32 v3, 15, v1
    v_mul_u32_u24 v3, 336, v3
    v_add_u32 v2, v2, v3
    s_mul_i32 s15, s12, 10752
    v_add_u32 v20, s15, v2
    v_add_u32 v2, 0, v0
    v_min_u32 v2, 639, v2
    v_mul_u32_u24 v3, 3277, v2
    v_lshrrev_b32 v3, 16, v3
    v_mul_u32_u24 v4, 20, v3
    v_sub_u32 v4, v2, v4
    v_mul_u32_u24 v5, 336, v3
    v_lshlrev_b32 v6, 4, v4
    v_add_u32 v21, v5, v6
    v_mul_u32_u24 v5, 640, v3
    v_lshlrev_b32 v6, 2, v4
    v_add_u32 v5, v5, v6
    v_add_u32 v24, s20, v5
    v_lshlrev_b32 v27, 4, v4
    v_add_u32 v2, 256, v0
    v_min_u32 v2, 639, v2
    v_mul_u32_u24 v3, 3277, v2
    v_lshrrev_b32 v3, 16, v3
    v_mul_u32_u24 v4, 20, v3
    v_sub_u32 v4, v2, v4
    v_mul_u32_u24 v5, 336, v3
    v_lshlrev_b32 v6, 4, v4
    v_add_u32 v22, v5, v6
    v_mul_u32_u24 v5, 640, v3
    v_lshlrev_b32 v6, 2, v4
    v_add_u32 v5, v5, v6
    v_add_u32 v25, s20, v5
    v_lshlrev_b32 v28, 4, v4
    v_add_u32 v2, 512, v0
    v_min_u32 v2, 639, v2
    v_mul_u32_u24 v3, 3277, v2
    v_lshrrev_b32 v3, 16, v3
    v_mul_u32_u24 v4, 20, v3
    v_sub_u32 v4, v2, v4
    v_mul_u32_u24 v5, 336, v3
    v_lshlrev_b32 v6, 4, v4
    v_add_u32 v23, v5, v6
    v_mul_u32_u24 v5, 640, v3
    v_lshlrev_b32 v6, 2, v4
    v_add_u32 v5, v5, v6
    v_add_u32 v26, s20, v5
    v_lshlrev_b32 v29, 4, v4
    s_lshl_b32 s15, s20, 2
    s_lshl_b32 s22, s20, 1
    v_add_u32 v2, s15, v27
    v_add_u32 v2, 131072, v2
    ds_read_b128 v[32:35], v2
    v_lshrrev_b32 v2, 1, v27
    v_add_u32 v2, s22, v2
    global_load_dwordx2 v[56:57], v2, s[44:45]
    v_add_u32 v2, s15, v28
    v_add_u32 v2, 131072, v2
    ds_read_b128 v[36:39], v2
    v_lshrrev_b32 v2, 1, v28
    v_add_u32 v2, s22, v2
    global_load_dwordx2 v[58:59], v2, s[44:45]
    v_add_u32 v2, s15, v29
    v_add_u32 v2, 131072, v2
    ds_read_b128 v[40:43], v2
    v_lshrrev_b32 v2, 1, v29
    v_add_u32 v2, s22, v2
    global_load_dwordx2 v[60:61], v2, s[44:45]
    s_waitcnt vmcnt(0) lgkmcnt(0)
    v_lshlrev_b32 v44, 16, v56
    v_and_b32 v45, 0xffff0000, v56
    v_lshlrev_b32 v46, 16, v57
    v_and_b32 v47, 0xffff0000, v57
    v_lshlrev_b32 v48, 16, v58
    v_and_b32 v49, 0xffff0000, v58
    v_lshlrev_b32 v50, 16, v59
    v_and_b32 v51, 0xffff0000, v59
    v_lshlrev_b32 v52, 16, v60
    v_and_b32 v53, 0xffff0000, v60
    v_lshlrev_b32 v54, 16, v61
    v_and_b32 v55, 0xffff0000, v61
    s_mul_i32 s15, s12, 24576
    v_lshlrev_b32 v8, 4, v1
    v_add_u32 v8, s15, v8
    v_lshlrev_b32 v9, 3, v1
    v_add_u32 v9, s15, v9
    v_add_u32 v9, 4096, v9
    s_lshl_b32 s16, s12, 10
    s_add_u32 s16, s16, 40960
    v_and_b32 v10, 7, v1
    v_lshlrev_b32 v10, 7, v10
    v_add_u32 v10, s16, v10
    s_cmp_eq_u32 s38, 0
    s_cselect_b32 s16, 0, 4096
    v_add_u32 v10, s16, v10
    s_mov_b32 s35, 43008
    s_mov_b32 s39, 0
    s_mov_b32 s36, 0
.LM2_top:
    s_cmp_eq_u32 s36, 1
    s_cbranch_scc1 .m2h_9
    s_add_u32 s33, s38, 1
.m2w_10:
    global_load_dword v3, v10, s[10:11] sc1
    s_waitcnt vmcnt(0)
    v_cmp_gt_u32 vcc, s33, v3
    s_cbranch_vccz .m2g_11
    s_sleep 2
    s_add_u32 s14, s14, 1
    s_cmp_gt_u32 s14, 400000
    s_cbranch_scc1 .Lend
    s_branch .m2w_10
.m2g_11:
    s_waitcnt vmcnt(0)
    s_mul_i32 s15, s38, 98304
    s_add_u32 s15, s15, 251658240
    s_add_u32 s40, s4, s15
    s_addc_u32 s41, s5, 0
    global_load_dwordx4 v[64:67], v8, s[40:41] offset:0 sc1
    global_load_dwordx4 v[72:75], v8, s[40:41] offset:1024 sc1
    global_load_dwordx4 v[80:83], v8, s[40:41] offset:2048 sc1
    global_load_dwordx4 v[88:91], v8, s[40:41] offset:3072 sc1
    global_load_dwordx2 v[96:97], v9, s[40:41] offset:0 sc1
    global_load_dwordx2 v[98:99], v9, s[40:41] offset:512 sc1
    global_load_dwordx2 v[104:105], v9, s[40:41] offset:1024 sc1
    global_load_dwordx2 v[106:107], v9, s[40:41] offset:1536 sc1
    s_add_u32 s40, s40, 6144
    s_addc_u32 s41, s41, 0
    global_load_dwordx4 v[68:71], v8, s[40:41] offset:0 sc1
    global_load_dwordx4 v[76:79], v8, s[40:41] offset:1024 sc1
    global_load_dwordx4 v[84:87], v8, s[40:41] offset:2048 sc1
    global_load_dwordx4 v[92:95], v8, s[40:41] offset:3072 sc1
    global_load_dwordx2 v[100:101], v9, s[40:41] offset:0 sc1
    global_load_dwordx2 v[102:103], v9, s[40:41] offset:512 sc1
    global_load_dwordx2 v[108:109], v9, s[40:41] offset:1024 sc1
    global_load_dwordx2 v[110:111], v9, s[40:41] offset:1536 sc1
    s_add_u32 s40, s40, 6144
    s_addc_u32 s41, s41, 0
    global_load_dwordx4 v[112:115], v8, s[40:41] offset:0 sc1
    global_load_dwordx4 v[120:123], v8, s[40:41] offset:1024 sc1
    global_load_dwordx4 v[128:131], v8, s[40:41] offset:2048 sc1
    global_load_dwordx4 v[136:139], v8, s[40:41] offset:3072 sc1
    global_load_dwordx2 v[144:145], v9, s[40:41] offset:0 sc1
    global_load_dwordx2 v[146:147], v9, s[40:41] offset:512 sc1
    global_load_dwordx2 v[152:153], v9, s[40:41] offset:1024 sc1
    global_load_dwordx2 v[154:155], v9, s[40:41] offset:1536 sc1
    s_add_u32 s40, s40, 6144
    s_addc_u32 s41, s41, 0
    global_load_dwordx4 v[116:119], v8, s[40:41] offset:0 sc1
    global_load_dwordx4 v[124:127], v8, s[40:41] offset:1024 sc1
    global_load_dwordx4 v[132:135], v8, s[40:41] offset:2048 sc1
    global_load_dwordx4 v[140:143], v8, s[40:41] offset:3072 sc1
    global_load_dwordx2 v[148:149], v9, s[40:41] offset:0 sc1
    global_load_dwordx2 v[150:151], v9, s[40:41] offset:512 sc1
    global_load_dwordx2 v[156:157], v9, s[40:41] offset:1024 sc1
    global_load_dwordx2 v[158:159], v9, s[40:41] offset:1536 sc1
    s_add_u32 s40, s40, 6144
    s_addc_u32 s41, s41, 0
    s_nop 0
    s_nop 0
    s_nop 0
    global_load_dword v11, v10, s[10:11] sc1
    global_load_dword v11, v10, s[10:11] sc1
    global_load_dword v11, v10, s[10:11] sc1
.m2h_9:
    s_mul_i32 s15, s38, 81920
    s_add_u32 s15, s15, 245366784
    v_lshlrev_b32 v2, 2, v24
    v_add_u32 v2, s15, v2
    global_load_dwordx4 a[240:243], v2, s[4:5] sc1
    v_lshlrev_b32 v2, 2, v25
    v_add_u32 v2, s15, v2
    global_load_dwordx4 a[244:247], v2, s[4:5] sc1
    v_lshlrev_b32 v2, 2, v26
    v_add_u32 v2, s15, v2
    global_load_dwordx4 a[248:251], v2, s[4:5] sc1
    global_load_dword v11, v10, s[10:11] sc1
    s_waitcnt vmcnt(31)
    v_mfma_f32_16x16x32_bf16 v[160:163], a[0:3], v[64:67], 0
    v_mfma_f32_16x16x32_bf16 v[164:167], a[4:7], v[64:67], 0
    v_mfma_f32_16x16x32_bf16 v[168:171], a[8:11], v[64:67], 0
    v_mfma_f32_16x16x32_bf16 v[172:175], a[12:15], v[64:67], 0
    v_mfma_f32_16x16x32_bf16 v[176:179], a[16:19], v[64:67], 0
    v_mfma_f32_16x16x32_bf16 v[160:163], a[20:23], v[72:75], v[160:163]
    v_mfma_f32_16x16x32_bf16 v[164:167], a[24:27], v[72:75], v[164:167]
    v_mfma_f32_16x16x32_bf16 v[168:171], a[28:31], v[72:75], v[168:171]
    v_mfma_f32_16x16x32_bf16 v[172:175], a[32:35], v[72:75], v[172:175]
    v_mfma_f32_16x16x32_bf16 v[176:179], a[36:39], v[72:75], v[176:179]
    v_mfma_f32_16x16x32_bf16 v[160:163], a[40:43], v[80:83], v[160:163]
    v_mfma_f32_16x16x32_bf16 v[164:167], a[44:47], v[80:83], v[164:167]
    v_mfma_f32_16x16x32_bf16 v[168:171], a[48:51], v[80:83], v[168:171]
    v_mfma_f32_16x16x32_bf16 v[172:175], a[52:55], v[80:83], v[172:175]
    v_mfma_f32_16x16x32_bf16 v[176:179], a[56:59], v[80:83], v[176:179]
    v_mfma_f32_16x16x32_bf16 v[160:163], a[60:63], v[88:91], v[160:163]
    v_mfma_f32_16x16x32_bf16 v[164:167], a[64:67], v[88:91], v[164:167]
    v_mfma_f32_16x16x32_bf16 v[168:171], a[68:71], v[88:91], v[168:171]
    v_mfma_f32_16x16x32_bf16 v[172:175], a[72:75], v[88:91], v[172:175]
    v_mfma_f32_16x16x32_bf16 v[176:179], a[76:79], v[88:91], v[176:179]
    v_mfma_f32_16x16x32_bf16 v[160:163], a[80:83], v[96:99], v[160:163]
    v_mfma_f32_16x16x32_bf16 v[164:167], a[84:87], v[96:99], v[164:167]
    v_mfma_f32_16x16x32_bf16 v[168:171], a[88:91], v[96:99], v[168:171]
    v_mfma_f32_16x16x32_bf16 v[172:175], a[92:95], v[96:99], v[172:175]
    v_mfma_f32_16x16x32_bf16 v[176:179], a[96:99], v[96:99], v[176:179]
    v_mfma_f32_16x16x32_bf16 v[160:163], a[100:103], v[104:107], v[160:163]
    v_mfma_f32_16x16x32_bf16 v[164:167], a[104:107], v[104:107], v[164:167]
    v_mfma_f32_16x16x32_bf16 v[168:171], a[108:111], v[104:107], v[168:171]
    v_mfma_f32_16x16x32_bf16 v[172:175], a[112:115], v[104:107], v[172:175]
    v_mfma_f32_16x16x32_bf16 v[176:179], a[116:119], v[104:107], v[176:179]
    s_waitcnt vmcnt(23)
    v_mfma_f32_16x16x32_bf16 v[180:183], a[0:3], v[68:71], 0
    v_mfma_f32_16x16x32_bf16 v[184:187], a[4:7], v[68:71], 0
    v_mfma_f32_16x16x32_bf16 v[188:191], a[8:11], v[68:71], 0
    v_mfma_f32_16x16x32_bf16 v[192:195], a[12:15], v[68:71], 0
    v_mfma_f32_16x16x32_bf16 v[196:199], a[16:19], v[68:71], 0
    v_mfma_f32_16x16x32_bf16 v[180:183], a[20:23], v[76:79], v[180:183]
    v_mfma_f32_16x16x32_bf16 v[184:187], a[24:27], v[76:79], v[184:187]
    v_mfma_f32_16x16x32_bf16 v[188:191], a[28:31], v[76:79], v[188:191]
    v_mfma_f32_16x16x32_bf16 v[192:195], a[32:35], v[76:79], v[192:195]
    v_mfma_f32_16x16x32_bf16 v[196:199], a[36:39], v[76:79], v[196:199]
    v_mfma_f32_16x16x32_bf16 v[180:183], a[40:43], v[84:87], v[180:183]
    v_mfma_f32_16x16x32_bf16 v[184:187], a[44:47], v[84:87], v[184:187]
    v_mfma_f32_16x16x32_bf16 v[188:191], a[48:51], v[84:87], v[188:191]
    v_mfma_f32_16x16x32_bf16 v[192:195], a[52:55], v[84:87], v[192:195]
    v_mfma_f32_16x16x32_bf16 v[196:199], a[56:59], v[84:87], v[196:199]
    v_mfma_f32_16x16x32_bf16 v[180:183], a[60:63], v[92:95], v[180:183]
    v_mfma_f32_16x16x32_bf16 v[184:187], a[64:67], v[92:95], v[184:187]
    v_mfma_f32_16x16x32_bf16 v[188:191], a[68:71], v[92:95], v[188:191]
    v_mfma_f32_16x16x32_bf16 v[192:195], a[72:75], v[92:95], v[192:195]
    v_mfma_f32_16x16x32_bf16 v[196:199], a[76:79], v[92:95], v[196:199]
    v_mfma_f32_16x16x32_bf16 v[180:183], a[80:83], v[100:103], v[180:183]
    v_mfma_f32_16x16x32_bf16 v[184:187], a[84:87], v[100:103], v[184:187]
    v_mfma_f32_16x16x32_bf16 v[188:191], a[88:91], v[100:103], v[188:191]
    v_mfma_f32_16x16x32_bf16 v[192:195], a[92:95], v[100:103], v[192:195]
    v_mfma_f32_16x16x32_bf16 v[196:199], a[96:99], v[100:103], v[196:199]
    v_mfma_f32_16x16x32_bf16 v[180:183], a[100:103], v[108:111], v[180:183]
    v_mfma_f32_16x16x32_bf16 v[184:187], a[104:107], v[108:111], v[184:187]
    v_mfma_f32_16x16x32_bf16 v[188:191], a[108:111], v[108:111], v[188:191]
    v_mfma_f32_16x16x32_bf16 v[192:195], a[112:115], v[108:111], v[192:195]
    v_mfma_f32_16x16x32_bf16 v[196:199], a[116:119], v[108:111], v[196:199]
    s_waitcnt vmcnt(15)
    v_mfma_f32_16x16x32_bf16 v[160:163], a[120:123], v[112:115], v[160:163]
    v_mfma_f32_16x16x32_bf16 v[164:167], a[124:127], v[112:115], v[164:167]
    v_mfma_f32_16x16x32_bf16 v[168:171], a[128:131], v[112:115], v[168:171]
    v_mfma_f32_16x16x32_bf16 v[172:175], a[132:135], v[112:115], v[172:175]
    v_mfma_f32_16x16x32_bf16 v[176:179], a[136:139], v[112:115], v[176:179]
    v_mfma_f32_16x16x32_bf16 v[160:163], a[140:143], v[120:123], v[160:163]
    v_mfma_f32_16x16x32_bf16 v[164:167], a[144:147], v[120:123], v[164:167]
    v_mfma_f32_16x16x32_bf16 v[168:171], a[148:151], v[120:123], v[168:171]
    v_mfma_f32_16x16x32_bf16 v[172:175], a[152:155], v[120:123], v[172:175]
    v_mfma_f32_16x16x32_bf16 v[176:179], a[156:159], v[120:123], v[176:179]
    v_mfma_f32_16x16x32_bf16 v[160:163], a[160:163], v[128:131], v[160:163]
    v_mfma_f32_16x16x32_bf16 v[164:167], a[164:167], v[128:131], v[164:167]
    v_mfma_f32_16x16x32_bf16 v[168:171], a[168:171], v[128:131], v[168:171]
    v_mfma_f32_16x16x32_bf16 v[172:175], a[172:175], v[128:131], v[172:175]
    v_mfma_f32_16x16x32_bf16 v[176:179], a[176:179], v[128:131], v[176:179]
    v_mfma_f32_16x16x32_bf16 v[160:163], a[180:183], v[136:139], v[160:163]
    v_mfma_f32_16x16x32_bf16 v[164:167], a[184:187], v[136:139], v[164:167]
    v_mfma_f32_16x16x32_bf16 v[168:171], a[188:191], v[136:139], v[168:171]
    v_mfma_f32_16x16x32_bf16 v[172:175], a[192:195], v[136:139], v[172:175]
    v_mfma_f32_16x16x32_bf16 v[176:179], a[196:199], v[136:139], v[176:179]
    v_mfma_f32_16x16x32_bf16 v[160:163], a[200:203], v[144:147], v[160:163]
    v_mfma_f32_16x16x32_bf16 v[164:167], a[204:207], v[144:147], v[164:167]
    v_mfma_f32_16x16x32_bf16 v[168:171], a[208:211], v[144:147], v[168:171]
    v_mfma_f32_16x16x32_bf16 v[172:175], a[212:215], v[144:147], v[172:175]
    v_mfma_f32_16x16x32_bf16 v[176:179], a[216:219], v[144:147], v[176:179]
    v_mfma_f32_16x16x32_bf16 v[160:163], a[220:223], v[152:155], v[160:163]
    v_mfma_f32_16x16x32_bf16 v[164:167], a[224:227], v[152:155], v[164:167]
    v_mfma_f32_16x16x32_bf16 v[168:171], a[228:231], v[152:155], v[168:171]
    v_mfma_f32_16x16x32_bf16 v[172:175], a[232:235], v[152:155], v[172:175]
    v_mfma_f32_16x16x32_bf16 v[176:179], a[236:239], v[152:155], v[176:179]
    s_waitcnt vmcnt(7)
    v_mfma_f32_16x16x32_bf16 v[180:183], a[120:123], v[116:119], v[180:183]
    v_mfma_f32_16x16x32_bf16 v[184:187], a[124:127], v[116:119], v[184:187]
    v_mfma_f32_16x16x32_bf16 v[188:191], a[128:131], v[116:119], v[188:191]
    v_mfma_f32_16x16x32_bf16 v[192:195], a[132:135], v[116:119], v[192:195]
    v_mfma_f32_16x16x32_bf16 v[196:199], a[136:139], v[116:119], v[196:199]
    v_mfma_f32_16x16x32_bf16 v[180:183], a[140:143], v[124:127], v[180:183]
    v_mfma_f32_16x16x32_bf16 v[184:187], a[144:147], v[124:127], v[184:187]
    v_mfma_f32_16x16x32_bf16 v[188:191], a[148:151], v[124:127], v[188:191]
    v_mfma_f32_16x16x32_bf16 v[192:195], a[152:155], v[124:127], v[192:195]
    v_mfma_f32_16x16x32_bf16 v[196:199], a[156:159], v[124:127], v[196:199]
    v_mfma_f32_16x16x32_bf16 v[180:183], a[160:163], v[132:135], v[180:183]
    v_mfma_f32_16x16x32_bf16 v[184:187], a[164:167], v[132:135], v[184:187]
    v_mfma_f32_16x16x32_bf16 v[188:191], a[168:171], v[132:135], v[188:191]
    v_mfma_f32_16x16x32_bf16 v[192:195], a[172:175], v[132:135], v[192:195]
    v_mfma_f32_16x16x32_bf16 v[196:199], a[176:179], v[132:135], v[196:199]
    v_mfma_f32_16x16x32_bf16 v[180:183], a[180:183], v[140:143], v[180:183]
    v_mfma_f32_16x16x32_bf16 v[184:187], a[184:187], v[140:143], v[184:187]
    v_mfma_f32_16x16x32_bf16 v[188:191], a[188:191], v[140:143], v[188:191]
    v_mfma_f32_16x16x32_bf16 v[192:195], a[192:195], v[140:143], v[192:195]
    v_mfma_f32_16x16x32_bf16 v[196:199], a[196:199], v[140:143], v[196:199]
    v_mfma_f32_16x16x32_bf16 v[180:183], a[200:203], v[148:151], v[180:183]
    v_mfma_f32_16x16x32_bf16 v[184:187], a[204:207], v[148:151], v[184:187]
    v_mfma_f32_16x16x32_bf16 v[188:191], a[208:211], v[148:151], v[188:191]
    v_mfma_f32_16x16x32_bf16 v[192:195], a[212:215], v[148:151], v[192:195]
    v_mfma_f32_16x16x32_bf16 v[196:199], a[216:219], v[148:151], v[196:199]
    v_mfma_f32_16x16x32_bf16 v[180:183], a[220:223], v[156:159], v[180:183]
    v_mfma_f32_16x16x32_bf16 v[184:187], a[224:227], v[156:159], v[184:187]
    v_mfma_f32_16x16x32_bf16 v[188:191], a[228:231], v[156:159], v[188:191]
    v_mfma_f32_16x16x32_bf16 v[192:195], a[232:235], v[156:159], v[192:195]
    v_mfma_f32_16x16x32_bf16 v[196:199], a[236:239], v[156:159], v[196:199]
    s_waitcnt vmcnt(0)
    s_add_u32 s37, s38, 1
    s_cmp_gt_u32 s37, 36
    s_cselect_b32 s15, 1, 0
    s_add_u32 s37, s37, s15
    s_add_u32 s33, s37, 1
    v_cmp_gt_u32 vcc, s33, v11
    s_cmp_eq_u64 vcc, 0
    s_cselect_b32 s36, 1, 0
    s_xor_b32 s39, s39, 43008
    v_xor_b32 v2, 0, v2
    v_add_u32 v20, s35, v20
    v_add_u32 v21, s35, v21
    v_add_u32 v22, s35, v22
    v_add_u32 v23, s35, v23
    s_sub_u32 s35, 0, s35
    ds_write_b128 v20, v[160:163] offset:0
    ds_write_b128 v20, v[164:167] offset:64
    ds_write_b128 v20, v[168:171] offset:128
    ds_write_b128 v20, v[172:175] offset:192
    ds_write_b128 v20, v[176:179] offset:256
    ds_write_b128 v20, v[180:183] offset:5376
    ds_write_b128 v20, v[184:187] offset:5440
    ds_write_b128 v20, v[188:191] offset:5504
    ds_write_b128 v20, v[192:195] offset:5568
    ds_write_b128 v20, v[196:199] offset:5632
    s_cmp_eq_u32 s36, 0
    s_cbranch_scc1 .m2s_12
    s_mul_i32 s15, s37, 98304
    s_add_u32 s15, s15, 251658240
    s_add_u32 s40, s4, s15
    s_addc_u32 s41, s5, 0
    global_load_dwordx4 v[64:67], v8, s[40:41] offset:0 sc1
    global_load_dwordx4 v[72:75], v8, s[40:41] offset:1024 sc1
    global_load_dwordx4 v[80:83], v8, s[40:41] offset:2048 sc1
    global_load_dwordx4 v[88:91], v8, s[40:41] offset:3072 sc1
    global_load_dwordx2 v[96:97], v9, s[40:41] offset:0 sc1
    global_load_dwordx2 v[98:99], v9, s[40:41] offset:512 sc1
    global_load_dwordx2 v[104:105], v9, s[40:41] offset:1024 sc1
    global_load_dwordx2 v[106:107], v9, s[40:41] offset:1536 sc1
    s_add_u32 s40, s40, 6144
    s_addc_u32 s41, s41, 0
    global_load_dwordx4 v[68:71], v8, s[40:41] offset:0 sc1
    global_load_dwordx4 v[76:79], v8, s[40:41] offset:1024 sc1
    global_load_dwordx4 v[84:87], v8, s[40:41] offset:2048 sc1
    global_load_dwordx4 v[92:95], v8, s[40:41] offset:3072 sc1
    global_load_dwordx2 v[100:101], v9, s[40:41] offset:0 sc1
    global_load_dwordx2 v[102:103], v9, s[40:41] offset:512 sc1
    global_load_dwordx2 v[108:109], v9, s[40:41] offset:1024 sc1
    global_load_dwordx2 v[110:111], v9, s[40:41] offset:1536 sc1
    s_add_u32 s40, s40, 6144
    s_addc_u32 s41, s41, 0
    global_load_dwordx4 v[112:115], v8, s[40:41] offset:0 sc1
    global_load_dwordx4 v[120:123], v8, s[40:41] offset:1024 sc1
    global_load_dwordx4 v[128:131], v8, s[40:41] offset:2048 sc1
    global_load_dwordx4 v[136:139], v8, s[40:41] offset:3072 sc1
    global_load_dwordx2 v[144:145], v9, s[40:41] offset:0 sc1
    global_load_dwordx2 v[146:147], v9, s[40:41] offset:512 sc1
    global_load_dwordx2 v[152:153], v9, s[40:41] offset:1024 sc1
    global_load_dwordx2 v[154:155], v9, s[40:41] offset:1536 sc1
    s_add_u32 s40, s40, 6144
    s_addc_u32 s41, s41, 0
    global_load_dwordx4 v[116:119], v8, s[40:41] offset:0 sc1
    global_load_dwordx4 v[124:127], v8, s[40:41] offset:1024 sc1
    global_load_dwordx4 v[132:135], v8, s[40:41] offset:2048 sc1
    global_load_dwordx4 v[140:143], v8, s[40:41] offset:3072 sc1
    global_load_dwordx2 v[148:149], v9, s[40:41] offset:0 sc1
    global_load_dwordx2 v[150:151], v9, s[40:41] offset:512 sc1
    global_load_dwordx2 v[156:157], v9, s[40:41] offset:1024 sc1
    global_load_dwordx2 v[158:159], v9, s[40:41] offset:1536 sc1
    s_add_u32 s40, s40, 6144
    s_addc_u32 s41, s41, 0
.m2s_12:
    s_waitcnt lgkmcnt(0)
    s_barrier
    ds_read_b128 v[200:203], v21 offset:0
    ds_read_b128 v[204:207], v21 offset:10752
    ds_read_b128 v[208:211], v21 offset:21504
    ds_read_b128 v[212:215], v21 offset:32256
    ds_read_b128 v[216:219], v22 offset:0
    ds_read_b128 v[220:223], v22 offset:10752
    ds_read_b128 v[224:227], v22 offset:21504
    ds_read_b128 v[228:231], v22 offset:32256
    ds_read_b128 v[232:235], v23 offset:0
    ds_read_b128 v[236:239], v23 offset:10752
    ds_read_b128 v[240:243], v23 offset:21504
    ds_read_b128 v[244:247], v23 offset:32256
    s_mul_i32 s15, s38, 40960
    v_accvgpr_read_b32 v12, a240
    v_accvgpr_read_b32 v13, a241
    v_accvgpr_read_b32 v14, a242
    v_accvgpr_read_b32 v15, a243
    s_waitcnt lgkmcnt(8)
    v_add_f32 v200, v200, v204
    v_add_f32 v208, v208, v212
    v_add_f32 v200, v200, v208
    v_add_f32 v201, v201, v205
    v_add_f32 v209, v209, v213
    v_add_f32 v201, v201, v209
    v_add_f32 v202, v202, v206
    v_add_f32 v210, v210, v214
    v_add_f32 v202, v202, v210
    v_add_f32 v203, v203, v207
    v_add_f32 v211, v211, v215
    v_add_f32 v203, v203, v211
    v_add_f32 v200, v200, v44
    v_fma_f32 v200, v200, v32, v12
    v_add_f32 v201, v201, v45
    v_fma_f32 v201, v201, v33, v13
    v_add_f32 v202, v202, v46
    v_fma_f32 v202, v202, v34, v14
    v_add_f32 v203, v203, v47
    v_fma_f32 v203, v203, v35, v15
    v_cvt_pk_bf16_f32 v204, v200, v201
    v_cvt_pk_bf16_f32 v205, v202, v203
    v_lshlrev_b32 v2, 1, v24
    v_add_u32 v2, s15, v2
    global_store_dwordx2 v2, v[204:205], s[8:9]
    v_accvgpr_read_b32 v12, a244
    v_accvgpr_read_b32 v13, a245
    v_accvgpr_read_b32 v14, a246
    v_accvgpr_read_b32 v15, a247
    s_waitcnt lgkmcnt(4)
    v_add_f32 v216, v216, v220
    v_add_f32 v224, v224, v228
    v_add_f32 v216, v216, v224
    v_add_f32 v217, v217, v221
    v_add_f32 v225, v225, v229
    v_add_f32 v217, v217, v225
    v_add_f32 v218, v218, v222
    v_add_f32 v226, v226, v230
    v_add_f32 v218, v218, v226
    v_add_f32 v219, v219, v223
    v_add_f32 v227, v227, v231
    v_add_f32 v219, v219, v227
    v_add_f32 v216, v216, v48
    v_fma_f32 v216, v216, v36, v12
    v_add_f32 v217, v217, v49
    v_fma_f32 v217, v217, v37, v13
    v_add_f32 v218, v218, v50
    v_fma_f32 v218, v218, v38, v14
    v_add_f32 v219, v219, v51
    v_fma_f32 v219, v219, v39, v15
    v_cvt_pk_bf16_f32 v220, v216, v217
    v_cvt_pk_bf16_f32 v221, v218, v219
    v_lshlrev_b32 v2, 1, v25
    v_add_u32 v2, s15, v2
    global_store_dwordx2 v2, v[220:221], s[8:9]
    v_accvgpr_read_b32 v12, a248
    v_accvgpr_read_b32 v13, a249
    v_accvgpr_read_b32 v14, a250
    v_accvgpr_read_b32 v15, a251
    s_waitcnt lgkmcnt(0)
    v_add_f32 v232, v232, v236
    v_add_f32 v240, v240, v244
    v_add_f32 v232, v232, v240
    v_add_f32 v233, v233, v237
    v_add_f32 v241, v241, v245
    v_add_f32 v233, v233, v241
    v_add_f32 v234, v234, v238
    v_add_f32 v242, v242, v246
    v_add_f32 v234, v234, v242
    v_add_f32 v235, v235, v239
    v_add_f32 v243, v243, v247
    v_add_f32 v235, v235, v243
    v_add_f32 v232, v232, v52
    v_fma_f32 v232, v232, v40, v12
    v_add_f32 v233, v233, v53
    v_fma_f32 v233, v233, v41, v13
    v_add_f32 v234, v234, v54
    v_fma_f32 v234, v234, v42, v14
    v_add_f32 v235, v235, v55
    v_fma_f32 v235, v235, v43, v15
    v_cvt_pk_bf16_f32 v236, v232, v233
    v_cvt_pk_bf16_f32 v237, v234, v235
    v_lshlrev_b32 v2, 1, v26
    v_add_u32 v2, s15, v2
    global_store_dwordx2 v2, v[236:237], s[8:9]
    s_mov_b32 s38, s37
    s_cmp_lt_u32 s38, 64
    s_cbranch_scc1 .LM2_top
    s_branch .Lend
.Lr_b1:
    s_bitcmp1_b32 s3, 4
    s_cbranch_scc0 .Lend
    s_load_dwordx2 s[18:19], s[0:1], 0
    s_lshr_b32 s38, s13, 3
    s_cmp_eq_u32 s38, 3
    s_cselect_b32 s38, 63, s38
    s_and_b32 s20, s13, 7
    s_mul_i32 s20, s20, 80
    s_lshl_b32 s47, s13, 7
    s_add_u32 s47, s47, 32768
    v_mov_b32 v2, 160
.iw_13:
    global_load_dword v3, v2, s[6:7] sc0 sc1
    s_waitcnt vmcnt(0)
    v_readfirstlane_b32 s15, v3
    s_nop 3
    s_cmp_ge_u32 s15, 64
    s_cbranch_scc1 .iwd_14
    s_sleep 4
    s_add_u32 s14, s14, 1
    s_cmp_gt_u32 s14, 400000
    s_cbranch_scc1 .Lend
    s_branch .iw_13
.iwd_14:
    v_lshlrev_b32 v2, 4, v0
    v_add_u32 v3, 259013632, v2
    v_cmp_gt_u32 vcc, 160, v0
    s_and_saveexec_b64 s[16:17], vcc
    s_cbranch_execz .m2l_15
    global_load_dwordx4 v[4:7], v3, s[4:5] sc1
    s_waitcnt vmcnt(0)
    v_add_u32 v2, 43008, v2
    ds_write_b128 v2, v[4:7]
.m2l_15:
    s_mov_b64 exec, -1
    s_waitcnt lgkmcnt(0)
    s_barrier
    v_lshrrev_b32 v2, 4, v1
    v_lshlrev_b32 v2, 4, v2
    v_and_b32 v3, 15, v1
    v_mul_u32_u24 v3, 336, v3
    v_add_u32 v2, v2, v3
    s_mul_i32 s15, s12, 10752
    v_add_u32 v20, s15, v2
    v_add_u32 v2, 0, v0
    v_min_u32 v2, 639, v2
    v_mul_u32_u24 v3, 3277, v2
    v_lshrrev_b32 v3, 16, v3
    v_mul_u32_u24 v4, 20, v3
    v_sub_u32 v4, v2, v4
    v_mul_u32_u24 v5, 336, v3
    v_lshlrev_b32 v6, 4, v4
    v_add_u32 v21, v5, v6
    v_mul_u32_u24 v5, 640, v3
    v_lshlrev_b32 v6, 2, v4
    v_add_u32 v5, v5, v6
    v_add_u32 v24, s20, v5
    v_lshlrev_b32 v27, 4, v4
    v_add_u32 v2, 256, v0
    v_min_u32 v2, 639, v2
    v_mul_u32_u24 v3, 3277, v2
    v_lshrrev_b32 v3, 16, v3
    v_mul_u32_u24 v4, 20, v3
    v_sub_u32 v4, v2, v4
    v_mul_u32_u24 v5, 336, v3
    v_lshlrev_b32 v6, 4, v4
    v_add_u32 v22, v5, v6
    v_mul_u32_u24 v5, 640, v3
    v_lshlrev_b32 v6, 2, v4
    v_add_u32 v5, v5, v6
    v_add_u32 v25, s20, v5
    v_lshlrev_b32 v28, 4, v4
    v_add_u32 v2, 512, v0
    v_min_u32 v2, 639, v2
    v_mul_u32_u24 v3, 3277, v2
    v_lshrrev_b32 v3, 16, v3
    v_mul_u32_u24 v4, 20, v3
    v_sub_u32 v4, v2, v4
    v_mul_u32_u24 v5, 336, v3
    v_lshlrev_b32 v6, 4, v4
    v_add_u32 v23, v5, v6
    v_mul_u32_u24 v5, 640, v3
    v_lshlrev_b32 v6, 2, v4
    v_add_u32 v5, v5, v6
    v_add_u32 v26, s20, v5
    v_lshlrev_b32 v29, 4, v4
    s_lshl_b32 s15, s20, 2
    v_add_u32 v2, s15, v27
    ds_read_b128 v[32:35], v2 offset:43008
    v_add_u32 v2, s15, v28
    ds_read_b128 v[36:39], v2 offset:43008
    v_add_u32 v2, s15, v29
    ds_read_b128 v[40:43], v2 offset:43008
    v_and_b32 v2, 15, v1
    v_lshrrev_b32 v3, 4, v1
    v_lshlrev_b32 v8, 6, v2
    v_lshlrev_b32 v4, 4, v3
    v_add_u32 v8, v8, v4
    s_lshl_b32 s15, s20, 6
    s_mul_i32 s16, s12, 327680
    s_add_u32 s15, s15, s16
    s_add_u32 s15, s15, 2048
    v_add_u32 v8, s15, v8
    s_mul_i32 s16, s12, 20480
    v_lshlrev_b32 v9, 4, v1
    v_add_u32 v9, s16, v9
    v_mul_u32_u24 v10, 2560, v3
    v_lshlrev_b32 v4, 4, v2
    v_add_u32 v10, v10, v4
    v_add_u32 v10, s16, v10
    v_add_u32 v10, 2048, v10
    v_add_u32 v11, 10240, v10
    v_and_b32 v3, 15, v1
    v_add_u32 v3, s20, v3
    v_add_u32 v3, 0, v3
    v_and_b32 v14, 15, v3
    v_sub_u32 v15, v3, v14
    v_lshlrev_b32 v14, 4, v14
    v_lshlrev_b32 v15, 9, v15
    v_add_u32 v12, v14, v15
    v_mov_b32 v13, 256
    v_add_u32 v6, 32768, v12
    v_mov_b32 v4, v13
    v_lshrrev_b32 v5, 4, v1
    s_lshl_b32 s15, s12, 3
    v_add_u32 v5, s15, v5
    v_mul_lo_u32 v5, v5, v4
    v_add_u32 v44, v6, v5
    v_lshlrev_b32 v4, 2, v4
    v_add_u32 v49, v44, v4
    v_lshrrev_b32 v2, 13, v44
    v_lshlrev_b32 v2, 13, v2
    v_add_u32 v44, v44, v2
    v_lshrrev_b32 v2, 13, v49
    v_lshlrev_b32 v2, 13, v2
    v_add_u32 v49, v49, v2
    v_and_b32 v3, 15, v1
    v_add_u32 v3, s20, v3
    v_add_u32 v3, 16, v3
    v_and_b32 v14, 15, v3
    v_sub_u32 v15, v3, v14
    v_lshlrev_b32 v14, 4, v14
    v_lshlrev_b32 v15, 9, v15
    v_add_u32 v12, v14, v15
    v_mov_b32 v13, 256
    v_add_u32 v6, 32768, v12
    v_mov_b32 v4, v13
    v_lshrrev_b32 v5, 4, v1
    s_lshl_b32 s15, s12, 3
    v_add_u32 v5, s15, v5
    v_mul_lo_u32 v5, v5, v4
    v_add_u32 v45, v6, v5
    v_lshlrev_b32 v4, 2, v4
    v_add_u32 v50, v45, v4
    v_lshrrev_b32 v2, 13, v45
    v_lshlrev_b32 v2, 13, v2
    v_add_u32 v45, v45, v2
    v_lshrrev_b32 v2, 13, v50
    v_lshlrev_b32 v2, 13, v2
    v_add_u32 v50, v50, v2
    v_and_b32 v3, 15, v1
    v_add_u32 v3, s20, v3
    v_add_u32 v3, 32, v3
    v_and_b32 v14, 15, v3
    v_sub_u32 v15, v3, v14
    v_lshlrev_b32 v14, 4, v14
    v_lshlrev_b32 v15, 9, v15
    v_add_u32 v12, v14, v15
    v_mov_b32 v13, 256
    v_add_u32 v6, 32768, v12
    v_mov_b32 v4, v13
    v_lshrrev_b32 v5, 4, v1
    s_lshl_b32 s15, s12, 3
    v_add_u32 v5, s15, v5
    v_mul_lo_u32 v5, v5, v4
    v_add_u32 v46, v6, v5
    v_lshlrev_b32 v4, 2, v4
    v_add_u32 v51, v46, v4
    v_lshrrev_b32 v2, 13, v46
    v_lshlrev_b32 v2, 13, v2
    v_add_u32 v46, v46, v2
    v_lshrrev_b32 v2, 13, v51
    v_lshlrev_b32 v2, 13, v2
    v_add_u32 v51, v51, v2
    v_and_b32 v3, 15, v1
    v_add_u32 v3, s20, v3
    v_add_u32 v3, 48, v3
    v_and_b32 v14, 15, v3
    v_sub_u32 v15, v3, v14
    v_lshlrev_b32 v14, 4, v14
    v_lshlrev_b32 v15, 9, v15
    v_add_u32 v12, v14, v15
    v_mov_b32 v13, 256
    v_add_u32 v6, 32768, v12
    v_mov_b32 v4, v13
    v_lshrrev_b32 v5, 4, v1
    s_lshl_b32 s15, s12, 3
    v_add_u32 v5, s15, v5
    v_mul_lo_u32 v5, v5, v4
    v_add_u32 v47, v6, v5
    v_lshlrev_b32 v4, 2, v4
    v_add_u32 v52, v47, v4
    v_lshrrev_b32 v2, 13, v47
    v_lshlrev_b32 v2, 13, v2
    v_add_u32 v47, v47, v2
    v_lshrrev_b32 v2, 13, v52
    v_lshlrev_b32 v2, 13, v2
    v_add_u32 v52, v52, v2
    v_and_b32 v3, 15, v1
    v_add_u32 v3, s20, v3
    v_add_u32 v3, 64, v3
    v_and_b32 v14, 15, v3
    v_sub_u32 v15, v3, v14
    v_lshlrev_b32 v14, 4, v14
    v_lshlrev_b32 v15, 9, v15
    v_add_u32 v12, v14, v15
    v_mov_b32 v13, 256
    v_add_u32 v6, 32768, v12
    v_mov_b32 v4, v13
    v_lshrrev_b32 v5, 4, v1
    s_lshl_b32 s15, s12, 3
    v_add_u32 v5, s15, v5
    v_mul_lo_u32 v5, v5, v4
    v_add_u32 v48, v6, v5
    v_lshlrev_b32 v4, 2, v4
    v_add_u32 v53, v48, v4
    v_lshrrev_b32 v2, 13, v48
    v_lshlrev_b32 v2, 13, v2
    v_add_u32 v48, v48, v2
    v_lshrrev_b32 v2, 13, v53
    v_lshlrev_b32 v2, 13, v2
    v_add_u32 v53, v53, v2
    v_and_b32 v3, 15, v1
    v_add_u32 v3, s20, v3
    v_add_u32 v3, 0, v3
    v_and_b32 v14, 15, v3
    v_sub_u32 v15, v3, v14
    v_lshlrev_b32 v14, 6, v14
    v_lshlrev_b32 v15, 11, v15
    v_add_u32 v12, v14, v15
    v_mov_b32 v13, 1024
    s_lshl_b32 s15, s12, 3
    v_mul_lo_u32 v14, v13, s15
    v_add_u32 v12, v12, v14
    v_lshrrev_b32 v14, 4, v1
    v_lshlrev_b32 v14, 4, v14
    v_add_u32 v192, v12, v14
    v_mov_b32 v197, v13
    v_and_b32 v3, 15, v1
    v_add_u32 v3, s20, v3
    v_add_u32 v3, 16, v3
    v_and_b32 v14, 15, v3
    v_sub_u32 v15, v3, v14
    v_lshlrev_b32 v14, 6, v14
    v_lshlrev_b32 v15, 11, v15
    v_add_u32 v12, v14, v15
    v_mov_b32 v13, 1024
    s_lshl_b32 s15, s12, 3
    v_mul_lo_u32 v14, v13, s15
    v_add_u32 v12, v12, v14
    v_lshrrev_b32 v14, 4, v1
    v_lshlrev_b32 v14, 4, v14
    v_add_u32 v193, v12, v14
    v_mov_b32 v198, v13
    v_and_b32 v3, 15, v1
    v_add_u32 v3, s20, v3
    v_add_u32 v3, 32, v3
    v_and_b32 v14, 15, v3
    v_sub_u32 v15, v3, v14
    v_lshlrev_b32 v14, 6, v14
    v_lshlrev_b32 v15, 11, v15
    v_add_u32 v12, v14, v15
    v_mov_b32 v13, 1024
    s_lshl_b32 s15, s12, 3
    v_mul_lo_u32 v14, v13, s15
    v_add_u32 v12, v12, v14
    v_lshrrev_b32 v14, 4, v1
    v_lshlrev_b32 v14, 4, v14
    v_add_u32 v194, v12, v14
    v_mov_b32 v199, v13
    v_and_b32 v3, 15, v1
    v_add_u32 v3, s20, v3
    v_add_u32 v3, 48, v3
    v_and_b32 v14, 15, v3
    v_sub_u32 v15, v3, v14
    v_lshlrev_b32 v14, 6, v14
    v_lshlrev_b32 v15, 11, v15
    v_add_u32 v12, v14, v15
    v_mov_b32 v13, 1024
    s_lshl_b32 s15, s12, 3
    v_mul_lo_u32 v14, v13, s15
    v_add_u32 v12, v12, v14
    v_lshrrev_b32 v14, 4, v1
    v_lshlrev_b32 v14, 4, v14
    v_add_u32 v195, v12, v14
    v_mov_b32 v200, v13
    v_and_b32 v3, 15, v1
    v_add_u32 v3, s20, v3
    v_add_u32 v3, 64, v3
    v_and_b32 v14, 15, v3
    v_sub_u32 v15, v3, v14
    v_lshlrev_b32 v14, 6, v14
    v_lshlrev_b32 v15, 11, v15
    v_add_u32 v12, v14, v15
    v_mov_b32 v13, 1024
    s_lshl_b32 s15, s12, 3
    v_mul_lo_u32 v14, v13, s15
    v_add_u32 v12, v12, v14
    v_lshrrev_b32 v14, 4, v1
    v_lshlrev_b32 v14, 4, v14
    v_add_u32 v196, v12, v14
    v_mov_b32 v201, v13
    v_mov_b32 v2, 128
.iw_16:
    global_load_dword v3, v2, s[6:7] sc0 sc1
    s_waitcnt vmcnt(0)
    v_readfirstlane_b32 s15, v3
    s_nop 3
    s_cmp_ge_u32 s15, 64
    s_cbranch_scc1 .iwd_17
    s_sleep 4
    s_add_u32 s14, s14, 1
    s_cmp_gt_u32 s14, 400000
    s_cbranch_scc1 .Lend
    s_branch .iw_16
.iwd_17:
.detw_18:
    v_mov_b32 v2, 72
    global_load_dword v3, v2, s[6:7] sc0 sc1
    s_waitcnt vmcnt(0)
    v_readfirstlane_b32 s60, v3
    s_add_u32 s14, s14, 1
    s_cmp_gt_u32 s14, 400000
    s_cbranch_scc1 .Lend
    s_and_b32 s15, s60, 0xff
    s_cmp_lt_u32 s15, 8
    s_cbranch_scc1 .detw_18
    s_cmp_ge_u32 s60, 0x500
    s_cselect_b32 s15, 8192, 0
    s_add_u32 s15, s15, 0
    s_add_u32 s34, s4, s15
    s_addc_u32 s35, s5, 0
    s_lshl_b32 s15, s20, 11
    s_mul_i32 s16, s12, 40960
    s_add_u32 s15, s15, s16
    v_lshlrev_b32 v207, 7, v1
    v_add_u32 v207, s15, v207
    s_mov_b32 s46, 0
    s_mov_b32 s48, 0
    s_mov_b32 s49, 0
    s_mov_b32 s50, 0
    s_waitcnt lgkmcnt(0)
    s_add_u32 s33, s38, 4
    s_min_u32 s33, s33, 64
    s_cmp_lt_u32 s46, s33
    s_cselect_b32 s46, 0, s46
    s_add_u32 s33, s38, 1
    s_cmp_ge_u32 s46, s33
    s_cbranch_scc1 .wpd_20
    v_and_b32 v2, 7, v1
    v_lshlrev_b32 v2, 7, v2
    v_add_u32 v2, 20480, v2
    s_lshl_b32 s15, s12, 10
    v_add_u32 v2, s15, v2
.wp_19:
    global_load_dword v3, v2, s[10:11] sc1
    s_waitcnt vmcnt(0)
    s_nop 1
    v_min_u32_dpp v3, v3, v3 row_ror:1 row_mask:0xf bank_mask:0xf
    s_nop 1
    v_min_u32_dpp v3, v3, v3 row_ror:2 row_mask:0xf bank_mask:0xf
    s_nop 1
    v_min_u32_dpp v3, v3, v3 row_ror:4 row_mask:0xf bank_mask:0xf
    s_nop 1
    v_readlane_b32 s46, v3, 0
    s_cmp_ge_u32 s46, s33
    s_cbranch_scc1 .wpd_20
    s_sleep 2
    s_add_u32 s14, s14, 1
    s_cmp_gt_u32 s14, 400000
    s_cbranch_scc1 .Lend
    s_branch .wp_19
.wpd_20:
    s_mul_i32 s15, s38, 1310720
    s_add_u32 s15, s15, 69206016
    s_add_u32 s40, s4, s15
    s_addc_u32 s41, s5, 0
    v_mov_b32 v202, v192
    v_mov_b32 v203, v193
    v_mov_b32 v204, v194
    v_mov_b32 v205, v195
    v_mov_b32 v206, v196
    global_load_dwordx4 a[0:3], v202, s[40:41] sc1
    v_add_u32 v202, v202, v197
    global_load_dwordx4 a[4:7], v203, s[40:41] sc1
    v_add_u32 v203, v203, v198
    global_load_dwordx4 a[8:11], v204, s[40:41] sc1
    v_add_u32 v204, v204, v199
    global_load_dwordx4 a[12:15], v205, s[40:41] sc1
    v_add_u32 v205, v205, v200
    global_load_dwordx4 a[16:19], v206, s[40:41] sc1
    v_add_u32 v206, v206, v201
    global_load_dwordx4 a[20:23], v202, s[40:41] sc1
    v_add_u32 v202, v202, v197
    global_load_dwordx4 a[24:27], v203, s[40:41] sc1
    v_add_u32 v203, v203, v198
    global_load_dwordx4 a[28:31], v204, s[40:41] sc1
    v_add_u32 v204, v204, v199
    global_load_dwordx4 a[32:35], v205, s[40:41] sc1
    v_add_u32 v205, v205, v200
    global_load_dwordx4 a[36:39], v206, s[40:41] sc1
    v_add_u32 v206, v206, v201
    global_load_dwordx4 a[40:43], v202, s[40:41] sc1
    v_add_u32 v202, v202, v197
    global_load_dwordx4 a[44:47], v203, s[40:41] sc1
    v_add_u32 v203, v203, v198
    global_load_dwordx4 a[48:51], v204, s[40:41] sc1
    v_add_u32 v204, v204, v199
    global_load_dwordx4 a[52:55], v205, s[40:41] sc1
    v_add_u32 v205, v205, v200
    global_load_dwordx4 a[56:59], v206, s[40:41] sc1
    v_add_u32 v206, v206, v201
    global_load_dwordx4 a[60:63], v202, s[40:41] sc1
    v_add_u32 v202, v202, v197
    global_load_dwordx4 a[64:67], v203, s[40:41] sc1
    v_add_u32 v203, v203, v198
    global_load_dwordx4 a[68:71], v204, s[40:41] sc1
    v_add_u32 v204, v204, v199
    global_load_dwordx4 a[72:75], v205, s[40:41] sc1
    v_add_u32 v205, v205, v200
    global_load_dwordx4 a[76:79], v206, s[40:41] sc1
    v_add_u32 v206, v206, v201
    global_load_dwordx4 a[80:83], v202, s[40:41] sc1
    v_add_u32 v202, v202, v197
    global_load_dwordx4 a[84:87], v203, s[40:41] sc1
    v_add_u32 v203, v203, v198
    global_load_dwordx4 a[88:91], v204, s[40:41] sc1
    v_add_u32 v204, v204, v199
    global_load_dwordx4 a[92:95], v205, s[40:41] sc1
    v_add_u32 v205, v205, v200
    global_load_dwordx4 a[96:99], v206, s[40:41] sc1
    v_add_u32 v206, v206, v201
    global_load_dwordx4 a[100:103], v202, s[40:41] sc1
    v_add_u32 v202, v202, v197
    global_load_dwordx4 a[104:107], v203, s[40:41] sc1
    v_add_u32 v203, v203, v198
    global_load_dwordx4 a[108:111], v204, s[40:41] sc1
    v_add_u32 v204, v204, v199
    global_load_dwordx4 a[112:115], v205, s[40:41] sc1
    v_add_u32 v205, v205, v200
    global_load_dwordx4 a[116:119], v206, s[40:41] sc1
    v_add_u32 v206, v206, v201
    global_load_dwordx4 a[120:123], v202, s[40:41] sc1
    v_add_u32 v202, v202, v197
    global_load_dwordx4 a[124:127], v203, s[40:41] sc1
    v_add_u32 v203, v203, v198
    global_load_dwordx4 a[128:131], v204, s[40:41] sc1
    v_add_u32 v204, v204, v199
    global_load_dwordx4 a[132:135], v205, s[40:41] sc1
    v_add_u32 v205, v205, v200
    global_load_dwordx4 a[136:139], v206, s[40:41] sc1
    v_add_u32 v206, v206, v201
    global_load_dwordx4 a[140:143], v202, s[40:41] sc1
    global_load_dwordx4 a[144:147], v203, s[40:41] sc1
    global_load_dwordx4 a[148:151], v204, s[40:41] sc1
    global_load_dwordx4 a[152:155], v205, s[40:41] sc1
    global_load_dwordx4 a[156:159], v206, s[40:41] sc1
.LB1_top:
    s_add_u32 s33, s38, 1
    s_cmp_ge_u32 s49, s33
    s_cbranch_scc1 .wpd_22
    v_and_b32 v2, 7, v1
    v_lshlrev_b32 v2, 7, v2
    v_add_u32 v2, 28672, v2
    s_lshl_b32 s15, s12, 10
    v_add_u32 v2, s15, v2
.wp_21:
    global_load_dword v3, v2, s[10:11] sc1
    s_waitcnt vmcnt(0)
    s_nop 1
    v_min_u32_dpp v3, v3, v3 row_ror:1 row_mask:0xf bank_mask:0xf
    s_nop 1
    v_min_u32_dpp v3, v3, v3 row_ror:2 row_mask:0xf bank_mask:0xf
    s_nop 1
    v_min_u32_dpp v3, v3, v3 row_ror:4 row_mask:0xf bank_mask:0xf
    s_nop 1
    v_readlane_b32 s49, v3, 0
    s_cmp_ge_u32 s49, s33
    s_cbranch_scc1 .wpd_22
    s_sleep 2
    s_add_u32 s14, s14, 1
    s_cmp_gt_u32 s14, 400000
    s_cbranch_scc1 .Lend
    s_branch .wp_21
.wpd_22:
    s_mul_i32 s15, s38, 81920
    s_add_u32 s15, s15, 232783872
    s_add_u32 s40, s4, s15
    s_addc_u32 s41, s5, 0
    s_lshl_b32 s15, s38, 20
    s_lshr_b32 s16, s38, 1
    s_and_b32 s16, s16, 1
    s_lshl_b32 s16, s16, 13
    s_xor_b32 s42, s34, s16
    s_add_u32 s42, s42, s15
    s_addc_u32 s43, s35, 0
    global_load_dwordx4 a[160:163], v44, s[42:43] sc1
    global_load_dwordx4 a[164:167], v45, s[42:43] sc1
    global_load_dwordx4 a[168:171], v46, s[42:43] sc1
    global_load_dwordx4 a[172:175], v47, s[42:43] sc1
    global_load_dwordx4 a[176:179], v48, s[42:43] sc1
    global_load_dwordx4 a[180:183], v49, s[42:43] sc1
    global_load_dwordx4 a[184:187], v50, s[42:43] sc1
    global_load_dwordx4 a[188:191], v51, s[42:43] sc1
    global_load_dwordx4 a[192:195], v52, s[42:43] sc1
    global_load_dwordx4 a[196:199], v53, s[42:43] sc1
    s_mul_i32 s15, s38, 20480
    v_add_u32 v2, s15, v24
    v_lshlrev_b32 v2, 1, v2
    global_load_dwordx2 v[184:185], v2, s[18:19]
    v_add_u32 v2, s15, v25
    v_lshlrev_b32 v2, 1, v2
    global_load_dwordx2 v[186:187], v2, s[18:19]
    v_add_u32 v2, s15, v26
    v_lshlrev_b32 v2, 1, v2
    global_load_dwordx2 v[188:189], v2, s[18:19]
    s_cmp_ge_u32 s48, s33
    s_cbranch_scc1 .wpd_24
    v_and_b32 v2, 7, v1
    v_lshlrev_b32 v2, 7, v2
    v_add_u32 v2, 24576, v2
    s_lshl_b32 s15, s12, 10
    v_add_u32 v2, s15, v2
.wp_23:
    global_load_dword v3, v2, s[10:11] sc1
    s_waitcnt vmcnt(0)
    s_nop 1
    v_min_u32_dpp v3, v3, v3 row_ror:1 row_mask:0xf bank_mask:0xf
    s_nop 1
    v_min_u32_dpp v3, v3, v3 row_ror:2 row_mask:0xf bank_mask:0xf
    s_nop 1
    v_min_u32_dpp v3, v3, v3 row_ror:4 row_mask:0xf bank_mask:0xf
    s_nop 1
    v_readlane_b32 s48, v3, 0
    s_cmp_ge_u32 s48, s33
    s_cbranch_scc1 .wpd_24
    s_sleep 2
    s_add_u32 s14, s14, 1
    s_cmp_gt_u32 s14, 400000
    s_cbranch_scc1 .Lend
    s_branch .wp_23
.wpd_24:
    global_load_dwordx4 v[128:131], v10, s[40:41] offset:0 sc1
    global_load_dwordx4 v[132:135], v10, s[40:41] offset:256 sc1
    global_load_dwordx4 v[136:139], v11, s[40:41] offset:0 sc1
    global_load_dwordx4 v[140:143], v11, s[40:41] offset:256 sc1
    global_load_dwordx4 v[64:67], v9, s[40:41] offset:0 sc1
    global_load_dwordx4 v[68:71], v9, s[40:41] offset:1024 sc1
    s_add_u32 s40, s40, 2560
    s_addc_u32 s41, s41, 0
    global_load_dwordx4 v[72:75], v9, s[40:41] offset:0 sc1
    global_load_dwordx4 v[76:79], v9, s[40:41] offset:1024 sc1
    s_add_u32 s40, s40, 2560
    s_addc_u32 s41, s41, 0
    global_load_dwordx4 v[80:83], v9, s[40:41] offset:0 sc1
    global_load_dwordx4 v[84:87], v9, s[40:41] offset:1024 sc1
    s_add_u32 s40, s40, 2560
    s_addc_u32 s41, s41, 0
    global_load_dwordx4 v[88:91], v9, s[40:41] offset:0 sc1
    global_load_dwordx4 v[92:95], v9, s[40:41] offset:1024 sc1
    s_add_u32 s40, s40, 2560
    s_addc_u32 s41, s41, 0
    global_load_dwordx4 v[96:99], v9, s[40:41] offset:0 sc1
    global_load_dwordx4 v[100:103], v9, s[40:41] offset:1024 sc1
    s_add_u32 s40, s40, 2560
    s_addc_u32 s41, s41, 0
    global_load_dwordx4 v[104:107], v9, s[40:41] offset:0 sc1
    global_load_dwordx4 v[108:111], v9, s[40:41] offset:1024 sc1
    s_add_u32 s40, s40, 2560
    s_addc_u32 s41, s41, 0
    global_load_dwordx4 v[112:115], v9, s[40:41] offset:0 sc1
    global_load_dwordx4 v[116:119], v9, s[40:41] offset:1024 sc1
    s_add_u32 s40, s40, 2560
    s_addc_u32 s41, s41, 0
    global_load_dwordx4 v[120:123], v9, s[40:41] offset:0 sc1
    global_load_dwordx4 v[124:127], v9, s[40:41] offset:1024 sc1
    s_waitcnt vmcnt(16)
    v_mfma_f32_16x16x32_bf16 v[144:147], a[160:163], v[128:131], 0
    v_mfma_f32_16x16x32_bf16 v[148:151], a[164:167], v[128:131], 0
    v_mfma_f32_16x16x32_bf16 v[152:155], a[168:171], v[128:131], 0
    v_mfma_f32_16x16x32_bf16 v[156:159], a[172:175], v[128:131], 0
    v_mfma_f32_16x16x32_bf16 v[160:163], a[176:179], v[128:131], 0
    v_mfma_f32_16x16x32_bf16 v[164:167], a[160:163], v[132:135], 0
    v_mfma_f32_16x16x32_bf16 v[168:171], a[164:167], v[132:135], 0
    v_mfma_f32_16x16x32_bf16 v[172:175], a[168:171], v[132:135], 0
    v_mfma_f32_16x16x32_bf16 v[176:179], a[172:175], v[132:135], 0
    v_mfma_f32_16x16x32_bf16 v[180:183], a[176:179], v[132:135], 0
    v_mfma_f32_16x16x32_bf16 v[144:147], a[180:183], v[136:139], v[144:147]
    v_mfma_f32_16x16x32_bf16 v[148:151], a[184:187], v[136:139], v[148:151]
    v_mfma_f32_16x16x32_bf16 v[152:155], a[188:191], v[136:139], v[152:155]
    v_mfma_f32_16x16x32_bf16 v[156:159], a[192:195], v[136:139], v[156:159]
    v_mfma_f32_16x16x32_bf16 v[160:163], a[196:199], v[136:139], v[160:163]
    v_mfma_f32_16x16x32_bf16 v[164:167], a[180:183], v[140:143], v[164:167]
    v_mfma_f32_16x16x32_bf16 v[168:171], a[184:187], v[140:143], v[168:171]
    v_mfma_f32_16x16x32_bf16 v[172:175], a[188:191], v[140:143], v[172:175]
    v_mfma_f32_16x16x32_bf16 v[176:179], a[192:195], v[140:143], v[176:179]
    v_mfma_f32_16x16x32_bf16 v[180:183], a[196:199], v[140:143], v[180:183]
    s_waitcnt vmcnt(14)
    v_mfma_f32_16x16x32_bf16 v[144:147], a[0:3], v[64:67], v[144:147]
    v_mfma_f32_16x16x32_bf16 v[148:151], a[4:7], v[64:67], v[148:151]
    v_mfma_f32_16x16x32_bf16 v[152:155], a[8:11], v[64:67], v[152:155]
    v_mfma_f32_16x16x32_bf16 v[156:159], a[12:15], v[64:67], v[156:159]
    v_mfma_f32_16x16x32_bf16 v[160:163], a[16:19], v[64:67], v[160:163]
    v_mfma_f32_16x16x32_bf16 v[164:167], a[0:3], v[68:71], v[164:167]
    v_mfma_f32_16x16x32_bf16 v[168:171], a[4:7], v[68:71], v[168:171]
    v_mfma_f32_16x16x32_bf16 v[172:175], a[8:11], v[68:71], v[172:175]
    v_mfma_f32_16x16x32_bf16 v[176:179], a[12:15], v[68:71], v[176:179]
    v_mfma_f32_16x16x32_bf16 v[180:183], a[16:19], v[68:71], v[180:183]
    s_waitcnt vmcnt(12)
    v_mfma_f32_16x16x32_bf16 v[144:147], a[20:23], v[72:75], v[144:147]
    v_mfma_f32_16x16x32_bf16 v[148:151], a[24:27], v[72:75], v[148:151]
    v_mfma_f32_16x16x32_bf16 v[152:155], a[28:31], v[72:75], v[152:155]
    v_mfma_f32_16x16x32_bf16 v[156:159], a[32:35], v[72:75], v[156:159]
    v_mfma_f32_16x16x32_bf16 v[160:163], a[36:39], v[72:75], v[160:163]
    v_mfma_f32_16x16x32_bf16 v[164:167], a[20:23], v[76:79], v[164:167]
    v_mfma_f32_16x16x32_bf16 v[168:171], a[24:27], v[76:79], v[168:171]
    v_mfma_f32_16x16x32_bf16 v[172:175], a[28:31], v[76:79], v[172:175]
    v_mfma_f32_16x16x32_bf16 v[176:179], a[32:35], v[76:79], v[176:179]
    v_mfma_f32_16x16x32_bf16 v[180:183], a[36:39], v[76:79], v[180:183]
    s_waitcnt vmcnt(10)
    v_mfma_f32_16x16x32_bf16 v[144:147], a[40:43], v[80:83], v[144:147]
    v_mfma_f32_16x16x32_bf16 v[148:151], a[44:47], v[80:83], v[148:151]
    v_mfma_f32_16x16x32_bf16 v[152:155], a[48:51], v[80:83], v[152:155]
    v_mfma_f32_16x16x32_bf16 v[156:159], a[52:55], v[80:83], v[156:159]
    v_mfma_f32_16x16x32_bf16 v[160:163], a[56:59], v[80:83], v[160:163]
    v_mfma_f32_16x16x32_bf16 v[164:167], a[40:43], v[84:87], v[164:167]
    v_mfma_f32_16x16x32_bf16 v[168:171], a[44:47], v[84:87], v[168:171]
    v_mfma_f32_16x16x32_bf16 v[172:175], a[48:51], v[84:87], v[172:175]
    v_mfma_f32_16x16x32_bf16 v[176:179], a[52:55], v[84:87], v[176:179]
    v_mfma_f32_16x16x32_bf16 v[180:183], a[56:59], v[84:87], v[180:183]
    s_waitcnt vmcnt(8)
    v_mfma_f32_16x16x32_bf16 v[144:147], a[60:63], v[88:91], v[144:147]
    v_mfma_f32_16x16x32_bf16 v[148:151], a[64:67], v[88:91], v[148:151]
    v_mfma_f32_16x16x32_bf16 v[152:155], a[68:71], v[88:91], v[152:155]
    v_mfma_f32_16x16x32_bf16 v[156:159], a[72:75], v[88:91], v[156:159]
    v_mfma_f32_16x16x32_bf16 v[160:163], a[76:79], v[88:91], v[160:163]
    v_mfma_f32_16x16x32_bf16 v[164:167], a[60:63], v[92:95], v[164:167]
    v_mfma_f32_16x16x32_bf16 v[168:171], a[64:67], v[92:95], v[168:171]
    v_mfma_f32_16x16x32_bf16 v[172:175], a[68:71], v[92:95], v[172:175]
    v_mfma_f32_16x16x32_bf16 v[176:179], a[72:75], v[92:95], v[176:179]
    v_mfma_f32_16x16x32_bf16 v[180:183], a[76:79], v[92:95], v[180:183]
    s_waitcnt vmcnt(6)
    v_mfma_f32_16x16x32_bf16 v[144:147], a[80:83], v[96:99], v[144:147]
    v_mfma_f32_16x16x32_bf16 v[148:151], a[84:87], v[96:99], v[148:151]
    v_mfma_f32_16x16x32_bf16 v[152:155], a[88:91], v[96:99], v[152:155]
    v_mfma_f32_16x16x32_bf16 v[156:159], a[92:95], v[96:99], v[156:159]
    v_mfma_f32_16x16x32_bf16 v[160:163], a[96:99], v[96:99], v[160:163]
    v_mfma_f32_16x16x32_bf16 v[164:167], a[80:83], v[100:103], v[164:167]
    v_mfma_f32_16x16x32_bf16 v[168:171], a[84:87], v[100:103], v[168:171]
    v_mfma_f32_16x16x32_bf16 v[172:175], a[88:91], v[100:103], v[172:175]
    v_mfma_f32_16x16x32_bf16 v[176:179], a[92:95], v[100:103], v[176:179]
    v_mfma_f32_16x16x32_bf16 v[180:183], a[96:99], v[100:103], v[180:183]
    s_waitcnt vmcnt(4)
    v_mfma_f32_16x16x32_bf16 v[144:147], a[100:103], v[104:107], v[144:147]
    v_mfma_f32_16x16x32_bf16 v[148:151], a[104:107], v[104:107], v[148:151]
    v_mfma_f32_16x16x32_bf16 v[152:155], a[108:111], v[104:107], v[152:155]
    v_mfma_f32_16x16x32_bf16 v[156:159], a[112:115], v[104:107], v[156:159]
    v_mfma_f32_16x16x32_bf16 v[160:163], a[116:119], v[104:107], v[160:163]
    v_mfma_f32_16x16x32_bf16 v[164:167], a[100:103], v[108:111], v[164:167]
    v_mfma_f32_16x16x32_bf16 v[168:171], a[104:107], v[108:111], v[168:171]
    v_mfma_f32_16x16x32_bf16 v[172:175], a[108:111], v[108:111], v[172:175]
    v_mfma_f32_16x16x32_bf16 v[176:179], a[112:115], v[108:111], v[176:179]
    v_mfma_f32_16x16x32_bf16 v[180:183], a[116:119], v[108:111], v[180:183]
    s_waitcnt vmcnt(2)
    v_mfma_f32_16x16x32_bf16 v[144:147], a[120:123], v[112:115], v[144:147]
    v_mfma_f32_16x16x32_bf16 v[148:151], a[124:127], v[112:115], v[148:151]
    v_mfma_f32_16x16x32_bf16 v[152:155], a[128:131], v[112:115], v[152:155]
    v_mfma_f32_16x16x32_bf16 v[156:159], a[132:135], v[112:115], v[156:159]
    v_mfma_f32_16x16x32_bf16 v[160:163], a[136:139], v[112:115], v[160:163]
    v_mfma_f32_16x16x32_bf16 v[164:167], a[120:123], v[116:119], v[164:167]
    v_mfma_f32_16x16x32_bf16 v[168:171], a[124:127], v[116:119], v[168:171]
    v_mfma_f32_16x16x32_bf16 v[172:175], a[128:131], v[116:119], v[172:175]
    v_mfma_f32_16x16x32_bf16 v[176:179], a[132:135], v[116:119], v[176:179]
    v_mfma_f32_16x16x32_bf16 v[180:183], a[136:139], v[116:119], v[180:183]
    s_waitcnt vmcnt(0)
    v_mfma_f32_16x16x32_bf16 v[144:147], a[140:143], v[120:123], v[144:147]
    v_mfma_f32_16x16x32_bf16 v[148:151], a[144:147], v[120:123], v[148:151]
    v_mfma_f32_16x16x32_bf16 v[152:155], a[148:151], v[120:123], v[152:155]
    v_mfma_f32_16x16x32_bf16 v[156:159], a[152:155], v[120:123], v[156:159]
    v_mfma_f32_16x16x32_bf16 v[160:163], a[156:159], v[120:123], v[160:163]
    v_mfma_f32_16x16x32_bf16 v[164:167], a[140:143], v[124:127], v[164:167]
    v_mfma_f32_16x16x32_bf16 v[168:171], a[144:147], v[124:127], v[168:171]
    v_mfma_f32_16x16x32_bf16 v[172:175], a[148:151], v[124:127], v[172:175]
    v_mfma_f32_16x16x32_bf16 v[176:179], a[152:155], v[124:127], v[176:179]
    v_mfma_f32_16x16x32_bf16 v[180:183], a[156:159], v[124:127], v[180:183]
    s_nop 7
    ds_write_b128 v20, v[144:147] offset:0
    ds_write_b128 v20, v[148:151] offset:64
    ds_write_b128 v20, v[152:155] offset:128
    ds_write_b128 v20, v[156:159] offset:192
    ds_write_b128 v20, v[160:163] offset:256
    ds_write_b128 v20, v[164:167] offset:5376
    ds_write_b128 v20, v[168:171] offset:5440
    ds_write_b128 v20, v[172:175] offset:5504
    ds_write_b128 v20, v[176:179] offset:5568
    ds_write_b128 v20, v[180:183] offset:5632
    s_waitcnt lgkmcnt(0) vmcnt(0)
    s_barrier
    s_mul_i32 s15, s38, 81920
    s_add_u32 s15, s15, 245366784
    ds_read_b128 v[64:67], v21 offset:0
    ds_read_b128 v[68:71], v21 offset:10752
    ds_read_b128 v[72:75], v21 offset:21504
    ds_read_b128 v[76:79], v21 offset:32256
    ds_read_b128 v[80:83], v22 offset:0
    ds_read_b128 v[84:87], v22 offset:10752
    ds_read_b128 v[88:91], v22 offset:21504
    ds_read_b128 v[92:95], v22 offset:32256
    ds_read_b128 v[96:99], v23 offset:0
    ds_read_b128 v[100:103], v23 offset:10752
    ds_read_b128 v[104:107], v23 offset:21504
    ds_read_b128 v[108:111], v23 offset:32256
    s_waitcnt lgkmcnt(8)
    v_add_f32 v64, v64, v68
    v_add_f32 v72, v72, v76
    v_add_f32 v64, v64, v72
    v_add_f32 v65, v65, v69
    v_add_f32 v73, v73, v77
    v_add_f32 v65, v65, v73
    v_add_f32 v66, v66, v70
    v_add_f32 v74, v74, v78
    v_add_f32 v66, v66, v74
    v_add_f32 v67, v67, v71
    v_add_f32 v75, v75, v79
    v_add_f32 v67, v67, v75
    v_lshlrev_b32 v68, 16, v184
    v_and_b32 v69, 0xffff0000, v184
    v_lshlrev_b32 v70, 16, v185
    v_and_b32 v71, 0xffff0000, v185
    v_fma_f32 v64, v64, v32, v68
    v_fma_f32 v65, v65, v33, v69
    v_fma_f32 v66, v66, v34, v70
    v_fma_f32 v67, v67, v35, v71
    v_lshlrev_b32 v2, 2, v24
    v_add_u32 v2, s15, v2
    global_store_dwordx4 v2, v[64:67], s[4:5] sc1
    s_waitcnt lgkmcnt(4)
    v_add_f32 v80, v80, v84
    v_add_f32 v88, v88, v92
    v_add_f32 v80, v80, v88
    v_add_f32 v81, v81, v85
    v_add_f32 v89, v89, v93
    v_add_f32 v81, v81, v89
    v_add_f32 v82, v82, v86
    v_add_f32 v90, v90, v94
    v_add_f32 v82, v82, v90
    v_add_f32 v83, v83, v87
    v_add_f32 v91, v91, v95
    v_add_f32 v83, v83, v91
    v_lshlrev_b32 v84, 16, v186
    v_and_b32 v85, 0xffff0000, v186
    v_lshlrev_b32 v86, 16, v187
    v_and_b32 v87, 0xffff0000, v187
    v_fma_f32 v80, v80, v36, v84
    v_fma_f32 v81, v81, v37, v85
    v_fma_f32 v82, v82, v38, v86
    v_fma_f32 v83, v83, v39, v87
    v_lshlrev_b32 v2, 2, v25
    v_add_u32 v2, s15, v2
    global_store_dwordx4 v2, v[80:83], s[4:5] sc1
    s_waitcnt lgkmcnt(0)
    v_add_f32 v96, v96, v100
    v_add_f32 v104, v104, v108
    v_add_f32 v96, v96, v104
    v_add_f32 v97, v97, v101
    v_add_f32 v105, v105, v109
    v_add_f32 v97, v97, v105
    v_add_f32 v98, v98, v102
    v_add_f32 v106, v106, v110
    v_add_f32 v98, v98, v106
    v_add_f32 v99, v99, v103
    v_add_f32 v107, v107, v111
    v_add_f32 v99, v99, v107
    v_lshlrev_b32 v100, 16, v188
    v_and_b32 v101, 0xffff0000, v188
    v_lshlrev_b32 v102, 16, v189
    v_and_b32 v103, 0xffff0000, v189
    v_fma_f32 v96, v96, v40, v100
    v_fma_f32 v97, v97, v41, v101
    v_fma_f32 v98, v98, v42, v102
    v_fma_f32 v99, v99, v43, v103
    v_lshlrev_b32 v2, 2, v26
    v_add_u32 v2, s15, v2
    global_store_dwordx4 v2, v[96:99], s[4:5] sc1
    s_waitcnt vmcnt(0)
    s_barrier
    s_add_u32 s50, s50, 1
    s_cmp_lg_u32 s12, 0
    s_cbranch_scc1 .pub_25
    v_mov_b32 v2, s47
    v_mov_b32 v3, s50
    s_mov_b64 exec, 1
    global_store_dword v2, v3, s[10:11] sc1
    s_mov_b64 exec, -1
.pub_25:
    s_add_u32 s38, s38, 3
    s_cmp_ge_u32 s38, 63
    s_cbranch_scc1 .LB1_fin
    s_add_u32 s33, s38, 4
    s_min_u32 s33, s33, 64
    s_cmp_lt_u32 s46, s33
    s_cselect_b32 s46, 0, s46
    s_add_u32 s33, s38, 1
    s_cmp_ge_u32 s46, s33
    s_cbranch_scc1 .wpd_27
    v_and_b32 v2, 7, v1
    v_lshlrev_b32 v2, 7, v2
    v_add_u32 v2, 20480, v2
    s_lshl_b32 s15, s12, 10
    v_add_u32 v2, s15, v2
.wp_26:
    global_load_dword v3, v2, s[10:11] sc1
    s_waitcnt vmcnt(0)
    s_nop 1
    v_min_u32_dpp v3, v3, v3 row_ror:1 row_mask:0xf bank_mask:0xf
    s_nop 1
    v_min_u32_dpp v3, v3, v3 row_ror:2 row_mask:0xf bank_mask:0xf
    s_nop 1
    v_min_u32_dpp v3, v3, v3 row_ror:4 row_mask:0xf bank_mask:0xf
    s_nop 1
    v_readlane_b32 s46, v3, 0
    s_cmp_ge_u32 s46, s33
    s_cbranch_scc1 .wpd_27
    s_sleep 2
    s_add_u32 s14, s14, 1
    s_cmp_gt_u32 s14, 400000
    s_cbranch_scc1 .Lend
    s_branch .wp_26
.wpd_27:
    s_mul_i32 s15, s38, 1310720
    s_add_u32 s15, s15, 69206016
    s_add_u32 s40, s4, s15
    s_addc_u32 s41, s5, 0
    v_mov_b32 v202, v192
    v_mov_b32 v203, v193
    v_mov_b32 v204, v194
    v_mov_b32 v205, v195
    v_mov_b32 v206, v196
    global_load_dwordx4 a[0:3], v202, s[40:41] sc1
    v_add_u32 v202, v202, v197
    global_load_dwordx4 a[4:7], v203, s[40:41] sc1
    v_add_u32 v203, v203, v198
    global_load_dwordx4 a[8:11], v204, s[40:41] sc1
    v_add_u32 v204, v204, v199
    global_load_dwordx4 a[12:15], v205, s[40:41] sc1
    v_add_u32 v205, v205, v200
    global_load_dwordx4 a[16:19], v206, s[40:41] sc1
    v_add_u32 v206, v206, v201
    global_load_dwordx4 a[20:23], v202, s[40:41] sc1
    v_add_u32 v202, v202, v197
    global_load_dwordx4 a[24:27], v203, s[40:41] sc1
    v_add_u32 v203, v203, v198
    global_load_dwordx4 a[28:31], v204, s[40:41] sc1
    v_add_u32 v204, v204, v199
    global_load_dwordx4 a[32:35], v205, s[40:41] sc1
    v_add_u32 v205, v205, v200
    global_load_dwordx4 a[36:39], v206, s[40:41] sc1
    v_add_u32 v206, v206, v201
    global_load_dwordx4 a[40:43], v202, s[40:41] sc1
    v_add_u32 v202, v202, v197
    global_load_dwordx4 a[44:47], v203, s[40:41] sc1
    v_add_u32 v203, v203, v198
    global_load_dwordx4 a[48:51], v204, s[40:41] sc1
    v_add_u32 v204, v204, v199
    global_load_dwordx4 a[52:55], v205, s[40:41] sc1
    v_add_u32 v205, v205, v200
    global_load_dwordx4 a[56:59], v206, s[40:41] sc1
    v_add_u32 v206, v206, v201
    global_load_dwordx4 a[60:63], v202, s[40:41] sc1
    v_add_u32 v202, v202, v197
    global_load_dwordx4 a[64:67], v203, s[40:41] sc1
    v_add_u32 v203, v203, v198
    global_load_dwordx4 a[68:71], v204, s[40:41] sc1
    v_add_u32 v204, v204, v199
    global_load_dwordx4 a[72:75], v205, s[40:41] sc1
    v_add_u32 v205, v205, v200
    global_load_dwordx4 a[76:79], v206, s[40:41] sc1
    v_add_u32 v206, v206, v201
    global_load_dwordx4 a[80:83], v202, s[40:41] sc1
    v_add_u32 v202, v202, v197
    global_load_dwordx4 a[84:87], v203, s[40:41] sc1
    v_add_u32 v203, v203, v198
    global_load_dwordx4 a[88:91], v204, s[40:41] sc1
    v_add_u32 v204, v204, v199
    global_load_dwordx4 a[92:95], v205, s[40:41] sc1
    v_add_u32 v205, v205, v200
    global_load_dwordx4 a[96:99], v206, s[40:41] sc1
    v_add_u32 v206, v206, v201
    global_load_dwordx4 a[100:103], v202, s[40:41] sc1
    v_add_u32 v202, v202, v197
    global_load_dwordx4 a[104:107], v203, s[40:41] sc1
    v_add_u32 v203, v203, v198
    global_load_dwordx4 a[108:111], v204, s[40:41] sc1
    v_add_u32 v204, v204, v199
    global_load_dwordx4 a[112:115], v205, s[40:41] sc1
    v_add_u32 v205, v205, v200
    global_load_dwordx4 a[116:119], v206, s[40:41] sc1
    v_add_u32 v206, v206, v201
    global_load_dwordx4 a[120:123], v202, s[40:41] sc1
    v_add_u32 v202, v202, v197
    global_load_dwordx4 a[124:127], v203, s[40:41] sc1
    v_add_u32 v203, v203, v198
    global_load_dwordx4 a[128:131], v204, s[40:41] sc1
    v_add_u32 v204, v204, v199
    global_load_dwordx4 a[132:135], v205, s[40:41] sc1
    v_add_u32 v205, v205, v200
    global_load_dwordx4 a[136:139], v206, s[40:41] sc1
    v_add_u32 v206, v206, v201
    global_load_dwordx4 a[140:143], v202, s[40:41] sc1
    global_load_dwordx4 a[144:147], v203, s[40:41] sc1
    global_load_dwordx4 a[148:151], v204, s[40:41] sc1
    global_load_dwordx4 a[152:155], v205, s[40:41] sc1
    global_load_dwordx4 a[156:159], v206, s[40:41] sc1
    s_branch .LB1_top
.LB1_fin:
    s_branch .Lend
.Lr_ln:
    s_bitcmp1_b32 s3, 5
    s_cbranch_scc0 .Lend
    s_sub_u32 s13, s13, 24
    s_lshr_b32 s38, s13, 1
    s_and_b32 s20, s13, 1
    s_lshl_b32 s47, s13, 7
    s_add_u32 s47, s47, 36864
    v_mov_b32 v2, 160
.iw_28:
    global_load_dword v3, v2, s[6:7] sc0 sc1
    s_waitcnt vmcnt(0)
    v_readfirstlane_b32 s15, v3
    s_nop 3
    s_cmp_ge_u32 s15, 64
    s_cbranch_scc1 .iwd_29
    s_sleep 4
    s_add_u32 s14, s14, 1
    s_cmp_gt_u32 s14, 400000
    s_cbranch_scc1 .Lend
    s_branch .iw_28
.iwd_29:
    v_lshlrev_b32 v2, 4, v0
    v_add_u32 v3, 259016192, v2
    global_load_dwordx4 v[4:7], v3, s[4:5] sc1
    s_waitcnt vmcnt(0)
    v_add_u32 v2, 0, v2
    ds_write_b128 v2, v[4:7]
    v_lshlrev_b32 v2, 4, v0
    v_add_u32 v2, 4096, v2
    v_add_u32 v3, 259016192, v2
    v_cmp_gt_u32 vcc, 64, v0
    s_and_saveexec_b64 s[16:17], vcc
    s_cbranch_execz .m2l_30
    global_load_dwordx4 v[4:7], v3, s[4:5] sc1
    s_waitcnt vmcnt(0)
    v_add_u32 v2, 0, v2
    ds_write_b128 v2, v[4:7]
.m2l_30:
    s_mov_b64 exec, -1
    s_waitcnt lgkmcnt(0)
    s_barrier
    v_and_b32 v2, 15, v1
    v_lshlrev_b32 v3, 5, v2
    ds_read_b128 v[64:67], v3 offset:0
    ds_read_b128 v[68:71], v3 offset:16
    ds_read_b128 v[104:107], v3 offset:2560
    ds_read_b128 v[108:111], v3 offset:2576
    ds_read_b128 v[72:75], v3 offset:512
    ds_read_b128 v[76:79], v3 offset:528
    ds_read_b128 v[112:115], v3 offset:3072
    ds_read_b128 v[116:119], v3 offset:3088
    ds_read_b128 v[80:83], v3 offset:1024
    ds_read_b128 v[84:87], v3 offset:1040
    ds_read_b128 v[120:123], v3 offset:3584
    ds_read_b128 v[124:127], v3 offset:3600
    ds_read_b128 v[88:91], v3 offset:1536
    ds_read_b128 v[92:95], v3 offset:1552
    ds_read_b128 v[128:131], v3 offset:4096
    ds_read_b128 v[132:135], v3 offset:4112
    ds_read_b128 v[96:99], v3 offset:2048
    ds_read_b128 v[100:103], v3 offset:2064
    ds_read_b128 v[136:139], v3 offset:4608
    ds_read_b128 v[140:143], v3 offset:4624
    v_lshrrev_b32 v4, 4, v1
    s_lshl_b32 s15, s12, 2
    v_add_u32 v4, s15, v4
    s_lshl_b32 s15, s20, 4
    v_add_u32 v5, s15, v4
    v_mul_u32_u24 v5, 2560, v5
    v_add_u32 v5, v5, v3
    v_lshrrev_b32 v6, 2, v2
    v_lshlrev_b32 v6, 10, v6
    v_and_b32 v7, 3, v2
    v_lshlrev_b32 v7, 8, v7
    v_add_u32 v6, v6, v7
    v_lshlrev_b32 v7, 4, v4
    v_add_u32 v6, v6, v7
    s_mul_i32 s15, s20, 20480
    v_add_u32 v6, s15, v6
    s_mov_b32 s50, 0
    s_waitcnt lgkmcnt(0)
    v_add_f32 v104, 1.0, v104
    v_add_f32 v105, 1.0, v105
    v_add_f32 v106, 1.0, v106
    v_add_f32 v107, 1.0, v107
    v_add_f32 v108, 1.0, v108
    v_add_f32 v109, 1.0, v109
    v_add_f32 v110, 1.0, v110
    v_add_f32 v111, 1.0, v111
    v_add_f32 v112, 1.0, v112
    v_add_f32 v113, 1.0, v113
    v_add_f32 v114, 1.0, v114
    v_add_f32 v115, 1.0, v115
    v_add_f32 v116, 1.0, v116
    v_add_f32 v117, 1.0, v117
    v_add_f32 v118, 1.0, v118
    v_add_f32 v119, 1.0, v119
    v_add_f32 v120, 1.0, v120
    v_add_f32 v121, 1.0, v121
    v_add_f32 v122, 1.0, v122
    v_add_f32 v123, 1.0, v123
    v_add_f32 v124, 1.0, v124
    v_add_f32 v125, 1.0, v125
    v_add_f32 v126, 1.0, v126
    v_add_f32 v127, 1.0, v127
    v_add_f32 v128, 1.0, v128
    v_add_f32 v129, 1.0, v129
    v_add_f32 v130, 1.0, v130
    v_add_f32 v131, 1.0, v131
    v_add_f32 v132, 1.0, v132
    v_add_f32 v133, 1.0, v133
    v_add_f32 v134, 1.0, v134
    v_add_f32 v135, 1.0, v135
    v_add_f32 v136, 1.0, v136
    v_add_f32 v137, 1.0, v137
    v_add_f32 v138, 1.0, v138
    v_add_f32 v139, 1.0, v139
    v_add_f32 v140, 1.0, v140
    v_add_f32 v141, 1.0, v141
    v_add_f32 v142, 1.0, v142
    v_add_f32 v143, 1.0, v143
.LLN_top:
    s_mul_i32 s15, s38, 171
    s_lshr_b32 s15, s15, 9
    s_mul_i32 s16, s15, 3
    s_sub_u32 s16, s38, s16
    s_add_u32 s33, s15, 1
    s_cmp_eq_u32 s38, 63
    s_cselect_b32 s33, 1, s33
    s_cselect_b32 s16, 3, s16
    s_lshl_b32 s16, s16, 10
    s_add_u32 s16, s16, 32768
    v_and_b32 v2, 7, v1
    v_lshlrev_b32 v2, 7, v2
    v_add_u32 v2, s16, v2
.lnw_31:
    global_load_dword v3, v2, s[10:11] sc1
    s_waitcnt vmcnt(0)
    v_cmp_gt_u32 vcc, s33, v3
    s_cbranch_vccz .LLN_go
    s_sleep 2
    s_add_u32 s14, s14, 1
    s_cmp_gt_u32 s14, 400000
    s_cbranch_scc1 .Lend
    s_branch .lnw_31
.LLN_go:
    s_mul_i32 s15, s38, 81920
    s_add_u32 s15, s15, 245366784
    s_add_u32 s40, s4, s15
    s_addc_u32 s41, s5, 0
    s_mul_i32 s15, s38, 40960
    s_add_u32 s15, s15, 242221056
    s_add_u32 s42, s4, s15
    s_addc_u32 s43, s5, 0
    global_load_dwordx4 v[16:19], v5, s[40:41] offset:0 sc1
    global_load_dwordx4 v[20:23], v5, s[40:41] offset:16 sc1
    global_load_dwordx4 v[24:27], v5, s[40:41] offset:512 sc1
    global_load_dwordx4 v[28:31], v5, s[40:41] offset:528 sc1
    global_load_dwordx4 v[32:35], v5, s[40:41] offset:1024 sc1
    global_load_dwordx4 v[36:39], v5, s[40:41] offset:1040 sc1
    global_load_dwordx4 v[40:43], v5, s[40:41] offset:1536 sc1
    global_load_dwordx4 v[44:47], v5, s[40:41] offset:1552 sc1
    global_load_dwordx4 v[48:51], v5, s[40:41] offset:2048 sc1
    global_load_dwordx4 v[52:55], v5, s[40:41] offset:2064 sc1
    s_waitcnt vmcnt(0)
    v_pk_add_f32 v[8:9], v[16:17], v[18:19]
    v_pk_add_f32 v[8:9], v[8:9], v[20:21]
    v_pk_add_f32 v[8:9], v[8:9], v[22:23]
    v_pk_add_f32 v[8:9], v[8:9], v[24:25]
    v_pk_add_f32 v[8:9], v[8:9], v[26:27]
    v_pk_add_f32 v[8:9], v[8:9], v[28:29]
    v_pk_add_f32 v[8:9], v[8:9], v[30:31]
    v_pk_add_f32 v[8:9], v[8:9], v[32:33]
    v_pk_add_f32 v[8:9], v[8:9], v[34:35]
    v_pk_add_f32 v[8:9], v[8:9], v[36:37]
    v_pk_add_f32 v[8:9], v[8:9], v[38:39]
    v_pk_add_f32 v[8:9], v[8:9], v[40:41]
    v_pk_add_f32 v[8:9], v[8:9], v[42:43]
    v_pk_add_f32 v[8:9], v[8:9], v[44:45]
    v_pk_add_f32 v[8:9], v[8:9], v[46:47]
    v_pk_add_f32 v[8:9], v[8:9], v[48:49]
    v_pk_add_f32 v[8:9], v[8:9], v[50:51]
    v_pk_add_f32 v[8:9], v[8:9], v[52:53]
    v_pk_add_f32 v[8:9], v[8:9], v[54:55]
    v_add_f32 v8, v8, v9
    s_nop 1
    v_add_f32_dpp v8, v8, v8 row_ror:8 row_mask:0xf bank_mask:0xf
    s_nop 1
    v_add_f32_dpp v8, v8, v8 row_ror:4 row_mask:0xf bank_mask:0xf
    s_nop 1
    v_add_f32_dpp v8, v8, v8 row_ror:2 row_mask:0xf bank_mask:0xf
    s_nop 1
    v_add_f32_dpp v8, v8, v8 row_ror:1 row_mask:0xf bank_mask:0xf
    v_mul_f32 v8, 0xbacccccd, v8
    v_mov_b32 v9, v8
    v_pk_add_f32 v[16:17], v[16:17], v[8:9]
    v_pk_add_f32 v[18:19], v[18:19], v[8:9]
    v_pk_add_f32 v[20:21], v[20:21], v[8:9]
    v_pk_add_f32 v[22:23], v[22:23], v[8:9]
    v_pk_add_f32 v[24:25], v[24:25], v[8:9]
    v_pk_add_f32 v[26:27], v[26:27], v[8:9]
    v_pk_add_f32 v[28:29], v[28:29], v[8:9]
    v_pk_add_f32 v[30:31], v[30:31], v[8:9]
    v_pk_add_f32 v[32:33], v[32:33], v[8:9]
    v_pk_add_f32 v[34:35], v[34:35], v[8:9]
    v_pk_add_f32 v[36:37], v[36:37], v[8:9]
    v_pk_add_f32 v[38:39], v[38:39], v[8:9]
    v_pk_add_f32 v[40:41], v[40:41], v[8:9]
    v_pk_add_f32 v[42:43], v[42:43], v[8:9]
    v_pk_add_f32 v[44:45], v[44:45], v[8:9]
    v_pk_add_f32 v[46:47], v[46:47], v[8:9]
    v_pk_add_f32 v[48:49], v[48:49], v[8:9]
    v_pk_add_f32 v[50:51], v[50:51], v[8:9]
    v_pk_add_f32 v[52:53], v[52:53], v[8:9]
    v_pk_add_f32 v[54:55], v[54:55], v[8:9]
    v_pk_mul_f32 v[10:11], v[16:17], v[16:17]
    v_pk_fma_f32 v[10:11], v[18:19], v[18:19], v[10:11]
    v_pk_fma_f32 v[10:11], v[20:21], v[20:21], v[10:11]
    v_pk_fma_f32 v[10:11], v[22:23], v[22:23], v[10:11]
    v_pk_fma_f32 v[10:11], v[24:25], v[24:25], v[10:11]
    v_pk_fma_f32 v[10:11], v[26:27], v[26:27], v[10:11]
    v_pk_fma_f32 v[10:11], v[28:29], v[28:29], v[10:11]
    v_pk_fma_f32 v[10:11], v[30:31], v[30:31], v[10:11]
    v_pk_fma_f32 v[10:11], v[32:33], v[32:33], v[10:11]
    v_pk_fma_f32 v[10:11], v[34:35], v[34:35], v[10:11]
    v_pk_fma_f32 v[10:11], v[36:37], v[36:37], v[10:11]
    v_pk_fma_f32 v[10:11], v[38:39], v[38:39], v[10:11]
    v_pk_fma_f32 v[10:11], v[40:41], v[40:41], v[10:11]
    v_pk_fma_f32 v[10:11], v[42:43], v[42:43], v[10:11]
    v_pk_fma_f32 v[10:11], v[44:45], v[44:45], v[10:11]
    v_pk_fma_f32 v[10:11], v[46:47], v[46:47], v[10:11]
    v_pk_fma_f32 v[10:11], v[48:49], v[48:49], v[10:11]
    v_pk_fma_f32 v[10:11], v[50:51], v[50:51], v[10:11]
    v_pk_fma_f32 v[10:11], v[52:53], v[52:53], v[10:11]
    v_pk_fma_f32 v[10:11], v[54:55], v[54:55], v[10:11]
    v_add_f32 v9, v10, v11
    s_nop 1
    v_add_f32_dpp v9, v9, v9 row_ror:8 row_mask:0xf bank_mask:0xf
    s_nop 1
    v_add_f32_dpp v9, v9, v9 row_ror:4 row_mask:0xf bank_mask:0xf
    s_nop 1
    v_add_f32_dpp v9, v9, v9 row_ror:2 row_mask:0xf bank_mask:0xf
    s_nop 1
    v_add_f32_dpp v9, v9, v9 row_ror:1 row_mask:0xf bank_mask:0xf
    v_mov_b32 v10, 0x3727c5ac
    v_fmac_f32 v10, 0x3acccccd, v9
    v_rsq_f32 v10, v10
    s_nop 0
    v_mov_b32 v11, v10
    v_pk_mul_f32 v[16:17], v[16:17], v[10:11]
    v_pk_mul_f32 v[18:19], v[18:19], v[10:11]
    v_pk_mul_f32 v[20:21], v[20:21], v[10:11]
    v_pk_mul_f32 v[22:23], v[22:23], v[10:11]
    v_pk_mul_f32 v[24:25], v[24:25], v[10:11]
    v_pk_mul_f32 v[26:27], v[26:27], v[10:11]
    v_pk_mul_f32 v[28:29], v[28:29], v[10:11]
    v_pk_mul_f32 v[30:31], v[30:31], v[10:11]
    v_pk_mul_f32 v[32:33], v[32:33], v[10:11]
    v_pk_mul_f32 v[34:35], v[34:35], v[10:11]
    v_pk_mul_f32 v[36:37], v[36:37], v[10:11]
    v_pk_mul_f32 v[38:39], v[38:39], v[10:11]
    v_pk_mul_f32 v[40:41], v[40:41], v[10:11]
    v_pk_mul_f32 v[42:43], v[42:43], v[10:11]
    v_pk_mul_f32 v[44:45], v[44:45], v[10:11]
    v_pk_mul_f32 v[46:47], v[46:47], v[10:11]
    v_pk_mul_f32 v[48:49], v[48:49], v[10:11]
    v_pk_mul_f32 v[50:51], v[50:51], v[10:11]
    v_pk_mul_f32 v[52:53], v[52:53], v[10:11]
    v_pk_mul_f32 v[54:55], v[54:55], v[10:11]
    v_pk_fma_f32 v[16:17], v[16:17], v[104:105], v[64:65]
    v_pk_fma_f32 v[18:19], v[18:19], v[106:107], v[66:67]
    v_pk_fma_f32 v[20:21], v[20:21], v[108:109], v[68:69]
    v_pk_fma_f32 v[22:23], v[22:23], v[110:111], v[70:71]
    v_pk_fma_f32 v[24:25], v[24:25], v[112:113], v[72:73]
    v_pk_fma_f32 v[26:27], v[26:27], v[114:115], v[74:75]
    v_pk_fma_f32 v[28:29], v[28:29], v[116:117], v[76:77]
    v_pk_fma_f32 v[30:31], v[30:31], v[118:119], v[78:79]
    v_pk_fma_f32 v[32:33], v[32:33], v[120:121], v[80:81]
    v_pk_fma_f32 v[34:35], v[34:35], v[122:123], v[82:83]
    v_pk_fma_f32 v[36:37], v[36:37], v[124:125], v[84:85]
    v_pk_fma_f32 v[38:39], v[38:39], v[126:127], v[86:87]
    v_pk_fma_f32 v[40:41], v[40:41], v[128:129], v[88:89]
    v_pk_fma_f32 v[42:43], v[42:43], v[130:131], v[90:91]
    v_pk_fma_f32 v[44:45], v[44:45], v[132:133], v[92:93]
    v_pk_fma_f32 v[46:47], v[46:47], v[134:135], v[94:95]
    v_pk_fma_f32 v[48:49], v[48:49], v[136:137], v[96:97]
    v_pk_fma_f32 v[50:51], v[50:51], v[138:139], v[98:99]
    v_pk_fma_f32 v[52:53], v[52:53], v[140:141], v[100:101]
    v_pk_fma_f32 v[54:55], v[54:55], v[142:143], v[102:103]
    v_pk_add_f32 v[8:9], v[16:17], v[18:19]
    v_pk_add_f32 v[8:9], v[8:9], v[20:21]
    v_pk_add_f32 v[8:9], v[8:9], v[22:23]
    v_pk_add_f32 v[8:9], v[8:9], v[24:25]
    v_pk_add_f32 v[8:9], v[8:9], v[26:27]
    v_pk_add_f32 v[8:9], v[8:9], v[28:29]
    v_pk_add_f32 v[8:9], v[8:9], v[30:31]
    v_pk_add_f32 v[8:9], v[8:9], v[32:33]
    v_pk_add_f32 v[8:9], v[8:9], v[34:35]
    v_pk_add_f32 v[8:9], v[8:9], v[36:37]
    v_pk_add_f32 v[8:9], v[8:9], v[38:39]
    v_pk_add_f32 v[8:9], v[8:9], v[40:41]
    v_pk_add_f32 v[8:9], v[8:9], v[42:43]
    v_pk_add_f32 v[8:9], v[8:9], v[44:45]
    v_pk_add_f32 v[8:9], v[8:9], v[46:47]
    v_pk_add_f32 v[8:9], v[8:9], v[48:49]
    v_pk_add_f32 v[8:9], v[8:9], v[50:51]
    v_pk_add_f32 v[8:9], v[8:9], v[52:53]
    v_pk_add_f32 v[8:9], v[8:9], v[54:55]
    v_add_f32 v8, v8, v9
    s_nop 1
    v_add_f32_dpp v8, v8, v8 row_ror:8 row_mask:0xf bank_mask:0xf
    s_nop 1
    v_add_f32_dpp v8, v8, v8 row_ror:4 row_mask:0xf bank_mask:0xf
    s_nop 1
    v_add_f32_dpp v8, v8, v8 row_ror:2 row_mask:0xf bank_mask:0xf
    s_nop 1
    v_add_f32_dpp v8, v8, v8 row_ror:1 row_mask:0xf bank_mask:0xf
    v_mul_f32 v8, 0xbacccccd, v8
    v_mov_b32 v9, v8
    v_pk_add_f32 v[16:17], v[16:17], v[8:9]
    v_pk_add_f32 v[18:19], v[18:19], v[8:9]
    v_pk_add_f32 v[20:21], v[20:21], v[8:9]
    v_pk_add_f32 v[22:23], v[22:23], v[8:9]
    v_pk_add_f32 v[24:25], v[24:25], v[8:9]
    v_pk_add_f32 v[26:27], v[26:27], v[8:9]
    v_pk_add_f32 v[28:29], v[28:29], v[8:9]
    v_pk_add_f32 v[30:31], v[30:31], v[8:9]
    v_pk_add_f32 v[32:33], v[32:33], v[8:9]
    v_pk_add_f32 v[34:35], v[34:35], v[8:9]
    v_pk_add_f32 v[36:37], v[36:37], v[8:9]
    v_pk_add_f32 v[38:39], v[38:39], v[8:9]
    v_pk_add_f32 v[40:41], v[40:41], v[8:9]
    v_pk_add_f32 v[42:43], v[42:43], v[8:9]
    v_pk_add_f32 v[44:45], v[44:45], v[8:9]
    v_pk_add_f32 v[46:47], v[46:47], v[8:9]
    v_pk_add_f32 v[48:49], v[48:49], v[8:9]
    v_pk_add_f32 v[50:51], v[50:51], v[8:9]
    v_pk_add_f32 v[52:53], v[52:53], v[8:9]
    v_pk_add_f32 v[54:55], v[54:55], v[8:9]
    v_pk_mul_f32 v[10:11], v[16:17], v[16:17]
    v_pk_fma_f32 v[10:11], v[18:19], v[18:19], v[10:11]
    v_pk_fma_f32 v[10:11], v[20:21], v[20:21], v[10:11]
    v_pk_fma_f32 v[10:11], v[22:23], v[22:23], v[10:11]
    v_pk_fma_f32 v[10:11], v[24:25], v[24:25], v[10:11]
    v_pk_fma_f32 v[10:11], v[26:27], v[26:27], v[10:11]
    v_pk_fma_f32 v[10:11], v[28:29], v[28:29], v[10:11]
    v_pk_fma_f32 v[10:11], v[30:31], v[30:31], v[10:11]
    v_pk_fma_f32 v[10:11], v[32:33], v[32:33], v[10:11]
    v_pk_fma_f32 v[10:11], v[34:35], v[34:35], v[10:11]
    v_pk_fma_f32 v[10:11], v[36:37], v[36:37], v[10:11]
    v_pk_fma_f32 v[10:11], v[38:39], v[38:39], v[10:11]
    v_pk_fma_f32 v[10:11], v[40:41], v[40:41], v[10:11]
    v_pk_fma_f32 v[10:11], v[42:43], v[42:43], v[10:11]
    v_pk_fma_f32 v[10:11], v[44:45], v[44:45], v[10:11]
    v_pk_fma_f32 v[10:11], v[46:47], v[46:47], v[10:11]
    v_pk_fma_f32 v[10:11], v[48:49], v[48:49], v[10:11]
    v_pk_fma_f32 v[10:11], v[50:51], v[50:51], v[10:11]
    v_pk_fma_f32 v[10:11], v[52:53], v[52:53], v[10:11]
    v_pk_fma_f32 v[10:11], v[54:55], v[54:55], v[10:11]
    v_add_f32 v9, v10, v11
    s_nop 1
    v_add_f32_dpp v9, v9, v9 row_ror:8 row_mask:0xf bank_mask:0xf
    s_nop 1
    v_add_f32_dpp v9, v9, v9 row_ror:4 row_mask:0xf bank_mask:0xf
    s_nop 1
    v_add_f32_dpp v9, v9, v9 row_ror:2 row_mask:0xf bank_mask:0xf
    s_nop 1
    v_add_f32_dpp v9, v9, v9 row_ror:1 row_mask:0xf bank_mask:0xf
    v_mov_b32 v10, 0x3727c5ac
    v_fmac_f32 v10, 0x3acccccd, v9
    v_rsq_f32 v10, v10
    s_nop 0
    v_mov_b32 v11, v10
    v_pk_mul_f32 v[16:17], v[16:17], v[10:11]
    v_pk_mul_f32 v[18:19], v[18:19], v[10:11]
    v_pk_mul_f32 v[20:21], v[20:21], v[10:11]
    v_pk_mul_f32 v[22:23], v[22:23], v[10:11]
    v_pk_mul_f32 v[24:25], v[24:25], v[10:11]
    v_pk_mul_f32 v[26:27], v[26:27], v[10:11]
    v_pk_mul_f32 v[28:29], v[28:29], v[10:11]
    v_pk_mul_f32 v[30:31], v[30:31], v[10:11]
    v_pk_mul_f32 v[32:33], v[32:33], v[10:11]
    v_pk_mul_f32 v[34:35], v[34:35], v[10:11]
    v_pk_mul_f32 v[36:37], v[36:37], v[10:11]
    v_pk_mul_f32 v[38:39], v[38:39], v[10:11]
    v_pk_mul_f32 v[40:41], v[40:41], v[10:11]
    v_pk_mul_f32 v[42:43], v[42:43], v[10:11]
    v_pk_mul_f32 v[44:45], v[44:45], v[10:11]
    v_pk_mul_f32 v[46:47], v[46:47], v[10:11]
    v_pk_mul_f32 v[48:49], v[48:49], v[10:11]
    v_pk_mul_f32 v[50:51], v[50:51], v[10:11]
    v_pk_mul_f32 v[52:53], v[52:53], v[10:11]
    v_pk_mul_f32 v[54:55], v[54:55], v[10:11]
    v_cvt_pk_bf16_f32 v144, v16, v17
    v_cvt_pk_bf16_f32 v145, v18, v19
    v_cvt_pk_bf16_f32 v146, v20, v21
    v_cvt_pk_bf16_f32 v147, v22, v23
    v_cvt_pk_bf16_f32 v148, v24, v25
    v_cvt_pk_bf16_f32 v149, v26, v27
    v_cvt_pk_bf16_f32 v150, v28, v29
    v_cvt_pk_bf16_f32 v151, v30, v31
    v_cvt_pk_bf16_f32 v152, v32, v33
    v_cvt_pk_bf16_f32 v153, v34, v35
    v_cvt_pk_bf16_f32 v154, v36, v37
    v_cvt_pk_bf16_f32 v155, v38, v39
    v_cvt_pk_bf16_f32 v156, v40, v41
    v_cvt_pk_bf16_f32 v157, v42, v43
    v_cvt_pk_bf16_f32 v158, v44, v45
    v_cvt_pk_bf16_f32 v159, v46, v47
    v_cvt_pk_bf16_f32 v160, v48, v49
    v_cvt_pk_bf16_f32 v161, v50, v51
    v_cvt_pk_bf16_f32 v162, v52, v53
    v_cvt_pk_bf16_f32 v163, v54, v55
    global_store_dwordx4 v6, v[144:147], s[42:43] sc1
    s_add_u32 s42, s42, 4096
    s_addc_u32 s43, s43, 0
    global_store_dwordx4 v6, v[148:151], s[42:43] sc1
    s_add_u32 s42, s42, 4096
    s_addc_u32 s43, s43, 0
    global_store_dwordx4 v6, v[152:155], s[42:43] sc1
    s_add_u32 s42, s42, 4096
    s_addc_u32 s43, s43, 0
    global_store_dwordx4 v6, v[156:159], s[42:43] sc1
    s_add_u32 s42, s42, 4096
    s_addc_u32 s43, s43, 0
    global_store_dwordx4 v6, v[160:163], s[42:43] sc1
    s_waitcnt vmcnt(0)
    s_barrier
    s_add_u32 s50, s50, 1
    s_cmp_lg_u32 s12, 0
    s_cbranch_scc1 .pub_32
    v_mov_b32 v2, s47
    v_mov_b32 v3, s50
    s_mov_b64 exec, 1
    global_store_dword v2, v3, s[10:11] sc1
    s_mov_b64 exec, -1
.pub_32:
    s_add_u32 s38, s38, 2
    s_cmp_lt_u32 s38, 64
    s_cbranch_scc1 .LLN_top
    s_branch .Lend
.Lr_m1:
    s_bitcmp1_b32 s3, 6
    s_cbranch_scc0 .Lend
    s_sub_u32 s13, s13, 28
    s_mov_b32 s38, 0
    s_mov_b32 s91, 0
.Lr_m1h:
    s_bitcmp1_b32 s3, 6
    s_cbranch_scc0 .Lend
    s_lshl_b32 s26, s13, 9
    s_lshl_b32 s16, s91, 12
    s_add_u32 s26, s26, s16
    s_add_u32 s26, s26, 40960
    s_load_dwordx2 s[20:21], s[0:1], 64
    s_mul_i32 s16, s13, 384
    s_waitcnt lgkmcnt(0)
    s_add_u32 s20, s20, s16
    s_addc_u32 s21, s21, 0
    v_lshrrev_b32 v16, 4, v1
    v_mul_u32_u24 v17, 3072, v16
    v_bfe_u32 v18, v1, 2, 2
    v_lshlrev_b32 v19, 7, v18
    v_add_u32 v17, v17, v19
    v_and_b32 v19, 3, v1
    v_lshlrev_b32 v19, 3, v19
    v_add_u32 v17, v17, v19
    v_lshrrev_b32 v18, 1, v18
    v_and_b32 v16, 1, v16
    v_lshlrev_b32 v16, 1, v16
    v_or_b32 v18, v18, v16
    v_xor_b32 v19, 0, v18
    v_lshlrev_b32 v19, 5, v19
    v_add_u32 v8, v17, v19
    v_xor_b32 v19, 1, v18
    v_lshlrev_b32 v19, 5, v19
    v_add_u32 v9, v17, v19
    v_xor_b32 v19, 2, v18
    v_lshlrev_b32 v19, 5, v19
    v_add_u32 v10, v17, v19
    v_xor_b32 v19, 3, v18
    v_lshlrev_b32 v19, 5, v19
    v_add_u32 v11, v17, v19
    s_cmp_lg_u32 s12, 0
    s_cbranch_scc1 .pw_33
    v_add_u32 v20, 0, v8
    v_add_u32 v21, 512, v9
    v_add_u32 v22, 0, v9
    v_add_u32 v23, 512, v8
    v_add_u32 v24, 0, v10
    v_add_u32 v25, 512, v11
.pw_33:
    s_cmp_lg_u32 s12, 1
    s_cbranch_scc1 .pw_34
    v_add_u32 v20, 0, v11
    v_add_u32 v21, 512, v10
    v_add_u32 v22, 1024, v8
    v_add_u32 v23, 1536, v9
    v_add_u32 v24, 1024, v9
    v_add_u32 v25, 1536, v8
.pw_34:
    s_cmp_lg_u32 s12, 2
    s_cbranch_scc1 .pw_35
    v_add_u32 v20, 1024, v10
    v_add_u32 v21, 1536, v11
    v_add_u32 v22, 1024, v11
    v_add_u32 v23, 1536, v10
    v_add_u32 v24, 2048, v8
    v_add_u32 v25, 2560, v9
.pw_35:
    s_cmp_lg_u32 s12, 3
    s_cbranch_scc1 .pw_36
    v_add_u32 v20, 2048, v9
    v_add_u32 v21, 2560, v8
    v_add_u32 v22, 2048, v10
    v_add_u32 v23, 2560, v11
    v_add_u32 v24, 2048, v11
    v_add_u32 v25, 2560, v10
.pw_36:
    v_lshrrev_b32 v2, 3, v1
    v_mul_u32_u24 v3, 3072, v2
    v_lshrrev_b32 v4, 1, v2
    v_lshrrev_b32 v5, 2, v2
    v_xor_b32 v4, v4, v5
    v_and_b32 v4, 1, v4
    v_lshlrev_b32 v4, 1, v4
    v_and_b32 v5, 7, v1
    v_xor_b32 v4, v4, v5
    v_xor_b32 v5, 4, v4
    v_lshlrev_b32 v4, 4, v4
    v_lshlrev_b32 v5, 4, v5
    v_add_u32 v4, v4, v3
    v_add_u32 v5, v5, v3
    s_mul_i32 s15, s12, 98304
    s_add_u32 s20, s20, s15
    s_addc_u32 s21, s21, 0
    s_mul_i32 s17, s12, 12288
    s_add_u32 m0, s17, 0
    s_nop 0
    global_load_lds_dwordx4 v4, s[20:21] offset:0
    s_add_u32 m0, s17, 896
    s_nop 0
    global_load_lds_dwordx4 v4, s[20:21] offset:128
    s_add_u32 m0, s17, 1792
    s_nop 0
    global_load_lds_dwordx4 v4, s[20:21] offset:256
    s_add_u32 s20, s20, 24576
    s_addc_u32 s21, s21, 0
    s_add_u32 m0, s17, 3072
    s_nop 0
    global_load_lds_dwordx4 v5, s[20:21] offset:0
    s_add_u32 m0, s17, 3968
    s_nop 0
    global_load_lds_dwordx4 v5, s[20:21] offset:128
    s_add_u32 m0, s17, 4864
    s_nop 0
    global_load_lds_dwordx4 v5, s[20:21] offset:256
    s_add_u32 s20, s20, 24576
    s_addc_u32 s21, s21, 0
    s_add_u32 m0, s17, 6144
    s_nop 0
    global_load_lds_dwordx4 v4, s[20:21] offset:0
    s_add_u32 m0, s17, 7040
    s_nop 0
    global_load_lds_dwordx4 v4, s[20:21] offset:128
    s_add_u32 m0, s17, 7936
    s_nop 0
    global_load_lds_dwordx4 v4, s[20:21] offset:256
    s_add_u32 s20, s20, 24576
    s_addc_u32 s21, s21, 0
    s_add_u32 m0, s17, 9216
    s_nop 0
    global_load_lds_dwordx4 v5, s[20:21] offset:0
    s_add_u32 m0, s17, 10112
    s_nop 0
    global_load_lds_dwordx4 v5, s[20:21] offset:128
    s_add_u32 m0, s17, 11008
    s_nop 0
    global_load_lds_dwordx4 v5, s[20:21] offset:256
    s_add_u32 s20, s20, 319488
    s_addc_u32 s21, s21, 0
    s_waitcnt vmcnt(0)
    s_barrier
    s_add_u32 m0, s17, 49152
    s_nop 0
    global_load_lds_dwordx4 v4, s[20:21] offset:0
    s_add_u32 m0, s17, 50048
    s_nop 0
    global_load_lds_dwordx4 v4, s[20:21] offset:128
    s_add_u32 m0, s17, 50944
    s_nop 0
    global_load_lds_dwordx4 v4, s[20:21] offset:256
    s_add_u32 s20, s20, 24576
    s_addc_u32 s21, s21, 0
    s_add_u32 m0, s17, 52224
    s_nop 0
    global_load_lds_dwordx4 v5, s[20:21] offset:0
    s_add_u32 m0, s17, 53120
    s_nop 0
    global_load_lds_dwordx4 v5, s[20:21] offset:128
    s_add_u32 m0, s17, 54016
    s_nop 0
    global_load_lds_dwordx4 v5, s[20:21] offset:256
    s_add_u32 s20, s20, 24576
    s_addc_u32 s21, s21, 0
    s_add_u32 m0, s17, 55296
    s_nop 0
    global_load_lds_dwordx4 v4, s[20:21] offset:0
    s_add_u32 m0, s17, 56192
    s_nop 0
    global_load_lds_dwordx4 v4, s[20:21] offset:128
    s_add_u32 m0, s17, 57088
    s_nop 0
    global_load_lds_dwordx4 v4, s[20:21] offset:256
    s_add_u32 s20, s20, 24576
    s_addc_u32 s21, s21, 0
    s_add_u32 m0, s17, 58368
    s_nop 0
    global_load_lds_dwordx4 v5, s[20:21] offset:0
    s_add_u32 m0, s17, 59264
    s_nop 0
    global_load_lds_dwordx4 v5, s[20:21] offset:128
    s_add_u32 m0, s17, 60160
    s_nop 0
    global_load_lds_dwordx4 v5, s[20:21] offset:256
    s_add_u32 s20, s20, 319488
    s_addc_u32 s21, s21, 0
    v_add_u32 v26, 0, v20
    v_add_u32 v27, 0, v21
    v_add_u32 v28, 0, v22
    v_add_u32 v29, 0, v23
    v_add_u32 v30, 0, v24
    v_add_u32 v31, 0, v25
    ds_read_b64_tr_b16 a[0:1], v26 offset:0
    ds_read_b64_tr_b16 a[2:3], v27 offset:0
    ds_read_b64_tr_b16 a[4:5], v28 offset:0
    ds_read_b64_tr_b16 a[6:7], v29 offset:0
    ds_read_b64_tr_b16 a[8:9], v30 offset:0
    ds_read_b64_tr_b16 a[10:11], v31 offset:0
    ds_read_b64_tr_b16 a[12:13], v26 offset:12288
    ds_read_b64_tr_b16 a[14:15], v27 offset:12288
    ds_read_b64_tr_b16 a[16:17], v28 offset:12288
    ds_read_b64_tr_b16 a[18:19], v29 offset:12288
    ds_read_b64_tr_b16 a[20:21], v30 offset:12288
    ds_read_b64_tr_b16 a[22:23], v31 offset:12288
    ds_read_b64_tr_b16 a[24:25], v26 offset:24576
    ds_read_b64_tr_b16 a[26:27], v27 offset:24576
    ds_read_b64_tr_b16 a[28:29], v28 offset:24576
    ds_read_b64_tr_b16 a[30:31], v29 offset:24576
    ds_read_b64_tr_b16 a[32:33], v30 offset:24576
    ds_read_b64_tr_b16 a[34:35], v31 offset:24576
    ds_read_b64_tr_b16 a[36:37], v26 offset:36864
    ds_read_b64_tr_b16 a[38:39], v27 offset:36864
    ds_read_b64_tr_b16 a[40:41], v28 offset:36864
    ds_read_b64_tr_b16 a[42:43], v29 offset:36864
    ds_read_b64_tr_b16 a[44:45], v30 offset:36864
    ds_read_b64_tr_b16 a[46:47], v31 offset:36864
    s_waitcnt lgkmcnt(0)
    s_waitcnt vmcnt(0)
    s_barrier
    s_add_u32 m0, s17, 0
    s_nop 0
    global_load_lds_dwordx4 v4, s[20:21] offset:0
    s_add_u32 m0, s17, 896
    s_nop 0
    global_load_lds_dwordx4 v4, s[20:21] offset:128
    s_add_u32 m0, s17, 1792
    s_nop 0
    global_load_lds_dwordx4 v4, s[20:21] offset:256
    s_add_u32 s20, s20, 24576
    s_addc_u32 s21, s21, 0
    s_add_u32 m0, s17, 3072
    s_nop 0
    global_load_lds_dwordx4 v5, s[20:21] offset:0
    s_add_u32 m0, s17, 3968
    s_nop 0
    global_load_lds_dwordx4 v5, s[20:21] offset:128
    s_add_u32 m0, s17, 4864
    s_nop 0
    global_load_lds_dwordx4 v5, s[20:21] offset:256
    s_add_u32 s20, s20, 24576
    s_addc_u32 s21, s21, 0
    s_add_u32 m0, s17, 6144
    s_nop 0
    global_load_lds_dwordx4 v4, s[20:21] offset:0
    s_add_u32 m0, s17, 7040
    s_nop 0
    global_load_lds_dwordx4 v4, s[20:21] offset:128
    s_add_u32 m0, s17, 7936
    s_nop 0
    global_load_lds_dwordx4 v4, s[20:21] offset:256
    s_add_u32 s20, s20, 24576
    s_addc_u32 s21, s21, 0
    s_add_u32 m0, s17, 9216
    s_nop 0
    global_load_lds_dwordx4 v5, s[20:21] offset:0
    s_add_u32 m0, s17, 10112
    s_nop 0
    global_load_lds_dwordx4 v5, s[20:21] offset:128
    s_add_u32 m0, s17, 11008
    s_nop 0
    global_load_lds_dwordx4 v5, s[20:21] offset:256
    s_add_u32 s20, s20, 319488
    s_addc_u32 s21, s21, 0
    v_add_u32 v26, 49152, v20
    v_add_u32 v27, 49152, v21
    v_add_u32 v28, 49152, v22
    v_add_u32 v29, 49152, v23
    v_add_u32 v30, 49152, v24
    v_add_u32 v31, 49152, v25
    ds_read_b64_tr_b16 a[48:49], v26 offset:0
    ds_read_b64_tr_b16 a[50:51], v27 offset:0
    ds_read_b64_tr_b16 a[52:53], v28 offset:0
    ds_read_b64_tr_b16 a[54:55], v29 offset:0
    ds_read_b64_tr_b16 a[56:57], v30 offset:0
    ds_read_b64_tr_b16 a[58:59], v31 offset:0
    ds_read_b64_tr_b16 a[60:61], v26 offset:12288
    ds_read_b64_tr_b16 a[62:63], v27 offset:12288
    ds_read_b64_tr_b16 a[64:65], v28 offset:12288
    ds_read_b64_tr_b16 a[66:67], v29 offset:12288
    ds_read_b64_tr_b16 a[68:69], v30 offset:12288
    ds_read_b64_tr_b16 a[70:71], v31 offset:12288
    ds_read_b64_tr_b16 a[72:73], v26 offset:24576
    ds_read_b64_tr_b16 a[74:75], v27 offset:24576
    ds_read_b64_tr_b16 a[76:77], v28 offset:24576
    ds_read_b64_tr_b16 a[78:79], v29 offset:24576
    ds_read_b64_tr_b16 a[80:81], v30 offset:24576
    ds_read_b64_tr_b16 a[82:83], v31 offset:24576
    ds_read_b64_tr_b16 a[84:85], v26 offset:36864
    ds_read_b64_tr_b16 a[86:87], v27 offset:36864
    ds_read_b64_tr_b16 a[88:89], v28 offset:36864
    ds_read_b64_tr_b16 a[90:91], v29 offset:36864
    ds_read_b64_tr_b16 a[92:93], v30 offset:36864
    ds_read_b64_tr_b16 a[94:95], v31 offset:36864
    s_waitcnt lgkmcnt(0)
    s_waitcnt vmcnt(0)
    s_barrier
    s_add_u32 m0, s17, 49152
    s_nop 0
    global_load_lds_dwordx4 v4, s[20:21] offset:0
    s_add_u32 m0, s17, 50048
    s_nop 0
    global_load_lds_dwordx4 v4, s[20:21] offset:128
    s_add_u32 m0, s17, 50944
    s_nop 0
    global_load_lds_dwordx4 v4, s[20:21] offset:256
    s_add_u32 s20, s20, 24576
    s_addc_u32 s21, s21, 0
    s_add_u32 m0, s17, 52224
    s_nop 0
    global_load_lds_dwordx4 v5, s[20:21] offset:0
    s_add_u32 m0, s17, 53120
    s_nop 0
    global_load_lds_dwordx4 v5, s[20:21] offset:128
    s_add_u32 m0, s17, 54016
    s_nop 0
    global_load_lds_dwordx4 v5, s[20:21] offset:256
    s_add_u32 s20, s20, 24576
    s_addc_u32 s21, s21, 0
    s_add_u32 m0, s17, 55296
    s_nop 0
    global_load_lds_dwordx4 v4, s[20:21] offset:0
    s_add_u32 m0, s17, 56192
    s_nop 0
    global_load_lds_dwordx4 v4, s[20:21] offset:128
    s_add_u32 m0, s17, 57088
    s_nop 0
    global_load_lds_dwordx4 v4, s[20:21] offset:256
    s_add_u32 s20, s20, 24576
    s_addc_u32 s21, s21, 0
    s_add_u32 m0, s17, 58368
    s_nop 0
    global_load_lds_dwordx4 v5, s[20:21] offset:0
    s_add_u32 m0, s17, 59264
    s_nop 0
    global_load_lds_dwordx4 v5, s[20:21] offset:128
    s_add_u32 m0, s17, 60160
    s_nop 0
    global_load_lds_dwordx4 v5, s[20:21] offset:256
    s_add_u32 s20, s20, 319488
    s_addc_u32 s21, s21, 0
    v_add_u32 v26, 0, v20
    v_add_u32 v27, 0, v21
    v_add_u32 v28, 0, v22
    v_add_u32 v29, 0, v23
    v_add_u32 v30, 0, v24
    v_add_u32 v31, 0, v25
    ds_read_b64_tr_b16 a[96:97], v26 offset:0
    ds_read_b64_tr_b16 a[98:99], v27 offset:0
    ds_read_b64_tr_b16 a[100:101], v28 offset:0
    ds_read_b64_tr_b16 a[102:103], v29 offset:0
    ds_read_b64_tr_b16 a[104:105], v30 offset:0
    ds_read_b64_tr_b16 a[106:107], v31 offset:0
    ds_read_b64_tr_b16 a[108:109], v26 offset:12288
    ds_read_b64_tr_b16 a[110:111], v27 offset:12288
    ds_read_b64_tr_b16 a[112:113], v28 offset:12288
    ds_read_b64_tr_b16 a[114:115], v29 offset:12288
    ds_read_b64_tr_b16 a[116:117], v30 offset:12288
    ds_read_b64_tr_b16 a[118:119], v31 offset:12288
    ds_read_b64_tr_b16 a[120:121], v26 offset:24576
    ds_read_b64_tr_b16 a[122:123], v27 offset:24576
    ds_read_b64_tr_b16 a[124:125], v28 offset:24576
    ds_read_b64_tr_b16 a[126:127], v29 offset:24576
    ds_read_b64_tr_b16 a[128:129], v30 offset:24576
    ds_read_b64_tr_b16 a[130:131], v31 offset:24576
    ds_read_b64_tr_b16 a[132:133], v26 offset:36864
    ds_read_b64_tr_b16 a[134:135], v27 offset:36864
    ds_read_b64_tr_b16 a[136:137], v28 offset:36864
    ds_read_b64_tr_b16 a[138:139], v29 offset:36864
    ds_read_b64_tr_b16 a[140:141], v30 offset:36864
    ds_read_b64_tr_b16 a[142:143], v31 offset:36864
    s_waitcnt lgkmcnt(0)
    s_waitcnt vmcnt(0)
    s_barrier
    s_add_u32 m0, s17, 0
    s_nop 0
    global_load_lds_dwordx4 v4, s[20:21] offset:0
    s_add_u32 m0, s17, 896
    s_nop 0
    global_load_lds_dwordx4 v4, s[20:21] offset:128
    s_add_u32 m0, s17, 1792
    s_nop 0
    global_load_lds_dwordx4 v4, s[20:21] offset:256
    s_add_u32 s20, s20, 24576
    s_addc_u32 s21, s21, 0
    s_add_u32 m0, s17, 3072
    s_nop 0
    global_load_lds_dwordx4 v5, s[20:21] offset:0
    s_add_u32 m0, s17, 3968
    s_nop 0
    global_load_lds_dwordx4 v5, s[20:21] offset:128
    s_add_u32 m0, s17, 4864
    s_nop 0
    global_load_lds_dwordx4 v5, s[20:21] offset:256
    s_add_u32 s20, s20, 24576
    s_addc_u32 s21, s21, 0
    s_add_u32 m0, s17, 6144
    s_nop 0
    global_load_lds_dwordx4 v4, s[20:21] offset:0
    s_add_u32 m0, s17, 7040
    s_nop 0
    global_load_lds_dwordx4 v4, s[20:21] offset:128
    s_add_u32 m0, s17, 7936
    s_nop 0
    global_load_lds_dwordx4 v4, s[20:21] offset:256
    s_add_u32 s20, s20, 24576
    s_addc_u32 s21, s21, 0
    s_add_u32 m0, s17, 9216
    s_nop 0
    global_load_lds_dwordx4 v5, s[20:21] offset:0
    s_add_u32 m0, s17, 10112
    s_nop 0
    global_load_lds_dwordx4 v5, s[20:21] offset:128
    s_add_u32 m0, s17, 11008
    s_nop 0
    global_load_lds_dwordx4 v5, s[20:21] offset:256
    s_add_u32 s20, s20, 319488
    s_addc_u32 s21, s21, 0
    v_add_u32 v26, 49152, v20
    v_add_u32 v27, 49152, v21
    v_add_u32 v28, 49152, v22
    v_add_u32 v29, 49152, v23
    v_add_u32 v30, 49152, v24
    v_add_u32 v31, 49152, v25
    ds_read_b64_tr_b16 a[144:145], v26 offset:0
    ds_read_b64_tr_b16 a[146:147], v27 offset:0
    ds_read_b64_tr_b16 a[148:149], v28 offset:0
    ds_read_b64_tr_b16 a[150:151], v29 offset:0
    ds_read_b64_tr_b16 a[152:153], v30 offset:0
    ds_read_b64_tr_b16 a[154:155], v31 offset:0
    ds_read_b64_tr_b16 a[156:157], v26 offset:12288
    ds_read_b64_tr_b16 a[158:159], v27 offset:12288
    ds_read_b64_tr_b16 a[160:161], v28 offset:12288
    ds_read_b64_tr_b16 a[162:163], v29 offset:12288
    ds_read_b64_tr_b16 a[164:165], v30 offset:12288
    ds_read_b64_tr_b16 a[166:167], v31 offset:12288
    ds_read_b64_tr_b16 a[168:169], v26 offset:24576
    ds_read_b64_tr_b16 a[170:171], v27 offset:24576
    ds_read_b64_tr_b16 a[172:173], v28 offset:24576
    ds_read_b64_tr_b16 a[174:175], v29 offset:24576
    ds_read_b64_tr_b16 a[176:177], v30 offset:24576
    ds_read_b64_tr_b16 a[178:179], v31 offset:24576
    ds_read_b64_tr_b16 a[180:181], v26 offset:36864
    ds_read_b64_tr_b16 a[182:183], v27 offset:36864
    ds_read_b64_tr_b16 a[184:185], v28 offset:36864
    ds_read_b64_tr_b16 a[186:187], v29 offset:36864
    ds_read_b64_tr_b16 a[188:189], v30 offset:36864
    ds_read_b64_tr_b16 a[190:191], v31 offset:36864
    s_waitcnt lgkmcnt(0)
    s_waitcnt vmcnt(0)
    s_barrier
    v_add_u32 v26, 0, v20
    v_add_u32 v27, 0, v21
    v_add_u32 v28, 0, v22
    v_add_u32 v29, 0, v23
    v_add_u32 v30, 0, v24
    v_add_u32 v31, 0, v25
    ds_read_b64_tr_b16 a[192:193], v26 offset:0
    ds_read_b64_tr_b16 a[194:195], v27 offset:0
    ds_read_b64_tr_b16 a[196:197], v28 offset:0
    ds_read_b64_tr_b16 a[198:199], v29 offset:0
    ds_read_b64_tr_b16 a[200:201], v30 offset:0
    ds_read_b64_tr_b16 a[202:203], v31 offset:0
    ds_read_b64_tr_b16 a[204:205], v26 offset:12288
    ds_read_b64_tr_b16 a[206:207], v27 offset:12288
    ds_read_b64_tr_b16 a[208:209], v28 offset:12288
    ds_read_b64_tr_b16 a[210:211], v29 offset:12288
    ds_read_b64_tr_b16 a[212:213], v30 offset:12288
    ds_read_b64_tr_b16 a[214:215], v31 offset:12288
    ds_read_b64_tr_b16 a[216:217], v26 offset:24576
    ds_read_b64_tr_b16 a[218:219], v27 offset:24576
    ds_read_b64_tr_b16 a[220:221], v28 offset:24576
    ds_read_b64_tr_b16 a[222:223], v29 offset:24576
    ds_read_b64_tr_b16 a[224:225], v30 offset:24576
    ds_read_b64_tr_b16 a[226:227], v31 offset:24576
    ds_read_b64_tr_b16 a[228:229], v26 offset:36864
    ds_read_b64_tr_b16 a[230:231], v27 offset:36864
    ds_read_b64_tr_b16 a[232:233], v28 offset:36864
    ds_read_b64_tr_b16 a[234:235], v29 offset:36864
    ds_read_b64_tr_b16 a[236:237], v30 offset:36864
    ds_read_b64_tr_b16 a[238:239], v31 offset:36864
    s_waitcnt lgkmcnt(0)
    s_barrier
    s_load_dwordx2 s[28:29], s[0:1], 72
    v_lshrrev_b32 v2, 4, v1
    v_lshlrev_b32 v2, 3, v2
    s_mul_i32 s15, s13, 384
    s_mul_i32 s16, s12, 96
    s_add_u32 s15, s15, s16
    v_add_u32 v2, s15, v2
    s_waitcnt lgkmcnt(0)
    global_load_dwordx2 v[52:53], v2, s[28:29] offset:0
    global_load_dwordx2 v[54:55], v2, s[28:29] offset:32
    global_load_dwordx2 v[56:57], v2, s[28:29] offset:64
    s_waitcnt vmcnt(0)
    v_lshlrev_b32 v40, 16, v52
    v_and_b32 v41, 0xffff0000, v52
    v_lshlrev_b32 v42, 16, v53
    v_and_b32 v43, 0xffff0000, v53
    v_lshlrev_b32 v44, 16, v54
    v_and_b32 v45, 0xffff0000, v54
    v_lshlrev_b32 v46, 16, v55
    v_and_b32 v47, 0xffff0000, v55
    v_lshlrev_b32 v48, 16, v56
    v_and_b32 v49, 0xffff0000, v56
    v_lshlrev_b32 v50, 16, v57
    v_and_b32 v51, 0xffff0000, v57
    v_lshlrev_b32 v4, 4, v1
    s_mul_i32 s15, s12, 10240
    v_add_u32 v5, s15, v4
    s_lshl_b32 s15, s12, 10
    v_add_u32 v6, s15, v4
    v_lshlrev_b32 v7, 3, v1
    s_lshl_b32 s15, s12, 9
    s_add_u32 s15, s15, 4096
    v_add_u32 v7, s15, v7
    v_add_u32 v32, 40960, v4
    s_mul_i32 s30, s12, 10240
    s_mov_b32 s31, 0
    s_mov_b32 s32, 0
    v_and_b32 v34, 1, v1
    v_lshlrev_b32 v34, 7, v34
    s_lshl_b32 s15, s12, 7
    s_add_u32 s15, s15, s26
    v_mov_b32 v35, s15
    v_mov_b32 v37, 0xc0135761
    s_mov_b32 s36, 0
    v_mov_b32 v38, 0xbdd2d3e8
    s_mov_b32 s31, s38
    s_mov_b32 s39, 0
.Lm1_top:
    s_waitcnt vmcnt(0)
    v_mov_b32 v36, s39
    s_mov_b64 exec, 1
    global_store_dword v35, v36, s[10:11] sc1
    s_mov_b64 exec, -1
    s_cmp_ge_u32 s31, 64
    s_cbranch_scc1 .Lm1_end
    s_cmp_eq_u32 s36, 1
    s_cbranch_scc1 .m1h_37
    s_and_b32 s15, s31, 1
    s_lshl_b32 s15, s15, 8
    s_add_u32 s15, s15, 36864
    v_add_u32 v33, s15, v34
    s_lshr_b32 s33, s31, 1
    s_add_u32 s33, s33, 1
.m1w_38:
    global_load_dword v3, v33, s[10:11] sc1
    s_waitcnt vmcnt(0)
    v_cmp_gt_u32 vcc, s33, v3
    s_cbranch_vccz .m1g_39
    s_sleep 2
    s_add_u32 s14, s14, 1
    s_cmp_gt_u32 s14, 400000
    s_cbranch_scc1 .Lend
    s_branch .m1w_38
.m1g_39:
    s_mul_i32 s15, s31, 40960
    s_add_u32 s15, s15, 242221056
    s_add_u32 s22, s4, s15
    s_addc_u32 s23, s5, 0
    s_add_u32 m0, s30, 0
    s_nop 0
    global_load_lds_dwordx4 v5, s[22:23] offset:0 sc1
    global_load_lds_dwordx4 v5, s[22:23] offset:1024 sc1
    global_load_lds_dwordx4 v5, s[22:23] offset:2048 sc1
    global_load_lds_dwordx4 v5, s[22:23] offset:3072 sc1
    s_add_u32 m0, s30, 4096
    v_add_u32 v5, 4096, v5
    global_load_lds_dwordx4 v5, s[22:23] offset:0 sc1
    global_load_lds_dwordx4 v5, s[22:23] offset:1024 sc1
    global_load_lds_dwordx4 v5, s[22:23] offset:2048 sc1
    global_load_lds_dwordx4 v5, s[22:23] offset:3072 sc1
    s_add_u32 m0, s30, 8192
    v_add_u32 v5, 4096, v5
    global_load_lds_dwordx4 v5, s[22:23] offset:0 sc1
    global_load_lds_dwordx4 v5, s[22:23] offset:1024 sc1
    v_subrev_u32 v5, 8192, v5
    s_waitcnt vmcnt(0)
    s_waitcnt vmcnt(0)
.m1h_37:
    s_barrier
    s_add_u32 s37, s31, 1
    s_cmp_gt_u32 s37, 36
    s_cselect_b32 s15, 1, 0
    s_add_u32 s37, s37, s15
    s_and_b32 s15, s37, 1
    s_lshl_b32 s15, s15, 8
    s_add_u32 s15, s15, 36864
    v_add_u32 v33, s15, v34
    s_lshr_b32 s33, s37, 1
    s_add_u32 s33, s33, 1
    global_load_dword v39, v33, s[10:11] sc1
    s_mul_i32 s15, s37, 40960
    s_add_u32 s15, s15, 242221056
    s_add_u32 s22, s4, s15
    s_addc_u32 s23, s5, 0
    s_lshl_b32 s15, s31, 3
    s_add_u32 s15, s15, s13
    s_mul_i32 s15, s15, 12288
    s_add_u32 s15, s15, 251658240
    s_add_u32 s24, s4, s15
    s_addc_u32 s25, s5, 0
    s_add_u32 s34, s24, 6144
    s_addc_u32 s35, s25, 0
    ds_read_b128 v[128:131], v4 offset:0
    ds_read_b128 v[132:135], v4 offset:1024
    ds_read_b128 v[136:139], v4 offset:2048
    ds_read_b128 v[140:143], v4 offset:3072
    ds_read_b128 v[144:147], v4 offset:4096
    ds_read_b128 v[148:151], v4 offset:5120
    ds_read_b128 v[152:155], v4 offset:6144
    ds_read_b128 v[156:159], v4 offset:7168
    s_waitcnt lgkmcnt(7)
    v_mfma_f32_16x16x32_bf16 v[64:67], a[0:3], v[128:131], 0
    v_mfma_f32_16x16x32_bf16 v[68:71], a[4:7], v[128:131], 0
    v_mfma_f32_16x16x32_bf16 v[72:75], a[8:11], v[128:131], 0
    ds_read_b128 v[128:131], v4 offset:8192
    s_waitcnt lgkmcnt(7)
    v_mfma_f32_16x16x32_bf16 v[64:67], a[12:15], v[132:135], v[64:67]
    v_mfma_f32_16x16x32_bf16 v[68:71], a[16:19], v[132:135], v[68:71]
    v_mfma_f32_16x16x32_bf16 v[72:75], a[20:23], v[132:135], v[72:75]
    ds_read_b128 v[132:135], v4 offset:9216
    s_waitcnt lgkmcnt(7)
    v_mfma_f32_16x16x32_bf16 v[64:67], a[24:27], v[136:139], v[64:67]
    v_mfma_f32_16x16x32_bf16 v[68:71], a[28:31], v[136:139], v[68:71]
    v_mfma_f32_16x16x32_bf16 v[72:75], a[32:35], v[136:139], v[72:75]
    ds_read_b128 v[136:139], v4 offset:10240
    s_waitcnt lgkmcnt(7)
    v_mfma_f32_16x16x32_bf16 v[64:67], a[36:39], v[140:143], v[64:67]
    v_mfma_f32_16x16x32_bf16 v[68:71], a[40:43], v[140:143], v[68:71]
    v_mfma_f32_16x16x32_bf16 v[72:75], a[44:47], v[140:143], v[72:75]
    ds_read_b128 v[140:143], v4 offset:11264
    s_waitcnt lgkmcnt(7)
    v_mfma_f32_16x16x32_bf16 v[64:67], a[48:51], v[144:147], v[64:67]
    v_mfma_f32_16x16x32_bf16 v[68:71], a[52:55], v[144:147], v[68:71]
    v_mfma_f32_16x16x32_bf16 v[72:75], a[56:59], v[144:147], v[72:75]
    ds_read_b128 v[144:147], v4 offset:12288
    s_waitcnt lgkmcnt(7)
    v_mfma_f32_16x16x32_bf16 v[64:67], a[60:63], v[148:151], v[64:67]
    v_mfma_f32_16x16x32_bf16 v[68:71], a[64:67], v[148:151], v[68:71]
    v_mfma_f32_16x16x32_bf16 v[72:75], a[68:71], v[148:151], v[72:75]
    ds_read_b128 v[148:151], v4 offset:13312
    s_waitcnt lgkmcnt(7)
    v_mfma_f32_16x16x32_bf16 v[64:67], a[72:75], v[152:155], v[64:67]
    v_mfma_f32_16x16x32_bf16 v[68:71], a[76:79], v[152:155], v[68:71]
    v_mfma_f32_16x16x32_bf16 v[72:75], a[80:83], v[152:155], v[72:75]
    ds_read_b128 v[152:155], v4 offset:14336
    s_waitcnt lgkmcnt(7)
    v_mfma_f32_16x16x32_bf16 v[64:67], a[84:87], v[156:159], v[64:67]
    v_mfma_f32_16x16x32_bf16 v[68:71], a[88:91], v[156:159], v[68:71]
    v_mfma_f32_16x16x32_bf16 v[72:75], a[92:95], v[156:159], v[72:75]
    ds_read_b128 v[156:159], v4 offset:15360
    s_waitcnt lgkmcnt(7)
    v_mfma_f32_16x16x32_bf16 v[64:67], a[96:99], v[128:131], v[64:67]
    v_mfma_f32_16x16x32_bf16 v[68:71], a[100:103], v[128:131], v[68:71]
    v_mfma_f32_16x16x32_bf16 v[72:75], a[104:107], v[128:131], v[72:75]
    ds_read_b128 v[128:131], v4 offset:16384
    s_waitcnt lgkmcnt(7)
    v_mfma_f32_16x16x32_bf16 v[64:67], a[108:111], v[132:135], v[64:67]
    v_mfma_f32_16x16x32_bf16 v[68:71], a[112:115], v[132:135], v[68:71]
    v_mfma_f32_16x16x32_bf16 v[72:75], a[116:119], v[132:135], v[72:75]
    s_waitcnt vmcnt(0)
    v_cmp_gt_u32 vcc, s33, v39
    s_cmp_eq_u64 vcc, 0
    s_cselect_b32 s36, 1, 0
    s_cmp_ge_u32 s37, 64
    s_cselect_b32 s36, 0, s36
    ds_read_b128 v[132:135], v4 offset:17408
    s_waitcnt lgkmcnt(7)
    v_mfma_f32_16x16x32_bf16 v[64:67], a[120:123], v[136:139], v[64:67]
    v_mfma_f32_16x16x32_bf16 v[68:71], a[124:127], v[136:139], v[68:71]
    v_mfma_f32_16x16x32_bf16 v[72:75], a[128:131], v[136:139], v[72:75]
    s_cmp_eq_u32 s36, 0
    s_cbranch_scc1 .m1s_40
    s_add_u32 m0, s30, 40960
    s_nop 0
    global_load_lds_dwordx4 v5, s[22:23] offset:0 sc1
.m1s_40:
    ds_read_b128 v[136:139], v4 offset:18432
    s_waitcnt lgkmcnt(7)
    v_mfma_f32_16x16x32_bf16 v[64:67], a[132:135], v[140:143], v[64:67]
    v_mfma_f32_16x16x32_bf16 v[68:71], a[136:139], v[140:143], v[68:71]
    v_mfma_f32_16x16x32_bf16 v[72:75], a[140:143], v[140:143], v[72:75]
    s_cmp_eq_u32 s36, 0
    s_cbranch_scc1 .m1s_41
    global_load_lds_dwordx4 v5, s[22:23] offset:1024 sc1
.m1s_41:
    ds_read_b128 v[140:143], v4 offset:19456
    s_waitcnt lgkmcnt(7)
    v_mfma_f32_16x16x32_bf16 v[64:67], a[144:147], v[144:147], v[64:67]
    v_mfma_f32_16x16x32_bf16 v[68:71], a[148:151], v[144:147], v[68:71]
    v_mfma_f32_16x16x32_bf16 v[72:75], a[152:155], v[144:147], v[72:75]
    s_cmp_eq_u32 s36, 0
    s_cbranch_scc1 .m1s_42
    global_load_lds_dwordx4 v5, s[22:23] offset:2048 sc1
.m1s_42:
    ds_read_b128 v[144:147], v4 offset:20480
    s_waitcnt lgkmcnt(7)
    v_mfma_f32_16x16x32_bf16 v[64:67], a[156:159], v[148:151], v[64:67]
    v_mfma_f32_16x16x32_bf16 v[68:71], a[160:163], v[148:151], v[68:71]
    v_mfma_f32_16x16x32_bf16 v[72:75], a[164:167], v[148:151], v[72:75]
    s_cmp_eq_u32 s36, 0
    s_cbranch_scc1 .m1s_43
    global_load_lds_dwordx4 v5, s[22:23] offset:3072 sc1
.m1s_43:
    ds_read_b128 v[148:151], v4 offset:21504
    s_waitcnt lgkmcnt(7)
    v_mfma_f32_16x16x32_bf16 v[64:67], a[168:171], v[152:155], v[64:67]
    v_mfma_f32_16x16x32_bf16 v[68:71], a[172:175], v[152:155], v[68:71]
    v_mfma_f32_16x16x32_bf16 v[72:75], a[176:179], v[152:155], v[72:75]
    s_cmp_eq_u32 s36, 0
    s_cbranch_scc1 .m1s_44
    s_add_u32 m0, s30, 45056
    v_add_u32 v5, 4096, v5
    global_load_lds_dwordx4 v5, s[22:23] offset:0 sc1
.m1s_44:
    ds_read_b128 v[152:155], v4 offset:22528
    s_waitcnt lgkmcnt(7)
    v_mfma_f32_16x16x32_bf16 v[64:67], a[180:183], v[156:159], v[64:67]
    v_mfma_f32_16x16x32_bf16 v[68:71], a[184:187], v[156:159], v[68:71]
    v_mfma_f32_16x16x32_bf16 v[72:75], a[188:191], v[156:159], v[72:75]
    s_cmp_eq_u32 s36, 0
    s_cbranch_scc1 .m1s_45
    global_load_lds_dwordx4 v5, s[22:23] offset:1024 sc1
.m1s_45:
    ds_read_b128 v[156:159], v4 offset:23552
    s_waitcnt lgkmcnt(7)
    v_mfma_f32_16x16x32_bf16 v[64:67], a[192:195], v[128:131], v[64:67]
    v_mfma_f32_16x16x32_bf16 v[68:71], a[196:199], v[128:131], v[68:71]
    v_mfma_f32_16x16x32_bf16 v[72:75], a[200:203], v[128:131], v[72:75]
    s_cmp_eq_u32 s36, 0
    s_cbranch_scc1 .m1s_46
    global_load_lds_dwordx4 v5, s[22:23] offset:2048 sc1
.m1s_46:
    ds_read_b128 v[128:131], v4 offset:24576
    s_waitcnt lgkmcnt(7)
    v_mfma_f32_16x16x32_bf16 v[64:67], a[204:207], v[132:135], v[64:67]
    v_mfma_f32_16x16x32_bf16 v[68:71], a[208:211], v[132:135], v[68:71]
    v_mfma_f32_16x16x32_bf16 v[72:75], a[212:215], v[132:135], v[72:75]
    s_cmp_eq_u32 s36, 0
    s_cbranch_scc1 .m1s_47
    global_load_lds_dwordx4 v5, s[22:23] offset:3072 sc1
.m1s_47:
    ds_read_b128 v[132:135], v4 offset:25600
    s_waitcnt lgkmcnt(7)
    v_mfma_f32_16x16x32_bf16 v[64:67], a[216:219], v[136:139], v[64:67]
    v_mfma_f32_16x16x32_bf16 v[68:71], a[220:223], v[136:139], v[68:71]
    v_mfma_f32_16x16x32_bf16 v[72:75], a[224:227], v[136:139], v[72:75]
    s_cmp_eq_u32 s36, 0
    s_cbranch_scc1 .m1s_48
    s_add_u32 m0, s30, 49152
    v_add_u32 v5, 4096, v5
    global_load_lds_dwordx4 v5, s[22:23] offset:0 sc1
.m1s_48:
    ds_read_b128 v[136:139], v4 offset:26624
    s_waitcnt lgkmcnt(7)
    v_mfma_f32_16x16x32_bf16 v[64:67], a[228:231], v[140:143], v[64:67]
    v_mfma_f32_16x16x32_bf16 v[68:71], a[232:235], v[140:143], v[68:71]
    v_mfma_f32_16x16x32_bf16 v[72:75], a[236:239], v[140:143], v[72:75]
    s_cmp_eq_u32 s36, 0
    s_cbranch_scc1 .m1s_49
    global_load_lds_dwordx4 v5, s[22:23] offset:1024 sc1
    v_subrev_u32 v5, 8192, v5
.m1s_49:
    ds_read_b128 v[140:143], v4 offset:27648
    s_waitcnt lgkmcnt(7)
    v_mfma_f32_16x16x32_bf16 v[76:79], a[0:3], v[144:147], 0
    v_mfma_f32_16x16x32_bf16 v[80:83], a[4:7], v[144:147], 0
    v_mfma_f32_16x16x32_bf16 v[84:87], a[8:11], v[144:147], 0
    ds_read_b128 v[144:147], v4 offset:28672
    s_waitcnt lgkmcnt(7)
    v_mfma_f32_16x16x32_bf16 v[76:79], a[12:15], v[148:151], v[76:79]
    v_mfma_f32_16x16x32_bf16 v[80:83], a[16:19], v[148:151], v[80:83]
    v_mfma_f32_16x16x32_bf16 v[84:87], a[20:23], v[148:151], v[84:87]
    ds_read_b128 v[148:151], v4 offset:29696
    s_waitcnt lgkmcnt(7)
    v_mfma_f32_16x16x32_bf16 v[76:79], a[24:27], v[152:155], v[76:79]
    v_mfma_f32_16x16x32_bf16 v[80:83], a[28:31], v[152:155], v[80:83]
    v_mfma_f32_16x16x32_bf16 v[84:87], a[32:35], v[152:155], v[84:87]
    ds_read_b128 v[152:155], v4 offset:30720
    s_waitcnt lgkmcnt(7)
    v_mfma_f32_16x16x32_bf16 v[76:79], a[36:39], v[156:159], v[76:79]
    v_add_f32 v64, v64, v40
    v_add_f32 v65, v65, v41
    v_mfma_f32_16x16x32_bf16 v[80:83], a[40:43], v[156:159], v[80:83]
    v_add_f32 v66, v66, v42
    v_add_f32 v67, v67, v43
    v_mfma_f32_16x16x32_bf16 v[84:87], a[44:47], v[156:159], v[84:87]
    v_mul_f32 v112, v64, v64
    v_mul_f32 v113, v65, v65
    ds_read_b128 v[156:159], v4 offset:31744
    s_waitcnt lgkmcnt(7)
    v_mfma_f32_16x16x32_bf16 v[76:79], a[48:51], v[128:131], v[76:79]
    v_mul_f32 v114, v66, v66
    v_mul_f32 v115, v67, v67
    v_mfma_f32_16x16x32_bf16 v[80:83], a[52:55], v[128:131], v[80:83]
    v_fma_f32 v112, v112, v38, v37
    v_fma_f32 v113, v113, v38, v37
    v_mfma_f32_16x16x32_bf16 v[84:87], a[56:59], v[128:131], v[84:87]
    v_fma_f32 v114, v114, v38, v37
    v_fma_f32 v115, v115, v38, v37
    ds_read_b128 v[128:131], v4 offset:32768
    s_waitcnt lgkmcnt(7)
    v_mfma_f32_16x16x32_bf16 v[76:79], a[60:63], v[132:135], v[76:79]
    v_mul_f32 v112, v112, v64
    v_mul_f32 v113, v113, v65
    v_mfma_f32_16x16x32_bf16 v[80:83], a[64:67], v[132:135], v[80:83]
    v_mul_f32 v114, v114, v66
    v_mul_f32 v115, v115, v67
    v_mfma_f32_16x16x32_bf16 v[84:87], a[68:71], v[132:135], v[84:87]
    v_exp_f32 v112, v112
    v_exp_f32 v113, v113
    ds_read_b128 v[132:135], v4 offset:33792
    s_waitcnt lgkmcnt(7)
    v_mfma_f32_16x16x32_bf16 v[76:79], a[72:75], v[136:139], v[76:79]
    v_exp_f32 v114, v114
    v_exp_f32 v115, v115
    v_mfma_f32_16x16x32_bf16 v[80:83], a[76:79], v[136:139], v[80:83]
    v_add_f32 v112, 1.0, v112
    v_add_f32 v113, 1.0, v113
    v_mfma_f32_16x16x32_bf16 v[84:87], a[80:83], v[136:139], v[84:87]
    v_add_f32 v114, 1.0, v114
    v_add_f32 v115, 1.0, v115
    ds_read_b128 v[136:139], v4 offset:34816
    s_waitcnt lgkmcnt(7)
    v_mfma_f32_16x16x32_bf16 v[76:79], a[84:87], v[140:143], v[76:79]
    v_rcp_f32 v112, v112
    v_rcp_f32 v113, v113
    v_mfma_f32_16x16x32_bf16 v[80:83], a[88:91], v[140:143], v[80:83]
    v_rcp_f32 v114, v114
    v_rcp_f32 v115, v115
    v_mfma_f32_16x16x32_bf16 v[84:87], a[92:95], v[140:143], v[84:87]
    v_mul_f32 v64, v64, v112
    v_mul_f32 v65, v65, v113
    ds_read_b128 v[140:143], v4 offset:35840
    s_waitcnt lgkmcnt(7)
    v_mfma_f32_16x16x32_bf16 v[76:79], a[96:99], v[144:147], v[76:79]
    v_mul_f32 v66, v66, v114
    v_mul_f32 v67, v67, v115
    v_mfma_f32_16x16x32_bf16 v[80:83], a[100:103], v[144:147], v[80:83]
    v_cvt_pk_bf16_f32 v96, v64, v65
    v_cvt_pk_bf16_f32 v97, v66, v67
    v_mfma_f32_16x16x32_bf16 v[84:87], a[104:107], v[144:147], v[84:87]
    v_add_f32 v68, v68, v44
    v_add_f32 v69, v69, v45
    ds_read_b128 v[144:147], v4 offset:36864
    s_waitcnt lgkmcnt(7)
    v_mfma_f32_16x16x32_bf16 v[76:79], a[108:111], v[148:151], v[76:79]
    v_add_f32 v70, v70, v46
    v_add_f32 v71, v71, v47
    v_mfma_f32_16x16x32_bf16 v[80:83], a[112:115], v[148:151], v[80:83]
    v_mul_f32 v116, v68, v68
    v_mul_f32 v117, v69, v69
    v_mfma_f32_16x16x32_bf16 v[84:87], a[116:119], v[148:151], v[84:87]
    v_mul_f32 v118, v70, v70
    v_mul_f32 v119, v71, v71
    ds_read_b128 v[148:151], v4 offset:37888
    s_waitcnt lgkmcnt(7)
    v_mfma_f32_16x16x32_bf16 v[76:79], a[120:123], v[152:155], v[76:79]
    v_fma_f32 v116, v116, v38, v37
    v_fma_f32 v117, v117, v38, v37
    v_mfma_f32_16x16x32_bf16 v[80:83], a[124:127], v[152:155], v[80:83]
    v_fma_f32 v118, v118, v38, v37
    v_fma_f32 v119, v119, v38, v37
    v_mfma_f32_16x16x32_bf16 v[84:87], a[128:131], v[152:155], v[84:87]
    v_mul_f32 v116, v116, v68
    v_mul_f32 v117, v117, v69
    ds_read_b128 v[152:155], v4 offset:38912
    s_waitcnt lgkmcnt(7)
    v_mfma_f32_16x16x32_bf16 v[76:79], a[132:135], v[156:159], v[76:79]
    v_mul_f32 v118, v118, v70
    v_mul_f32 v119, v119, v71
    v_mfma_f32_16x16x32_bf16 v[80:83], a[136:139], v[156:159], v[80:83]
    v_exp_f32 v116, v116
    v_exp_f32 v117, v117
    v_mfma_f32_16x16x32_bf16 v[84:87], a[140:143], v[156:159], v[84:87]
    v_exp_f32 v118, v118
    v_exp_f32 v119, v119
    ds_read_b128 v[156:159], v4 offset:39936
    s_waitcnt lgkmcnt(7)
    v_mfma_f32_16x16x32_bf16 v[76:79], a[144:147], v[128:131], v[76:79]
    v_add_f32 v116, 1.0, v116
    v_add_f32 v117, 1.0, v117
    v_mfma_f32_16x16x32_bf16 v[80:83], a[148:151], v[128:131], v[80:83]
    v_add_f32 v118, 1.0, v118
    v_add_f32 v119, 1.0, v119
    v_mfma_f32_16x16x32_bf16 v[84:87], a[152:155], v[128:131], v[84:87]
    v_rcp_f32 v116, v116
    v_rcp_f32 v117, v117
    s_waitcnt lgkmcnt(6)
    v_mfma_f32_16x16x32_bf16 v[76:79], a[156:159], v[132:135], v[76:79]
    v_rcp_f32 v118, v118
    v_rcp_f32 v119, v119
    v_mfma_f32_16x16x32_bf16 v[80:83], a[160:163], v[132:135], v[80:83]
    v_mul_f32 v68, v68, v116
    v_mul_f32 v69, v69, v117
    v_mfma_f32_16x16x32_bf16 v[84:87], a[164:167], v[132:135], v[84:87]
    v_mul_f32 v70, v70, v118
    v_mul_f32 v71, v71, v119
    s_waitcnt lgkmcnt(5)
    v_mfma_f32_16x16x32_bf16 v[76:79], a[168:171], v[136:139], v[76:79]
    v_cvt_pk_bf16_f32 v98, v68, v69
    v_cvt_pk_bf16_f32 v99, v70, v71
    v_mfma_f32_16x16x32_bf16 v[80:83], a[172:175], v[136:139], v[80:83]
    v_add_f32 v72, v72, v48
    v_add_f32 v73, v73, v49
    v_mfma_f32_16x16x32_bf16 v[84:87], a[176:179], v[136:139], v[84:87]
    v_add_f32 v74, v74, v50
    v_add_f32 v75, v75, v51
    s_waitcnt lgkmcnt(4)
    v_mfma_f32_16x16x32_bf16 v[76:79], a[180:183], v[140:143], v[76:79]
    v_mul_f32 v120, v72, v72
    v_mul_f32 v121, v73, v73
    v_mfma_f32_16x16x32_bf16 v[80:83], a[184:187], v[140:143], v[80:83]
    v_mul_f32 v122, v74, v74
    v_mul_f32 v123, v75, v75
    v_mfma_f32_16x16x32_bf16 v[84:87], a[188:191], v[140:143], v[84:87]
    v_fma_f32 v120, v120, v38, v37
    v_fma_f32 v121, v121, v38, v37
    s_waitcnt lgkmcnt(3)
    v_mfma_f32_16x16x32_bf16 v[76:79], a[192:195], v[144:147], v[76:79]
    v_fma_f32 v122, v122, v38, v37
    v_fma_f32 v123, v123, v38, v37
    v_mfma_f32_16x16x32_bf16 v[80:83], a[196:199], v[144:147], v[80:83]
    v_mul_f32 v120, v120, v72
    v_mul_f32 v121, v121, v73
    v_mfma_f32_16x16x32_bf16 v[84:87], a[200:203], v[144:147], v[84:87]
    v_mul_f32 v122, v122, v74
    v_mul_f32 v123, v123, v75
    s_waitcnt lgkmcnt(2)
    v_mfma_f32_16x16x32_bf16 v[76:79], a[204:207], v[148:151], v[76:79]
    v_exp_f32 v120, v120
    v_exp_f32 v121, v121
    v_mfma_f32_16x16x32_bf16 v[80:83], a[208:211], v[148:151], v[80:83]
    v_exp_f32 v122, v122
    v_exp_f32 v123, v123
    v_mfma_f32_16x16x32_bf16 v[84:87], a[212:215], v[148:151], v[84:87]
    v_add_f32 v120, 1.0, v120
    v_add_f32 v121, 1.0, v121
    s_waitcnt lgkmcnt(1)
    v_mfma_f32_16x16x32_bf16 v[76:79], a[216:219], v[152:155], v[76:79]
    v_add_f32 v122, 1.0, v122
    v_add_f32 v123, 1.0, v123
    v_mfma_f32_16x16x32_bf16 v[80:83], a[220:223], v[152:155], v[80:83]
    v_rcp_f32 v120, v120
    v_rcp_f32 v121, v121
    v_mfma_f32_16x16x32_bf16 v[84:87], a[224:227], v[152:155], v[84:87]
    v_rcp_f32 v122, v122
    v_rcp_f32 v123, v123
    s_waitcnt lgkmcnt(0)
    v_mfma_f32_16x16x32_bf16 v[76:79], a[228:231], v[156:159], v[76:79]
    v_mul_f32 v72, v72, v120
    v_mul_f32 v73, v73, v121
    v_mfma_f32_16x16x32_bf16 v[80:83], a[232:235], v[156:159], v[80:83]
    v_mul_f32 v74, v74, v122
    v_mul_f32 v75, v75, v123
    v_mfma_f32_16x16x32_bf16 v[84:87], a[236:239], v[156:159], v[84:87]
    v_cvt_pk_bf16_f32 v100, v72, v73
    v_cvt_pk_bf16_f32 v101, v74, v75
    global_store_dwordx4 v6, v[96:99], s[24:25] sc1
    global_store_dwordx2 v7, v[100:101], s[24:25] sc1
    s_nop 7
    v_add_f32 v76, v76, v40
    v_add_f32 v77, v77, v41
    v_add_f32 v78, v78, v42
    v_add_f32 v79, v79, v43
    v_mul_f32 v112, v76, v76
    v_mul_f32 v113, v77, v77
    v_mul_f32 v114, v78, v78
    v_mul_f32 v115, v79, v79
    v_fma_f32 v112, v112, v38, v37
    v_fma_f32 v113, v113, v38, v37
    v_fma_f32 v114, v114, v38, v37
    v_fma_f32 v115, v115, v38, v37
    v_mul_f32 v112, v112, v76
    v_mul_f32 v113, v113, v77
    v_mul_f32 v114, v114, v78
    v_mul_f32 v115, v115, v79
    v_exp_f32 v112, v112
    v_exp_f32 v113, v113
    v_exp_f32 v114, v114
    v_exp_f32 v115, v115
    v_add_f32 v112, 1.0, v112
    v_add_f32 v113, 1.0, v113
    v_add_f32 v114, 1.0, v114
    v_add_f32 v115, 1.0, v115
    v_rcp_f32 v112, v112
    v_rcp_f32 v113, v113
    v_rcp_f32 v114, v114
    v_rcp_f32 v115, v115
    v_mul_f32 v76, v76, v112
    v_mul_f32 v77, v77, v113
    v_mul_f32 v78, v78, v114
    v_mul_f32 v79, v79, v115
    v_cvt_pk_bf16_f32 v104, v76, v77
    v_cvt_pk_bf16_f32 v105, v78, v79
    v_add_f32 v80, v80, v44
    v_add_f32 v81, v81, v45
    v_add_f32 v82, v82, v46
    v_add_f32 v83, v83, v47
    v_mul_f32 v116, v80, v80
    v_mul_f32 v117, v81, v81
    v_mul_f32 v118, v82, v82
    v_mul_f32 v119, v83, v83
    v_fma_f32 v116, v116, v38, v37
    v_fma_f32 v117, v117, v38, v37
    v_fma_f32 v118, v118, v38, v37
    v_fma_f32 v119, v119, v38, v37
    v_mul_f32 v116, v116, v80
    v_mul_f32 v117, v117, v81
    v_mul_f32 v118, v118, v82
    v_mul_f32 v119, v119, v83
    v_exp_f32 v116, v116
    v_exp_f32 v117, v117
    v_exp_f32 v118, v118
    v_exp_f32 v119, v119
    v_add_f32 v116, 1.0, v116
    v_add_f32 v117, 1.0, v117
    v_add_f32 v118, 1.0, v118
    v_add_f32 v119, 1.0, v119
    v_rcp_f32 v116, v116
    v_rcp_f32 v117, v117
    v_rcp_f32 v118, v118
    v_rcp_f32 v119, v119
    v_mul_f32 v80, v80, v116
    v_mul_f32 v81, v81, v117
    v_mul_f32 v82, v82, v118
    v_mul_f32 v83, v83, v119
    v_cvt_pk_bf16_f32 v106, v80, v81
    v_cvt_pk_bf16_f32 v107, v82, v83
    v_add_f32 v84, v84, v48
    v_add_f32 v85, v85, v49
    v_add_f32 v86, v86, v50
    v_add_f32 v87, v87, v51
    v_mul_f32 v120, v84, v84
    v_mul_f32 v121, v85, v85
    v_mul_f32 v122, v86, v86
    v_mul_f32 v123, v87, v87
    v_fma_f32 v120, v120, v38, v37
    v_fma_f32 v121, v121, v38, v37
    v_fma_f32 v122, v122, v38, v37
    v_fma_f32 v123, v123, v38, v37
    v_mul_f32 v120, v120, v84
    v_mul_f32 v121, v121, v85
    v_mul_f32 v122, v122, v86
    v_mul_f32 v123, v123, v87
    v_exp_f32 v120, v120
    v_exp_f32 v121, v121
    v_exp_f32 v122, v122
    v_exp_f32 v123, v123
    v_add_f32 v120, 1.0, v120
    v_add_f32 v121, 1.0, v121
    v_add_f32 v122, 1.0, v122
    v_add_f32 v123, 1.0, v123
    v_rcp_f32 v120, v120
    v_rcp_f32 v121, v121
    v_rcp_f32 v122, v122
    v_rcp_f32 v123, v123
    v_mul_f32 v84, v84, v120
    v_mul_f32 v85, v85, v121
    v_mul_f32 v86, v86, v122
    v_mul_f32 v87, v87, v123
    v_cvt_pk_bf16_f32 v108, v84, v85
    v_cvt_pk_bf16_f32 v109, v86, v87
    global_store_dwordx4 v6, v[104:107], s[34:35] sc1
    global_store_dwordx2 v7, v[108:109], s[34:35] sc1
    s_add_u32 s39, s31, 1
    s_mov_b32 s31, s37
    s_waitcnt vmcnt(0)
    v_mov_b32 v36, s39
    s_mov_b64 exec, 1
    global_store_dword v35, v36, s[10:11] sc1
    s_mov_b64 exec, -1
    s_cmp_ge_u32 s31, 64
    s_cbranch_scc1 .Lm1_end
    s_cmp_eq_u32 s36, 1
    s_cbranch_scc1 .m1h_50
    s_and_b32 s15, s31, 1
    s_lshl_b32 s15, s15, 8
    s_add_u32 s15, s15, 36864
    v_add_u32 v33, s15, v34
    s_lshr_b32 s33, s31, 1
    s_add_u32 s33, s33, 1
.m1w_51:
    global_load_dword v3, v33, s[10:11] sc1
    s_waitcnt vmcnt(0)
    v_cmp_gt_u32 vcc, s33, v3
    s_cbranch_vccz .m1g_52
    s_sleep 2
    s_add_u32 s14, s14, 1
    s_cmp_gt_u32 s14, 400000
    s_cbranch_scc1 .Lend
    s_branch .m1w_51
.m1g_52:
    s_mul_i32 s15, s31, 40960
    s_add_u32 s15, s15, 242221056
    s_add_u32 s22, s4, s15
    s_addc_u32 s23, s5, 0
    s_add_u32 m0, s30, 40960
    s_nop 0
    global_load_lds_dwordx4 v5, s[22:23] offset:0 sc1
    global_load_lds_dwordx4 v5, s[22:23] offset:1024 sc1
    global_load_lds_dwordx4 v5, s[22:23] offset:2048 sc1
    global_load_lds_dwordx4 v5, s[22:23] offset:3072 sc1
    s_add_u32 m0, s30, 45056
    v_add_u32 v5, 4096, v5
    global_load_lds_dwordx4 v5, s[22:23] offset:0 sc1
    global_load_lds_dwordx4 v5, s[22:23] offset:1024 sc1
    global_load_lds_dwordx4 v5, s[22:23] offset:2048 sc1
    global_load_lds_dwordx4 v5, s[22:23] offset:3072 sc1
    s_add_u32 m0, s30, 49152
    v_add_u32 v5, 4096, v5
    global_load_lds_dwordx4 v5, s[22:23] offset:0 sc1
    global_load_lds_dwordx4 v5, s[22:23] offset:1024 sc1
    v_subrev_u32 v5, 8192, v5
    s_waitcnt vmcnt(0)
    s_waitcnt vmcnt(0)
.m1h_50:
    s_barrier
    s_add_u32 s37, s31, 1
    s_cmp_gt_u32 s37, 36
    s_cselect_b32 s15, 1, 0
    s_add_u32 s37, s37, s15
    s_and_b32 s15, s37, 1
    s_lshl_b32 s15, s15, 8
    s_add_u32 s15, s15, 36864
    v_add_u32 v33, s15, v34
    s_lshr_b32 s33, s37, 1
    s_add_u32 s33, s33, 1
    global_load_dword v39, v33, s[10:11] sc1
    s_mul_i32 s15, s37, 40960
    s_add_u32 s15, s15, 242221056
    s_add_u32 s22, s4, s15
    s_addc_u32 s23, s5, 0
    s_lshl_b32 s15, s31, 3
    s_add_u32 s15, s15, s13
    s_mul_i32 s15, s15, 12288
    s_add_u32 s15, s15, 251658240
    s_add_u32 s24, s4, s15
    s_addc_u32 s25, s5, 0
    s_add_u32 s34, s24, 6144
    s_addc_u32 s35, s25, 0
    ds_read_b128 v[128:131], v32 offset:0
    ds_read_b128 v[132:135], v32 offset:1024
    ds_read_b128 v[136:139], v32 offset:2048
    ds_read_b128 v[140:143], v32 offset:3072
    ds_read_b128 v[144:147], v32 offset:4096
    ds_read_b128 v[148:151], v32 offset:5120
    ds_read_b128 v[152:155], v32 offset:6144
    ds_read_b128 v[156:159], v32 offset:7168
    s_waitcnt lgkmcnt(7)
    v_mfma_f32_16x16x32_bf16 v[64:67], a[0:3], v[128:131], 0
    v_mfma_f32_16x16x32_bf16 v[68:71], a[4:7], v[128:131], 0
    v_mfma_f32_16x16x32_bf16 v[72:75], a[8:11], v[128:131], 0
    ds_read_b128 v[128:131], v32 offset:8192
    s_waitcnt lgkmcnt(7)
    v_mfma_f32_16x16x32_bf16 v[64:67], a[12:15], v[132:135], v[64:67]
    v_mfma_f32_16x16x32_bf16 v[68:71], a[16:19], v[132:135], v[68:71]
    v_mfma_f32_16x16x32_bf16 v[72:75], a[20:23], v[132:135], v[72:75]
    ds_read_b128 v[132:135], v32 offset:9216
    s_waitcnt lgkmcnt(7)
    v_mfma_f32_16x16x32_bf16 v[64:67], a[24:27], v[136:139], v[64:67]
    v_mfma_f32_16x16x32_bf16 v[68:71], a[28:31], v[136:139], v[68:71]
    v_mfma_f32_16x16x32_bf16 v[72:75], a[32:35], v[136:139], v[72:75]
    ds_read_b128 v[136:139], v32 offset:10240
    s_waitcnt lgkmcnt(7)
    v_mfma_f32_16x16x32_bf16 v[64:67], a[36:39], v[140:143], v[64:67]
    v_mfma_f32_16x16x32_bf16 v[68:71], a[40:43], v[140:143], v[68:71]
    v_mfma_f32_16x16x32_bf16 v[72:75], a[44:47], v[140:143], v[72:75]
    ds_read_b128 v[140:143], v32 offset:11264
    s_waitcnt lgkmcnt(7)
    v_mfma_f32_16x16x32_bf16 v[64:67], a[48:51], v[144:147], v[64:67]
    v_mfma_f32_16x16x32_bf16 v[68:71], a[52:55], v[144:147], v[68:71]
    v_mfma_f32_16x16x32_bf16 v[72:75], a[56:59], v[144:147], v[72:75]
    ds_read_b128 v[144:147], v32 offset:12288
    s_waitcnt lgkmcnt(7)
    v_mfma_f32_16x16x32_bf16 v[64:67], a[60:63], v[148:151], v[64:67]
    v_mfma_f32_16x16x32_bf16 v[68:71], a[64:67], v[148:151], v[68:71]
    v_mfma_f32_16x16x32_bf16 v[72:75], a[68:71], v[148:151], v[72:75]
    ds_read_b128 v[148:151], v32 offset:13312
    s_waitcnt lgkmcnt(7)
    v_mfma_f32_16x16x32_bf16 v[64:67], a[72:75], v[152:155], v[64:67]
    v_mfma_f32_16x16x32_bf16 v[68:71], a[76:79], v[152:155], v[68:71]
    v_mfma_f32_16x16x32_bf16 v[72:75], a[80:83], v[152:155], v[72:75]
    ds_read_b128 v[152:155], v32 offset:14336
    s_waitcnt lgkmcnt(7)
    v_mfma_f32_16x16x32_bf16 v[64:67], a[84:87], v[156:159], v[64:67]
    v_mfma_f32_16x16x32_bf16 v[68:71], a[88:91], v[156:159], v[68:71]
    v_mfma_f32_16x16x32_bf16 v[72:75], a[92:95], v[156:159], v[72:75]
    ds_read_b128 v[156:159], v32 offset:15360
    s_waitcnt lgkmcnt(7)
    v_mfma_f32_16x16x32_bf16 v[64:67], a[96:99], v[128:131], v[64:67]
    v_mfma_f32_16x16x32_bf16 v[68:71], a[100:103], v[128:131], v[68:71]
    v_mfma_f32_16x16x32_bf16 v[72:75], a[104:107], v[128:131], v[72:75]
    ds_read_b128 v[128:131], v32 offset:16384
    s_waitcnt lgkmcnt(7)
    v_mfma_f32_16x16x32_bf16 v[64:67], a[108:111], v[132:135], v[64:67]
    v_mfma_f32_16x16x32_bf16 v[68:71], a[112:115], v[132:135], v[68:71]
    v_mfma_f32_16x16x32_bf16 v[72:75], a[116:119], v[132:135], v[72:75]
    s_waitcnt vmcnt(0)
    v_cmp_gt_u32 vcc, s33, v39
    s_cmp_eq_u64 vcc, 0
    s_cselect_b32 s36, 1, 0
    s_cmp_ge_u32 s37, 64
    s_cselect_b32 s36, 0, s36
    ds_read_b128 v[132:135], v32 offset:17408
    s_waitcnt lgkmcnt(7)
    v_mfma_f32_16x16x32_bf16 v[64:67], a[120:123], v[136:139], v[64:67]
    v_mfma_f32_16x16x32_bf16 v[68:71], a[124:127], v[136:139], v[68:71]
    v_mfma_f32_16x16x32_bf16 v[72:75], a[128:131], v[136:139], v[72:75]
    s_cmp_eq_u32 s36, 0
    s_cbranch_scc1 .m1s_53
    s_add_u32 m0, s30, 0
    s_nop 0
    global_load_lds_dwordx4 v5, s[22:23] offset:0 sc1
.m1s_53:
    ds_read_b128 v[136:139], v32 offset:18432
    s_waitcnt lgkmcnt(7)
    v_mfma_f32_16x16x32_bf16 v[64:67], a[132:135], v[140:143], v[64:67]
    v_mfma_f32_16x16x32_bf16 v[68:71], a[136:139], v[140:143], v[68:71]
    v_mfma_f32_16x16x32_bf16 v[72:75], a[140:143], v[140:143], v[72:75]
    s_cmp_eq_u32 s36, 0
    s_cbranch_scc1 .m1s_54
    global_load_lds_dwordx4 v5, s[22:23] offset:1024 sc1
.m1s_54:
    ds_read_b128 v[140:143], v32 offset:19456
    s_waitcnt lgkmcnt(7)
    v_mfma_f32_16x16x32_bf16 v[64:67], a[144:147], v[144:147], v[64:67]
    v_mfma_f32_16x16x32_bf16 v[68:71], a[148:151], v[144:147], v[68:71]
    v_mfma_f32_16x16x32_bf16 v[72:75], a[152:155], v[144:147], v[72:75]
    s_cmp_eq_u32 s36, 0
    s_cbranch_scc1 .m1s_55
    global_load_lds_dwordx4 v5, s[22:23] offset:2048 sc1
.m1s_55:
    ds_read_b128 v[144:147], v32 offset:20480
    s_waitcnt lgkmcnt(7)
    v_mfma_f32_16x16x32_bf16 v[64:67], a[156:159], v[148:151], v[64:67]
    v_mfma_f32_16x16x32_bf16 v[68:71], a[160:163], v[148:151], v[68:71]
    v_mfma_f32_16x16x32_bf16 v[72:75], a[164:167], v[148:151], v[72:75]
    s_cmp_eq_u32 s36, 0
    s_cbranch_scc1 .m1s_56
    global_load_lds_dwordx4 v5, s[22:23] offset:3072 sc1
.m1s_56:
    ds_read_b128 v[148:151], v32 offset:21504
    s_waitcnt lgkmcnt(7)
    v_mfma_f32_16x16x32_bf16 v[64:67], a[168:171], v[152:155], v[64:67]
    v_mfma_f32_16x16x32_bf16 v[68:71], a[172:175], v[152:155], v[68:71]
    v_mfma_f32_16x16x32_bf16 v[72:75], a[176:179], v[152:155], v[72:75]
    s_cmp_eq_u32 s36, 0
    s_cbranch_scc1 .m1s_57
    s_add_u32 m0, s30, 4096
    v_add_u32 v5, 4096, v5
    global_load_lds_dwordx4 v5, s[22:23] offset:0 sc1
.m1s_57:
    ds_read_b128 v[152:155], v32 offset:22528
    s_waitcnt lgkmcnt(7)
    v_mfma_f32_16x16x32_bf16 v[64:67], a[180:183], v[156:159], v[64:67]
    v_mfma_f32_16x16x32_bf16 v[68:71], a[184:187], v[156:159], v[68:71]
    v_mfma_f32_16x16x32_bf16 v[72:75], a[188:191], v[156:159], v[72:75]
    s_cmp_eq_u32 s36, 0
    s_cbranch_scc1 .m1s_58
    global_load_lds_dwordx4 v5, s[22:23] offset:1024 sc1
.m1s_58:
    ds_read_b128 v[156:159], v32 offset:23552
    s_waitcnt lgkmcnt(7)
    v_mfma_f32_16x16x32_bf16 v[64:67], a[192:195], v[128:131], v[64:67]
    v_mfma_f32_16x16x32_bf16 v[68:71], a[196:199], v[128:131], v[68:71]
    v_mfma_f32_16x16x32_bf16 v[72:75], a[200:203], v[128:131], v[72:75]
    s_cmp_eq_u32 s36, 0
    s_cbranch_scc1 .m1s_59
    global_load_lds_dwordx4 v5, s[22:23] offset:2048 sc1
.m1s_59:
    ds_read_b128 v[128:131], v32 offset:24576
    s_waitcnt lgkmcnt(7)
    v_mfma_f32_16x16x32_bf16 v[64:67], a[204:207], v[132:135], v[64:67]
    v_mfma_f32_16x16x32_bf16 v[68:71], a[208:211], v[132:135], v[68:71]
    v_mfma_f32_16x16x32_bf16 v[72:75], a[212:215], v[132:135], v[72:75]
    s_cmp_eq_u32 s36, 0
    s_cbranch_scc1 .m1s_60
    global_load_lds_dwordx4 v5, s[22:23] offset:3072 sc1
.m1s_60:
    ds_read_b128 v[132:135], v32 offset:25600
    s_waitcnt lgkmcnt(7)
    v_mfma_f32_16x16x32_bf16 v[64:67], a[216:219], v[136:139], v[64:67]
    v_mfma_f32_16x16x32_bf16 v[68:71], a[220:223], v[136:139], v[68:71]
    v_mfma_f32_16x16x32_bf16 v[72:75], a[224:227], v[136:139], v[72:75]
    s_cmp_eq_u32 s36, 0
    s_cbranch_scc1 .m1s_61
    s_add_u32 m0, s30, 8192
    v_add_u32 v5, 4096, v5
    global_load_lds_dwordx4 v5, s[22:23] offset:0 sc1
.m1s_61:
    ds_read_b128 v[136:139], v32 offset:26624
    s_waitcnt lgkmcnt(7)
    v_mfma_f32_16x16x32_bf16 v[64:67], a[228:231], v[140:143], v[64:67]
    v_mfma_f32_16x16x32_bf16 v[68:71], a[232:235], v[140:143], v[68:71]
    v_mfma_f32_16x16x32_bf16 v[72:75], a[236:239], v[140:143], v[72:75]
    s_cmp_eq_u32 s36, 0
    s_cbranch_scc1 .m1s_62
    global_load_lds_dwordx4 v5, s[22:23] offset:1024 sc1
    v_subrev_u32 v5, 8192, v5
.m1s_62:
    ds_read_b128 v[140:143], v32 offset:27648
    s_waitcnt lgkmcnt(7)
    v_mfma_f32_16x16x32_bf16 v[76:79], a[0:3], v[144:147], 0
    v_mfma_f32_16x16x32_bf16 v[80:83], a[4:7], v[144:147], 0
    v_mfma_f32_16x16x32_bf16 v[84:87], a[8:11], v[144:147], 0
    ds_read_b128 v[144:147], v32 offset:28672
    s_waitcnt lgkmcnt(7)
    v_mfma_f32_16x16x32_bf16 v[76:79], a[12:15], v[148:151], v[76:79]
    v_mfma_f32_16x16x32_bf16 v[80:83], a[16:19], v[148:151], v[80:83]
    v_mfma_f32_16x16x32_bf16 v[84:87], a[20:23], v[148:151], v[84:87]
    ds_read_b128 v[148:151], v32 offset:29696
    s_waitcnt lgkmcnt(7)
    v_mfma_f32_16x16x32_bf16 v[76:79], a[24:27], v[152:155], v[76:79]
    v_mfma_f32_16x16x32_bf16 v[80:83], a[28:31], v[152:155], v[80:83]
    v_mfma_f32_16x16x32_bf16 v[84:87], a[32:35], v[152:155], v[84:87]
    ds_read_b128 v[152:155], v32 offset:30720
    s_waitcnt lgkmcnt(7)
    v_mfma_f32_16x16x32_bf16 v[76:79], a[36:39], v[156:159], v[76:79]
    v_add_f32 v64, v64, v40
    v_add_f32 v65, v65, v41
    v_mfma_f32_16x16x32_bf16 v[80:83], a[40:43], v[156:159], v[80:83]
    v_add_f32 v66, v66, v42
    v_add_f32 v67, v67, v43
    v_mfma_f32_16x16x32_bf16 v[84:87], a[44:47], v[156:159], v[84:87]
    v_mul_f32 v112, v64, v64
    v_mul_f32 v113, v65, v65
    ds_read_b128 v[156:159], v32 offset:31744
    s_waitcnt lgkmcnt(7)
    v_mfma_f32_16x16x32_bf16 v[76:79], a[48:51], v[128:131], v[76:79]
    v_mul_f32 v114, v66, v66
    v_mul_f32 v115, v67, v67
    v_mfma_f32_16x16x32_bf16 v[80:83], a[52:55], v[128:131], v[80:83]
    v_fma_f32 v112, v112, v38, v37
    v_fma_f32 v113, v113, v38, v37
    v_mfma_f32_16x16x32_bf16 v[84:87], a[56:59], v[128:131], v[84:87]
    v_fma_f32 v114, v114, v38, v37
    v_fma_f32 v115, v115, v38, v37
    ds_read_b128 v[128:131], v32 offset:32768
    s_waitcnt lgkmcnt(7)
    v_mfma_f32_16x16x32_bf16 v[76:79], a[60:63], v[132:135], v[76:79]
    v_mul_f32 v112, v112, v64
    v_mul_f32 v113, v113, v65
    v_mfma_f32_16x16x32_bf16 v[80:83], a[64:67], v[132:135], v[80:83]
    v_mul_f32 v114, v114, v66
    v_mul_f32 v115, v115, v67
    v_mfma_f32_16x16x32_bf16 v[84:87], a[68:71], v[132:135], v[84:87]
    v_exp_f32 v112, v112
    v_exp_f32 v113, v113
    ds_read_b128 v[132:135], v32 offset:33792
    s_waitcnt lgkmcnt(7)
    v_mfma_f32_16x16x32_bf16 v[76:79], a[72:75], v[136:139], v[76:79]
    v_exp_f32 v114, v114
    v_exp_f32 v115, v115
    v_mfma_f32_16x16x32_bf16 v[80:83], a[76:79], v[136:139], v[80:83]
    v_add_f32 v112, 1.0, v112
    v_add_f32 v113, 1.0, v113
    v_mfma_f32_16x16x32_bf16 v[84:87], a[80:83], v[136:139], v[84:87]
    v_add_f32 v114, 1.0, v114
    v_add_f32 v115, 1.0, v115
    ds_read_b128 v[136:139], v32 offset:34816
    s_waitcnt lgkmcnt(7)
    v_mfma_f32_16x16x32_bf16 v[76:79], a[84:87], v[140:143], v[76:79]
    v_rcp_f32 v112, v112
    v_rcp_f32 v113, v113
    v_mfma_f32_16x16x32_bf16 v[80:83], a[88:91], v[140:143], v[80:83]
    v_rcp_f32 v114, v114
    v_rcp_f32 v115, v115
    v_mfma_f32_16x16x32_bf16 v[84:87], a[92:95], v[140:143], v[84:87]
    v_mul_f32 v64, v64, v112
    v_mul_f32 v65, v65, v113
    ds_read_b128 v[140:143], v32 offset:35840
    s_waitcnt lgkmcnt(7)
    v_mfma_f32_16x16x32_bf16 v[76:79], a[96:99], v[144:147], v[76:79]
    v_mul_f32 v66, v66, v114
    v_mul_f32 v67, v67, v115
    v_mfma_f32_16x16x32_bf16 v[80:83], a[100:103], v[144:147], v[80:83]
    v_cvt_pk_bf16_f32 v96, v64, v65
    v_cvt_pk_bf16_f32 v97, v66, v67
    v_mfma_f32_16x16x32_bf16 v[84:87], a[104:107], v[144:147], v[84:87]
    v_add_f32 v68, v68, v44
    v_add_f32 v69, v69, v45
    ds_read_b128 v[144:147], v32 offset:36864
    s_waitcnt lgkmcnt(7)
    v_mfma_f32_16x16x32_bf16 v[76:79], a[108:111], v[148:151], v[76:79]
    v_add_f32 v70, v70, v46
    v_add_f32 v71, v71, v47
    v_mfma_f32_16x16x32_bf16 v[80:83], a[112:115], v[148:151], v[80:83]
    v_mul_f32 v116, v68, v68
    v_mul_f32 v117, v69, v69
    v_mfma_f32_16x16x32_bf16 v[84:87], a[116:119], v[148:151], v[84:87]
    v_mul_f32 v118, v70, v70
    v_mul_f32 v119, v71, v71
    ds_read_b128 v[148:151], v32 offset:37888
    s_waitcnt lgkmcnt(7)
    v_mfma_f32_16x16x32_bf16 v[76:79], a[120:123], v[152:155], v[76:79]
    v_fma_f32 v116, v116, v38, v37
    v_fma_f32 v117, v117, v38, v37
    v_mfma_f32_16x16x32_bf16 v[80:83], a[124:127], v[152:155], v[80:83]
    v_fma_f32 v118, v118, v38, v37
    v_fma_f32 v119, v119, v38, v37
    v_mfma_f32_16x16x32_bf16 v[84:87], a[128:131], v[152:155], v[84:87]
    v_mul_f32 v116, v116, v68
    v_mul_f32 v117, v117, v69
    ds_read_b128 v[152:155], v32 offset:38912
    s_waitcnt lgkmcnt(7)
    v_mfma_f32_16x16x32_bf16 v[76:79], a[132:135], v[156:159], v[76:79]
    v_mul_f32 v118, v118, v70
    v_mul_f32 v119, v119, v71
    v_mfma_f32_16x16x32_bf16 v[80:83], a[136:139], v[156:159], v[80:83]
    v_exp_f32 v116, v116
    v_exp_f32 v117, v117
    v_mfma_f32_16x16x32_bf16 v[84:87], a[140:143], v[156:159], v[84:87]
    v_exp_f32 v118, v118
    v_exp_f32 v119, v119
    ds_read_b128 v[156:159], v32 offset:39936
    s_waitcnt lgkmcnt(7)
    v_mfma_f32_16x16x32_bf16 v[76:79], a[144:147], v[128:131], v[76:79]
    v_add_f32 v116, 1.0, v116
    v_add_f32 v117, 1.0, v117
    v_mfma_f32_16x16x32_bf16 v[80:83], a[148:151], v[128:131], v[80:83]
    v_add_f32 v118, 1.0, v118
    v_add_f32 v119, 1.0, v119
    v_mfma_f32_16x16x32_bf16 v[84:87], a[152:155], v[128:131], v[84:87]
    v_rcp_f32 v116, v116
    v_rcp_f32 v117, v117
    s_waitcnt lgkmcnt(6)
    v_mfma_f32_16x16x32_bf16 v[76:79], a[156:159], v[132:135], v[76:79]
    v_rcp_f32 v118, v118
    v_rcp_f32 v119, v119
    v_mfma_f32_16x16x32_bf16 v[80:83], a[160:163], v[132:135], v[80:83]
    v_mul_f32 v68, v68, v116
    v_mul_f32 v69, v69, v117
    v_mfma_f32_16x16x32_bf16 v[84:87], a[164:167], v[132:135], v[84:87]
    v_mul_f32 v70, v70, v118
    v_mul_f32 v71, v71, v119
    s_waitcnt lgkmcnt(5)
    v_mfma_f32_16x16x32_bf16 v[76:79], a[168:171], v[136:139], v[76:79]
    v_cvt_pk_bf16_f32 v98, v68, v69
    v_cvt_pk_bf16_f32 v99, v70, v71
    v_mfma_f32_16x16x32_bf16 v[80:83], a[172:175], v[136:139], v[80:83]
    v_add_f32 v72, v72, v48
    v_add_f32 v73, v73, v49
    v_mfma_f32_16x16x32_bf16 v[84:87], a[176:179], v[136:139], v[84:87]
    v_add_f32 v74, v74, v50
    v_add_f32 v75, v75, v51
    s_waitcnt lgkmcnt(4)
    v_mfma_f32_16x16x32_bf16 v[76:79], a[180:183], v[140:143], v[76:79]
    v_mul_f32 v120, v72, v72
    v_mul_f32 v121, v73, v73
    v_mfma_f32_16x16x32_bf16 v[80:83], a[184:187], v[140:143], v[80:83]
    v_mul_f32 v122, v74, v74
    v_mul_f32 v123, v75, v75
    v_mfma_f32_16x16x32_bf16 v[84:87], a[188:191], v[140:143], v[84:87]
    v_fma_f32 v120, v120, v38, v37
    v_fma_f32 v121, v121, v38, v37
    s_waitcnt lgkmcnt(3)
    v_mfma_f32_16x16x32_bf16 v[76:79], a[192:195], v[144:147], v[76:79]
    v_fma_f32 v122, v122, v38, v37
    v_fma_f32 v123, v123, v38, v37
    v_mfma_f32_16x16x32_bf16 v[80:83], a[196:199], v[144:147], v[80:83]
    v_mul_f32 v120, v120, v72
    v_mul_f32 v121, v121, v73
    v_mfma_f32_16x16x32_bf16 v[84:87], a[200:203], v[144:147], v[84:87]
    v_mul_f32 v122, v122, v74
    v_mul_f32 v123, v123, v75
    s_waitcnt lgkmcnt(2)
    v_mfma_f32_16x16x32_bf16 v[76:79], a[204:207], v[148:151], v[76:79]
    v_exp_f32 v120, v120
    v_exp_f32 v121, v121
    v_mfma_f32_16x16x32_bf16 v[80:83], a[208:211], v[148:151], v[80:83]
    v_exp_f32 v122, v122
    v_exp_f32 v123, v123
    v_mfma_f32_16x16x32_bf16 v[84:87], a[212:215], v[148:151], v[84:87]
    v_add_f32 v120, 1.0, v120
    v_add_f32 v121, 1.0, v121
    s_waitcnt lgkmcnt(1)
    v_mfma_f32_16x16x32_bf16 v[76:79], a[216:219], v[152:155], v[76:79]
    v_add_f32 v122, 1.0, v122
    v_add_f32 v123, 1.0, v123
    v_mfma_f32_16x16x32_bf16 v[80:83], a[220:223], v[152:155], v[80:83]
    v_rcp_f32 v120, v120
    v_rcp_f32 v121, v121
    v_mfma_f32_16x16x32_bf16 v[84:87], a[224:227], v[152:155], v[84:87]
    v_rcp_f32 v122, v122
    v_rcp_f32 v123, v123
    s_waitcnt lgkmcnt(0)
    v_mfma_f32_16x16x32_bf16 v[76:79], a[228:231], v[156:159], v[76:79]
    v_mul_f32 v72, v72, v120
    v_mul_f32 v73, v73, v121
    v_mfma_f32_16x16x32_bf16 v[80:83], a[232:235], v[156:159], v[80:83]
    v_mul_f32 v74, v74, v122
    v_mul_f32 v75, v75, v123
    v_mfma_f32_16x16x32_bf16 v[84:87], a[236:239], v[156:159], v[84:87]
    v_cvt_pk_bf16_f32 v100, v72, v73
    v_cvt_pk_bf16_f32 v101, v74, v75
    global_store_dwordx4 v6, v[96:99], s[24:25] sc1
    global_store_dwordx2 v7, v[100:101], s[24:25] sc1
    s_nop 7
    v_add_f32 v76, v76, v40
    v_add_f32 v77, v77, v41
    v_add_f32 v78, v78, v42
    v_add_f32 v79, v79, v43
    v_mul_f32 v112, v76, v76
    v_mul_f32 v113, v77, v77
    v_mul_f32 v114, v78, v78
    v_mul_f32 v115, v79, v79
    v_fma_f32 v112, v112, v38, v37
    v_fma_f32 v113, v113, v38, v37
    v_fma_f32 v114, v114, v38, v37
    v_fma_f32 v115, v115, v38, v37
    v_mul_f32 v112, v112, v76
    v_mul_f32 v113, v113, v77
    v_mul_f32 v114, v114, v78
    v_mul_f32 v115, v115, v79
    v_exp_f32 v112, v112
    v_exp_f32 v113, v113
    v_exp_f32 v114, v114
    v_exp_f32 v115, v115
    v_add_f32 v112, 1.0, v112
    v_add_f32 v113, 1.0, v113
    v_add_f32 v114, 1.0, v114
    v_add_f32 v115, 1.0, v115
    v_rcp_f32 v112, v112
    v_rcp_f32 v113, v113
    v_rcp_f32 v114, v114
    v_rcp_f32 v115, v115
    v_mul_f32 v76, v76, v112
    v_mul_f32 v77, v77, v113
    v_mul_f32 v78, v78, v114
    v_mul_f32 v79, v79, v115
    v_cvt_pk_bf16_f32 v104, v76, v77
    v_cvt_pk_bf16_f32 v105, v78, v79
    v_add_f32 v80, v80, v44
    v_add_f32 v81, v81, v45
    v_add_f32 v82, v82, v46
    v_add_f32 v83, v83, v47
    v_mul_f32 v116, v80, v80
    v_mul_f32 v117, v81, v81
    v_mul_f32 v118, v82, v82
    v_mul_f32 v119, v83, v83
    v_fma_f32 v116, v116, v38, v37
    v_fma_f32 v117, v117, v38, v37
    v_fma_f32 v118, v118, v38, v37
    v_fma_f32 v119, v119, v38, v37
    v_mul_f32 v116, v116, v80
    v_mul_f32 v117, v117, v81
    v_mul_f32 v118, v118, v82
    v_mul_f32 v119, v119, v83
    v_exp_f32 v116, v116
    v_exp_f32 v117, v117
    v_exp_f32 v118, v118
    v_exp_f32 v119, v119
    v_add_f32 v116, 1.0, v116
    v_add_f32 v117, 1.0, v117
    v_add_f32 v118, 1.0, v118
    v_add_f32 v119, 1.0, v119
    v_rcp_f32 v116, v116
    v_rcp_f32 v117, v117
    v_rcp_f32 v118, v118
    v_rcp_f32 v119, v119
    v_mul_f32 v80, v80, v116
    v_mul_f32 v81, v81, v117
    v_mul_f32 v82, v82, v118
    v_mul_f32 v83, v83, v119
    v_cvt_pk_bf16_f32 v106, v80, v81
    v_cvt_pk_bf16_f32 v107, v82, v83
    v_add_f32 v84, v84, v48
    v_add_f32 v85, v85, v49
    v_add_f32 v86, v86, v50
    v_add_f32 v87, v87, v51
    v_mul_f32 v120, v84, v84
    v_mul_f32 v121, v85, v85
    v_mul_f32 v122, v86, v86
    v_mul_f32 v123, v87, v87
    v_fma_f32 v120, v120, v38, v37
    v_fma_f32 v121, v121, v38, v37
    v_fma_f32 v122, v122, v38, v37
    v_fma_f32 v123, v123, v38, v37
    v_mul_f32 v120, v120, v84
    v_mul_f32 v121, v121, v85
    v_mul_f32 v122, v122, v86
    v_mul_f32 v123, v123, v87
    v_exp_f32 v120, v120
    v_exp_f32 v121, v121
    v_exp_f32 v122, v122
    v_exp_f32 v123, v123
    v_add_f32 v120, 1.0, v120
    v_add_f32 v121, 1.0, v121
    v_add_f32 v122, 1.0, v122
    v_add_f32 v123, 1.0, v123
    v_rcp_f32 v120, v120
    v_rcp_f32 v121, v121
    v_rcp_f32 v122, v122
    v_rcp_f32 v123, v123
    v_mul_f32 v84, v84, v120
    v_mul_f32 v85, v85, v121
    v_mul_f32 v86, v86, v122
    v_mul_f32 v87, v87, v123
    v_cvt_pk_bf16_f32 v108, v84, v85
    v_cvt_pk_bf16_f32 v109, v86, v87
    global_store_dwordx4 v6, v[104:107], s[34:35] sc1
    global_store_dwordx2 v7, v[108:109], s[34:35] sc1
    s_add_u32 s39, s31, 1
    s_mov_b32 s31, s37
    s_branch .Lm1_top
.Lm1_end:
    s_branch .Lend
    s_branch .Lend
.Lrole_A:
    s_lshl_b32 s96, s15, 5
    s_add_u32 s96, s96, s13
    s_add_u32 s96, s96, 128
    s_mov_b32 s92, s15
    s_cmp_eq_u32 s15, 3
    s_cbranch_scc1 .Lrole_U
    s_bitcmp1_b32 s3, 1
    s_cbranch_scc0 .Lend
    s_lshl_b32 s16, s15, 3
    s_add_u32 s16, s16, 16
    s_load_dwordx2 s[20:21], s[0:1], s16
    s_lshl_b32 s17, s13, 2
    s_add_u32 s17, s17, s12
    s_mul_i32 s16, s17, 171
    s_lshr_b32 s16, s16, 9
    s_mul_i32 s18, s16, 3
    s_sub_u32 s17, s17, s18
    s_mul_i32 s16, s16, 12288
    s_lshl_b32 s17, s17, 11
    s_add_u32 s16, s16, s17
    s_mul_i32 s17, s15, 25165824
    s_add_u32 s16, s16, s17
    s_add_u32 s16, s16, 157286400
    s_add_u32 s24, s4, s16
    s_addc_u32 s25, s5, 0
    s_add_u32 s22, s4, 239075328
    s_addc_u32 s23, s5, 0
    s_lshl_b32 s26, s15, 12
    s_lshl_b32 s16, s13, 7
    s_add_u32 s26, s26, s16
    s_add_u32 s26, s26, 8192
    s_lshl_b32 s16, s13, 9
    s_waitcnt lgkmcnt(0)
    s_add_u32 s20, s20, s16
    s_addc_u32 s21, s21, 0
    v_lshrrev_b32 v16, 4, v1
    v_mul_u32_u24 v17, 4096, v16
    v_bfe_u32 v18, v1, 2, 2
    v_lshlrev_b32 v19, 7, v18
    v_add_u32 v17, v17, v19
    v_and_b32 v19, 3, v1
    v_lshlrev_b32 v19, 3, v19
    v_add_u32 v17, v17, v19
    v_lshrrev_b32 v18, 1, v18
    v_and_b32 v16, 1, v16
    v_lshlrev_b32 v16, 1, v16
    v_or_b32 v18, v18, v16
    v_xor_b32 v19, 0, v18
    v_lshlrev_b32 v19, 5, v19
    v_add_u32 v8, v17, v19
    v_xor_b32 v19, 1, v18
    v_lshlrev_b32 v19, 5, v19
    v_add_u32 v9, v17, v19
    v_xor_b32 v19, 2, v18
    v_lshlrev_b32 v19, 5, v19
    v_add_u32 v10, v17, v19
    v_xor_b32 v19, 3, v18
    v_lshlrev_b32 v19, 5, v19
    v_add_u32 v11, v17, v19
    s_lshl_b32 s16, s12, 10
    v_add_u32 v8, s16, v8
    v_add_u32 v9, s16, v9
    v_add_u32 v10, s16, v10
    v_add_u32 v11, s16, v11
    v_lshrrev_b32 v2, 3, v1
    v_mul_u32_u24 v3, 12288, v2
    v_lshrrev_b32 v4, 1, v2
    v_lshrrev_b32 v5, 2, v2
    v_xor_b32 v4, v4, v5
    v_and_b32 v4, 1, v4
    v_lshlrev_b32 v4, 1, v4
    v_and_b32 v5, 7, v1
    v_xor_b32 v4, v4, v5
    v_xor_b32 v5, 4, v4
    v_lshlrev_b32 v4, 4, v4
    v_lshlrev_b32 v5, 4, v5
    v_add_u32 v4, v4, v3
    v_add_u32 v5, v5, v3
    s_mul_i32 s15, s12, 196608
    s_add_u32 s20, s20, s15
    s_addc_u32 s21, s21, 0
    s_mul_i32 s17, s12, 8192
    s_add_u32 m0, s17, 0
    s_nop 0
    global_load_lds_dwordx4 v4, s[20:21] offset:0
    s_add_u32 m0, s17, 896
    s_nop 0
    global_load_lds_dwordx4 v4, s[20:21] offset:128
    s_add_u32 m0, s17, 1792
    s_nop 0
    global_load_lds_dwordx4 v4, s[20:21] offset:256
    s_add_u32 m0, s17, 2688
    s_nop 0
    global_load_lds_dwordx4 v4, s[20:21] offset:384
    s_add_u32 s20, s20, 98304
    s_addc_u32 s21, s21, 0
    s_add_u32 m0, s17, 4096
    s_nop 0
    global_load_lds_dwordx4 v5, s[20:21] offset:0
    s_add_u32 m0, s17, 4992
    s_nop 0
    global_load_lds_dwordx4 v5, s[20:21] offset:128
    s_add_u32 m0, s17, 5888
    s_nop 0
    global_load_lds_dwordx4 v5, s[20:21] offset:256
    s_add_u32 m0, s17, 6784
    s_nop 0
    global_load_lds_dwordx4 v5, s[20:21] offset:384
    s_add_u32 s20, s20, 688128
    s_addc_u32 s21, s21, 0
    s_add_u32 m0, s17, 32768
    s_nop 0
    global_load_lds_dwordx4 v4, s[20:21] offset:0
    s_add_u32 m0, s17, 33664
    s_nop 0
    global_load_lds_dwordx4 v4, s[20:21] offset:128
    s_add_u32 m0, s17, 34560
    s_nop 0
    global_load_lds_dwordx4 v4, s[20:21] offset:256
    s_add_u32 m0, s17, 35456
    s_nop 0
    global_load_lds_dwordx4 v4, s[20:21] offset:384
    s_add_u32 s20, s20, 98304
    s_addc_u32 s21, s21, 0
    s_add_u32 m0, s17, 36864
    s_nop 0
    global_load_lds_dwordx4 v5, s[20:21] offset:0
    s_add_u32 m0, s17, 37760
    s_nop 0
    global_load_lds_dwordx4 v5, s[20:21] offset:128
    s_add_u32 m0, s17, 38656
    s_nop 0
    global_load_lds_dwordx4 v5, s[20:21] offset:256
    s_add_u32 m0, s17, 39552
    s_nop 0
    global_load_lds_dwordx4 v5, s[20:21] offset:384
    s_add_u32 s20, s20, 688128
    s_addc_u32 s21, s21, 0
    s_waitcnt vmcnt(8)
    s_barrier
    s_add_u32 m0, s17, 65536
    s_nop 0
    global_load_lds_dwordx4 v4, s[20:21] offset:0
    s_add_u32 m0, s17, 66432
    s_nop 0
    global_load_lds_dwordx4 v4, s[20:21] offset:128
    s_add_u32 m0, s17, 67328
    s_nop 0
    global_load_lds_dwordx4 v4, s[20:21] offset:256
    s_add_u32 m0, s17, 68224
    s_nop 0
    global_load_lds_dwordx4 v4, s[20:21] offset:384
    s_add_u32 s20, s20, 98304
    s_addc_u32 s21, s21, 0
    s_add_u32 m0, s17, 69632
    s_nop 0
    global_load_lds_dwordx4 v5, s[20:21] offset:0
    s_add_u32 m0, s17, 70528
    s_nop 0
    global_load_lds_dwordx4 v5, s[20:21] offset:128
    s_add_u32 m0, s17, 71424
    s_nop 0
    global_load_lds_dwordx4 v5, s[20:21] offset:256
    s_add_u32 m0, s17, 72320
    s_nop 0
    global_load_lds_dwordx4 v5, s[20:21] offset:384
    s_add_u32 s20, s20, 688128
    s_addc_u32 s21, s21, 0
    v_add_u32 v20, 0, v8
    v_add_u32 v21, 0, v9
    v_add_u32 v22, 0, v10
    v_add_u32 v23, 0, v11
    ds_read_b64_tr_b16 a[0:1], v20 offset:0
    ds_read_b64_tr_b16 a[2:3], v21 offset:512
    ds_read_b64_tr_b16 a[4:5], v21 offset:0
    ds_read_b64_tr_b16 a[6:7], v20 offset:512
    ds_read_b64_tr_b16 a[8:9], v22 offset:0
    ds_read_b64_tr_b16 a[10:11], v23 offset:512
    ds_read_b64_tr_b16 a[12:13], v23 offset:0
    ds_read_b64_tr_b16 a[14:15], v22 offset:512
    ds_read_b64_tr_b16 a[16:17], v20 offset:16384
    ds_read_b64_tr_b16 a[18:19], v21 offset:16896
    ds_read_b64_tr_b16 a[20:21], v21 offset:16384
    ds_read_b64_tr_b16 a[22:23], v20 offset:16896
    ds_read_b64_tr_b16 a[24:25], v22 offset:16384
    ds_read_b64_tr_b16 a[26:27], v23 offset:16896
    ds_read_b64_tr_b16 a[28:29], v23 offset:16384
    ds_read_b64_tr_b16 a[30:31], v22 offset:16896
    s_waitcnt lgkmcnt(0)
    s_waitcnt vmcnt(8)
    s_barrier
    s_add_u32 m0, s17, 0
    s_nop 0
    global_load_lds_dwordx4 v4, s[20:21] offset:0
    s_add_u32 m0, s17, 896
    s_nop 0
    global_load_lds_dwordx4 v4, s[20:21] offset:128
    s_add_u32 m0, s17, 1792
    s_nop 0
    global_load_lds_dwordx4 v4, s[20:21] offset:256
    s_add_u32 m0, s17, 2688
    s_nop 0
    global_load_lds_dwordx4 v4, s[20:21] offset:384
    s_add_u32 s20, s20, 98304
    s_addc_u32 s21, s21, 0
    s_add_u32 m0, s17, 4096
    s_nop 0
    global_load_lds_dwordx4 v5, s[20:21] offset:0
    s_add_u32 m0, s17, 4992
    s_nop 0
    global_load_lds_dwordx4 v5, s[20:21] offset:128
    s_add_u32 m0, s17, 5888
    s_nop 0
    global_load_lds_dwordx4 v5, s[20:21] offset:256
    s_add_u32 m0, s17, 6784
    s_nop 0
    global_load_lds_dwordx4 v5, s[20:21] offset:384
    s_add_u32 s20, s20, 688128
    s_addc_u32 s21, s21, 0
    v_add_u32 v20, 32768, v8
    v_add_u32 v21, 32768, v9
    v_add_u32 v22, 32768, v10
    v_add_u32 v23, 32768, v11
    ds_read_b64_tr_b16 a[32:33], v20 offset:0
    ds_read_b64_tr_b16 a[34:35], v21 offset:512
    ds_read_b64_tr_b16 a[36:37], v21 offset:0
    ds_read_b64_tr_b16 a[38:39], v20 offset:512
    ds_read_b64_tr_b16 a[40:41], v22 offset:0
    ds_read_b64_tr_b16 a[42:43], v23 offset:512
    ds_read_b64_tr_b16 a[44:45], v23 offset:0
    ds_read_b64_tr_b16 a[46:47], v22 offset:512
    ds_read_b64_tr_b16 a[48:49], v20 offset:16384
    ds_read_b64_tr_b16 a[50:51], v21 offset:16896
    ds_read_b64_tr_b16 a[52:53], v21 offset:16384
    ds_read_b64_tr_b16 a[54:55], v20 offset:16896
    ds_read_b64_tr_b16 a[56:57], v22 offset:16384
    ds_read_b64_tr_b16 a[58:59], v23 offset:16896
    ds_read_b64_tr_b16 a[60:61], v23 offset:16384
    ds_read_b64_tr_b16 a[62:63], v22 offset:16896
    s_waitcnt lgkmcnt(0)
    s_waitcnt vmcnt(8)
    s_barrier
    s_add_u32 m0, s17, 32768
    s_nop 0
    global_load_lds_dwordx4 v4, s[20:21] offset:0
    s_add_u32 m0, s17, 33664
    s_nop 0
    global_load_lds_dwordx4 v4, s[20:21] offset:128
    s_add_u32 m0, s17, 34560
    s_nop 0
    global_load_lds_dwordx4 v4, s[20:21] offset:256
    s_add_u32 m0, s17, 35456
    s_nop 0
    global_load_lds_dwordx4 v4, s[20:21] offset:384
    s_add_u32 s20, s20, 98304
    s_addc_u32 s21, s21, 0
    s_add_u32 m0, s17, 36864
    s_nop 0
    global_load_lds_dwordx4 v5, s[20:21] offset:0
    s_add_u32 m0, s17, 37760
    s_nop 0
    global_load_lds_dwordx4 v5, s[20:21] offset:128
    s_add_u32 m0, s17, 38656
    s_nop 0
    global_load_lds_dwordx4 v5, s[20:21] offset:256
    s_add_u32 m0, s17, 39552
    s_nop 0
    global_load_lds_dwordx4 v5, s[20:21] offset:384
    s_add_u32 s20, s20, 688128
    s_addc_u32 s21, s21, 0
    v_add_u32 v20, 65536, v8
    v_add_u32 v21, 65536, v9
    v_add_u32 v22, 65536, v10
    v_add_u32 v23, 65536, v11
    ds_read_b64_tr_b16 a[64:65], v20 offset:0
    ds_read_b64_tr_b16 a[66:67], v21 offset:512
    ds_read_b64_tr_b16 a[68:69], v21 offset:0
    ds_read_b64_tr_b16 a[70:71], v20 offset:512
    ds_read_b64_tr_b16 a[72:73], v22 offset:0
    ds_read_b64_tr_b16 a[74:75], v23 offset:512
    ds_read_b64_tr_b16 a[76:77], v23 offset:0
    ds_read_b64_tr_b16 a[78:79], v22 offset:512
    ds_read_b64_tr_b16 a[80:81], v20 offset:16384
    ds_read_b64_tr_b16 a[82:83], v21 offset:16896
    ds_read_b64_tr_b16 a[84:85], v21 offset:16384
    ds_read_b64_tr_b16 a[86:87], v20 offset:16896
    ds_read_b64_tr_b16 a[88:89], v22 offset:16384
    ds_read_b64_tr_b16 a[90:91], v23 offset:16896
    ds_read_b64_tr_b16 a[92:93], v23 offset:16384
    ds_read_b64_tr_b16 a[94:95], v22 offset:16896
    s_waitcnt lgkmcnt(0)
    s_waitcnt vmcnt(8)
    s_barrier
    s_add_u32 m0, s17, 65536
    s_nop 0
    global_load_lds_dwordx4 v4, s[20:21] offset:0
    s_add_u32 m0, s17, 66432
    s_nop 0
    global_load_lds_dwordx4 v4, s[20:21] offset:128
    s_add_u32 m0, s17, 67328
    s_nop 0
    global_load_lds_dwordx4 v4, s[20:21] offset:256
    s_add_u32 m0, s17, 68224
    s_nop 0
    global_load_lds_dwordx4 v4, s[20:21] offset:384
    s_add_u32 s20, s20, 98304
    s_addc_u32 s21, s21, 0
    s_add_u32 m0, s17, 69632
    s_nop 0
    global_load_lds_dwordx4 v5, s[20:21] offset:0
    s_add_u32 m0, s17, 70528
    s_nop 0
    global_load_lds_dwordx4 v5, s[20:21] offset:128
    s_add_u32 m0, s17, 71424
    s_nop 0
    global_load_lds_dwordx4 v5, s[20:21] offset:256
    s_add_u32 m0, s17, 72320
    s_nop 0
    global_load_lds_dwordx4 v5, s[20:21] offset:384
    s_add_u32 s20, s20, 688128
    s_addc_u32 s21, s21, 0
    v_add_u32 v20, 0, v8
    v_add_u32 v21, 0, v9
    v_add_u32 v22, 0, v10
    v_add_u32 v23, 0, v11
    ds_read_b64_tr_b16 a[96:97], v20 offset:0
    ds_read_b64_tr_b16 a[98:99], v21 offset:512
    ds_read_b64_tr_b16 a[100:101], v21 offset:0
    ds_read_b64_tr_b16 a[102:103], v20 offset:512
    ds_read_b64_tr_b16 a[104:105], v22 offset:0
    ds_read_b64_tr_b16 a[106:107], v23 offset:512
    ds_read_b64_tr_b16 a[108:109], v23 offset:0
    ds_read_b64_tr_b16 a[110:111], v22 offset:512
    ds_read_b64_tr_b16 a[112:113], v20 offset:16384
    ds_read_b64_tr_b16 a[114:115], v21 offset:16896
    ds_read_b64_tr_b16 a[116:117], v21 offset:16384
    ds_read_b64_tr_b16 a[118:119], v20 offset:16896
    ds_read_b64_tr_b16 a[120:121], v22 offset:16384
    ds_read_b64_tr_b16 a[122:123], v23 offset:16896
    ds_read_b64_tr_b16 a[124:125], v23 offset:16384
    ds_read_b64_tr_b16 a[126:127], v22 offset:16896
    s_waitcnt lgkmcnt(0)
    s_waitcnt vmcnt(8)
    s_barrier
    s_add_u32 m0, s17, 0
    s_nop 0
    global_load_lds_dwordx4 v4, s[20:21] offset:0
    s_add_u32 m0, s17, 896
    s_nop 0
    global_load_lds_dwordx4 v4, s[20:21] offset:128
    s_add_u32 m0, s17, 1792
    s_nop 0
    global_load_lds_dwordx4 v4, s[20:21] offset:256
    s_add_u32 m0, s17, 2688
    s_nop 0
    global_load_lds_dwordx4 v4, s[20:21] offset:384
    s_add_u32 s20, s20, 98304
    s_addc_u32 s21, s21, 0
    s_add_u32 m0, s17, 4096
    s_nop 0
    global_load_lds_dwordx4 v5, s[20:21] offset:0
    s_add_u32 m0, s17, 4992
    s_nop 0
    global_load_lds_dwordx4 v5, s[20:21] offset:128
    s_add_u32 m0, s17, 5888
    s_nop 0
    global_load_lds_dwordx4 v5, s[20:21] offset:256
    s_add_u32 m0, s17, 6784
    s_nop 0
    global_load_lds_dwordx4 v5, s[20:21] offset:384
    s_add_u32 s20, s20, 688128
    s_addc_u32 s21, s21, 0
    v_add_u32 v20, 32768, v8
    v_add_u32 v21, 32768, v9
    v_add_u32 v22, 32768, v10
    v_add_u32 v23, 32768, v11
    ds_read_b64_tr_b16 a[128:129], v20 offset:0
    ds_read_b64_tr_b16 a[130:131], v21 offset:512
    ds_read_b64_tr_b16 a[132:133], v21 offset:0
    ds_read_b64_tr_b16 a[134:135], v20 offset:512
    ds_read_b64_tr_b16 a[136:137], v22 offset:0
    ds_read_b64_tr_b16 a[138:139], v23 offset:512
    ds_read_b64_tr_b16 a[140:141], v23 offset:0
    ds_read_b64_tr_b16 a[142:143], v22 offset:512
    ds_read_b64_tr_b16 a[144:145], v20 offset:16384
    ds_read_b64_tr_b16 a[146:147], v21 offset:16896
    ds_read_b64_tr_b16 a[148:149], v21 offset:16384
    ds_read_b64_tr_b16 a[150:151], v20 offset:16896
    ds_read_b64_tr_b16 a[152:153], v22 offset:16384
    ds_read_b64_tr_b16 a[154:155], v23 offset:16896
    ds_read_b64_tr_b16 a[156:157], v23 offset:16384
    ds_read_b64_tr_b16 a[158:159], v22 offset:16896
    s_waitcnt lgkmcnt(0)
    s_waitcnt vmcnt(8)
    s_barrier
    s_add_u32 m0, s17, 32768
    s_nop 0
    global_load_lds_dwordx4 v4, s[20:21] offset:0
    s_add_u32 m0, s17, 33664
    s_nop 0
    global_load_lds_dwordx4 v4, s[20:21] offset:128
    s_add_u32 m0, s17, 34560
    s_nop 0
    global_load_lds_dwordx4 v4, s[20:21] offset:256
    s_add_u32 m0, s17, 35456
    s_nop 0
    global_load_lds_dwordx4 v4, s[20:21] offset:384
    s_add_u32 s20, s20, 98304
    s_addc_u32 s21, s21, 0
    s_add_u32 m0, s17, 36864
    s_nop 0
    global_load_lds_dwordx4 v5, s[20:21] offset:0
    s_add_u32 m0, s17, 37760
    s_nop 0
    global_load_lds_dwordx4 v5, s[20:21] offset:128
    s_add_u32 m0, s17, 38656
    s_nop 0
    global_load_lds_dwordx4 v5, s[20:21] offset:256
    s_add_u32 m0, s17, 39552
    s_nop 0
    global_load_lds_dwordx4 v5, s[20:21] offset:384
    s_add_u32 s20, s20, 688128
    s_addc_u32 s21, s21, 0
    v_add_u32 v20, 65536, v8
    v_add_u32 v21, 65536, v9
    v_add_u32 v22, 65536, v10
    v_add_u32 v23, 65536, v11
    ds_read_b64_tr_b16 a[160:161], v20 offset:0
    ds_read_b64_tr_b16 a[162:163], v21 offset:512
    ds_read_b64_tr_b16 a[164:165], v21 offset:0
    ds_read_b64_tr_b16 a[166:167], v20 offset:512
    ds_read_b64_tr_b16 a[168:169], v22 offset:0
    ds_read_b64_tr_b16 a[170:171], v23 offset:512
    ds_read_b64_tr_b16 a[172:173], v23 offset:0
    ds_read_b64_tr_b16 a[174:175], v22 offset:512
    ds_read_b64_tr_b16 a[176:177], v20 offset:16384
    ds_read_b64_tr_b16 a[178:179], v21 offset:16896
    ds_read_b64_tr_b16 a[180:181], v21 offset:16384
    ds_read_b64_tr_b16 a[182:183], v20 offset:16896
    ds_read_b64_tr_b16 a[184:185], v22 offset:16384
    ds_read_b64_tr_b16 a[186:187], v23 offset:16896
    ds_read_b64_tr_b16 a[188:189], v23 offset:16384
    ds_read_b64_tr_b16 a[190:191], v22 offset:16896
    s_waitcnt lgkmcnt(0)
    s_waitcnt vmcnt(8)
    s_barrier
    s_add_u32 m0, s17, 65536
    s_nop 0
    global_load_lds_dwordx4 v4, s[20:21] offset:0
    s_add_u32 m0, s17, 66432
    s_nop 0
    global_load_lds_dwordx4 v4, s[20:21] offset:128
    s_add_u32 m0, s17, 67328
    s_nop 0
    global_load_lds_dwordx4 v4, s[20:21] offset:256
    s_add_u32 m0, s17, 68224
    s_nop 0
    global_load_lds_dwordx4 v4, s[20:21] offset:384
    s_add_u32 s20, s20, 98304
    s_addc_u32 s21, s21, 0
    s_add_u32 m0, s17, 69632
    s_nop 0
    global_load_lds_dwordx4 v5, s[20:21] offset:0
    s_add_u32 m0, s17, 70528
    s_nop 0
    global_load_lds_dwordx4 v5, s[20:21] offset:128
    s_add_u32 m0, s17, 71424
    s_nop 0
    global_load_lds_dwordx4 v5, s[20:21] offset:256
    s_add_u32 m0, s17, 72320
    s_nop 0
    global_load_lds_dwordx4 v5, s[20:21] offset:384
    s_add_u32 s20, s20, 688128
    s_addc_u32 s21, s21, 0
    v_add_u32 v20, 0, v8
    v_add_u32 v21, 0, v9
    v_add_u32 v22, 0, v10
    v_add_u32 v23, 0, v11
    ds_read_b64_tr_b16 a[192:193], v20 offset:0
    ds_read_b64_tr_b16 a[194:195], v21 offset:512
    ds_read_b64_tr_b16 a[196:197], v21 offset:0
    ds_read_b64_tr_b16 a[198:199], v20 offset:512
    ds_read_b64_tr_b16 a[200:201], v22 offset:0
    ds_read_b64_tr_b16 a[202:203], v23 offset:512
    ds_read_b64_tr_b16 a[204:205], v23 offset:0
    ds_read_b64_tr_b16 a[206:207], v22 offset:512
    ds_read_b64_tr_b16 a[208:209], v20 offset:16384
    ds_read_b64_tr_b16 a[210:211], v21 offset:16896
    ds_read_b64_tr_b16 a[212:213], v21 offset:16384
    ds_read_b64_tr_b16 a[214:215], v20 offset:16896
    ds_read_b64_tr_b16 a[216:217], v22 offset:16384
    ds_read_b64_tr_b16 a[218:219], v23 offset:16896
    ds_read_b64_tr_b16 a[220:221], v23 offset:16384
    ds_read_b64_tr_b16 a[222:223], v22 offset:16896
    s_waitcnt lgkmcnt(0)
    s_waitcnt vmcnt(8)
    s_barrier
    s_add_u32 m0, s17, 0
    s_nop 0
    global_load_lds_dwordx4 v4, s[20:21] offset:0
    s_add_u32 m0, s17, 896
    s_nop 0
    global_load_lds_dwordx4 v4, s[20:21] offset:128
    s_add_u32 m0, s17, 1792
    s_nop 0
    global_load_lds_dwordx4 v4, s[20:21] offset:256
    s_add_u32 m0, s17, 2688
    s_nop 0
    global_load_lds_dwordx4 v4, s[20:21] offset:384
    s_add_u32 s20, s20, 98304
    s_addc_u32 s21, s21, 0
    s_add_u32 m0, s17, 4096
    s_nop 0
    global_load_lds_dwordx4 v5, s[20:21] offset:0
    s_add_u32 m0, s17, 4992
    s_nop 0
    global_load_lds_dwordx4 v5, s[20:21] offset:128
    s_add_u32 m0, s17, 5888
    s_nop 0
    global_load_lds_dwordx4 v5, s[20:21] offset:256
    s_add_u32 m0, s17, 6784
    s_nop 0
    global_load_lds_dwordx4 v5, s[20:21] offset:384
    s_add_u32 s20, s20, 688128
    s_addc_u32 s21, s21, 0
    v_add_u32 v20, 32768, v8
    v_add_u32 v21, 32768, v9
    v_add_u32 v22, 32768, v10
    v_add_u32 v23, 32768, v11
    ds_read_b64_tr_b16 a[224:225], v20 offset:0
    ds_read_b64_tr_b16 a[226:227], v21 offset:512
    ds_read_b64_tr_b16 a[228:229], v21 offset:0
    ds_read_b64_tr_b16 a[230:231], v20 offset:512
    ds_read_b64_tr_b16 a[232:233], v22 offset:0
    ds_read_b64_tr_b16 a[234:235], v23 offset:512
    ds_read_b64_tr_b16 a[236:237], v23 offset:0
    ds_read_b64_tr_b16 a[238:239], v22 offset:512
    ds_read_b64_tr_b16 a[240:241], v20 offset:16384
    ds_read_b64_tr_b16 a[242:243], v21 offset:16896
    ds_read_b64_tr_b16 a[244:245], v21 offset:16384
    ds_read_b64_tr_b16 a[246:247], v20 offset:16896
    ds_read_b64_tr_b16 a[248:249], v22 offset:16384
    ds_read_b64_tr_b16 a[250:251], v23 offset:16896
    ds_read_b64_tr_b16 a[252:253], v23 offset:16384
    ds_read_b64_tr_b16 a[254:255], v22 offset:16896
    s_waitcnt lgkmcnt(0)
    s_waitcnt vmcnt(8)
    s_barrier
    v_add_u32 v20, 65536, v8
    v_add_u32 v21, 65536, v9
    v_add_u32 v22, 65536, v10
    v_add_u32 v23, 65536, v11
    ds_read_b64_tr_b16 v[192:193], v20 offset:0
    ds_read_b64_tr_b16 v[194:195], v21 offset:512
    ds_read_b64_tr_b16 v[196:197], v21 offset:0
    ds_read_b64_tr_b16 v[198:199], v20 offset:512
    ds_read_b64_tr_b16 v[200:201], v22 offset:0
    ds_read_b64_tr_b16 v[202:203], v23 offset:512
    ds_read_b64_tr_b16 v[204:205], v23 offset:0
    ds_read_b64_tr_b16 v[206:207], v22 offset:512
    ds_read_b64_tr_b16 v[208:209], v20 offset:16384
    ds_read_b64_tr_b16 v[210:211], v21 offset:16896
    ds_read_b64_tr_b16 v[212:213], v21 offset:16384
    ds_read_b64_tr_b16 v[214:215], v20 offset:16896
    ds_read_b64_tr_b16 v[216:217], v22 offset:16384
    ds_read_b64_tr_b16 v[218:219], v23 offset:16896
    ds_read_b64_tr_b16 v[220:221], v23 offset:16384
    ds_read_b64_tr_b16 v[222:223], v22 offset:16896
    s_waitcnt lgkmcnt(0)
    s_waitcnt vmcnt(0)
    s_barrier
    v_add_u32 v20, 0, v8
    v_add_u32 v21, 0, v9
    v_add_u32 v22, 0, v10
    v_add_u32 v23, 0, v11
    ds_read_b64_tr_b16 v[224:225], v20 offset:0
    ds_read_b64_tr_b16 v[226:227], v21 offset:512
    ds_read_b64_tr_b16 v[228:229], v21 offset:0
    ds_read_b64_tr_b16 v[230:231], v20 offset:512
    ds_read_b64_tr_b16 v[232:233], v22 offset:0
    ds_read_b64_tr_b16 v[234:235], v23 offset:512
    ds_read_b64_tr_b16 v[236:237], v23 offset:0
    ds_read_b64_tr_b16 v[238:239], v22 offset:512
    ds_read_b64_tr_b16 v[240:241], v20 offset:16384
    ds_read_b64_tr_b16 v[242:243], v21 offset:16896
    ds_read_b64_tr_b16 v[244:245], v21 offset:16384
    ds_read_b64_tr_b16 v[246:247], v20 offset:16896
    ds_read_b64_tr_b16 v[248:249], v22 offset:16384
    ds_read_b64_tr_b16 v[250:251], v23 offset:16896
    ds_read_b64_tr_b16 v[252:253], v23 offset:16384
    ds_read_b64_tr_b16 v[254:255], v22 offset:16896
    s_waitcnt lgkmcnt(0)
    s_barrier
    v_lshlrev_b32 v4, 4, v1
    s_mul_i32 s30, s12, 10240
    v_add_u32 v5, s30, v4
    v_add_u32 v32, 40960, v4
    v_add_u32 v6, 6144, v4
    s_mov_b32 s31, 0
    s_mov_b32 s32, 0
    v_mov_b32 v2, 128
.iw_63:
    global_load_dword v3, v2, s[6:7] sc0 sc1
    s_waitcnt vmcnt(0)
    v_readfirstlane_b32 s15, v3
    s_nop 3
    s_cmp_ge_u32 s15, 64
    s_cbranch_scc1 .iwd_64
    s_sleep 4
    s_add_u32 s14, s14, 1
    s_cmp_gt_u32 s14, 400000
    s_cbranch_scc1 .Lend
    s_branch .iw_63
.iwd_64:
    s_mov_b32 s33, 1
    s_mov_b32 s34, 0
    s_cmp_ge_u32 s34, s33
    s_cbranch_scc1 .wpd_66
    v_and_b32 v2, 1, v1
    v_lshlrev_b32 v2, 7, v2
    v_add_u32 v2, 0, v2
.wp_65:
    global_load_dword v3, v2, s[10:11] sc1
    s_waitcnt vmcnt(0)
    s_nop 1
    v_min_u32_dpp v3, v3, v3 row_ror:1 row_mask:0xf bank_mask:0xf
    s_nop 1
    v_readlane_b32 s34, v3, 0
    s_cmp_ge_u32 s34, s33
    s_cbranch_scc1 .wpd_66
    s_sleep 2
    s_add_u32 s14, s14, 1
    s_cmp_gt_u32 s14, 400000
    s_cbranch_scc1 .Lend
    s_branch .wp_65
.wpd_66:
    s_add_u32 m0, s30, 0
    s_nop 0
    global_load_lds_dwordx4 v5, s[22:23] offset:0 sc1
    global_load_lds_dwordx4 v5, s[22:23] offset:1024 sc1
    global_load_lds_dwordx4 v5, s[22:23] offset:2048 sc1
    global_load_lds_dwordx4 v5, s[22:23] offset:3072 sc1
    s_add_u32 m0, s30, 4096
    v_add_u32 v5, 4096, v5
    global_load_lds_dwordx4 v5, s[22:23] offset:0 sc1
    global_load_lds_dwordx4 v5, s[22:23] offset:1024 sc1
    global_load_lds_dwordx4 v5, s[22:23] offset:2048 sc1
    global_load_lds_dwordx4 v5, s[22:23] offset:3072 sc1
    s_add_u32 m0, s30, 8192
    v_add_u32 v5, 4096, v5
    global_load_lds_dwordx4 v5, s[22:23] offset:0 sc1
    global_load_lds_dwordx4 v5, s[22:23] offset:1024 sc1
    v_subrev_u32 v5, 8192, v5
    s_add_u32 s22, s22, 40960
    s_addc_u32 s23, s23, 0
    s_waitcnt vmcnt(0)
    s_waitcnt vmcnt(0)
.Lp4_top:
    s_sub_u32 s33, s31, 1
    s_cmp_gt_u32 s31, 8
    s_cbranch_scc1 .eg_67
    s_waitcnt vmcnt(0)
    s_mov_b32 s33, s31
.eg_67:
    s_waitcnt vmcnt(2)
    s_barrier
    s_cmp_lg_u32 s12, 0
    s_cbranch_scc1 .pub_68
    v_mov_b32 v2, s26
    v_mov_b32 v3, s33
    s_mov_b64 exec, 1
    global_store_dword v2, v3, s[10:11] sc1
    s_mov_b64 exec, -1
.pub_68:
    ds_read_b128 v[128:131], v4 offset:0
    ds_read_b128 v[132:135], v4 offset:1024
    ds_read_b128 v[136:139], v4 offset:2048
    ds_read_b128 v[140:143], v4 offset:3072
    ds_read_b128 v[144:147], v4 offset:4096
    ds_read_b128 v[148:151], v4 offset:5120
    ds_read_b128 v[152:155], v4 offset:6144
    ds_read_b128 v[156:159], v4 offset:7168
    s_waitcnt lgkmcnt(7)
    v_mfma_f32_16x16x32_bf16 v[64:67], a[0:3], v[128:131], 0
    v_mfma_f32_16x16x32_bf16 v[68:71], a[4:7], v[128:131], 0
    v_mfma_f32_16x16x32_bf16 v[72:75], a[8:11], v[128:131], 0
    v_mfma_f32_16x16x32_bf16 v[76:79], a[12:15], v[128:131], 0
    ds_read_b128 v[128:131], v4 offset:8192
    s_waitcnt lgkmcnt(7)
    v_mfma_f32_16x16x32_bf16 v[64:67], a[16:19], v[132:135], v[64:67]
    v_mfma_f32_16x16x32_bf16 v[68:71], a[20:23], v[132:135], v[68:71]
    v_mfma_f32_16x16x32_bf16 v[72:75], a[24:27], v[132:135], v[72:75]
    v_mfma_f32_16x16x32_bf16 v[76:79], a[28:31], v[132:135], v[76:79]
    s_add_u32 m0, s30, 40960
    s_nop 0
    global_load_lds_dwordx4 v5, s[22:23] offset:0 sc1
    ds_read_b128 v[132:135], v4 offset:9216
    s_waitcnt lgkmcnt(7)
    v_mfma_f32_16x16x32_bf16 v[64:67], a[32:35], v[136:139], v[64:67]
    v_mfma_f32_16x16x32_bf16 v[68:71], a[36:39], v[136:139], v[68:71]
    v_mfma_f32_16x16x32_bf16 v[72:75], a[40:43], v[136:139], v[72:75]
    v_mfma_f32_16x16x32_bf16 v[76:79], a[44:47], v[136:139], v[76:79]
    ds_read_b128 v[136:139], v4 offset:10240
    s_waitcnt lgkmcnt(7)
    v_mfma_f32_16x16x32_bf16 v[64:67], a[48:51], v[140:143], v[64:67]
    v_mfma_f32_16x16x32_bf16 v[68:71], a[52:55], v[140:143], v[68:71]
    v_mfma_f32_16x16x32_bf16 v[72:75], a[56:59], v[140:143], v[72:75]
    v_mfma_f32_16x16x32_bf16 v[76:79], a[60:63], v[140:143], v[76:79]
    global_load_lds_dwordx4 v5, s[22:23] offset:1024 sc1
    ds_read_b128 v[140:143], v4 offset:11264
    s_waitcnt lgkmcnt(7)
    v_mfma_f32_16x16x32_bf16 v[64:67], a[64:67], v[144:147], v[64:67]
    v_mfma_f32_16x16x32_bf16 v[68:71], a[68:71], v[144:147], v[68:71]
    v_mfma_f32_16x16x32_bf16 v[72:75], a[72:75], v[144:147], v[72:75]
    v_mfma_f32_16x16x32_bf16 v[76:79], a[76:79], v[144:147], v[76:79]
    ds_read_b128 v[144:147], v4 offset:12288
    s_waitcnt lgkmcnt(7)
    v_mfma_f32_16x16x32_bf16 v[64:67], a[80:83], v[148:151], v[64:67]
    v_mfma_f32_16x16x32_bf16 v[68:71], a[84:87], v[148:151], v[68:71]
    v_mfma_f32_16x16x32_bf16 v[72:75], a[88:91], v[148:151], v[72:75]
    v_mfma_f32_16x16x32_bf16 v[76:79], a[92:95], v[148:151], v[76:79]
    global_load_lds_dwordx4 v5, s[22:23] offset:2048 sc1
    ds_read_b128 v[148:151], v4 offset:13312
    s_waitcnt lgkmcnt(7)
    v_mfma_f32_16x16x32_bf16 v[64:67], a[96:99], v[152:155], v[64:67]
    v_mfma_f32_16x16x32_bf16 v[68:71], a[100:103], v[152:155], v[68:71]
    v_mfma_f32_16x16x32_bf16 v[72:75], a[104:107], v[152:155], v[72:75]
    v_mfma_f32_16x16x32_bf16 v[76:79], a[108:111], v[152:155], v[76:79]
    ds_read_b128 v[152:155], v4 offset:14336
    s_waitcnt lgkmcnt(7)
    v_mfma_f32_16x16x32_bf16 v[64:67], a[112:115], v[156:159], v[64:67]
    v_mfma_f32_16x16x32_bf16 v[68:71], a[116:119], v[156:159], v[68:71]
    v_mfma_f32_16x16x32_bf16 v[72:75], a[120:123], v[156:159], v[72:75]
    v_mfma_f32_16x16x32_bf16 v[76:79], a[124:127], v[156:159], v[76:79]
    global_load_lds_dwordx4 v5, s[22:23] offset:3072 sc1
    ds_read_b128 v[156:159], v4 offset:15360
    s_waitcnt lgkmcnt(7)
    v_mfma_f32_16x16x32_bf16 v[64:67], a[128:131], v[128:131], v[64:67]
    v_mfma_f32_16x16x32_bf16 v[68:71], a[132:135], v[128:131], v[68:71]
    v_mfma_f32_16x16x32_bf16 v[72:75], a[136:139], v[128:131], v[72:75]
    v_mfma_f32_16x16x32_bf16 v[76:79], a[140:143], v[128:131], v[76:79]
    ds_read_b128 v[128:131], v4 offset:16384
    s_waitcnt lgkmcnt(7)
    v_mfma_f32_16x16x32_bf16 v[64:67], a[144:147], v[132:135], v[64:67]
    v_mfma_f32_16x16x32_bf16 v[68:71], a[148:151], v[132:135], v[68:71]
    v_mfma_f32_16x16x32_bf16 v[72:75], a[152:155], v[132:135], v[72:75]
    v_mfma_f32_16x16x32_bf16 v[76:79], a[156:159], v[132:135], v[76:79]
    s_add_u32 m0, s30, 45056
    v_add_u32 v5, 4096, v5
    global_load_lds_dwordx4 v5, s[22:23] offset:0 sc1
    ds_read_b128 v[132:135], v4 offset:17408
    s_waitcnt lgkmcnt(7)
    v_mfma_f32_16x16x32_bf16 v[64:67], a[160:163], v[136:139], v[64:67]
    v_mfma_f32_16x16x32_bf16 v[68:71], a[164:167], v[136:139], v[68:71]
    v_mfma_f32_16x16x32_bf16 v[72:75], a[168:171], v[136:139], v[72:75]
    v_mfma_f32_16x16x32_bf16 v[76:79], a[172:175], v[136:139], v[76:79]
    ds_read_b128 v[136:139], v4 offset:18432
    s_waitcnt lgkmcnt(7)
    v_mfma_f32_16x16x32_bf16 v[64:67], a[176:179], v[140:143], v[64:67]
    v_mfma_f32_16x16x32_bf16 v[68:71], a[180:183], v[140:143], v[68:71]
    v_mfma_f32_16x16x32_bf16 v[72:75], a[184:187], v[140:143], v[72:75]
    v_mfma_f32_16x16x32_bf16 v[76:79], a[188:191], v[140:143], v[76:79]
    global_load_lds_dwordx4 v5, s[22:23] offset:1024 sc1
    ds_read_b128 v[140:143], v4 offset:19456
    s_waitcnt lgkmcnt(7)
    v_mfma_f32_16x16x32_bf16 v[64:67], a[192:195], v[144:147], v[64:67]
    v_mfma_f32_16x16x32_bf16 v[68:71], a[196:199], v[144:147], v[68:71]
    v_mfma_f32_16x16x32_bf16 v[72:75], a[200:203], v[144:147], v[72:75]
    v_mfma_f32_16x16x32_bf16 v[76:79], a[204:207], v[144:147], v[76:79]
    ds_read_b128 v[144:147], v4 offset:20480
    s_waitcnt lgkmcnt(7)
    v_mfma_f32_16x16x32_bf16 v[64:67], a[208:211], v[148:151], v[64:67]
    v_mfma_f32_16x16x32_bf16 v[68:71], a[212:215], v[148:151], v[68:71]
    v_mfma_f32_16x16x32_bf16 v[72:75], a[216:219], v[148:151], v[72:75]
    v_mfma_f32_16x16x32_bf16 v[76:79], a[220:223], v[148:151], v[76:79]
    global_load_lds_dwordx4 v5, s[22:23] offset:2048 sc1
    ds_read_b128 v[148:151], v4 offset:21504
    s_waitcnt lgkmcnt(7)
    v_mfma_f32_16x16x32_bf16 v[64:67], a[224:227], v[152:155], v[64:67]
    v_mfma_f32_16x16x32_bf16 v[68:71], a[228:231], v[152:155], v[68:71]
    v_mfma_f32_16x16x32_bf16 v[72:75], a[232:235], v[152:155], v[72:75]
    v_mfma_f32_16x16x32_bf16 v[76:79], a[236:239], v[152:155], v[76:79]
    ds_read_b128 v[152:155], v4 offset:22528
    s_waitcnt lgkmcnt(7)
    v_mfma_f32_16x16x32_bf16 v[64:67], a[240:243], v[156:159], v[64:67]
    v_mfma_f32_16x16x32_bf16 v[68:71], a[244:247], v[156:159], v[68:71]
    v_mfma_f32_16x16x32_bf16 v[72:75], a[248:251], v[156:159], v[72:75]
    v_mfma_f32_16x16x32_bf16 v[76:79], a[252:255], v[156:159], v[76:79]
    global_load_lds_dwordx4 v5, s[22:23] offset:3072 sc1
    ds_read_b128 v[156:159], v4 offset:23552
    s_waitcnt lgkmcnt(7)
    v_mfma_f32_16x16x32_bf16 v[64:67], v[192:195], v[128:131], v[64:67]
    v_mfma_f32_16x16x32_bf16 v[68:71], v[196:199], v[128:131], v[68:71]
    v_mfma_f32_16x16x32_bf16 v[72:75], v[200:203], v[128:131], v[72:75]
    v_mfma_f32_16x16x32_bf16 v[76:79], v[204:207], v[128:131], v[76:79]
    ds_read_b128 v[128:131], v4 offset:24576
    s_waitcnt lgkmcnt(7)
    v_mfma_f32_16x16x32_bf16 v[64:67], v[208:211], v[132:135], v[64:67]
    v_mfma_f32_16x16x32_bf16 v[68:71], v[212:215], v[132:135], v[68:71]
    v_mfma_f32_16x16x32_bf16 v[72:75], v[216:219], v[132:135], v[72:75]
    v_mfma_f32_16x16x32_bf16 v[76:79], v[220:223], v[132:135], v[76:79]
    s_add_u32 m0, s30, 49152
    v_add_u32 v5, 4096, v5
    global_load_lds_dwordx4 v5, s[22:23] offset:0 sc1
    ds_read_b128 v[132:135], v4 offset:25600
    s_waitcnt lgkmcnt(7)
    v_mfma_f32_16x16x32_bf16 v[64:67], v[224:227], v[136:139], v[64:67]
    v_mfma_f32_16x16x32_bf16 v[68:71], v[228:231], v[136:139], v[68:71]
    v_mfma_f32_16x16x32_bf16 v[72:75], v[232:235], v[136:139], v[72:75]
    v_mfma_f32_16x16x32_bf16 v[76:79], v[236:239], v[136:139], v[76:79]
    ds_read_b128 v[136:139], v4 offset:26624
    s_waitcnt lgkmcnt(7)
    v_mfma_f32_16x16x32_bf16 v[64:67], v[240:243], v[140:143], v[64:67]
    v_mfma_f32_16x16x32_bf16 v[68:71], v[244:247], v[140:143], v[68:71]
    v_mfma_f32_16x16x32_bf16 v[72:75], v[248:251], v[140:143], v[72:75]
    v_mfma_f32_16x16x32_bf16 v[76:79], v[252:255], v[140:143], v[76:79]
    global_load_lds_dwordx4 v5, s[22:23] offset:1024 sc1
    v_subrev_u32 v5, 8192, v5
    ds_read_b128 v[140:143], v4 offset:27648
    s_waitcnt lgkmcnt(7)
    v_mfma_f32_16x16x32_bf16 v[80:83], a[0:3], v[144:147], 0
    v_mfma_f32_16x16x32_bf16 v[84:87], a[4:7], v[144:147], 0
    v_mfma_f32_16x16x32_bf16 v[88:91], a[8:11], v[144:147], 0
    v_mfma_f32_16x16x32_bf16 v[92:95], a[12:15], v[144:147], 0
    ds_read_b128 v[144:147], v4 offset:28672
    s_waitcnt lgkmcnt(7)
    v_mfma_f32_16x16x32_bf16 v[80:83], a[16:19], v[148:151], v[80:83]
    v_mfma_f32_16x16x32_bf16 v[84:87], a[20:23], v[148:151], v[84:87]
    v_mfma_f32_16x16x32_bf16 v[88:91], a[24:27], v[148:151], v[88:91]
    v_mfma_f32_16x16x32_bf16 v[92:95], a[28:31], v[148:151], v[92:95]
    ds_read_b128 v[148:151], v4 offset:29696
    s_waitcnt lgkmcnt(7)
    v_mfma_f32_16x16x32_bf16 v[80:83], a[32:35], v[152:155], v[80:83]
    v_mfma_f32_16x16x32_bf16 v[84:87], a[36:39], v[152:155], v[84:87]
    v_mfma_f32_16x16x32_bf16 v[88:91], a[40:43], v[152:155], v[88:91]
    v_mfma_f32_16x16x32_bf16 v[92:95], a[44:47], v[152:155], v[92:95]
    ds_read_b128 v[152:155], v4 offset:30720
    s_waitcnt lgkmcnt(7)
    v_mfma_f32_16x16x32_bf16 v[80:83], a[48:51], v[156:159], v[80:83]
    v_mfma_f32_16x16x32_bf16 v[84:87], a[52:55], v[156:159], v[84:87]
    v_cvt_pk_bf16_f32 v96, v64, v65
    v_mfma_f32_16x16x32_bf16 v[88:91], a[56:59], v[156:159], v[88:91]
    v_mfma_f32_16x16x32_bf16 v[92:95], a[60:63], v[156:159], v[92:95]
    v_cvt_pk_bf16_f32 v97, v66, v67
    ds_read_b128 v[156:159], v4 offset:31744
    s_waitcnt lgkmcnt(7)
    v_mfma_f32_16x16x32_bf16 v[80:83], a[64:67], v[128:131], v[80:83]
    v_mfma_f32_16x16x32_bf16 v[84:87], a[68:71], v[128:131], v[84:87]
    v_cvt_pk_bf16_f32 v98, v68, v69
    v_mfma_f32_16x16x32_bf16 v[88:91], a[72:75], v[128:131], v[88:91]
    v_mfma_f32_16x16x32_bf16 v[92:95], a[76:79], v[128:131], v[92:95]
    v_cvt_pk_bf16_f32 v99, v70, v71
    ds_read_b128 v[128:131], v4 offset:32768
    s_waitcnt lgkmcnt(7)
    v_mfma_f32_16x16x32_bf16 v[80:83], a[80:83], v[132:135], v[80:83]
    v_mfma_f32_16x16x32_bf16 v[84:87], a[84:87], v[132:135], v[84:87]
    global_store_dwordx4 v4, v[96:99], s[24:25] offset:0 sc1
    v_mfma_f32_16x16x32_bf16 v[88:91], a[88:91], v[132:135], v[88:91]
    v_mfma_f32_16x16x32_bf16 v[92:95], a[92:95], v[132:135], v[92:95]
    v_cvt_pk_bf16_f32 v100, v72, v73
    ds_read_b128 v[132:135], v4 offset:33792
    s_waitcnt lgkmcnt(7)
    v_mfma_f32_16x16x32_bf16 v[80:83], a[96:99], v[136:139], v[80:83]
    v_mfma_f32_16x16x32_bf16 v[84:87], a[100:103], v[136:139], v[84:87]
    v_cvt_pk_bf16_f32 v101, v74, v75
    v_mfma_f32_16x16x32_bf16 v[88:91], a[104:107], v[136:139], v[88:91]
    v_mfma_f32_16x16x32_bf16 v[92:95], a[108:111], v[136:139], v[92:95]
    v_cvt_pk_bf16_f32 v102, v76, v77
    ds_read_b128 v[136:139], v4 offset:34816
    s_waitcnt lgkmcnt(7)
    v_mfma_f32_16x16x32_bf16 v[80:83], a[112:115], v[140:143], v[80:83]
    v_mfma_f32_16x16x32_bf16 v[84:87], a[116:119], v[140:143], v[84:87]
    v_cvt_pk_bf16_f32 v103, v78, v79
    v_mfma_f32_16x16x32_bf16 v[88:91], a[120:123], v[140:143], v[88:91]
    v_mfma_f32_16x16x32_bf16 v[92:95], a[124:127], v[140:143], v[92:95]
    global_store_dwordx4 v4, v[100:103], s[24:25] offset:1024 sc1
    ds_read_b128 v[140:143], v4 offset:35840
    s_waitcnt lgkmcnt(7)
    v_mfma_f32_16x16x32_bf16 v[80:83], a[128:131], v[144:147], v[80:83]
    v_mfma_f32_16x16x32_bf16 v[84:87], a[132:135], v[144:147], v[84:87]
    v_mfma_f32_16x16x32_bf16 v[88:91], a[136:139], v[144:147], v[88:91]
    v_mfma_f32_16x16x32_bf16 v[92:95], a[140:143], v[144:147], v[92:95]
    ds_read_b128 v[144:147], v4 offset:36864
    s_waitcnt lgkmcnt(7)
    v_mfma_f32_16x16x32_bf16 v[80:83], a[144:147], v[148:151], v[80:83]
    v_mfma_f32_16x16x32_bf16 v[84:87], a[148:151], v[148:151], v[84:87]
    v_mfma_f32_16x16x32_bf16 v[88:91], a[152:155], v[148:151], v[88:91]
    v_mfma_f32_16x16x32_bf16 v[92:95], a[156:159], v[148:151], v[92:95]
    ds_read_b128 v[148:151], v4 offset:37888
    s_waitcnt lgkmcnt(7)
    v_mfma_f32_16x16x32_bf16 v[80:83], a[160:163], v[152:155], v[80:83]
    v_mfma_f32_16x16x32_bf16 v[84:87], a[164:167], v[152:155], v[84:87]
    v_mfma_f32_16x16x32_bf16 v[88:91], a[168:171], v[152:155], v[88:91]
    v_mfma_f32_16x16x32_bf16 v[92:95], a[172:175], v[152:155], v[92:95]
    ds_read_b128 v[152:155], v4 offset:38912
    s_waitcnt lgkmcnt(7)
    v_mfma_f32_16x16x32_bf16 v[80:83], a[176:179], v[156:159], v[80:83]
    v_mfma_f32_16x16x32_bf16 v[84:87], a[180:183], v[156:159], v[84:87]
    v_mfma_f32_16x16x32_bf16 v[88:91], a[184:187], v[156:159], v[88:91]
    v_mfma_f32_16x16x32_bf16 v[92:95], a[188:191], v[156:159], v[92:95]
    ds_read_b128 v[156:159], v4 offset:39936
    s_waitcnt lgkmcnt(7)
    v_mfma_f32_16x16x32_bf16 v[80:83], a[192:195], v[128:131], v[80:83]
    v_mfma_f32_16x16x32_bf16 v[84:87], a[196:199], v[128:131], v[84:87]
    v_mfma_f32_16x16x32_bf16 v[88:91], a[200:203], v[128:131], v[88:91]
    v_mfma_f32_16x16x32_bf16 v[92:95], a[204:207], v[128:131], v[92:95]
    s_waitcnt lgkmcnt(6)
    v_mfma_f32_16x16x32_bf16 v[80:83], a[208:211], v[132:135], v[80:83]
    v_mfma_f32_16x16x32_bf16 v[84:87], a[212:215], v[132:135], v[84:87]
    v_mfma_f32_16x16x32_bf16 v[88:91], a[216:219], v[132:135], v[88:91]
    v_mfma_f32_16x16x32_bf16 v[92:95], a[220:223], v[132:135], v[92:95]
    s_waitcnt lgkmcnt(5)
    v_mfma_f32_16x16x32_bf16 v[80:83], a[224:227], v[136:139], v[80:83]
    v_mfma_f32_16x16x32_bf16 v[84:87], a[228:231], v[136:139], v[84:87]
    v_mfma_f32_16x16x32_bf16 v[88:91], a[232:235], v[136:139], v[88:91]
    v_mfma_f32_16x16x32_bf16 v[92:95], a[236:239], v[136:139], v[92:95]
    s_waitcnt lgkmcnt(4)
    v_mfma_f32_16x16x32_bf16 v[80:83], a[240:243], v[140:143], v[80:83]
    v_mfma_f32_16x16x32_bf16 v[84:87], a[244:247], v[140:143], v[84:87]
    v_mfma_f32_16x16x32_bf16 v[88:91], a[248:251], v[140:143], v[88:91]
    v_mfma_f32_16x16x32_bf16 v[92:95], a[252:255], v[140:143], v[92:95]
    s_waitcnt lgkmcnt(3)
    v_mfma_f32_16x16x32_bf16 v[80:83], v[192:195], v[144:147], v[80:83]
    v_mfma_f32_16x16x32_bf16 v[84:87], v[196:199], v[144:147], v[84:87]
    v_mfma_f32_16x16x32_bf16 v[88:91], v[200:203], v[144:147], v[88:91]
    v_mfma_f32_16x16x32_bf16 v[92:95], v[204:207], v[144:147], v[92:95]
    s_waitcnt lgkmcnt(2)
    v_mfma_f32_16x16x32_bf16 v[80:83], v[208:211], v[148:151], v[80:83]
    v_mfma_f32_16x16x32_bf16 v[84:87], v[212:215], v[148:151], v[84:87]
    v_mfma_f32_16x16x32_bf16 v[88:91], v[216:219], v[148:151], v[88:91]
    v_mfma_f32_16x16x32_bf16 v[92:95], v[220:223], v[148:151], v[92:95]
    s_waitcnt lgkmcnt(1)
    v_mfma_f32_16x16x32_bf16 v[80:83], v[224:227], v[152:155], v[80:83]
    v_mfma_f32_16x16x32_bf16 v[84:87], v[228:231], v[152:155], v[84:87]
    v_mfma_f32_16x16x32_bf16 v[88:91], v[232:235], v[152:155], v[88:91]
    v_mfma_f32_16x16x32_bf16 v[92:95], v[236:239], v[152:155], v[92:95]
    s_waitcnt lgkmcnt(0)
    v_mfma_f32_16x16x32_bf16 v[80:83], v[240:243], v[156:159], v[80:83]
    v_mfma_f32_16x16x32_bf16 v[84:87], v[244:247], v[156:159], v[84:87]
    v_mfma_f32_16x16x32_bf16 v[88:91], v[248:251], v[156:159], v[88:91]
    v_mfma_f32_16x16x32_bf16 v[92:95], v[252:255], v[156:159], v[92:95]
    s_add_u32 s22, s22, 40960
    s_addc_u32 s23, s23, 0
    s_nop 5
    v_cvt_pk_bf16_f32 v104, v80, v81
    v_cvt_pk_bf16_f32 v105, v82, v83
    v_cvt_pk_bf16_f32 v106, v84, v85
    v_cvt_pk_bf16_f32 v107, v86, v87
    global_store_dwordx4 v6, v[104:107], s[24:25] offset:0 sc1
    v_cvt_pk_bf16_f32 v108, v88, v89
    v_cvt_pk_bf16_f32 v109, v90, v91
    v_cvt_pk_bf16_f32 v110, v92, v93
    v_cvt_pk_bf16_f32 v111, v94, v95
    global_store_dwordx4 v6, v[108:111], s[24:25] offset:1024 sc1
    s_add_u32 s24, s24, 393216
    s_addc_u32 s25, s25, 0
    s_add_u32 s31, s31, 1
    s_sub_u32 s33, s31, 1
    s_cmp_gt_u32 s31, 8
    s_cbranch_scc1 .eg_69
    s_waitcnt vmcnt(0)
    s_mov_b32 s33, s31
.eg_69:
    s_waitcnt vmcnt(2)
    s_barrier
    s_cmp_lg_u32 s12, 0
    s_cbranch_scc1 .pub_70
    v_mov_b32 v2, s26
    v_mov_b32 v3, s33
    s_mov_b64 exec, 1
    global_store_dword v2, v3, s[10:11] sc1
    s_mov_b64 exec, -1
.pub_70:
    s_mov_b32 s33, 1
    s_cmp_ge_u32 s32, s33
    s_cbranch_scc1 .wpd_72
    v_and_b32 v2, 63, v1
    v_lshlrev_b32 v2, 7, v2
    v_add_u32 v2, 0, v2
.wp_71:
    global_load_dword v3, v2, s[10:11] sc1
    s_waitcnt vmcnt(0)
    s_nop 1
    v_min_u32_dpp v3, v3, v3 row_ror:1 row_mask:0xf bank_mask:0xf
    s_nop 1
    v_min_u32_dpp v3, v3, v3 row_ror:2 row_mask:0xf bank_mask:0xf
    s_nop 1
    v_min_u32_dpp v3, v3, v3 row_ror:4 row_mask:0xf bank_mask:0xf
    s_nop 1
    v_min_u32_dpp v3, v3, v3 row_ror:8 row_mask:0xf bank_mask:0xf
    s_nop 1
    v_readlane_b32 s32, v3, 0
    v_readlane_b32 s15, v3, 16
    s_nop 0
    s_min_u32 s32, s32, s15
    v_readlane_b32 s15, v3, 32
    v_readlane_b32 s16, v3, 48
    s_nop 0
    s_min_u32 s32, s32, s15
    s_min_u32 s32, s32, s16
    s_cmp_ge_u32 s32, s33
    s_cbranch_scc1 .wpd_72
    s_sleep 2
    s_add_u32 s14, s14, 1
    s_cmp_gt_u32 s14, 400000
    s_cbranch_scc1 .Lend
    s_branch .wp_71
.wpd_72:
    ds_read_b128 v[128:131], v32 offset:0
    ds_read_b128 v[132:135], v32 offset:1024
    ds_read_b128 v[136:139], v32 offset:2048
    ds_read_b128 v[140:143], v32 offset:3072
    ds_read_b128 v[144:147], v32 offset:4096
    ds_read_b128 v[148:151], v32 offset:5120
    ds_read_b128 v[152:155], v32 offset:6144
    ds_read_b128 v[156:159], v32 offset:7168
    s_waitcnt lgkmcnt(7)
    v_mfma_f32_16x16x32_bf16 v[64:67], a[0:3], v[128:131], 0
    v_mfma_f32_16x16x32_bf16 v[68:71], a[4:7], v[128:131], 0
    v_mfma_f32_16x16x32_bf16 v[72:75], a[8:11], v[128:131], 0
    v_mfma_f32_16x16x32_bf16 v[76:79], a[12:15], v[128:131], 0
    ds_read_b128 v[128:131], v32 offset:8192
    s_waitcnt lgkmcnt(7)
    v_mfma_f32_16x16x32_bf16 v[64:67], a[16:19], v[132:135], v[64:67]
    v_mfma_f32_16x16x32_bf16 v[68:71], a[20:23], v[132:135], v[68:71]
    v_mfma_f32_16x16x32_bf16 v[72:75], a[24:27], v[132:135], v[72:75]
    v_mfma_f32_16x16x32_bf16 v[76:79], a[28:31], v[132:135], v[76:79]
    s_add_u32 m0, s30, 0
    s_nop 0
    global_load_lds_dwordx4 v5, s[22:23] offset:0 sc1
    ds_read_b128 v[132:135], v32 offset:9216
    s_waitcnt lgkmcnt(7)
    v_mfma_f32_16x16x32_bf16 v[64:67], a[32:35], v[136:139], v[64:67]
    v_mfma_f32_16x16x32_bf16 v[68:71], a[36:39], v[136:139], v[68:71]
    v_mfma_f32_16x16x32_bf16 v[72:75], a[40:43], v[136:139], v[72:75]
    v_mfma_f32_16x16x32_bf16 v[76:79], a[44:47], v[136:139], v[76:79]
    ds_read_b128 v[136:139], v32 offset:10240
    s_waitcnt lgkmcnt(7)
    v_mfma_f32_16x16x32_bf16 v[64:67], a[48:51], v[140:143], v[64:67]
    v_mfma_f32_16x16x32_bf16 v[68:71], a[52:55], v[140:143], v[68:71]
    v_mfma_f32_16x16x32_bf16 v[72:75], a[56:59], v[140:143], v[72:75]
    v_mfma_f32_16x16x32_bf16 v[76:79], a[60:63], v[140:143], v[76:79]
    global_load_lds_dwordx4 v5, s[22:23] offset:1024 sc1
    ds_read_b128 v[140:143], v32 offset:11264
    s_waitcnt lgkmcnt(7)
    v_mfma_f32_16x16x32_bf16 v[64:67], a[64:67], v[144:147], v[64:67]
    v_mfma_f32_16x16x32_bf16 v[68:71], a[68:71], v[144:147], v[68:71]
    v_mfma_f32_16x16x32_bf16 v[72:75], a[72:75], v[144:147], v[72:75]
    v_mfma_f32_16x16x32_bf16 v[76:79], a[76:79], v[144:147], v[76:79]
    ds_read_b128 v[144:147], v32 offset:12288
    s_waitcnt lgkmcnt(7)
    v_mfma_f32_16x16x32_bf16 v[64:67], a[80:83], v[148:151], v[64:67]
    v_mfma_f32_16x16x32_bf16 v[68:71], a[84:87], v[148:151], v[68:71]
    v_mfma_f32_16x16x32_bf16 v[72:75], a[88:91], v[148:151], v[72:75]
    v_mfma_f32_16x16x32_bf16 v[76:79], a[92:95], v[148:151], v[76:79]
    global_load_lds_dwordx4 v5, s[22:23] offset:2048 sc1
    ds_read_b128 v[148:151], v32 offset:13312
    s_waitcnt lgkmcnt(7)
    v_mfma_f32_16x16x32_bf16 v[64:67], a[96:99], v[152:155], v[64:67]
    v_mfma_f32_16x16x32_bf16 v[68:71], a[100:103], v[152:155], v[68:71]
    v_mfma_f32_16x16x32_bf16 v[72:75], a[104:107], v[152:155], v[72:75]
    v_mfma_f32_16x16x32_bf16 v[76:79], a[108:111], v[152:155], v[76:79]
    ds_read_b128 v[152:155], v32 offset:14336
    s_waitcnt lgkmcnt(7)
    v_mfma_f32_16x16x32_bf16 v[64:67], a[112:115], v[156:159], v[64:67]
    v_mfma_f32_16x16x32_bf16 v[68:71], a[116:119], v[156:159], v[68:71]
    v_mfma_f32_16x16x32_bf16 v[72:75], a[120:123], v[156:159], v[72:75]
    v_mfma_f32_16x16x32_bf16 v[76:79], a[124:127], v[156:159], v[76:79]
    global_load_lds_dwordx4 v5, s[22:23] offset:3072 sc1
    ds_read_b128 v[156:159], v32 offset:15360
    s_waitcnt lgkmcnt(7)
    v_mfma_f32_16x16x32_bf16 v[64:67], a[128:131], v[128:131], v[64:67]
    v_mfma_f32_16x16x32_bf16 v[68:71], a[132:135], v[128:131], v[68:71]
    v_mfma_f32_16x16x32_bf16 v[72:75], a[136:139], v[128:131], v[72:75]
    v_mfma_f32_16x16x32_bf16 v[76:79], a[140:143], v[128:131], v[76:79]
    ds_read_b128 v[128:131], v32 offset:16384
    s_waitcnt lgkmcnt(7)
    v_mfma_f32_16x16x32_bf16 v[64:67], a[144:147], v[132:135], v[64:67]
    v_mfma_f32_16x16x32_bf16 v[68:71], a[148:151], v[132:135], v[68:71]
    v_mfma_f32_16x16x32_bf16 v[72:75], a[152:155], v[132:135], v[72:75]
    v_mfma_f32_16x16x32_bf16 v[76:79], a[156:159], v[132:135], v[76:79]
    s_add_u32 m0, s30, 4096
    v_add_u32 v5, 4096, v5
    global_load_lds_dwordx4 v5, s[22:23] offset:0 sc1
    ds_read_b128 v[132:135], v32 offset:17408
    s_waitcnt lgkmcnt(7)
    v_mfma_f32_16x16x32_bf16 v[64:67], a[160:163], v[136:139], v[64:67]
    v_mfma_f32_16x16x32_bf16 v[68:71], a[164:167], v[136:139], v[68:71]
    v_mfma_f32_16x16x32_bf16 v[72:75], a[168:171], v[136:139], v[72:75]
    v_mfma_f32_16x16x32_bf16 v[76:79], a[172:175], v[136:139], v[76:79]
    ds_read_b128 v[136:139], v32 offset:18432
    s_waitcnt lgkmcnt(7)
    v_mfma_f32_16x16x32_bf16 v[64:67], a[176:179], v[140:143], v[64:67]
    v_mfma_f32_16x16x32_bf16 v[68:71], a[180:183], v[140:143], v[68:71]
    v_mfma_f32_16x16x32_bf16 v[72:75], a[184:187], v[140:143], v[72:75]
    v_mfma_f32_16x16x32_bf16 v[76:79], a[188:191], v[140:143], v[76:79]
    global_load_lds_dwordx4 v5, s[22:23] offset:1024 sc1
    ds_read_b128 v[140:143], v32 offset:19456
    s_waitcnt lgkmcnt(7)
    v_mfma_f32_16x16x32_bf16 v[64:67], a[192:195], v[144:147], v[64:67]
    v_mfma_f32_16x16x32_bf16 v[68:71], a[196:199], v[144:147], v[68:71]
    v_mfma_f32_16x16x32_bf16 v[72:75], a[200:203], v[144:147], v[72:75]
    v_mfma_f32_16x16x32_bf16 v[76:79], a[204:207], v[144:147], v[76:79]
    ds_read_b128 v[144:147], v32 offset:20480
    s_waitcnt lgkmcnt(7)
    v_mfma_f32_16x16x32_bf16 v[64:67], a[208:211], v[148:151], v[64:67]
    v_mfma_f32_16x16x32_bf16 v[68:71], a[212:215], v[148:151], v[68:71]
    v_mfma_f32_16x16x32_bf16 v[72:75], a[216:219], v[148:151], v[72:75]
    v_mfma_f32_16x16x32_bf16 v[76:79], a[220:223], v[148:151], v[76:79]
    global_load_lds_dwordx4 v5, s[22:23] offset:2048 sc1
    ds_read_b128 v[148:151], v32 offset:21504
    s_waitcnt lgkmcnt(7)
    v_mfma_f32_16x16x32_bf16 v[64:67], a[224:227], v[152:155], v[64:67]
    v_mfma_f32_16x16x32_bf16 v[68:71], a[228:231], v[152:155], v[68:71]
    v_mfma_f32_16x16x32_bf16 v[72:75], a[232:235], v[152:155], v[72:75]
    v_mfma_f32_16x16x32_bf16 v[76:79], a[236:239], v[152:155], v[76:79]
    ds_read_b128 v[152:155], v32 offset:22528
    s_waitcnt lgkmcnt(7)
    v_mfma_f32_16x16x32_bf16 v[64:67], a[240:243], v[156:159], v[64:67]
    v_mfma_f32_16x16x32_bf16 v[68:71], a[244:247], v[156:159], v[68:71]
    v_mfma_f32_16x16x32_bf16 v[72:75], a[248:251], v[156:159], v[72:75]
    v_mfma_f32_16x16x32_bf16 v[76:79], a[252:255], v[156:159], v[76:79]
    global_load_lds_dwordx4 v5, s[22:23] offset:3072 sc1
    ds_read_b128 v[156:159], v32 offset:23552
    s_waitcnt lgkmcnt(7)
    v_mfma_f32_16x16x32_bf16 v[64:67], v[192:195], v[128:131], v[64:67]
    v_mfma_f32_16x16x32_bf16 v[68:71], v[196:199], v[128:131], v[68:71]
    v_mfma_f32_16x16x32_bf16 v[72:75], v[200:203], v[128:131], v[72:75]
    v_mfma_f32_16x16x32_bf16 v[76:79], v[204:207], v[128:131], v[76:79]
    ds_read_b128 v[128:131], v32 offset:24576
    s_waitcnt lgkmcnt(7)
    v_mfma_f32_16x16x32_bf16 v[64:67], v[208:211], v[132:135], v[64:67]
    v_mfma_f32_16x16x32_bf16 v[68:71], v[212:215], v[132:135], v[68:71]
    v_mfma_f32_16x16x32_bf16 v[72:75], v[216:219], v[132:135], v[72:75]
    v_mfma_f32_16x16x32_bf16 v[76:79], v[220:223], v[132:135], v[76:79]
    s_add_u32 m0, s30, 8192
    v_add_u32 v5, 4096, v5
    global_load_lds_dwordx4 v5, s[22:23] offset:0 sc1
    ds_read_b128 v[132:135], v32 offset:25600
    s_waitcnt lgkmcnt(7)
    v_mfma_f32_16x16x32_bf16 v[64:67], v[224:227], v[136:139], v[64:67]
    v_mfma_f32_16x16x32_bf16 v[68:71], v[228:231], v[136:139], v[68:71]
    v_mfma_f32_16x16x32_bf16 v[72:75], v[232:235], v[136:139], v[72:75]
    v_mfma_f32_16x16x32_bf16 v[76:79], v[236:239], v[136:139], v[76:79]
    ds_read_b128 v[136:139], v32 offset:26624
    s_waitcnt lgkmcnt(7)
    v_mfma_f32_16x16x32_bf16 v[64:67], v[240:243], v[140:143], v[64:67]
    v_mfma_f32_16x16x32_bf16 v[68:71], v[244:247], v[140:143], v[68:71]
    v_mfma_f32_16x16x32_bf16 v[72:75], v[248:251], v[140:143], v[72:75]
    v_mfma_f32_16x16x32_bf16 v[76:79], v[252:255], v[140:143], v[76:79]
    global_load_lds_dwordx4 v5, s[22:23] offset:1024 sc1
    v_subrev_u32 v5, 8192, v5
    ds_read_b128 v[140:143], v32 offset:27648
    s_waitcnt lgkmcnt(7)
    v_mfma_f32_16x16x32_bf16 v[80:83], a[0:3], v[144:147], 0
    v_mfma_f32_16x16x32_bf16 v[84:87], a[4:7], v[144:147], 0
    v_mfma_f32_16x16x32_bf16 v[88:91], a[8:11], v[144:147], 0
    v_mfma_f32_16x16x32_bf16 v[92:95], a[12:15], v[144:147], 0
    ds_read_b128 v[144:147], v32 offset:28672
    s_waitcnt lgkmcnt(7)
    v_mfma_f32_16x16x32_bf16 v[80:83], a[16:19], v[148:151], v[80:83]
    v_mfma_f32_16x16x32_bf16 v[84:87], a[20:23], v[148:151], v[84:87]
    v_mfma_f32_16x16x32_bf16 v[88:91], a[24:27], v[148:151], v[88:91]
    v_mfma_f32_16x16x32_bf16 v[92:95], a[28:31], v[148:151], v[92:95]
    ds_read_b128 v[148:151], v32 offset:29696
    s_waitcnt lgkmcnt(7)
    v_mfma_f32_16x16x32_bf16 v[80:83], a[32:35], v[152:155], v[80:83]
    v_mfma_f32_16x16x32_bf16 v[84:87], a[36:39], v[152:155], v[84:87]
    v_mfma_f32_16x16x32_bf16 v[88:91], a[40:43], v[152:155], v[88:91]
    v_mfma_f32_16x16x32_bf16 v[92:95], a[44:47], v[152:155], v[92:95]
    ds_read_b128 v[152:155], v32 offset:30720
    s_waitcnt lgkmcnt(7)
    v_mfma_f32_16x16x32_bf16 v[80:83], a[48:51], v[156:159], v[80:83]
    v_mfma_f32_16x16x32_bf16 v[84:87], a[52:55], v[156:159], v[84:87]
    v_cvt_pk_bf16_f32 v96, v64, v65
    v_mfma_f32_16x16x32_bf16 v[88:91], a[56:59], v[156:159], v[88:91]
    v_mfma_f32_16x16x32_bf16 v[92:95], a[60:63], v[156:159], v[92:95]
    v_cvt_pk_bf16_f32 v97, v66, v67
    ds_read_b128 v[156:159], v32 offset:31744
    s_waitcnt lgkmcnt(7)
    v_mfma_f32_16x16x32_bf16 v[80:83], a[64:67], v[128:131], v[80:83]
    v_mfma_f32_16x16x32_bf16 v[84:87], a[68:71], v[128:131], v[84:87]
    v_cvt_pk_bf16_f32 v98, v68, v69
    v_mfma_f32_16x16x32_bf16 v[88:91], a[72:75], v[128:131], v[88:91]
    v_mfma_f32_16x16x32_bf16 v[92:95], a[76:79], v[128:131], v[92:95]
    v_cvt_pk_bf16_f32 v99, v70, v71
    ds_read_b128 v[128:131], v32 offset:32768
    s_waitcnt lgkmcnt(7)
    v_mfma_f32_16x16x32_bf16 v[80:83], a[80:83], v[132:135], v[80:83]
    v_mfma_f32_16x16x32_bf16 v[84:87], a[84:87], v[132:135], v[84:87]
    global_store_dwordx4 v4, v[96:99], s[24:25] offset:0 sc1
    v_mfma_f32_16x16x32_bf16 v[88:91], a[88:91], v[132:135], v[88:91]
    v_mfma_f32_16x16x32_bf16 v[92:95], a[92:95], v[132:135], v[92:95]
    v_cvt_pk_bf16_f32 v100, v72, v73
    ds_read_b128 v[132:135], v32 offset:33792
    s_waitcnt lgkmcnt(7)
    v_mfma_f32_16x16x32_bf16 v[80:83], a[96:99], v[136:139], v[80:83]
    v_mfma_f32_16x16x32_bf16 v[84:87], a[100:103], v[136:139], v[84:87]
    v_cvt_pk_bf16_f32 v101, v74, v75
    v_mfma_f32_16x16x32_bf16 v[88:91], a[104:107], v[136:139], v[88:91]
    v_mfma_f32_16x16x32_bf16 v[92:95], a[108:111], v[136:139], v[92:95]
    v_cvt_pk_bf16_f32 v102, v76, v77
    ds_read_b128 v[136:139], v32 offset:34816
    s_waitcnt lgkmcnt(7)
    v_mfma_f32_16x16x32_bf16 v[80:83], a[112:115], v[140:143], v[80:83]
    v_mfma_f32_16x16x32_bf16 v[84:87], a[116:119], v[140:143], v[84:87]
    v_cvt_pk_bf16_f32 v103, v78, v79
    v_mfma_f32_16x16x32_bf16 v[88:91], a[120:123], v[140:143], v[88:91]
    v_mfma_f32_16x16x32_bf16 v[92:95], a[124:127], v[140:143], v[92:95]
    global_store_dwordx4 v4, v[100:103], s[24:25] offset:1024 sc1
    ds_read_b128 v[140:143], v32 offset:35840
    s_waitcnt lgkmcnt(7)
    v_mfma_f32_16x16x32_bf16 v[80:83], a[128:131], v[144:147], v[80:83]
    v_mfma_f32_16x16x32_bf16 v[84:87], a[132:135], v[144:147], v[84:87]
    v_mfma_f32_16x16x32_bf16 v[88:91], a[136:139], v[144:147], v[88:91]
    v_mfma_f32_16x16x32_bf16 v[92:95], a[140:143], v[144:147], v[92:95]
    ds_read_b128 v[144:147], v32 offset:36864
    s_waitcnt lgkmcnt(7)
    v_mfma_f32_16x16x32_bf16 v[80:83], a[144:147], v[148:151], v[80:83]
    v_mfma_f32_16x16x32_bf16 v[84:87], a[148:151], v[148:151], v[84:87]
    v_mfma_f32_16x16x32_bf16 v[88:91], a[152:155], v[148:151], v[88:91]
    v_mfma_f32_16x16x32_bf16 v[92:95], a[156:159], v[148:151], v[92:95]
    ds_read_b128 v[148:151], v32 offset:37888
    s_waitcnt lgkmcnt(7)
    v_mfma_f32_16x16x32_bf16 v[80:83], a[160:163], v[152:155], v[80:83]
    v_mfma_f32_16x16x32_bf16 v[84:87], a[164:167], v[152:155], v[84:87]
    v_mfma_f32_16x16x32_bf16 v[88:91], a[168:171], v[152:155], v[88:91]
    v_mfma_f32_16x16x32_bf16 v[92:95], a[172:175], v[152:155], v[92:95]
    ds_read_b128 v[152:155], v32 offset:38912
    s_waitcnt lgkmcnt(7)
    v_mfma_f32_16x16x32_bf16 v[80:83], a[176:179], v[156:159], v[80:83]
    v_mfma_f32_16x16x32_bf16 v[84:87], a[180:183], v[156:159], v[84:87]
    v_mfma_f32_16x16x32_bf16 v[88:91], a[184:187], v[156:159], v[88:91]
    v_mfma_f32_16x16x32_bf16 v[92:95], a[188:191], v[156:159], v[92:95]
    ds_read_b128 v[156:159], v32 offset:39936
    s_waitcnt lgkmcnt(7)
    v_mfma_f32_16x16x32_bf16 v[80:83], a[192:195], v[128:131], v[80:83]
    v_mfma_f32_16x16x32_bf16 v[84:87], a[196:199], v[128:131], v[84:87]
    v_mfma_f32_16x16x32_bf16 v[88:91], a[200:203], v[128:131], v[88:91]
    v_mfma_f32_16x16x32_bf16 v[92:95], a[204:207], v[128:131], v[92:95]
    s_waitcnt lgkmcnt(6)
    v_mfma_f32_16x16x32_bf16 v[80:83], a[208:211], v[132:135], v[80:83]
    v_mfma_f32_16x16x32_bf16 v[84:87], a[212:215], v[132:135], v[84:87]
    v_mfma_f32_16x16x32_bf16 v[88:91], a[216:219], v[132:135], v[88:91]
    v_mfma_f32_16x16x32_bf16 v[92:95], a[220:223], v[132:135], v[92:95]
    s_waitcnt lgkmcnt(5)
    v_mfma_f32_16x16x32_bf16 v[80:83], a[224:227], v[136:139], v[80:83]
    v_mfma_f32_16x16x32_bf16 v[84:87], a[228:231], v[136:139], v[84:87]
    v_mfma_f32_16x16x32_bf16 v[88:91], a[232:235], v[136:139], v[88:91]
    v_mfma_f32_16x16x32_bf16 v[92:95], a[236:239], v[136:139], v[92:95]
    s_waitcnt lgkmcnt(4)
    v_mfma_f32_16x16x32_bf16 v[80:83], a[240:243], v[140:143], v[80:83]
    v_mfma_f32_16x16x32_bf16 v[84:87], a[244:247], v[140:143], v[84:87]
    v_mfma_f32_16x16x32_bf16 v[88:91], a[248:251], v[140:143], v[88:91]
    v_mfma_f32_16x16x32_bf16 v[92:95], a[252:255], v[140:143], v[92:95]
    s_waitcnt lgkmcnt(3)
    v_mfma_f32_16x16x32_bf16 v[80:83], v[192:195], v[144:147], v[80:83]
    v_mfma_f32_16x16x32_bf16 v[84:87], v[196:199], v[144:147], v[84:87]
    v_mfma_f32_16x16x32_bf16 v[88:91], v[200:203], v[144:147], v[88:91]
    v_mfma_f32_16x16x32_bf16 v[92:95], v[204:207], v[144:147], v[92:95]
    s_waitcnt lgkmcnt(2)
    v_mfma_f32_16x16x32_bf16 v[80:83], v[208:211], v[148:151], v[80:83]
    v_mfma_f32_16x16x32_bf16 v[84:87], v[212:215], v[148:151], v[84:87]
    v_mfma_f32_16x16x32_bf16 v[88:91], v[216:219], v[148:151], v[88:91]
    v_mfma_f32_16x16x32_bf16 v[92:95], v[220:223], v[148:151], v[92:95]
    s_waitcnt lgkmcnt(1)
    v_mfma_f32_16x16x32_bf16 v[80:83], v[224:227], v[152:155], v[80:83]
    v_mfma_f32_16x16x32_bf16 v[84:87], v[228:231], v[152:155], v[84:87]
    v_mfma_f32_16x16x32_bf16 v[88:91], v[232:235], v[152:155], v[88:91]
    v_mfma_f32_16x16x32_bf16 v[92:95], v[236:239], v[152:155], v[92:95]
    s_waitcnt lgkmcnt(0)
    v_mfma_f32_16x16x32_bf16 v[80:83], v[240:243], v[156:159], v[80:83]
    v_mfma_f32_16x16x32_bf16 v[84:87], v[244:247], v[156:159], v[84:87]
    v_mfma_f32_16x16x32_bf16 v[88:91], v[248:251], v[156:159], v[88:91]
    v_mfma_f32_16x16x32_bf16 v[92:95], v[252:255], v[156:159], v[92:95]
    s_add_u32 s22, s22, 40960
    s_addc_u32 s23, s23, 0
    s_nop 5
    v_cvt_pk_bf16_f32 v104, v80, v81
    v_cvt_pk_bf16_f32 v105, v82, v83
    v_cvt_pk_bf16_f32 v106, v84, v85
    v_cvt_pk_bf16_f32 v107, v86, v87
    global_store_dwordx4 v6, v[104:107], s[24:25] offset:0 sc1
    v_cvt_pk_bf16_f32 v108, v88, v89
    v_cvt_pk_bf16_f32 v109, v90, v91
    v_cvt_pk_bf16_f32 v110, v92, v93
    v_cvt_pk_bf16_f32 v111, v94, v95
    global_store_dwordx4 v6, v[108:111], s[24:25] offset:1024 sc1
    s_add_u32 s24, s24, 393216
    s_addc_u32 s25, s25, 0
    s_add_u32 s31, s31, 1
    s_cmp_lt_u32 s31, 64
    s_cbranch_scc1 .Lp4_top
    s_waitcnt vmcnt(0)
    s_barrier
    s_cmp_lg_u32 s12, 0
    s_cbranch_scc1 .pub_73
    v_mov_b32 v2, s26
    v_mov_b32 v3, s31
    s_mov_b64 exec, 1
    global_store_dword v2, v3, s[10:11] sc1
    s_mov_b64 exec, -1
.pub_73:
    s_cmp_eq_u32 s89, 0
    s_cbranch_scc1 .Lend
    s_mov_b32 s13, s90
    s_mov_b32 s38, 37
    s_mov_b32 s91, 1
    s_add_u32 s96, s13, 152
    s_cmp_eq_u32 s89, 1
    s_cbranch_scc1 .Lr_m1h
    s_add_u32 s96, s13, 184
    s_cmp_eq_u32 s89, 2
    s_cbranch_scc1 .Lr_m2h
    s_add_u32 s96, s13, 216
    s_add_u32 s13, s13, 24
    s_branch .Lr_b1
.Lrole_U:
    s_bitcmp1_b32 s3, 2
    s_cbranch_scc0 .Lend
    s_load_dwordx2 s[20:21], s[0:1], 40
    s_mul_i32 s16, s13, 245760
    s_mul_i32 s17, s13, 12288
    s_add_u32 s17, s17, 207618048
    s_add_u32 s22, s4, s17
    s_addc_u32 s23, s5, 0
    s_mov_b32 s17, 69206016
    s_add_u32 s24, s4, s17
    s_addc_u32 s25, s5, 0
    s_lshl_b32 s26, s13, 7
    s_add_u32 s26, s26, 20480
    s_waitcnt lgkmcnt(0)
    s_add_u32 s20, s20, s16
    s_addc_u32 s21, s21, 0
    v_lshrrev_b32 v12, 5, v1
    v_mul_u32_u24 v13, 10240, v12
    v_bfe_u32 v12, v1, 2, 3
    v_lshlrev_b32 v14, 7, v12
    v_add_u32 v13, v13, v14
    v_and_b32 v14, 3, v1
    v_lshlrev_b32 v14, 3, v14
    v_add_u32 v13, v13, v14
    v_lshrrev_b32 v12, 1, v12
    v_xor_b32 v14, 0, v12
    v_lshlrev_b32 v14, 5, v14
    v_add_u32 v8, v13, v14
    v_xor_b32 v14, 1, v12
    v_lshlrev_b32 v14, 5, v14
    v_add_u32 v9, v13, v14
    v_xor_b32 v14, 2, v12
    v_lshlrev_b32 v14, 5, v14
    v_add_u32 v10, v13, v14
    v_xor_b32 v14, 3, v12
    v_lshlrev_b32 v14, 5, v14
    v_add_u32 v11, v13, v14
    s_cmp_lg_u32 s12, 0
    s_cbranch_scc1 .uw_74
    v_add_u32 v20, 0, v8
    v_add_u32 v21, 0, v9
    v_add_u32 v22, 0, v10
    v_add_u32 v23, 0, v11
    v_add_u32 v24, 1024, v8
    v_add_u32 v25, 1024, v9
    v_add_u32 v26, 1024, v10
    v_add_u32 v27, 1024, v11
    v_add_u32 v28, 2048, v8
    v_add_u32 v29, 2048, v9
.uw_74:
    s_cmp_lg_u32 s12, 1
    s_cbranch_scc1 .uw_75
    v_add_u32 v20, 2048, v10
    v_add_u32 v21, 2048, v11
    v_add_u32 v22, 3072, v8
    v_add_u32 v23, 3072, v9
    v_add_u32 v24, 3072, v10
    v_add_u32 v25, 3072, v11
    v_add_u32 v26, 4096, v8
    v_add_u32 v27, 4096, v9
    v_add_u32 v28, 4096, v10
    v_add_u32 v29, 4096, v11
.uw_75:
    s_cmp_lg_u32 s12, 2
    s_cbranch_scc1 .uw_76
    v_add_u32 v20, 5120, v8
    v_add_u32 v21, 5120, v9
    v_add_u32 v22, 5120, v10
    v_add_u32 v23, 5120, v11
    v_add_u32 v24, 6144, v8
    v_add_u32 v25, 6144, v9
    v_add_u32 v26, 6144, v10
    v_add_u32 v27, 6144, v11
    v_add_u32 v28, 7168, v8
    v_add_u32 v29, 7168, v9
.uw_76:
    s_cmp_lg_u32 s12, 3
    s_cbranch_scc1 .uw_77
    v_add_u32 v20, 7168, v10
    v_add_u32 v21, 7168, v11
    v_add_u32 v22, 8192, v8
    v_add_u32 v23, 8192, v9
    v_add_u32 v24, 8192, v10
    v_add_u32 v25, 8192, v11
    v_add_u32 v26, 9216, v8
    v_add_u32 v27, 9216, v9
    v_add_u32 v28, 9216, v10
    v_add_u32 v29, 9216, v11
.uw_77:
    v_lshrrev_b32 v2, 3, v1
    v_mul_u32_u24 v3, 1280, v2
    v_lshrrev_b32 v4, 1, v2
    v_and_b32 v4, 3, v4
    v_lshlrev_b32 v4, 1, v4
    v_and_b32 v5, 7, v1
    v_xor_b32 v4, v4, v5
    v_xor_b32 v5, 0, v4
    v_lshlrev_b32 v4, 4, v4
    v_lshlrev_b32 v5, 4, v5
    v_add_u32 v4, v4, v3
    v_add_u32 v5, v5, v3
    s_mul_i32 s15, s12, 10240
    s_add_u32 s20, s20, s15
    s_addc_u32 s21, s21, 0
    s_mul_i32 s17, s12, 10240
    s_add_u32 m0, s17, 0
    s_nop 0
    global_load_lds_dwordx4 v4, s[20:21] offset:0
    s_add_u32 m0, s17, 896
    s_nop 0
    global_load_lds_dwordx4 v4, s[20:21] offset:128
    s_add_u32 m0, s17, 1792
    s_nop 0
    global_load_lds_dwordx4 v4, s[20:21] offset:256
    s_add_u32 m0, s17, 2688
    s_nop 0
    global_load_lds_dwordx4 v4, s[20:21] offset:384
    s_add_u32 m0, s17, 3584
    s_nop 0
    global_load_lds_dwordx4 v4, s[20:21] offset:512
    s_add_u32 m0, s17, 4480
    s_nop 0
    global_load_lds_dwordx4 v4, s[20:21] offset:640
    s_add_u32 m0, s17, 5376
    s_nop 0
    global_load_lds_dwordx4 v4, s[20:21] offset:768
    s_add_u32 m0, s17, 6272
    s_nop 0
    global_load_lds_dwordx4 v4, s[20:21] offset:896
    s_add_u32 m0, s17, 7168
    s_nop 0
    global_load_lds_dwordx4 v4, s[20:21] offset:1024
    s_add_u32 m0, s17, 8064
    s_nop 0
    global_load_lds_dwordx4 v4, s[20:21] offset:1152
    s_add_u32 s20, s20, 40960
    s_addc_u32 s21, s21, 0
    s_waitcnt vmcnt(0)
    s_barrier
    s_add_u32 m0, s17, 40960
    s_nop 0
    global_load_lds_dwordx4 v4, s[20:21] offset:0
    s_add_u32 m0, s17, 41856
    s_nop 0
    global_load_lds_dwordx4 v4, s[20:21] offset:128
    s_add_u32 m0, s17, 42752
    s_nop 0
    global_load_lds_dwordx4 v4, s[20:21] offset:256
    s_add_u32 m0, s17, 43648
    s_nop 0
    global_load_lds_dwordx4 v4, s[20:21] offset:384
    s_add_u32 m0, s17, 44544
    s_nop 0
    global_load_lds_dwordx4 v4, s[20:21] offset:512
    s_add_u32 m0, s17, 45440
    s_nop 0
    global_load_lds_dwordx4 v4, s[20:21] offset:640
    s_add_u32 m0, s17, 46336
    s_nop 0
    global_load_lds_dwordx4 v4, s[20:21] offset:768
    s_add_u32 m0, s17, 47232
    s_nop 0
    global_load_lds_dwordx4 v4, s[20:21] offset:896
    s_add_u32 m0, s17, 48128
    s_nop 0
    global_load_lds_dwordx4 v4, s[20:21] offset:1024
    s_add_u32 m0, s17, 49024
    s_nop 0
    global_load_lds_dwordx4 v4, s[20:21] offset:1152
    s_add_u32 s20, s20, 40960
    s_addc_u32 s21, s21, 0
    v_add_u32 v30, 0, v20
    v_add_u32 v31, 0, v21
    v_add_u32 v32, 0, v22
    v_add_u32 v33, 0, v23
    v_add_u32 v34, 0, v24
    v_add_u32 v35, 0, v25
    v_add_u32 v36, 0, v26
    v_add_u32 v37, 0, v27
    v_add_u32 v38, 0, v28
    v_add_u32 v39, 0, v29
    ds_read_b64_tr_b16 a[0:1], v30 offset:0
    ds_read_b64_tr_b16 a[4:5], v31 offset:0
    ds_read_b64_tr_b16 a[8:9], v32 offset:0
    ds_read_b64_tr_b16 a[12:13], v33 offset:0
    ds_read_b64_tr_b16 a[16:17], v34 offset:0
    ds_read_b64_tr_b16 a[20:21], v35 offset:0
    ds_read_b64_tr_b16 a[24:25], v36 offset:0
    ds_read_b64_tr_b16 a[28:29], v37 offset:0
    ds_read_b64_tr_b16 a[32:33], v38 offset:0
    ds_read_b64_tr_b16 a[36:37], v39 offset:0
    ds_read_b64_tr_b16 a[2:3], v30 offset:20480
    ds_read_b64_tr_b16 a[6:7], v31 offset:20480
    ds_read_b64_tr_b16 a[10:11], v32 offset:20480
    ds_read_b64_tr_b16 a[14:15], v33 offset:20480
    ds_read_b64_tr_b16 a[18:19], v34 offset:20480
    ds_read_b64_tr_b16 a[22:23], v35 offset:20480
    ds_read_b64_tr_b16 a[26:27], v36 offset:20480
    ds_read_b64_tr_b16 a[30:31], v37 offset:20480
    ds_read_b64_tr_b16 a[34:35], v38 offset:20480
    ds_read_b64_tr_b16 a[38:39], v39 offset:20480
    s_waitcnt lgkmcnt(0)
    s_waitcnt vmcnt(0)
    s_barrier
    s_add_u32 m0, s17, 0
    s_nop 0
    global_load_lds_dwordx4 v4, s[20:21] offset:0
    s_add_u32 m0, s17, 896
    s_nop 0
    global_load_lds_dwordx4 v4, s[20:21] offset:128
    s_add_u32 m0, s17, 1792
    s_nop 0
    global_load_lds_dwordx4 v4, s[20:21] offset:256
    s_add_u32 m0, s17, 2688
    s_nop 0
    global_load_lds_dwordx4 v4, s[20:21] offset:384
    s_add_u32 m0, s17, 3584
    s_nop 0
    global_load_lds_dwordx4 v4, s[20:21] offset:512
    s_add_u32 m0, s17, 4480
    s_nop 0
    global_load_lds_dwordx4 v4, s[20:21] offset:640
    s_add_u32 m0, s17, 5376
    s_nop 0
    global_load_lds_dwordx4 v4, s[20:21] offset:768
    s_add_u32 m0, s17, 6272
    s_nop 0
    global_load_lds_dwordx4 v4, s[20:21] offset:896
    s_add_u32 m0, s17, 7168
    s_nop 0
    global_load_lds_dwordx4 v4, s[20:21] offset:1024
    s_add_u32 m0, s17, 8064
    s_nop 0
    global_load_lds_dwordx4 v4, s[20:21] offset:1152
    s_add_u32 s20, s20, 40960
    s_addc_u32 s21, s21, 0
    v_add_u32 v30, 40960, v20
    v_add_u32 v31, 40960, v21
    v_add_u32 v32, 40960, v22
    v_add_u32 v33, 40960, v23
    v_add_u32 v34, 40960, v24
    v_add_u32 v35, 40960, v25
    v_add_u32 v36, 40960, v26
    v_add_u32 v37, 40960, v27
    v_add_u32 v38, 40960, v28
    v_add_u32 v39, 40960, v29
    ds_read_b64_tr_b16 a[40:41], v30 offset:0
    ds_read_b64_tr_b16 a[44:45], v31 offset:0
    ds_read_b64_tr_b16 a[48:49], v32 offset:0
    ds_read_b64_tr_b16 a[52:53], v33 offset:0
    ds_read_b64_tr_b16 a[56:57], v34 offset:0
    ds_read_b64_tr_b16 a[60:61], v35 offset:0
    ds_read_b64_tr_b16 a[64:65], v36 offset:0
    ds_read_b64_tr_b16 a[68:69], v37 offset:0
    ds_read_b64_tr_b16 a[72:73], v38 offset:0
    ds_read_b64_tr_b16 a[76:77], v39 offset:0
    ds_read_b64_tr_b16 a[42:43], v30 offset:20480
    ds_read_b64_tr_b16 a[46:47], v31 offset:20480
    ds_read_b64_tr_b16 a[50:51], v32 offset:20480
    ds_read_b64_tr_b16 a[54:55], v33 offset:20480
    ds_read_b64_tr_b16 a[58:59], v34 offset:20480
    ds_read_b64_tr_b16 a[62:63], v35 offset:20480
    ds_read_b64_tr_b16 a[66:67], v36 offset:20480
    ds_read_b64_tr_b16 a[70:71], v37 offset:20480
    ds_read_b64_tr_b16 a[74:75], v38 offset:20480
    ds_read_b64_tr_b16 a[78:79], v39 offset:20480
    s_waitcnt lgkmcnt(0)
    s_waitcnt vmcnt(0)
    s_barrier
    s_add_u32 m0, s17, 40960
    s_nop 0
    global_load_lds_dwordx4 v4, s[20:21] offset:0
    s_add_u32 m0, s17, 41856
    s_nop 0
    global_load_lds_dwordx4 v4, s[20:21] offset:128
    s_add_u32 m0, s17, 42752
    s_nop 0
    global_load_lds_dwordx4 v4, s[20:21] offset:256
    s_add_u32 m0, s17, 43648
    s_nop 0
    global_load_lds_dwordx4 v4, s[20:21] offset:384
    s_add_u32 m0, s17, 44544
    s_nop 0
    global_load_lds_dwordx4 v4, s[20:21] offset:512
    s_add_u32 m0, s17, 45440
    s_nop 0
    global_load_lds_dwordx4 v4, s[20:21] offset:640
    s_add_u32 m0, s17, 46336
    s_nop 0
    global_load_lds_dwordx4 v4, s[20:21] offset:768
    s_add_u32 m0, s17, 47232
    s_nop 0
    global_load_lds_dwordx4 v4, s[20:21] offset:896
    s_add_u32 m0, s17, 48128
    s_nop 0
    global_load_lds_dwordx4 v4, s[20:21] offset:1024
    s_add_u32 m0, s17, 49024
    s_nop 0
    global_load_lds_dwordx4 v4, s[20:21] offset:1152
    s_add_u32 s20, s20, 40960
    s_addc_u32 s21, s21, 0
    v_add_u32 v30, 0, v20
    v_add_u32 v31, 0, v21
    v_add_u32 v32, 0, v22
    v_add_u32 v33, 0, v23
    v_add_u32 v34, 0, v24
    v_add_u32 v35, 0, v25
    v_add_u32 v36, 0, v26
    v_add_u32 v37, 0, v27
    v_add_u32 v38, 0, v28
    v_add_u32 v39, 0, v29
    ds_read_b64_tr_b16 a[80:81], v30 offset:0
    ds_read_b64_tr_b16 a[84:85], v31 offset:0
    ds_read_b64_tr_b16 a[88:89], v32 offset:0
    ds_read_b64_tr_b16 a[92:93], v33 offset:0
    ds_read_b64_tr_b16 a[96:97], v34 offset:0
    ds_read_b64_tr_b16 a[100:101], v35 offset:0
    ds_read_b64_tr_b16 a[104:105], v36 offset:0
    ds_read_b64_tr_b16 a[108:109], v37 offset:0
    ds_read_b64_tr_b16 a[112:113], v38 offset:0
    ds_read_b64_tr_b16 a[116:117], v39 offset:0
    ds_read_b64_tr_b16 a[82:83], v30 offset:20480
    ds_read_b64_tr_b16 a[86:87], v31 offset:20480
    ds_read_b64_tr_b16 a[90:91], v32 offset:20480
    ds_read_b64_tr_b16 a[94:95], v33 offset:20480
    ds_read_b64_tr_b16 a[98:99], v34 offset:20480
    ds_read_b64_tr_b16 a[102:103], v35 offset:20480
    ds_read_b64_tr_b16 a[106:107], v36 offset:20480
    ds_read_b64_tr_b16 a[110:111], v37 offset:20480
    ds_read_b64_tr_b16 a[114:115], v38 offset:20480
    ds_read_b64_tr_b16 a[118:119], v39 offset:20480
    s_waitcnt lgkmcnt(0)
    s_waitcnt vmcnt(0)
    s_barrier
    s_add_u32 m0, s17, 0
    s_nop 0
    global_load_lds_dwordx4 v4, s[20:21] offset:0
    s_add_u32 m0, s17, 896
    s_nop 0
    global_load_lds_dwordx4 v4, s[20:21] offset:128
    s_add_u32 m0, s17, 1792
    s_nop 0
    global_load_lds_dwordx4 v4, s[20:21] offset:256
    s_add_u32 m0, s17, 2688
    s_nop 0
    global_load_lds_dwordx4 v4, s[20:21] offset:384
    s_add_u32 m0, s17, 3584
    s_nop 0
    global_load_lds_dwordx4 v4, s[20:21] offset:512
    s_add_u32 m0, s17, 4480
    s_nop 0
    global_load_lds_dwordx4 v4, s[20:21] offset:640
    s_add_u32 m0, s17, 5376
    s_nop 0
    global_load_lds_dwordx4 v4, s[20:21] offset:768
    s_add_u32 m0, s17, 6272
    s_nop 0
    global_load_lds_dwordx4 v4, s[20:21] offset:896
    s_add_u32 m0, s17, 7168
    s_nop 0
    global_load_lds_dwordx4 v4, s[20:21] offset:1024
    s_add_u32 m0, s17, 8064
    s_nop 0
    global_load_lds_dwordx4 v4, s[20:21] offset:1152
    s_add_u32 s20, s20, 40960
    s_addc_u32 s21, s21, 0
    v_add_u32 v30, 40960, v20
    v_add_u32 v31, 40960, v21
    v_add_u32 v32, 40960, v22
    v_add_u32 v33, 40960, v23
    v_add_u32 v34, 40960, v24
    v_add_u32 v35, 40960, v25
    v_add_u32 v36, 40960, v26
    v_add_u32 v37, 40960, v27
    v_add_u32 v38, 40960, v28
    v_add_u32 v39, 40960, v29
    ds_read_b64_tr_b16 a[120:121], v30 offset:0
    ds_read_b64_tr_b16 a[124:125], v31 offset:0
    ds_read_b64_tr_b16 a[128:129], v32 offset:0
    ds_read_b64_tr_b16 a[132:133], v33 offset:0
    ds_read_b64_tr_b16 a[136:137], v34 offset:0
    ds_read_b64_tr_b16 a[140:141], v35 offset:0
    ds_read_b64_tr_b16 a[144:145], v36 offset:0
    ds_read_b64_tr_b16 a[148:149], v37 offset:0
    ds_read_b64_tr_b16 a[152:153], v38 offset:0
    ds_read_b64_tr_b16 a[156:157], v39 offset:0
    ds_read_b64_tr_b16 a[122:123], v30 offset:20480
    ds_read_b64_tr_b16 a[126:127], v31 offset:20480
    ds_read_b64_tr_b16 a[130:131], v32 offset:20480
    ds_read_b64_tr_b16 a[134:135], v33 offset:20480
    ds_read_b64_tr_b16 a[138:139], v34 offset:20480
    ds_read_b64_tr_b16 a[142:143], v35 offset:20480
    ds_read_b64_tr_b16 a[146:147], v36 offset:20480
    ds_read_b64_tr_b16 a[150:151], v37 offset:20480
    ds_read_b64_tr_b16 a[154:155], v38 offset:20480
    ds_read_b64_tr_b16 a[158:159], v39 offset:20480
    s_waitcnt lgkmcnt(0)
    s_waitcnt vmcnt(0)
    s_barrier
    s_add_u32 m0, s17, 40960
    s_nop 0
    global_load_lds_dwordx4 v4, s[20:21] offset:0
    s_add_u32 m0, s17, 41856
    s_nop 0
    global_load_lds_dwordx4 v4, s[20:21] offset:128
    s_add_u32 m0, s17, 42752
    s_nop 0
    global_load_lds_dwordx4 v4, s[20:21] offset:256
    s_add_u32 m0, s17, 43648
    s_nop 0
    global_load_lds_dwordx4 v4, s[20:21] offset:384
    s_add_u32 m0, s17, 44544
    s_nop 0
    global_load_lds_dwordx4 v4, s[20:21] offset:512
    s_add_u32 m0, s17, 45440
    s_nop 0
    global_load_lds_dwordx4 v4, s[20:21] offset:640
    s_add_u32 m0, s17, 46336
    s_nop 0
    global_load_lds_dwordx4 v4, s[20:21] offset:768
    s_add_u32 m0, s17, 47232
    s_nop 0
    global_load_lds_dwordx4 v4, s[20:21] offset:896
    s_add_u32 m0, s17, 48128
    s_nop 0
    global_load_lds_dwordx4 v4, s[20:21] offset:1024
    s_add_u32 m0, s17, 49024
    s_nop 0
    global_load_lds_dwordx4 v4, s[20:21] offset:1152
    s_add_u32 s20, s20, 40960
    s_addc_u32 s21, s21, 0
    v_add_u32 v30, 0, v20
    v_add_u32 v31, 0, v21
    v_add_u32 v32, 0, v22
    v_add_u32 v33, 0, v23
    v_add_u32 v34, 0, v24
    v_add_u32 v35, 0, v25
    v_add_u32 v36, 0, v26
    v_add_u32 v37, 0, v27
    v_add_u32 v38, 0, v28
    v_add_u32 v39, 0, v29
    ds_read_b64_tr_b16 a[160:161], v30 offset:0
    ds_read_b64_tr_b16 a[164:165], v31 offset:0
    ds_read_b64_tr_b16 a[168:169], v32 offset:0
    ds_read_b64_tr_b16 a[172:173], v33 offset:0
    ds_read_b64_tr_b16 a[176:177], v34 offset:0
    ds_read_b64_tr_b16 a[180:181], v35 offset:0
    ds_read_b64_tr_b16 a[184:185], v36 offset:0
    ds_read_b64_tr_b16 a[188:189], v37 offset:0
    ds_read_b64_tr_b16 a[192:193], v38 offset:0
    ds_read_b64_tr_b16 a[196:197], v39 offset:0
    ds_read_b64_tr_b16 a[162:163], v30 offset:20480
    ds_read_b64_tr_b16 a[166:167], v31 offset:20480
    ds_read_b64_tr_b16 a[170:171], v32 offset:20480
    ds_read_b64_tr_b16 a[174:175], v33 offset:20480
    ds_read_b64_tr_b16 a[178:179], v34 offset:20480
    ds_read_b64_tr_b16 a[182:183], v35 offset:20480
    ds_read_b64_tr_b16 a[186:187], v36 offset:20480
    ds_read_b64_tr_b16 a[190:191], v37 offset:20480
    ds_read_b64_tr_b16 a[194:195], v38 offset:20480
    ds_read_b64_tr_b16 a[198:199], v39 offset:20480
    s_waitcnt lgkmcnt(0)
    s_waitcnt vmcnt(0)
    s_barrier
    v_add_u32 v30, 40960, v20
    v_add_u32 v31, 40960, v21
    v_add_u32 v32, 40960, v22
    v_add_u32 v33, 40960, v23
    v_add_u32 v34, 40960, v24
    v_add_u32 v35, 40960, v25
    v_add_u32 v36, 40960, v26
    v_add_u32 v37, 40960, v27
    v_add_u32 v38, 40960, v28
    v_add_u32 v39, 40960, v29
    ds_read_b64_tr_b16 a[200:201], v30 offset:0
    ds_read_b64_tr_b16 a[204:205], v31 offset:0
    ds_read_b64_tr_b16 a[208:209], v32 offset:0
    ds_read_b64_tr_b16 a[212:213], v33 offset:0
    ds_read_b64_tr_b16 a[216:217], v34 offset:0
    ds_read_b64_tr_b16 a[220:221], v35 offset:0
    ds_read_b64_tr_b16 a[224:225], v36 offset:0
    ds_read_b64_tr_b16 a[228:229], v37 offset:0
    ds_read_b64_tr_b16 a[232:233], v38 offset:0
    ds_read_b64_tr_b16 a[236:237], v39 offset:0
    ds_read_b64_tr_b16 a[202:203], v30 offset:20480
    ds_read_b64_tr_b16 a[206:207], v31 offset:20480
    ds_read_b64_tr_b16 a[210:211], v32 offset:20480
    ds_read_b64_tr_b16 a[214:215], v33 offset:20480
    ds_read_b64_tr_b16 a[218:219], v34 offset:20480
    ds_read_b64_tr_b16 a[222:223], v35 offset:20480
    ds_read_b64_tr_b16 a[226:227], v36 offset:20480
    ds_read_b64_tr_b16 a[230:231], v37 offset:20480
    ds_read_b64_tr_b16 a[234:235], v38 offset:20480
    ds_read_b64_tr_b16 a[238:239], v39 offset:20480
    s_waitcnt lgkmcnt(0)
    s_barrier
    v_lshlrev_b32 v4, 4, v1
    v_lshlrev_b32 v6, 3, v1
    s_mul_i32 s30, s12, 3072
    v_add_u32 v5, s30, v4
    s_mul_i32 s15, s12, 160
    v_and_b32 v3, 15, v1
    v_add_u32 v3, s15, v3
    v_add_u32 v3, 0, v3
    v_and_b32 v10, 15, v3
    v_sub_u32 v11, v3, v10
    v_lshlrev_b32 v10, 6, v10
    v_lshlrev_b32 v11, 11, v11
    v_add_u32 v8, v10, v11
    v_mov_b32 v9, 1024
    v_mul_lo_u32 v9, v9, s13
    v_add_u32 v8, v8, v9
    v_lshrrev_b32 v9, 4, v1
    v_lshlrev_b32 v9, 4, v9
    v_add_u32 v20, v8, v9
    s_mul_i32 s15, s12, 160
    v_and_b32 v3, 15, v1
    v_add_u32 v3, s15, v3
    v_add_u32 v3, 16, v3
    v_and_b32 v10, 15, v3
    v_sub_u32 v11, v3, v10
    v_lshlrev_b32 v10, 6, v10
    v_lshlrev_b32 v11, 11, v11
    v_add_u32 v8, v10, v11
    v_mov_b32 v9, 1024
    v_mul_lo_u32 v9, v9, s13
    v_add_u32 v8, v8, v9
    v_lshrrev_b32 v9, 4, v1
    v_lshlrev_b32 v9, 4, v9
    v_add_u32 v21, v8, v9
    s_mul_i32 s15, s12, 160
    v_and_b32 v3, 15, v1
    v_add_u32 v3, s15, v3
    v_add_u32 v3, 32, v3
    v_and_b32 v10, 15, v3
    v_sub_u32 v11, v3, v10
    v_lshlrev_b32 v10, 6, v10
    v_lshlrev_b32 v11, 11, v11
    v_add_u32 v8, v10, v11
    v_mov_b32 v9, 1024
    v_mul_lo_u32 v9, v9, s13
    v_add_u32 v8, v8, v9
    v_lshrrev_b32 v9, 4, v1
    v_lshlrev_b32 v9, 4, v9
    v_add_u32 v22, v8, v9
    s_mul_i32 s15, s12, 160
    v_and_b32 v3, 15, v1
    v_add_u32 v3, s15, v3
    v_add_u32 v3, 48, v3
    v_and_b32 v10, 15, v3
    v_sub_u32 v11, v3, v10
    v_lshlrev_b32 v10, 6, v10
    v_lshlrev_b32 v11, 11, v11
    v_add_u32 v8, v10, v11
    v_mov_b32 v9, 1024
    v_mul_lo_u32 v9, v9, s13
    v_add_u32 v8, v8, v9
    v_lshrrev_b32 v9, 4, v1
    v_lshlrev_b32 v9, 4, v9
    v_add_u32 v23, v8, v9
    s_mul_i32 s15, s12, 160
    v_and_b32 v3, 15, v1
    v_add_u32 v3, s15, v3
    v_add_u32 v3, 64, v3
    v_and_b32 v10, 15, v3
    v_sub_u32 v11, v3, v10
    v_lshlrev_b32 v10, 6, v10
    v_lshlrev_b32 v11, 11, v11
    v_add_u32 v8, v10, v11
    v_mov_b32 v9, 1024
    v_mul_lo_u32 v9, v9, s13
    v_add_u32 v8, v8, v9
    v_lshrrev_b32 v9, 4, v1
    v_lshlrev_b32 v9, 4, v9
    v_add_u32 v24, v8, v9
    s_mul_i32 s15, s12, 160
    v_and_b32 v3, 15, v1
    v_add_u32 v3, s15, v3
    v_add_u32 v3, 80, v3
    v_and_b32 v10, 15, v3
    v_sub_u32 v11, v3, v10
    v_lshlrev_b32 v10, 6, v10
    v_lshlrev_b32 v11, 11, v11
    v_add_u32 v8, v10, v11
    v_mov_b32 v9, 1024
    v_mul_lo_u32 v9, v9, s13
    v_add_u32 v8, v8, v9
    v_lshrrev_b32 v9, 4, v1
    v_lshlrev_b32 v9, 4, v9
    v_add_u32 v25, v8, v9
    s_mul_i32 s15, s12, 160
    v_and_b32 v3, 15, v1
    v_add_u32 v3, s15, v3
    v_add_u32 v3, 96, v3
    v_and_b32 v10, 15, v3
    v_sub_u32 v11, v3, v10
    v_lshlrev_b32 v10, 6, v10
    v_lshlrev_b32 v11, 11, v11
    v_add_u32 v8, v10, v11
    v_mov_b32 v9, 1024
    v_mul_lo_u32 v9, v9, s13
    v_add_u32 v8, v8, v9
    v_lshrrev_b32 v9, 4, v1
    v_lshlrev_b32 v9, 4, v9
    v_add_u32 v26, v8, v9
    s_mul_i32 s15, s12, 160
    v_and_b32 v3, 15, v1
    v_add_u32 v3, s15, v3
    v_add_u32 v3, 112, v3
    v_and_b32 v10, 15, v3
    v_sub_u32 v11, v3, v10
    v_lshlrev_b32 v10, 6, v10
    v_lshlrev_b32 v11, 11, v11
    v_add_u32 v8, v10, v11
    v_mov_b32 v9, 1024
    v_mul_lo_u32 v9, v9, s13
    v_add_u32 v8, v8, v9
    v_lshrrev_b32 v9, 4, v1
    v_lshlrev_b32 v9, 4, v9
    v_add_u32 v27, v8, v9
    s_mul_i32 s15, s12, 160
    v_and_b32 v3, 15, v1
    v_add_u32 v3, s15, v3
    v_add_u32 v3, 128, v3
    v_and_b32 v10, 15, v3
    v_sub_u32 v11, v3, v10
    v_lshlrev_b32 v10, 6, v10
    v_lshlrev_b32 v11, 11, v11
    v_add_u32 v8, v10, v11
    v_mov_b32 v9, 1024
    v_mul_lo_u32 v9, v9, s13
    v_add_u32 v8, v8, v9
    v_lshrrev_b32 v9, 4, v1
    v_lshlrev_b32 v9, 4, v9
    v_add_u32 v28, v8, v9
    s_mul_i32 s15, s12, 160
    v_and_b32 v3, 15, v1
    v_add_u32 v3, s15, v3
    v_add_u32 v3, 144, v3
    v_and_b32 v10, 15, v3
    v_sub_u32 v11, v3, v10
    v_lshlrev_b32 v10, 6, v10
    v_lshlrev_b32 v11, 11, v11
    v_add_u32 v8, v10, v11
    v_mov_b32 v9, 1024
    v_mul_lo_u32 v9, v9, s13
    v_add_u32 v8, v8, v9
    v_lshrrev_b32 v9, 4, v1
    v_lshlrev_b32 v9, 4, v9
    v_add_u32 v29, v8, v9
    s_mov_b32 s31, 0
    s_mov_b32 s32, 0
    s_mul_i32 s36, s13, 3
    s_add_u32 s37, s36, 2
    s_lshr_b32 s36, s36, 2
    s_lshr_b32 s37, s37, 2
    s_sub_u32 s37, s37, s36
    s_lshl_b32 s37, s37, 7
    v_and_b32 v48, 1, v1
    v_mul_lo_u32 v48, v48, s37
    s_lshl_b32 s36, s36, 7
    s_add_u32 s36, s36, 16384
    s_add_u32 s36, s10, s36
    s_addc_u32 s37, s11, 0
    v_mov_b32 v2, 128
.iw_78:
    global_load_dword v3, v2, s[6:7] sc0 sc1
    s_waitcnt vmcnt(0)
    v_readfirstlane_b32 s15, v3
    s_nop 3
    s_cmp_ge_u32 s15, 64
    s_cbranch_scc1 .iwd_79
    s_sleep 4
    s_add_u32 s14, s14, 1
    s_cmp_gt_u32 s14, 400000
    s_cbranch_scc1 .Lend
    s_branch .iw_78
.iwd_79:
.detw_80:
    v_mov_b32 v2, 72
    global_load_dword v3, v2, s[6:7] sc0 sc1
    s_waitcnt vmcnt(0)
    v_readfirstlane_b32 s60, v3
    s_add_u32 s14, s14, 1
    s_cmp_gt_u32 s14, 400000
    s_cbranch_scc1 .Lend
    s_and_b32 s15, s60, 0xff
    s_cmp_lt_u32 s15, 8
    s_cbranch_scc1 .detw_80
    s_cmp_ge_u32 s60, 0x500
    s_cselect_b32 s15, 8192, 0
    s_add_u32 s15, s15, 0
    s_add_u32 s34, s4, s15
    s_addc_u32 s35, s5, 0
    s_mul_i32 s15, s12, 3
    s_add_u32 s15, s15, 0
    s_min_u32 s15, s15, 10
    s_lshl_b32 s15, s15, 10
    s_mul_i32 s16, s13, 11264
    s_add_u32 s15, s15, s16
    v_add_u32 v40, s15, v4
    v_lshrrev_b32 v2, 13, v40
    v_lshlrev_b32 v2, 13, v2
    v_add_u32 v40, v40, v2
    s_mul_i32 s15, s12, 3
    s_add_u32 s15, s15, 1
    s_min_u32 s15, s15, 10
    s_lshl_b32 s15, s15, 10
    s_mul_i32 s16, s13, 11264
    s_add_u32 s15, s15, s16
    v_add_u32 v41, s15, v4
    v_lshrrev_b32 v2, 13, v41
    v_lshlrev_b32 v2, 13, v2
    v_add_u32 v41, v41, v2
    s_mul_i32 s15, s12, 3
    s_add_u32 s15, s15, 2
    s_min_u32 s15, s15, 10
    s_lshl_b32 s15, s15, 10
    s_mul_i32 s16, s13, 11264
    s_add_u32 s15, s15, s16
    v_add_u32 v42, s15, v4
    v_lshrrev_b32 v2, 13, v42
    v_lshlrev_b32 v2, 13, v2
    v_add_u32 v42, v42, v2
    v_mov_b32 v44, -1
    v_mov_b32 v45, -1
    v_mov_b32 v46, -1
    v_mov_b32 v47, -1
    s_add_u32 s34, s34, 2097152
    s_addc_u32 s35, s35, 0
    s_xor_b32 s34, s34, 8192
    s_mov_b32 s33, 1
    s_cmp_ge_u32 s32, s33
    s_cbranch_scc1 .wvd_82
    v_mov_b32 v2, 0
.wv_81:
    global_load_dword v3, v48, s[36:37] sc1
    s_waitcnt vmcnt(0)
    v_readlane_b32 s32, v3, 0
    v_readlane_b32 s15, v3, 1
    s_nop 3
    s_min_u32 s32, s32, s15
    s_cmp_ge_u32 s32, s33
    s_cbranch_scc1 .wvd_82
    s_sleep 2
    s_add_u32 s14, s14, 1
    s_cmp_gt_u32 s14, 400000
    s_cbranch_scc1 .Lend
    s_branch .wv_81
.wvd_82:
    s_add_u32 m0, s30, 0
    s_nop 0
    global_load_lds_dwordx4 v5, s[22:23] offset:0 sc1
    global_load_lds_dwordx4 v5, s[22:23] offset:1024 sc1
    global_load_lds_dwordx4 v5, s[22:23] offset:2048 sc1
    s_add_u32 s22, s22, 393216
    s_addc_u32 s23, s23, 0
    s_waitcnt vmcnt(0)
    s_waitcnt vmcnt(0)
.Lu_top:
    s_sub_u32 s33, s31, 1
    s_cmp_gt_u32 s31, 8
    s_cbranch_scc1 .eg_83
    s_waitcnt vmcnt(0)
    s_mov_b32 s33, s31
.eg_83:
    s_waitcnt vmcnt(8)
    s_barrier
    s_cmp_lg_u32 s12, 0
    s_cbranch_scc1 .pub_84
    v_mov_b32 v2, s26
    v_mov_b32 v3, s33
    s_mov_b64 exec, 1
    global_store_dword v2, v3, s[10:11] sc1
    s_mov_b64 exec, -1
.pub_84:
    ds_read_b128 v[64:67], v4 offset:0
    ds_read_b128 v[68:71], v4 offset:1024
    ds_read_b128 v[72:75], v4 offset:2048
    ds_read_b128 v[76:79], v4 offset:3072
    ds_read_b128 v[80:83], v4 offset:4096
    ds_read_b128 v[84:87], v4 offset:5120
    ds_read_b128 v[88:91], v4 offset:6144
    ds_read_b128 v[92:95], v4 offset:7168
    ds_read_b128 v[96:99], v4 offset:8192
    ds_read_b128 v[100:103], v4 offset:9216
    ds_read_b128 v[104:107], v4 offset:10240
    ds_read_b128 v[108:111], v4 offset:11264
    s_waitcnt lgkmcnt(0)
    v_mfma_f32_16x16x32_bf16 v[112:115], v[64:67], a[0:3], 0
    v_mfma_f32_16x16x32_bf16 v[116:119], v[88:91], a[0:3], 0
    v_mfma_f32_16x16x32_bf16 v[112:115], v[68:71], a[40:43], v[112:115]
    v_mfma_f32_16x16x32_bf16 v[116:119], v[92:95], a[40:43], v[116:119]
    v_mfma_f32_16x16x32_bf16 v[112:115], v[72:75], a[80:83], v[112:115]
    v_mfma_f32_16x16x32_bf16 v[116:119], v[96:99], a[80:83], v[116:119]
    v_mfma_f32_16x16x32_bf16 v[112:115], v[76:79], a[120:123], v[112:115]
    v_mfma_f32_16x16x32_bf16 v[116:119], v[100:103], a[120:123], v[116:119]
    v_mfma_f32_16x16x32_bf16 v[112:115], v[80:83], a[160:163], v[112:115]
    v_mfma_f32_16x16x32_bf16 v[116:119], v[104:107], a[160:163], v[116:119]
    v_mfma_f32_16x16x32_bf16 v[112:115], v[84:87], a[200:203], v[112:115]
    v_mfma_f32_16x16x32_bf16 v[116:119], v[108:111], a[200:203], v[116:119]
    v_mfma_f32_16x16x32_bf16 v[120:123], v[64:67], a[4:7], 0
    v_mfma_f32_16x16x32_bf16 v[124:127], v[88:91], a[4:7], 0
    v_mfma_f32_16x16x32_bf16 v[120:123], v[68:71], a[44:47], v[120:123]
    v_mfma_f32_16x16x32_bf16 v[124:127], v[92:95], a[44:47], v[124:127]
    v_mfma_f32_16x16x32_bf16 v[120:123], v[72:75], a[84:87], v[120:123]
    v_mfma_f32_16x16x32_bf16 v[124:127], v[96:99], a[84:87], v[124:127]
    v_mfma_f32_16x16x32_bf16 v[120:123], v[76:79], a[124:127], v[120:123]
    v_mfma_f32_16x16x32_bf16 v[124:127], v[100:103], a[124:127], v[124:127]
    v_cvt_pk_bf16_f32 v144, v112, v113
    v_cvt_pk_bf16_f32 v145, v114, v115
    v_cvt_pk_bf16_f32 v146, v116, v117
    v_cvt_pk_bf16_f32 v147, v118, v119
    global_store_dwordx4 v20, v[144:147], s[24:25] sc1
    v_mfma_f32_16x16x32_bf16 v[120:123], v[80:83], a[164:167], v[120:123]
    v_mfma_f32_16x16x32_bf16 v[124:127], v[104:107], a[164:167], v[124:127]
    v_mfma_f32_16x16x32_bf16 v[120:123], v[84:87], a[204:207], v[120:123]
    v_mfma_f32_16x16x32_bf16 v[124:127], v[108:111], a[204:207], v[124:127]
    v_mfma_f32_16x16x32_bf16 v[128:131], v[64:67], a[8:11], 0
    v_mfma_f32_16x16x32_bf16 v[132:135], v[88:91], a[8:11], 0
    v_mfma_f32_16x16x32_bf16 v[128:131], v[68:71], a[48:51], v[128:131]
    global_store_dwordx4 v40, v[44:47], s[34:35] sc1
    v_mfma_f32_16x16x32_bf16 v[132:135], v[92:95], a[48:51], v[132:135]
    v_mfma_f32_16x16x32_bf16 v[128:131], v[72:75], a[88:91], v[128:131]
    v_mfma_f32_16x16x32_bf16 v[132:135], v[96:99], a[88:91], v[132:135]
    v_mfma_f32_16x16x32_bf16 v[128:131], v[76:79], a[128:131], v[128:131]
    v_mfma_f32_16x16x32_bf16 v[132:135], v[100:103], a[128:131], v[132:135]
    v_cvt_pk_bf16_f32 v148, v120, v121
    v_cvt_pk_bf16_f32 v149, v122, v123
    v_cvt_pk_bf16_f32 v150, v124, v125
    v_cvt_pk_bf16_f32 v151, v126, v127
    global_store_dwordx4 v21, v[148:151], s[24:25] sc1
    v_mfma_f32_16x16x32_bf16 v[128:131], v[80:83], a[168:171], v[128:131]
    v_mfma_f32_16x16x32_bf16 v[132:135], v[104:107], a[168:171], v[132:135]
    v_mfma_f32_16x16x32_bf16 v[128:131], v[84:87], a[208:211], v[128:131]
    v_mfma_f32_16x16x32_bf16 v[132:135], v[108:111], a[208:211], v[132:135]
    v_mfma_f32_16x16x32_bf16 v[136:139], v[64:67], a[12:15], 0
    v_mfma_f32_16x16x32_bf16 v[140:143], v[88:91], a[12:15], 0
    v_mfma_f32_16x16x32_bf16 v[136:139], v[68:71], a[52:55], v[136:139]
    v_mfma_f32_16x16x32_bf16 v[140:143], v[92:95], a[52:55], v[140:143]
    v_mfma_f32_16x16x32_bf16 v[136:139], v[72:75], a[92:95], v[136:139]
    v_mfma_f32_16x16x32_bf16 v[140:143], v[96:99], a[92:95], v[140:143]
    v_mfma_f32_16x16x32_bf16 v[136:139], v[76:79], a[132:135], v[136:139]
    v_mfma_f32_16x16x32_bf16 v[140:143], v[100:103], a[132:135], v[140:143]
    v_cvt_pk_bf16_f32 v152, v128, v129
    v_cvt_pk_bf16_f32 v153, v130, v131
    v_cvt_pk_bf16_f32 v154, v132, v133
    v_cvt_pk_bf16_f32 v155, v134, v135
    global_store_dwordx4 v22, v[152:155], s[24:25] sc1
    v_mfma_f32_16x16x32_bf16 v[136:139], v[80:83], a[172:175], v[136:139]
    v_mfma_f32_16x16x32_bf16 v[140:143], v[104:107], a[172:175], v[140:143]
    v_mfma_f32_16x16x32_bf16 v[136:139], v[84:87], a[212:215], v[136:139]
    v_mfma_f32_16x16x32_bf16 v[140:143], v[108:111], a[212:215], v[140:143]
    v_mfma_f32_16x16x32_bf16 v[112:115], v[64:67], a[16:19], 0
    v_mfma_f32_16x16x32_bf16 v[116:119], v[88:91], a[16:19], 0
    v_mfma_f32_16x16x32_bf16 v[112:115], v[68:71], a[56:59], v[112:115]
    v_mfma_f32_16x16x32_bf16 v[116:119], v[92:95], a[56:59], v[116:119]
    v_mfma_f32_16x16x32_bf16 v[112:115], v[72:75], a[96:99], v[112:115]
    v_mfma_f32_16x16x32_bf16 v[116:119], v[96:99], a[96:99], v[116:119]
    v_mfma_f32_16x16x32_bf16 v[112:115], v[76:79], a[136:139], v[112:115]
    v_mfma_f32_16x16x32_bf16 v[116:119], v[100:103], a[136:139], v[116:119]
    v_cvt_pk_bf16_f32 v156, v136, v137
    v_cvt_pk_bf16_f32 v157, v138, v139
    v_cvt_pk_bf16_f32 v158, v140, v141
    v_cvt_pk_bf16_f32 v159, v142, v143
    global_store_dwordx4 v23, v[156:159], s[24:25] sc1
    v_mfma_f32_16x16x32_bf16 v[112:115], v[80:83], a[176:179], v[112:115]
    v_mfma_f32_16x16x32_bf16 v[116:119], v[104:107], a[176:179], v[116:119]
    v_mfma_f32_16x16x32_bf16 v[112:115], v[84:87], a[216:219], v[112:115]
    v_mfma_f32_16x16x32_bf16 v[116:119], v[108:111], a[216:219], v[116:119]
    s_cmp_ge_u32 s31, 63
    s_cbranch_scc1 .und_85
    s_add_u32 s33, s31, 2
    s_cmp_ge_u32 s32, s33
    s_cbranch_scc1 .wvd_87
    v_mov_b32 v2, 0
.wv_86:
    global_load_dword v3, v48, s[36:37] sc1
    s_waitcnt vmcnt(0)
    v_readlane_b32 s32, v3, 0
    v_readlane_b32 s15, v3, 1
    s_nop 3
    s_min_u32 s32, s32, s15
    s_cmp_ge_u32 s32, s33
    s_cbranch_scc1 .wvd_87
    s_sleep 2
    s_add_u32 s14, s14, 1
    s_cmp_gt_u32 s14, 400000
    s_cbranch_scc1 .Lend
    s_branch .wv_86
.wvd_87:
    s_add_u32 m0, s30, 12288
    s_nop 0
    global_load_lds_dwordx4 v5, s[22:23] offset:0 sc1
    global_load_lds_dwordx4 v5, s[22:23] offset:1024 sc1
    global_load_lds_dwordx4 v5, s[22:23] offset:2048 sc1
    s_add_u32 s22, s22, 393216
    s_addc_u32 s23, s23, 0
.und_85:
    v_mfma_f32_16x16x32_bf16 v[120:123], v[64:67], a[20:23], 0
    v_mfma_f32_16x16x32_bf16 v[124:127], v[88:91], a[20:23], 0
    v_mfma_f32_16x16x32_bf16 v[120:123], v[68:71], a[60:63], v[120:123]
    global_store_dwordx4 v41, v[44:47], s[34:35] sc1
    v_mfma_f32_16x16x32_bf16 v[124:127], v[92:95], a[60:63], v[124:127]
    v_mfma_f32_16x16x32_bf16 v[120:123], v[72:75], a[100:103], v[120:123]
    v_mfma_f32_16x16x32_bf16 v[124:127], v[96:99], a[100:103], v[124:127]
    v_mfma_f32_16x16x32_bf16 v[120:123], v[76:79], a[140:143], v[120:123]
    v_mfma_f32_16x16x32_bf16 v[124:127], v[100:103], a[140:143], v[124:127]
    v_cvt_pk_bf16_f32 v144, v112, v113
    v_cvt_pk_bf16_f32 v145, v114, v115
    v_cvt_pk_bf16_f32 v146, v116, v117
    v_cvt_pk_bf16_f32 v147, v118, v119
    global_store_dwordx4 v24, v[144:147], s[24:25] sc1
    v_mfma_f32_16x16x32_bf16 v[120:123], v[80:83], a[180:183], v[120:123]
    v_mfma_f32_16x16x32_bf16 v[124:127], v[104:107], a[180:183], v[124:127]
    v_mfma_f32_16x16x32_bf16 v[120:123], v[84:87], a[220:223], v[120:123]
    v_mfma_f32_16x16x32_bf16 v[124:127], v[108:111], a[220:223], v[124:127]
    v_mfma_f32_16x16x32_bf16 v[128:131], v[64:67], a[24:27], 0
    v_mfma_f32_16x16x32_bf16 v[132:135], v[88:91], a[24:27], 0
    v_mfma_f32_16x16x32_bf16 v[128:131], v[68:71], a[64:67], v[128:131]
    v_mfma_f32_16x16x32_bf16 v[132:135], v[92:95], a[64:67], v[132:135]
    v_mfma_f32_16x16x32_bf16 v[128:131], v[72:75], a[104:107], v[128:131]
    v_mfma_f32_16x16x32_bf16 v[132:135], v[96:99], a[104:107], v[132:135]
    v_mfma_f32_16x16x32_bf16 v[128:131], v[76:79], a[144:147], v[128:131]
    v_mfma_f32_16x16x32_bf16 v[132:135], v[100:103], a[144:147], v[132:135]
    v_cvt_pk_bf16_f32 v148, v120, v121
    v_cvt_pk_bf16_f32 v149, v122, v123
    v_cvt_pk_bf16_f32 v150, v124, v125
    v_cvt_pk_bf16_f32 v151, v126, v127
    global_store_dwordx4 v25, v[148:151], s[24:25] sc1
    v_mfma_f32_16x16x32_bf16 v[128:131], v[80:83], a[184:187], v[128:131]
    v_mfma_f32_16x16x32_bf16 v[132:135], v[104:107], a[184:187], v[132:135]
    v_mfma_f32_16x16x32_bf16 v[128:131], v[84:87], a[224:227], v[128:131]
    v_mfma_f32_16x16x32_bf16 v[132:135], v[108:111], a[224:227], v[132:135]
    v_mfma_f32_16x16x32_bf16 v[136:139], v[64:67], a[28:31], 0
    v_mfma_f32_16x16x32_bf16 v[140:143], v[88:91], a[28:31], 0
    v_mfma_f32_16x16x32_bf16 v[136:139], v[68:71], a[68:71], v[136:139]
    v_mfma_f32_16x16x32_bf16 v[140:143], v[92:95], a[68:71], v[140:143]
    v_mfma_f32_16x16x32_bf16 v[136:139], v[72:75], a[108:111], v[136:139]
    v_mfma_f32_16x16x32_bf16 v[140:143], v[96:99], a[108:111], v[140:143]
    v_mfma_f32_16x16x32_bf16 v[136:139], v[76:79], a[148:151], v[136:139]
    v_mfma_f32_16x16x32_bf16 v[140:143], v[100:103], a[148:151], v[140:143]
    v_cvt_pk_bf16_f32 v152, v128, v129
    v_cvt_pk_bf16_f32 v153, v130, v131
    v_cvt_pk_bf16_f32 v154, v132, v133
    v_cvt_pk_bf16_f32 v155, v134, v135
    global_store_dwordx4 v26, v[152:155], s[24:25] sc1
    v_mfma_f32_16x16x32_bf16 v[136:139], v[80:83], a[188:191], v[136:139]
    v_mfma_f32_16x16x32_bf16 v[140:143], v[104:107], a[188:191], v[140:143]
    v_mfma_f32_16x16x32_bf16 v[136:139], v[84:87], a[228:231], v[136:139]
    v_mfma_f32_16x16x32_bf16 v[140:143], v[108:111], a[228:231], v[140:143]
    v_mfma_f32_16x16x32_bf16 v[112:115], v[64:67], a[32:35], 0
    v_mfma_f32_16x16x32_bf16 v[116:119], v[88:91], a[32:35], 0
    v_mfma_f32_16x16x32_bf16 v[112:115], v[68:71], a[72:75], v[112:115]
    global_store_dwordx4 v42, v[44:47], s[34:35] sc1
    v_mfma_f32_16x16x32_bf16 v[116:119], v[92:95], a[72:75], v[116:119]
    v_mfma_f32_16x16x32_bf16 v[112:115], v[72:75], a[112:115], v[112:115]
    v_mfma_f32_16x16x32_bf16 v[116:119], v[96:99], a[112:115], v[116:119]
    v_mfma_f32_16x16x32_bf16 v[112:115], v[76:79], a[152:155], v[112:115]
    v_mfma_f32_16x16x32_bf16 v[116:119], v[100:103], a[152:155], v[116:119]
    v_cvt_pk_bf16_f32 v156, v136, v137
    v_cvt_pk_bf16_f32 v157, v138, v139
    v_cvt_pk_bf16_f32 v158, v140, v141
    v_cvt_pk_bf16_f32 v159, v142, v143
    global_store_dwordx4 v27, v[156:159], s[24:25] sc1
    v_mfma_f32_16x16x32_bf16 v[112:115], v[80:83], a[192:195], v[112:115]
    v_mfma_f32_16x16x32_bf16 v[116:119], v[104:107], a[192:195], v[116:119]
    v_mfma_f32_16x16x32_bf16 v[112:115], v[84:87], a[232:235], v[112:115]
    v_mfma_f32_16x16x32_bf16 v[116:119], v[108:111], a[232:235], v[116:119]
    v_mfma_f32_16x16x32_bf16 v[120:123], v[64:67], a[36:39], 0
    v_mfma_f32_16x16x32_bf16 v[124:127], v[88:91], a[36:39], 0
    v_mfma_f32_16x16x32_bf16 v[120:123], v[68:71], a[76:79], v[120:123]
    v_mfma_f32_16x16x32_bf16 v[124:127], v[92:95], a[76:79], v[124:127]
    v_mfma_f32_16x16x32_bf16 v[120:123], v[72:75], a[116:119], v[120:123]
    v_mfma_f32_16x16x32_bf16 v[124:127], v[96:99], a[116:119], v[124:127]
    v_mfma_f32_16x16x32_bf16 v[120:123], v[76:79], a[156:159], v[120:123]
    v_mfma_f32_16x16x32_bf16 v[124:127], v[100:103], a[156:159], v[124:127]
    v_cvt_pk_bf16_f32 v144, v112, v113
    v_cvt_pk_bf16_f32 v145, v114, v115
    v_cvt_pk_bf16_f32 v146, v116, v117
    v_cvt_pk_bf16_f32 v147, v118, v119
    global_store_dwordx4 v28, v[144:147], s[24:25] sc1
    v_mfma_f32_16x16x32_bf16 v[120:123], v[80:83], a[196:199], v[120:123]
    v_mfma_f32_16x16x32_bf16 v[124:127], v[104:107], a[196:199], v[124:127]
    v_mfma_f32_16x16x32_bf16 v[120:123], v[84:87], a[236:239], v[120:123]
    v_mfma_f32_16x16x32_bf16 v[124:127], v[108:111], a[236:239], v[124:127]
    s_nop 7
    v_cvt_pk_bf16_f32 v148, v120, v121
    v_cvt_pk_bf16_f32 v149, v122, v123
    v_cvt_pk_bf16_f32 v150, v124, v125
    v_cvt_pk_bf16_f32 v151, v126, v127
    global_store_dwordx4 v29, v[148:151], s[24:25] sc1
    s_add_u32 s24, s24, 1310720
    s_addc_u32 s25, s25, 0
    s_add_u32 s31, s31, 1
    s_add_u32 s34, s34, 1048576
    s_addc_u32 s35, s35, 0
    s_sub_u32 s33, s31, 1
    s_cmp_gt_u32 s31, 8
    s_cbranch_scc1 .eg_88
    s_waitcnt vmcnt(0)
    s_mov_b32 s33, s31
.eg_88:
    s_waitcnt vmcnt(8)
    s_barrier
    s_cmp_lg_u32 s12, 0
    s_cbranch_scc1 .pub_89
    v_mov_b32 v2, s26
    v_mov_b32 v3, s33
    s_mov_b64 exec, 1
    global_store_dword v2, v3, s[10:11] sc1
    s_mov_b64 exec, -1
.pub_89:
    ds_read_b128 v[64:67], v4 offset:12288
    ds_read_b128 v[68:71], v4 offset:13312
    ds_read_b128 v[72:75], v4 offset:14336
    ds_read_b128 v[76:79], v4 offset:15360
    ds_read_b128 v[80:83], v4 offset:16384
    ds_read_b128 v[84:87], v4 offset:17408
    ds_read_b128 v[88:91], v4 offset:18432
    ds_read_b128 v[92:95], v4 offset:19456
    ds_read_b128 v[96:99], v4 offset:20480
    ds_read_b128 v[100:103], v4 offset:21504
    ds_read_b128 v[104:107], v4 offset:22528
    ds_read_b128 v[108:111], v4 offset:23552
    s_waitcnt lgkmcnt(0)
    v_mfma_f32_16x16x32_bf16 v[112:115], v[64:67], a[0:3], 0
    v_mfma_f32_16x16x32_bf16 v[116:119], v[88:91], a[0:3], 0
    v_mfma_f32_16x16x32_bf16 v[112:115], v[68:71], a[40:43], v[112:115]
    v_mfma_f32_16x16x32_bf16 v[116:119], v[92:95], a[40:43], v[116:119]
    v_mfma_f32_16x16x32_bf16 v[112:115], v[72:75], a[80:83], v[112:115]
    v_mfma_f32_16x16x32_bf16 v[116:119], v[96:99], a[80:83], v[116:119]
    v_mfma_f32_16x16x32_bf16 v[112:115], v[76:79], a[120:123], v[112:115]
    v_mfma_f32_16x16x32_bf16 v[116:119], v[100:103], a[120:123], v[116:119]
    v_mfma_f32_16x16x32_bf16 v[112:115], v[80:83], a[160:163], v[112:115]
    v_mfma_f32_16x16x32_bf16 v[116:119], v[104:107], a[160:163], v[116:119]
    v_mfma_f32_16x16x32_bf16 v[112:115], v[84:87], a[200:203], v[112:115]
    v_mfma_f32_16x16x32_bf16 v[116:119], v[108:111], a[200:203], v[116:119]
    v_mfma_f32_16x16x32_bf16 v[120:123], v[64:67], a[4:7], 0
    v_mfma_f32_16x16x32_bf16 v[124:127], v[88:91], a[4:7], 0
    v_mfma_f32_16x16x32_bf16 v[120:123], v[68:71], a[44:47], v[120:123]
    v_mfma_f32_16x16x32_bf16 v[124:127], v[92:95], a[44:47], v[124:127]
    v_mfma_f32_16x16x32_bf16 v[120:123], v[72:75], a[84:87], v[120:123]
    v_mfma_f32_16x16x32_bf16 v[124:127], v[96:99], a[84:87], v[124:127]
    v_mfma_f32_16x16x32_bf16 v[120:123], v[76:79], a[124:127], v[120:123]
    v_mfma_f32_16x16x32_bf16 v[124:127], v[100:103], a[124:127], v[124:127]
    v_cvt_pk_bf16_f32 v144, v112, v113
    v_cvt_pk_bf16_f32 v145, v114, v115
    v_cvt_pk_bf16_f32 v146, v116, v117
    v_cvt_pk_bf16_f32 v147, v118, v119
    global_store_dwordx4 v20, v[144:147], s[24:25] sc1
    v_mfma_f32_16x16x32_bf16 v[120:123], v[80:83], a[164:167], v[120:123]
    v_mfma_f32_16x16x32_bf16 v[124:127], v[104:107], a[164:167], v[124:127]
    v_mfma_f32_16x16x32_bf16 v[120:123], v[84:87], a[204:207], v[120:123]
    v_mfma_f32_16x16x32_bf16 v[124:127], v[108:111], a[204:207], v[124:127]
    v_mfma_f32_16x16x32_bf16 v[128:131], v[64:67], a[8:11], 0
    v_mfma_f32_16x16x32_bf16 v[132:135], v[88:91], a[8:11], 0
    v_mfma_f32_16x16x32_bf16 v[128:131], v[68:71], a[48:51], v[128:131]
    global_store_dwordx4 v40, v[44:47], s[34:35] sc1
    v_mfma_f32_16x16x32_bf16 v[132:135], v[92:95], a[48:51], v[132:135]
    v_mfma_f32_16x16x32_bf16 v[128:131], v[72:75], a[88:91], v[128:131]
    v_mfma_f32_16x16x32_bf16 v[132:135], v[96:99], a[88:91], v[132:135]
    v_mfma_f32_16x16x32_bf16 v[128:131], v[76:79], a[128:131], v[128:131]
    v_mfma_f32_16x16x32_bf16 v[132:135], v[100:103], a[128:131], v[132:135]
    v_cvt_pk_bf16_f32 v148, v120, v121
    v_cvt_pk_bf16_f32 v149, v122, v123
    v_cvt_pk_bf16_f32 v150, v124, v125
    v_cvt_pk_bf16_f32 v151, v126, v127
    global_store_dwordx4 v21, v[148:151], s[24:25] sc1
    v_mfma_f32_16x16x32_bf16 v[128:131], v[80:83], a[168:171], v[128:131]
    v_mfma_f32_16x16x32_bf16 v[132:135], v[104:107], a[168:171], v[132:135]
    v_mfma_f32_16x16x32_bf16 v[128:131], v[84:87], a[208:211], v[128:131]
    v_mfma_f32_16x16x32_bf16 v[132:135], v[108:111], a[208:211], v[132:135]
    v_mfma_f32_16x16x32_bf16 v[136:139], v[64:67], a[12:15], 0
    v_mfma_f32_16x16x32_bf16 v[140:143], v[88:91], a[12:15], 0
    v_mfma_f32_16x16x32_bf16 v[136:139], v[68:71], a[52:55], v[136:139]
    v_mfma_f32_16x16x32_bf16 v[140:143], v[92:95], a[52:55], v[140:143]
    v_mfma_f32_16x16x32_bf16 v[136:139], v[72:75], a[92:95], v[136:139]
    v_mfma_f32_16x16x32_bf16 v[140:143], v[96:99], a[92:95], v[140:143]
    v_mfma_f32_16x16x32_bf16 v[136:139], v[76:79], a[132:135], v[136:139]
    v_mfma_f32_16x16x32_bf16 v[140:143], v[100:103], a[132:135], v[140:143]
    v_cvt_pk_bf16_f32 v152, v128, v129
    v_cvt_pk_bf16_f32 v153, v130, v131
    v_cvt_pk_bf16_f32 v154, v132, v133
    v_cvt_pk_bf16_f32 v155, v134, v135
    global_store_dwordx4 v22, v[152:155], s[24:25] sc1
    v_mfma_f32_16x16x32_bf16 v[136:139], v[80:83], a[172:175], v[136:139]
    v_mfma_f32_16x16x32_bf16 v[140:143], v[104:107], a[172:175], v[140:143]
    v_mfma_f32_16x16x32_bf16 v[136:139], v[84:87], a[212:215], v[136:139]
    v_mfma_f32_16x16x32_bf16 v[140:143], v[108:111], a[212:215], v[140:143]
    v_mfma_f32_16x16x32_bf16 v[112:115], v[64:67], a[16:19], 0
    v_mfma_f32_16x16x32_bf16 v[116:119], v[88:91], a[16:19], 0
    v_mfma_f32_16x16x32_bf16 v[112:115], v[68:71], a[56:59], v[112:115]
    v_mfma_f32_16x16x32_bf16 v[116:119], v[92:95], a[56:59], v[116:119]
    v_mfma_f32_16x16x32_bf16 v[112:115], v[72:75], a[96:99], v[112:115]
    v_mfma_f32_16x16x32_bf16 v[116:119], v[96:99], a[96:99], v[116:119]
    v_mfma_f32_16x16x32_bf16 v[112:115], v[76:79], a[136:139], v[112:115]
    v_mfma_f32_16x16x32_bf16 v[116:119], v[100:103], a[136:139], v[116:119]
    v_cvt_pk_bf16_f32 v156, v136, v137
    v_cvt_pk_bf16_f32 v157, v138, v139
    v_cvt_pk_bf16_f32 v158, v140, v141
    v_cvt_pk_bf16_f32 v159, v142, v143
    global_store_dwordx4 v23, v[156:159], s[24:25] sc1
    v_mfma_f32_16x16x32_bf16 v[112:115], v[80:83], a[176:179], v[112:115]
    v_mfma_f32_16x16x32_bf16 v[116:119], v[104:107], a[176:179], v[116:119]
    v_mfma_f32_16x16x32_bf16 v[112:115], v[84:87], a[216:219], v[112:115]
    v_mfma_f32_16x16x32_bf16 v[116:119], v[108:111], a[216:219], v[116:119]
    s_cmp_ge_u32 s31, 63
    s_cbranch_scc1 .und_90
    s_add_u32 s33, s31, 2
    s_cmp_ge_u32 s32, s33
    s_cbranch_scc1 .wvd_92
    v_mov_b32 v2, 0
.wv_91:
    global_load_dword v3, v48, s[36:37] sc1
    s_waitcnt vmcnt(0)
    v_readlane_b32 s32, v3, 0
    v_readlane_b32 s15, v3, 1
    s_nop 3
    s_min_u32 s32, s32, s15
    s_cmp_ge_u32 s32, s33
    s_cbranch_scc1 .wvd_92
    s_sleep 2
    s_add_u32 s14, s14, 1
    s_cmp_gt_u32 s14, 400000
    s_cbranch_scc1 .Lend
    s_branch .wv_91
.wvd_92:
    s_add_u32 m0, s30, 0
    s_nop 0
    global_load_lds_dwordx4 v5, s[22:23] offset:0 sc1
    global_load_lds_dwordx4 v5, s[22:23] offset:1024 sc1
    global_load_lds_dwordx4 v5, s[22:23] offset:2048 sc1
    s_add_u32 s22, s22, 393216
    s_addc_u32 s23, s23, 0
.und_90:
    v_mfma_f32_16x16x32_bf16 v[120:123], v[64:67], a[20:23], 0
    v_mfma_f32_16x16x32_bf16 v[124:127], v[88:91], a[20:23], 0
    v_mfma_f32_16x16x32_bf16 v[120:123], v[68:71], a[60:63], v[120:123]
    global_store_dwordx4 v41, v[44:47], s[34:35] sc1
    v_mfma_f32_16x16x32_bf16 v[124:127], v[92:95], a[60:63], v[124:127]
    v_mfma_f32_16x16x32_bf16 v[120:123], v[72:75], a[100:103], v[120:123]
    v_mfma_f32_16x16x32_bf16 v[124:127], v[96:99], a[100:103], v[124:127]
    v_mfma_f32_16x16x32_bf16 v[120:123], v[76:79], a[140:143], v[120:123]
    v_mfma_f32_16x16x32_bf16 v[124:127], v[100:103], a[140:143], v[124:127]
    v_cvt_pk_bf16_f32 v144, v112, v113
    v_cvt_pk_bf16_f32 v145, v114, v115
    v_cvt_pk_bf16_f32 v146, v116, v117
    v_cvt_pk_bf16_f32 v147, v118, v119
    global_store_dwordx4 v24, v[144:147], s[24:25] sc1
    v_mfma_f32_16x16x32_bf16 v[120:123], v[80:83], a[180:183], v[120:123]
    v_mfma_f32_16x16x32_bf16 v[124:127], v[104:107], a[180:183], v[124:127]
    v_mfma_f32_16x16x32_bf16 v[120:123], v[84:87], a[220:223], v[120:123]
    v_mfma_f32_16x16x32_bf16 v[124:127], v[108:111], a[220:223], v[124:127]
    v_mfma_f32_16x16x32_bf16 v[128:131], v[64:67], a[24:27], 0
    v_mfma_f32_16x16x32_bf16 v[132:135], v[88:91], a[24:27], 0
    v_mfma_f32_16x16x32_bf16 v[128:131], v[68:71], a[64:67], v[128:131]
    v_mfma_f32_16x16x32_bf16 v[132:135], v[92:95], a[64:67], v[132:135]
    v_mfma_f32_16x16x32_bf16 v[128:131], v[72:75], a[104:107], v[128:131]
    v_mfma_f32_16x16x32_bf16 v[132:135], v[96:99], a[104:107], v[132:135]
    v_mfma_f32_16x16x32_bf16 v[128:131], v[76:79], a[144:147], v[128:131]
    v_mfma_f32_16x16x32_bf16 v[132:135], v[100:103], a[144:147], v[132:135]
    v_cvt_pk_bf16_f32 v148, v120, v121
    v_cvt_pk_bf16_f32 v149, v122, v123
    v_cvt_pk_bf16_f32 v150, v124, v125
    v_cvt_pk_bf16_f32 v151, v126, v127
    global_store_dwordx4 v25, v[148:151], s[24:25] sc1
    v_mfma_f32_16x16x32_bf16 v[128:131], v[80:83], a[184:187], v[128:131]
    v_mfma_f32_16x16x32_bf16 v[132:135], v[104:107], a[184:187], v[132:135]
    v_mfma_f32_16x16x32_bf16 v[128:131], v[84:87], a[224:227], v[128:131]
    v_mfma_f32_16x16x32_bf16 v[132:135], v[108:111], a[224:227], v[132:135]
    v_mfma_f32_16x16x32_bf16 v[136:139], v[64:67], a[28:31], 0
    v_mfma_f32_16x16x32_bf16 v[140:143], v[88:91], a[28:31], 0
    v_mfma_f32_16x16x32_bf16 v[136:139], v[68:71], a[68:71], v[136:139]
    v_mfma_f32_16x16x32_bf16 v[140:143], v[92:95], a[68:71], v[140:143]
    v_mfma_f32_16x16x32_bf16 v[136:139], v[72:75], a[108:111], v[136:139]
    v_mfma_f32_16x16x32_bf16 v[140:143], v[96:99], a[108:111], v[140:143]
    v_mfma_f32_16x16x32_bf16 v[136:139], v[76:79], a[148:151], v[136:139]
    v_mfma_f32_16x16x32_bf16 v[140:143], v[100:103], a[148:151], v[140:143]
    v_cvt_pk_bf16_f32 v152, v128, v129
    v_cvt_pk_bf16_f32 v153, v130, v131
    v_cvt_pk_bf16_f32 v154, v132, v133
    v_cvt_pk_bf16_f32 v155, v134, v135
    global_store_dwordx4 v26, v[152:155], s[24:25] sc1
    v_mfma_f32_16x16x32_bf16 v[136:139], v[80:83], a[188:191], v[136:139]
    v_mfma_f32_16x16x32_bf16 v[140:143], v[104:107], a[188:191], v[140:143]
    v_mfma_f32_16x16x32_bf16 v[136:139], v[84:87], a[228:231], v[136:139]
    v_mfma_f32_16x16x32_bf16 v[140:143], v[108:111], a[228:231], v[140:143]
    v_mfma_f32_16x16x32_bf16 v[112:115], v[64:67], a[32:35], 0
    v_mfma_f32_16x16x32_bf16 v[116:119], v[88:91], a[32:35], 0
    v_mfma_f32_16x16x32_bf16 v[112:115], v[68:71], a[72:75], v[112:115]
    global_store_dwordx4 v42, v[44:47], s[34:35] sc1
    v_mfma_f32_16x16x32_bf16 v[116:119], v[92:95], a[72:75], v[116:119]
    v_mfma_f32_16x16x32_bf16 v[112:115], v[72:75], a[112:115], v[112:115]
    v_mfma_f32_16x16x32_bf16 v[116:119], v[96:99], a[112:115], v[116:119]
    v_mfma_f32_16x16x32_bf16 v[112:115], v[76:79], a[152:155], v[112:115]
    v_mfma_f32_16x16x32_bf16 v[116:119], v[100:103], a[152:155], v[116:119]
    v_cvt_pk_bf16_f32 v156, v136, v137
    v_cvt_pk_bf16_f32 v157, v138, v139
    v_cvt_pk_bf16_f32 v158, v140, v141
    v_cvt_pk_bf16_f32 v159, v142, v143
    global_store_dwordx4 v27, v[156:159], s[24:25] sc1
    v_mfma_f32_16x16x32_bf16 v[112:115], v[80:83], a[192:195], v[112:115]
    v_mfma_f32_16x16x32_bf16 v[116:119], v[104:107], a[192:195], v[116:119]
    v_mfma_f32_16x16x32_bf16 v[112:115], v[84:87], a[232:235], v[112:115]
    v_mfma_f32_16x16x32_bf16 v[116:119], v[108:111], a[232:235], v[116:119]
    v_mfma_f32_16x16x32_bf16 v[120:123], v[64:67], a[36:39], 0
    v_mfma_f32_16x16x32_bf16 v[124:127], v[88:91], a[36:39], 0
    v_mfma_f32_16x16x32_bf16 v[120:123], v[68:71], a[76:79], v[120:123]
    v_mfma_f32_16x16x32_bf16 v[124:127], v[92:95], a[76:79], v[124:127]
    v_mfma_f32_16x16x32_bf16 v[120:123], v[72:75], a[116:119], v[120:123]
    v_mfma_f32_16x16x32_bf16 v[124:127], v[96:99], a[116:119], v[124:127]
    v_mfma_f32_16x16x32_bf16 v[120:123], v[76:79], a[156:159], v[120:123]
    v_mfma_f32_16x16x32_bf16 v[124:127], v[100:103], a[156:159], v[124:127]
    v_cvt_pk_bf16_f32 v144, v112, v113
    v_cvt_pk_bf16_f32 v145, v114, v115
    v_cvt_pk_bf16_f32 v146, v116, v117
    v_cvt_pk_bf16_f32 v147, v118, v119
    global_store_dwordx4 v28, v[144:147], s[24:25] sc1
    v_mfma_f32_16x16x32_bf16 v[120:123], v[80:83], a[196:199], v[120:123]
    v_mfma_f32_16x16x32_bf16 v[124:127], v[104:107], a[196:199], v[124:127]
    v_mfma_f32_16x16x32_bf16 v[120:123], v[84:87], a[236:239], v[120:123]
    v_mfma_f32_16x16x32_bf16 v[124:127], v[108:111], a[236:239], v[124:127]
    s_nop 7
    v_cvt_pk_bf16_f32 v148, v120, v121
    v_cvt_pk_bf16_f32 v149, v122, v123
    v_cvt_pk_bf16_f32 v150, v124, v125
    v_cvt_pk_bf16_f32 v151, v126, v127
    global_store_dwordx4 v29, v[148:151], s[24:25] sc1
    s_add_u32 s24, s24, 1310720
    s_addc_u32 s25, s25, 0
    s_add_u32 s31, s31, 1
    s_add_u32 s34, s34, 1048576
    s_addc_u32 s35, s35, 0
    s_xor_b32 s34, s34, 8192
    s_cmp_lt_u32 s31, 64
    s_cbranch_scc1 .Lu_top
    s_waitcnt vmcnt(0)
    s_barrier
    s_cmp_lg_u32 s12, 0
    s_cbranch_scc1 .pub_93
    v_mov_b32 v2, s26
    v_mov_b32 v3, s31
    s_mov_b64 exec, 1
    global_store_dword v2, v3, s[10:11] sc1
    s_mov_b64 exec, -1
.pub_93:
    s_branch .Lend
.Lrole_S:
    s_load_dwordx4 s[48:51], s[0:1], 16
    s_lshr_b32 s18, s13, 1
    s_mul_i32 s16, s18, 384
    s_waitcnt lgkmcnt(0)
    s_add_u32 s48, s48, s16
    s_addc_u32 s49, s49, 0
    s_add_u32 s50, s50, s16
    s_addc_u32 s51, s51, 0
    v_lshrrev_b32 v12, 5, v1
    v_lshlrev_b32 v12, 1, v12
    v_bfe_u32 v13, v1, 3, 1
    v_add_u32 v12, v12, v13
    v_mul_u32_u24 v12, 3072, v12
    v_bfe_u32 v14, v1, 4, 1
    v_lshlrev_b32 v15, 9, v14
    v_add_u32 v12, v12, v15
    v_bfe_u32 v15, v1, 2, 1
    v_lshlrev_b32 v15, 7, v15
    v_add_u32 v12, v12, v15
    v_and_b32 v15, 3, v1
    v_lshlrev_b32 v15, 3, v15
    v_add_u32 v12, v12, v15
    v_lshlrev_b32 v13, 1, v13
    v_or_b32 v13, v13, v14
    v_xor_b32 v14, 0, v13
    v_lshlrev_b32 v14, 5, v14
    v_add_u32 v8, v12, v14
    v_xor_b32 v14, 1, v13
    v_lshlrev_b32 v14, 5, v14
    v_add_u32 v9, v12, v14
    v_xor_b32 v14, 2, v13
    v_lshlrev_b32 v14, 5, v14
    v_add_u32 v10, v12, v14
    v_xor_b32 v14, 3, v13
    v_lshlrev_b32 v14, 5, v14
    v_add_u32 v11, v12, v14
    s_cmp_lg_u32 s12, 0
    s_cbranch_scc1 .sw_94
    v_add_u32 v12, 0, v8
    v_add_u32 v13, 256, v9
    v_add_u32 v14, 0, v9
    v_add_u32 v15, 256, v8
    v_add_u32 v16, 0, v10
    v_add_u32 v17, 256, v11
.sw_94:
    s_cmp_lg_u32 s12, 1
    s_cbranch_scc1 .sw_95
    v_add_u32 v12, 0, v11
    v_add_u32 v13, 256, v10
    v_add_u32 v14, 1024, v8
    v_add_u32 v15, 1280, v9
    v_add_u32 v16, 1024, v9
    v_add_u32 v17, 1280, v8
.sw_95:
    s_cmp_lg_u32 s12, 2
    s_cbranch_scc1 .sw_96
    v_add_u32 v12, 1024, v10
    v_add_u32 v13, 1280, v11
    v_add_u32 v14, 1024, v11
    v_add_u32 v15, 1280, v10
    v_add_u32 v16, 2048, v8
    v_add_u32 v17, 2304, v9
.sw_96:
    s_cmp_lg_u32 s12, 3
    s_cbranch_scc1 .sw_97
    v_add_u32 v12, 2048, v9
    v_add_u32 v13, 2304, v8
    v_add_u32 v14, 2048, v10
    v_add_u32 v15, 2304, v11
    v_add_u32 v16, 2048, v11
    v_add_u32 v17, 2304, v10
.sw_97:
    v_lshrrev_b32 v2, 3, v1
    v_mul_u32_u24 v3, 12288, v2
    v_lshrrev_b32 v4, 1, v2
    v_lshrrev_b32 v5, 2, v2
    v_xor_b32 v4, v4, v5
    v_and_b32 v4, 1, v4
    v_lshlrev_b32 v4, 1, v4
    v_and_b32 v5, 7, v1
    v_xor_b32 v4, v4, v5
    v_xor_b32 v5, 4, v4
    v_lshlrev_b32 v4, 4, v4
    v_lshlrev_b32 v5, 4, v5
    v_add_u32 v4, v4, v3
    v_add_u32 v5, v5, v3
    s_mul_i32 s15, s12, 393216
    s_add_u32 s48, s48, s15
    s_addc_u32 s49, s49, 0
    s_mul_i32 s17, s12, 12288
    s_add_u32 m0, s17, 0
    s_nop 0
    global_load_lds_dwordx4 v4, s[48:49] offset:0
    s_add_u32 m0, s17, 896
    s_nop 0
    global_load_lds_dwordx4 v4, s[48:49] offset:128
    s_add_u32 m0, s17, 1792
    s_nop 0
    global_load_lds_dwordx4 v4, s[48:49] offset:256
    s_add_u32 s48, s48, 98304
    s_addc_u32 s49, s49, 0
    s_add_u32 m0, s17, 3072
    s_nop 0
    global_load_lds_dwordx4 v5, s[48:49] offset:0
    s_add_u32 m0, s17, 3968
    s_nop 0
    global_load_lds_dwordx4 v5, s[48:49] offset:128
    s_add_u32 m0, s17, 4864
    s_nop 0
    global_load_lds_dwordx4 v5, s[48:49] offset:256
    s_add_u32 s48, s48, 98304
    s_addc_u32 s49, s49, 0
    s_add_u32 m0, s17, 6144
    s_nop 0
    global_load_lds_dwordx4 v4, s[48:49] offset:0
    s_add_u32 m0, s17, 7040
    s_nop 0
    global_load_lds_dwordx4 v4, s[48:49] offset:128
    s_add_u32 m0, s17, 7936
    s_nop 0
    global_load_lds_dwordx4 v4, s[48:49] offset:256
    s_add_u32 s48, s48, 98304
    s_addc_u32 s49, s49, 0
    s_add_u32 m0, s17, 9216
    s_nop 0
    global_load_lds_dwordx4 v5, s[48:49] offset:0
    s_add_u32 m0, s17, 10112
    s_nop 0
    global_load_lds_dwordx4 v5, s[48:49] offset:128
    s_add_u32 m0, s17, 11008
    s_nop 0
    global_load_lds_dwordx4 v5, s[48:49] offset:256
    s_add_u32 s48, s48, 1277952
    s_addc_u32 s49, s49, 0
    s_add_u32 m0, s17, 49152
    s_nop 0
    global_load_lds_dwordx4 v4, s[48:49] offset:0
    s_add_u32 m0, s17, 50048
    s_nop 0
    global_load_lds_dwordx4 v4, s[48:49] offset:128
    s_add_u32 m0, s17, 50944
    s_nop 0
    global_load_lds_dwordx4 v4, s[48:49] offset:256
    s_add_u32 s48, s48, 98304
    s_addc_u32 s49, s49, 0
    s_add_u32 m0, s17, 52224
    s_nop 0
    global_load_lds_dwordx4 v5, s[48:49] offset:0
    s_add_u32 m0, s17, 53120
    s_nop 0
    global_load_lds_dwordx4 v5, s[48:49] offset:128
    s_add_u32 m0, s17, 54016
    s_nop 0
    global_load_lds_dwordx4 v5, s[48:49] offset:256
    s_add_u32 s48, s48, 98304
    s_addc_u32 s49, s49, 0
    s_add_u32 m0, s17, 55296
    s_nop 0
    global_load_lds_dwordx4 v4, s[48:49] offset:0
    s_add_u32 m0, s17, 56192
    s_nop 0
    global_load_lds_dwordx4 v4, s[48:49] offset:128
    s_add_u32 m0, s17, 57088
    s_nop 0
    global_load_lds_dwordx4 v4, s[48:49] offset:256
    s_add_u32 s48, s48, 98304
    s_addc_u32 s49, s49, 0
    s_add_u32 m0, s17, 58368
    s_nop 0
    global_load_lds_dwordx4 v5, s[48:49] offset:0
    s_add_u32 m0, s17, 59264
    s_nop 0
    global_load_lds_dwordx4 v5, s[48:49] offset:128
    s_add_u32 m0, s17, 60160
    s_nop 0
    global_load_lds_dwordx4 v5, s[48:49] offset:256
    s_add_u32 s48, s48, 1277952
    s_addc_u32 s49, s49, 0
    s_waitcnt vmcnt(12)
    s_barrier
    s_add_u32 m0, s17, 98304
    s_nop 0
    global_load_lds_dwordx4 v4, s[48:49] offset:0
    s_add_u32 m0, s17, 99200
    s_nop 0
    global_load_lds_dwordx4 v4, s[48:49] offset:128
    s_add_u32 m0, s17, 100096
    s_nop 0
    global_load_lds_dwordx4 v4, s[48:49] offset:256
    s_add_u32 s48, s48, 98304
    s_addc_u32 s49, s49, 0
    s_add_u32 m0, s17, 101376
    s_nop 0
    global_load_lds_dwordx4 v5, s[48:49] offset:0
    s_add_u32 m0, s17, 102272
    s_nop 0
    global_load_lds_dwordx4 v5, s[48:49] offset:128
    s_add_u32 m0, s17, 103168
    s_nop 0
    global_load_lds_dwordx4 v5, s[48:49] offset:256
    s_add_u32 s48, s48, 98304
    s_addc_u32 s49, s49, 0
    s_add_u32 m0, s17, 104448
    s_nop 0
    global_load_lds_dwordx4 v4, s[48:49] offset:0
    s_add_u32 m0, s17, 105344
    s_nop 0
    global_load_lds_dwordx4 v4, s[48:49] offset:128
    s_add_u32 m0, s17, 106240
    s_nop 0
    global_load_lds_dwordx4 v4, s[48:49] offset:256
    s_add_u32 s48, s48, 98304
    s_addc_u32 s49, s49, 0
    s_add_u32 m0, s17, 107520
    s_nop 0
    global_load_lds_dwordx4 v5, s[48:49] offset:0
    s_add_u32 m0, s17, 108416
    s_nop 0
    global_load_lds_dwordx4 v5, s[48:49] offset:128
    s_add_u32 m0, s17, 109312
    s_nop 0
    global_load_lds_dwordx4 v5, s[48:49] offset:256
    s_add_u32 s48, s48, 1277952
    s_addc_u32 s49, s49, 0
    ds_read_b64_tr_b16 a[0:1], v12 offset:0
    ds_read_b64_tr_b16 a[2:3], v13 offset:0
    ds_read_b64_tr_b16 a[4:5], v12 offset:12288
    ds_read_b64_tr_b16 a[6:7], v13 offset:12288
    ds_read_b64_tr_b16 v[32:33], v14 offset:0
    ds_read_b64_tr_b16 v[34:35], v15 offset:0
    ds_read_b64_tr_b16 v[36:37], v14 offset:12288
    ds_read_b64_tr_b16 v[38:39], v15 offset:12288
    ds_read_b64_tr_b16 a[8:9], v16 offset:0
    ds_read_b64_tr_b16 a[10:11], v17 offset:0
    ds_read_b64_tr_b16 a[12:13], v16 offset:12288
    ds_read_b64_tr_b16 a[14:15], v17 offset:12288
    ds_read_b64_tr_b16 a[16:17], v12 offset:24576
    ds_read_b64_tr_b16 a[18:19], v13 offset:24576
    ds_read_b64_tr_b16 a[20:21], v12 offset:36864
    ds_read_b64_tr_b16 a[22:23], v13 offset:36864
    ds_read_b64_tr_b16 v[40:41], v14 offset:24576
    ds_read_b64_tr_b16 v[42:43], v15 offset:24576
    ds_read_b64_tr_b16 v[44:45], v14 offset:36864
    ds_read_b64_tr_b16 v[46:47], v15 offset:36864
    ds_read_b64_tr_b16 a[24:25], v16 offset:24576
    ds_read_b64_tr_b16 a[26:27], v17 offset:24576
    ds_read_b64_tr_b16 a[28:29], v16 offset:36864
    ds_read_b64_tr_b16 a[30:31], v17 offset:36864
    s_waitcnt lgkmcnt(0)
    s_waitcnt vmcnt(12)
    s_barrier
    s_add_u32 m0, s17, 0
    s_nop 0
    global_load_lds_dwordx4 v4, s[48:49] offset:0
    s_add_u32 m0, s17, 896
    s_nop 0
    global_load_lds_dwordx4 v4, s[48:49] offset:128
    s_add_u32 m0, s17, 1792
    s_nop 0
    global_load_lds_dwordx4 v4, s[48:49] offset:256
    s_add_u32 s48, s48, 98304
    s_addc_u32 s49, s49, 0
    s_add_u32 m0, s17, 3072
    s_nop 0
    global_load_lds_dwordx4 v5, s[48:49] offset:0
    s_add_u32 m0, s17, 3968
    s_nop 0
    global_load_lds_dwordx4 v5, s[48:49] offset:128
    s_add_u32 m0, s17, 4864
    s_nop 0
    global_load_lds_dwordx4 v5, s[48:49] offset:256
    s_add_u32 s48, s48, 98304
    s_addc_u32 s49, s49, 0
    s_add_u32 m0, s17, 6144
    s_nop 0
    global_load_lds_dwordx4 v4, s[48:49] offset:0
    s_add_u32 m0, s17, 7040
    s_nop 0
    global_load_lds_dwordx4 v4, s[48:49] offset:128
    s_add_u32 m0, s17, 7936
    s_nop 0
    global_load_lds_dwordx4 v4, s[48:49] offset:256
    s_add_u32 s48, s48, 98304
    s_addc_u32 s49, s49, 0
    s_add_u32 m0, s17, 9216
    s_nop 0
    global_load_lds_dwordx4 v5, s[48:49] offset:0
    s_add_u32 m0, s17, 10112
    s_nop 0
    global_load_lds_dwordx4 v5, s[48:49] offset:128
    s_add_u32 m0, s17, 11008
    s_nop 0
    global_load_lds_dwordx4 v5, s[48:49] offset:256
    s_add_u32 s48, s48, 1277952
    s_addc_u32 s49, s49, 0
    v_add_u32 v12, 49152, v12
    v_add_u32 v13, 49152, v13
    v_add_u32 v14, 49152, v14
    v_add_u32 v15, 49152, v15
    v_add_u32 v16, 49152, v16
    v_add_u32 v17, 49152, v17
    ds_read_b64_tr_b16 a[32:33], v12 offset:0
    ds_read_b64_tr_b16 a[34:35], v13 offset:0
    ds_read_b64_tr_b16 a[36:37], v12 offset:12288
    ds_read_b64_tr_b16 a[38:39], v13 offset:12288
    ds_read_b64_tr_b16 v[48:49], v14 offset:0
    ds_read_b64_tr_b16 v[50:51], v15 offset:0
    ds_read_b64_tr_b16 v[52:53], v14 offset:12288
    ds_read_b64_tr_b16 v[54:55], v15 offset:12288
    ds_read_b64_tr_b16 a[40:41], v16 offset:0
    ds_read_b64_tr_b16 a[42:43], v17 offset:0
    ds_read_b64_tr_b16 a[44:45], v16 offset:12288
    ds_read_b64_tr_b16 a[46:47], v17 offset:12288
    ds_read_b64_tr_b16 a[48:49], v12 offset:24576
    ds_read_b64_tr_b16 a[50:51], v13 offset:24576
    ds_read_b64_tr_b16 a[52:53], v12 offset:36864
    ds_read_b64_tr_b16 a[54:55], v13 offset:36864
    ds_read_b64_tr_b16 v[56:57], v14 offset:24576
    ds_read_b64_tr_b16 v[58:59], v15 offset:24576
    ds_read_b64_tr_b16 v[60:61], v14 offset:36864
    ds_read_b64_tr_b16 v[62:63], v15 offset:36864
    ds_read_b64_tr_b16 a[56:57], v16 offset:24576
    ds_read_b64_tr_b16 a[58:59], v17 offset:24576
    ds_read_b64_tr_b16 a[60:61], v16 offset:36864
    ds_read_b64_tr_b16 a[62:63], v17 offset:36864
    s_waitcnt lgkmcnt(0)
    s_waitcnt vmcnt(12)
    s_barrier
    s_add_u32 m0, s17, 49152
    s_nop 0
    global_load_lds_dwordx4 v4, s[48:49] offset:0
    s_add_u32 m0, s17, 50048
    s_nop 0
    global_load_lds_dwordx4 v4, s[48:49] offset:128
    s_add_u32 m0, s17, 50944
    s_nop 0
    global_load_lds_dwordx4 v4, s[48:49] offset:256
    s_add_u32 s48, s48, 98304
    s_addc_u32 s49, s49, 0
    s_add_u32 m0, s17, 52224
    s_nop 0
    global_load_lds_dwordx4 v5, s[48:49] offset:0
    s_add_u32 m0, s17, 53120
    s_nop 0
    global_load_lds_dwordx4 v5, s[48:49] offset:128
    s_add_u32 m0, s17, 54016
    s_nop 0
    global_load_lds_dwordx4 v5, s[48:49] offset:256
    s_add_u32 s48, s48, 98304
    s_addc_u32 s49, s49, 0
    s_add_u32 m0, s17, 55296
    s_nop 0
    global_load_lds_dwordx4 v4, s[48:49] offset:0
    s_add_u32 m0, s17, 56192
    s_nop 0
    global_load_lds_dwordx4 v4, s[48:49] offset:128
    s_add_u32 m0, s17, 57088
    s_nop 0
    global_load_lds_dwordx4 v4, s[48:49] offset:256
    s_add_u32 s48, s48, 98304
    s_addc_u32 s49, s49, 0
    s_add_u32 m0, s17, 58368
    s_nop 0
    global_load_lds_dwordx4 v5, s[48:49] offset:0
    s_add_u32 m0, s17, 59264
    s_nop 0
    global_load_lds_dwordx4 v5, s[48:49] offset:128
    s_add_u32 m0, s17, 60160
    s_nop 0
    global_load_lds_dwordx4 v5, s[48:49] offset:256
    s_add_u32 s48, s48, 1277952
    s_addc_u32 s49, s49, 0
    v_add_u32 v12, 49152, v12
    v_add_u32 v13, 49152, v13
    v_add_u32 v14, 49152, v14
    v_add_u32 v15, 49152, v15
    v_add_u32 v16, 49152, v16
    v_add_u32 v17, 49152, v17
    ds_read_b64_tr_b16 a[64:65], v12 offset:0
    ds_read_b64_tr_b16 a[66:67], v13 offset:0
    ds_read_b64_tr_b16 a[68:69], v12 offset:12288
    ds_read_b64_tr_b16 a[70:71], v13 offset:12288
    ds_read_b64_tr_b16 v[64:65], v14 offset:0
    ds_read_b64_tr_b16 v[66:67], v15 offset:0
    ds_read_b64_tr_b16 v[68:69], v14 offset:12288
    ds_read_b64_tr_b16 v[70:71], v15 offset:12288
    ds_read_b64_tr_b16 a[72:73], v16 offset:0
    ds_read_b64_tr_b16 a[74:75], v17 offset:0
    ds_read_b64_tr_b16 a[76:77], v16 offset:12288
    ds_read_b64_tr_b16 a[78:79], v17 offset:12288
    ds_read_b64_tr_b16 a[80:81], v12 offset:24576
    ds_read_b64_tr_b16 a[82:83], v13 offset:24576
    ds_read_b64_tr_b16 a[84:85], v12 offset:36864
    ds_read_b64_tr_b16 a[86:87], v13 offset:36864
    ds_read_b64_tr_b16 v[72:73], v14 offset:24576
    ds_read_b64_tr_b16 v[74:75], v15 offset:24576
    ds_read_b64_tr_b16 v[76:77], v14 offset:36864
    ds_read_b64_tr_b16 v[78:79], v15 offset:36864
    ds_read_b64_tr_b16 a[88:89], v16 offset:24576
    ds_read_b64_tr_b16 a[90:91], v17 offset:24576
    ds_read_b64_tr_b16 a[92:93], v16 offset:36864
    ds_read_b64_tr_b16 a[94:95], v17 offset:36864
    s_waitcnt lgkmcnt(0)
    s_waitcnt vmcnt(12)
    s_barrier
    v_add_u32 v12, 4294868992, v12
    v_add_u32 v13, 4294868992, v13
    v_add_u32 v14, 4294868992, v14
    v_add_u32 v15, 4294868992, v15
    v_add_u32 v16, 4294868992, v16
    v_add_u32 v17, 4294868992, v17
    ds_read_b64_tr_b16 a[96:97], v12 offset:0
    ds_read_b64_tr_b16 a[98:99], v13 offset:0
    ds_read_b64_tr_b16 a[100:101], v12 offset:12288
    ds_read_b64_tr_b16 a[102:103], v13 offset:12288
    ds_read_b64_tr_b16 v[80:81], v14 offset:0
    ds_read_b64_tr_b16 v[82:83], v15 offset:0
    ds_read_b64_tr_b16 v[84:85], v14 offset:12288
    ds_read_b64_tr_b16 v[86:87], v15 offset:12288
    ds_read_b64_tr_b16 a[104:105], v16 offset:0
    ds_read_b64_tr_b16 a[106:107], v17 offset:0
    ds_read_b64_tr_b16 a[108:109], v16 offset:12288
    ds_read_b64_tr_b16 a[110:111], v17 offset:12288
    ds_read_b64_tr_b16 a[112:113], v12 offset:24576
    ds_read_b64_tr_b16 a[114:115], v13 offset:24576
    ds_read_b64_tr_b16 a[116:117], v12 offset:36864
    ds_read_b64_tr_b16 a[118:119], v13 offset:36864
    ds_read_b64_tr_b16 a[128:129], v14 offset:24576
    ds_read_b64_tr_b16 a[130:131], v15 offset:24576
    ds_read_b64_tr_b16 a[132:133], v14 offset:36864
    ds_read_b64_tr_b16 a[134:135], v15 offset:36864
    ds_read_b64_tr_b16 a[144:145], v16 offset:24576
    ds_read_b64_tr_b16 a[146:147], v17 offset:24576
    ds_read_b64_tr_b16 a[148:149], v16 offset:36864
    ds_read_b64_tr_b16 a[150:151], v17 offset:36864
    s_waitcnt lgkmcnt(0)
    s_waitcnt vmcnt(0)
    s_barrier
    v_add_u32 v12, 49152, v12
    v_add_u32 v13, 49152, v13
    v_add_u32 v14, 49152, v14
    v_add_u32 v15, 49152, v15
    v_add_u32 v16, 49152, v16
    v_add_u32 v17, 49152, v17
    ds_read_b64_tr_b16 v[88:89], v12 offset:0
    ds_read_b64_tr_b16 v[90:91], v13 offset:0
    ds_read_b64_tr_b16 v[92:93], v12 offset:12288
    ds_read_b64_tr_b16 v[94:95], v13 offset:12288
    ds_read_b64_tr_b16 v[96:97], v14 offset:0
    ds_read_b64_tr_b16 v[98:99], v15 offset:0
    ds_read_b64_tr_b16 v[100:101], v14 offset:12288
    ds_read_b64_tr_b16 v[102:103], v15 offset:12288
    ds_read_b64_tr_b16 v[104:105], v16 offset:0
    ds_read_b64_tr_b16 v[106:107], v17 offset:0
    ds_read_b64_tr_b16 v[108:109], v16 offset:12288
    ds_read_b64_tr_b16 v[110:111], v17 offset:12288
    ds_read_b64_tr_b16 a[120:121], v12 offset:24576
    ds_read_b64_tr_b16 a[122:123], v13 offset:24576
    ds_read_b64_tr_b16 a[124:125], v12 offset:36864
    ds_read_b64_tr_b16 a[126:127], v13 offset:36864
    ds_read_b64_tr_b16 a[136:137], v14 offset:24576
    ds_read_b64_tr_b16 a[138:139], v15 offset:24576
    ds_read_b64_tr_b16 a[140:141], v14 offset:36864
    ds_read_b64_tr_b16 a[142:143], v15 offset:36864
    ds_read_b64_tr_b16 a[152:153], v16 offset:24576
    ds_read_b64_tr_b16 a[154:155], v17 offset:24576
    ds_read_b64_tr_b16 a[156:157], v16 offset:36864
    ds_read_b64_tr_b16 a[158:159], v17 offset:36864
    s_waitcnt lgkmcnt(0)
    s_barrier
    v_lshrrev_b32 v12, 5, v1
    v_lshlrev_b32 v12, 1, v12
    v_bfe_u32 v13, v1, 3, 1
    v_add_u32 v12, v12, v13
    v_mul_u32_u24 v12, 3072, v12
    v_bfe_u32 v14, v1, 4, 1
    v_lshlrev_b32 v15, 9, v14
    v_add_u32 v12, v12, v15
    v_bfe_u32 v15, v1, 2, 1
    v_lshlrev_b32 v15, 7, v15
    v_add_u32 v12, v12, v15
    v_and_b32 v15, 3, v1
    v_lshlrev_b32 v15, 3, v15
    v_add_u32 v12, v12, v15
    v_lshlrev_b32 v13, 1, v13
    v_or_b32 v13, v13, v14
    v_xor_b32 v14, 0, v13
    v_lshlrev_b32 v14, 5, v14
    v_add_u32 v8, v12, v14
    v_xor_b32 v14, 1, v13
    v_lshlrev_b32 v14, 5, v14
    v_add_u32 v9, v12, v14
    v_xor_b32 v14, 2, v13
    v_lshlrev_b32 v14, 5, v14
    v_add_u32 v10, v12, v14
    v_xor_b32 v14, 3, v13
    v_lshlrev_b32 v14, 5, v14
    v_add_u32 v11, v12, v14
    s_cmp_lg_u32 s12, 0
    s_cbranch_scc1 .sw_98
    v_add_u32 v12, 0, v8
    v_add_u32 v13, 256, v9
    v_add_u32 v14, 0, v9
    v_add_u32 v15, 256, v8
    v_add_u32 v16, 0, v10
    v_add_u32 v17, 256, v11
.sw_98:
    s_cmp_lg_u32 s12, 1
    s_cbranch_scc1 .sw_99
    v_add_u32 v12, 0, v11
    v_add_u32 v13, 256, v10
    v_add_u32 v14, 1024, v8
    v_add_u32 v15, 1280, v9
    v_add_u32 v16, 1024, v9
    v_add_u32 v17, 1280, v8
.sw_99:
    s_cmp_lg_u32 s12, 2
    s_cbranch_scc1 .sw_100
    v_add_u32 v12, 1024, v10
    v_add_u32 v13, 1280, v11
    v_add_u32 v14, 1024, v11
    v_add_u32 v15, 1280, v10
    v_add_u32 v16, 2048, v8
    v_add_u32 v17, 2304, v9
.sw_100:
    s_cmp_lg_u32 s12, 3
    s_cbranch_scc1 .sw_101
    v_add_u32 v12, 2048, v9
    v_add_u32 v13, 2304, v8
    v_add_u32 v14, 2048, v10
    v_add_u32 v15, 2304, v11
    v_add_u32 v16, 2048, v11
    v_add_u32 v17, 2304, v10
.sw_101:
    v_lshrrev_b32 v2, 3, v1
    v_mul_u32_u24 v3, 12288, v2
    v_lshrrev_b32 v4, 1, v2
    v_lshrrev_b32 v5, 2, v2
    v_xor_b32 v4, v4, v5
    v_and_b32 v4, 1, v4
    v_lshlrev_b32 v4, 1, v4
    v_and_b32 v5, 7, v1
    v_xor_b32 v4, v4, v5
    v_xor_b32 v5, 4, v4
    v_lshlrev_b32 v4, 4, v4
    v_lshlrev_b32 v5, 4, v5
    v_add_u32 v4, v4, v3
    v_add_u32 v5, v5, v3
    s_mul_i32 s15, s12, 393216
    s_add_u32 s50, s50, s15
    s_addc_u32 s51, s51, 0
    s_mul_i32 s17, s12, 12288
    s_add_u32 m0, s17, 0
    s_nop 0
    global_load_lds_dwordx4 v4, s[50:51] offset:0
    s_add_u32 m0, s17, 896
    s_nop 0
    global_load_lds_dwordx4 v4, s[50:51] offset:128
    s_add_u32 m0, s17, 1792
    s_nop 0
    global_load_lds_dwordx4 v4, s[50:51] offset:256
    s_add_u32 s50, s50, 98304
    s_addc_u32 s51, s51, 0
    s_add_u32 m0, s17, 3072
    s_nop 0
    global_load_lds_dwordx4 v5, s[50:51] offset:0
    s_add_u32 m0, s17, 3968
    s_nop 0
    global_load_lds_dwordx4 v5, s[50:51] offset:128
    s_add_u32 m0, s17, 4864
    s_nop 0
    global_load_lds_dwordx4 v5, s[50:51] offset:256
    s_add_u32 s50, s50, 98304
    s_addc_u32 s51, s51, 0
    s_add_u32 m0, s17, 6144
    s_nop 0
    global_load_lds_dwordx4 v4, s[50:51] offset:0
    s_add_u32 m0, s17, 7040
    s_nop 0
    global_load_lds_dwordx4 v4, s[50:51] offset:128
    s_add_u32 m0, s17, 7936
    s_nop 0
    global_load_lds_dwordx4 v4, s[50:51] offset:256
    s_add_u32 s50, s50, 98304
    s_addc_u32 s51, s51, 0
    s_add_u32 m0, s17, 9216
    s_nop 0
    global_load_lds_dwordx4 v5, s[50:51] offset:0
    s_add_u32 m0, s17, 10112
    s_nop 0
    global_load_lds_dwordx4 v5, s[50:51] offset:128
    s_add_u32 m0, s17, 11008
    s_nop 0
    global_load_lds_dwordx4 v5, s[50:51] offset:256
    s_add_u32 s50, s50, 1277952
    s_addc_u32 s51, s51, 0
    s_add_u32 m0, s17, 49152
    s_nop 0
    global_load_lds_dwordx4 v4, s[50:51] offset:0
    s_add_u32 m0, s17, 50048
    s_nop 0
    global_load_lds_dwordx4 v4, s[50:51] offset:128
    s_add_u32 m0, s17, 50944
    s_nop 0
    global_load_lds_dwordx4 v4, s[50:51] offset:256
    s_add_u32 s50, s50, 98304
    s_addc_u32 s51, s51, 0
    s_add_u32 m0, s17, 52224
    s_nop 0
    global_load_lds_dwordx4 v5, s[50:51] offset:0
    s_add_u32 m0, s17, 53120
    s_nop 0
    global_load_lds_dwordx4 v5, s[50:51] offset:128
    s_add_u32 m0, s17, 54016
    s_nop 0
    global_load_lds_dwordx4 v5, s[50:51] offset:256
    s_add_u32 s50, s50, 98304
    s_addc_u32 s51, s51, 0
    s_add_u32 m0, s17, 55296
    s_nop 0
    global_load_lds_dwordx4 v4, s[50:51] offset:0
    s_add_u32 m0, s17, 56192
    s_nop 0
    global_load_lds_dwordx4 v4, s[50:51] offset:128
    s_add_u32 m0, s17, 57088
    s_nop 0
    global_load_lds_dwordx4 v4, s[50:51] offset:256
    s_add_u32 s50, s50, 98304
    s_addc_u32 s51, s51, 0
    s_add_u32 m0, s17, 58368
    s_nop 0
    global_load_lds_dwordx4 v5, s[50:51] offset:0
    s_add_u32 m0, s17, 59264
    s_nop 0
    global_load_lds_dwordx4 v5, s[50:51] offset:128
    s_add_u32 m0, s17, 60160
    s_nop 0
    global_load_lds_dwordx4 v5, s[50:51] offset:256
    s_add_u32 s50, s50, 1277952
    s_addc_u32 s51, s51, 0
    s_waitcnt vmcnt(12)
    s_barrier
    s_add_u32 m0, s17, 98304
    s_nop 0
    global_load_lds_dwordx4 v4, s[50:51] offset:0
    s_add_u32 m0, s17, 99200
    s_nop 0
    global_load_lds_dwordx4 v4, s[50:51] offset:128
    s_add_u32 m0, s17, 100096
    s_nop 0
    global_load_lds_dwordx4 v4, s[50:51] offset:256
    s_add_u32 s50, s50, 98304
    s_addc_u32 s51, s51, 0
    s_add_u32 m0, s17, 101376
    s_nop 0
    global_load_lds_dwordx4 v5, s[50:51] offset:0
    s_add_u32 m0, s17, 102272
    s_nop 0
    global_load_lds_dwordx4 v5, s[50:51] offset:128
    s_add_u32 m0, s17, 103168
    s_nop 0
    global_load_lds_dwordx4 v5, s[50:51] offset:256
    s_add_u32 s50, s50, 98304
    s_addc_u32 s51, s51, 0
    s_add_u32 m0, s17, 104448
    s_nop 0
    global_load_lds_dwordx4 v4, s[50:51] offset:0
    s_add_u32 m0, s17, 105344
    s_nop 0
    global_load_lds_dwordx4 v4, s[50:51] offset:128
    s_add_u32 m0, s17, 106240
    s_nop 0
    global_load_lds_dwordx4 v4, s[50:51] offset:256
    s_add_u32 s50, s50, 98304
    s_addc_u32 s51, s51, 0
    s_add_u32 m0, s17, 107520
    s_nop 0
    global_load_lds_dwordx4 v5, s[50:51] offset:0
    s_add_u32 m0, s17, 108416
    s_nop 0
    global_load_lds_dwordx4 v5, s[50:51] offset:128
    s_add_u32 m0, s17, 109312
    s_nop 0
    global_load_lds_dwordx4 v5, s[50:51] offset:256
    s_add_u32 s50, s50, 1277952
    s_addc_u32 s51, s51, 0
    ds_read_b64_tr_b16 a[160:161], v12 offset:0
    ds_read_b64_tr_b16 a[162:163], v13 offset:0
    ds_read_b64_tr_b16 a[164:165], v12 offset:12288
    ds_read_b64_tr_b16 a[166:167], v13 offset:12288
    ds_read_b64_tr_b16 v[112:113], v14 offset:0
    ds_read_b64_tr_b16 v[114:115], v15 offset:0
    ds_read_b64_tr_b16 v[116:117], v14 offset:12288
    ds_read_b64_tr_b16 v[118:119], v15 offset:12288
    ds_read_b64_tr_b16 a[168:169], v16 offset:0
    ds_read_b64_tr_b16 a[170:171], v17 offset:0
    ds_read_b64_tr_b16 a[172:173], v16 offset:12288
    ds_read_b64_tr_b16 a[174:175], v17 offset:12288
    ds_read_b64_tr_b16 a[176:177], v12 offset:24576
    ds_read_b64_tr_b16 a[178:179], v13 offset:24576
    ds_read_b64_tr_b16 a[180:181], v12 offset:36864
    ds_read_b64_tr_b16 a[182:183], v13 offset:36864
    ds_read_b64_tr_b16 v[120:121], v14 offset:24576
    ds_read_b64_tr_b16 v[122:123], v15 offset:24576
    ds_read_b64_tr_b16 v[124:125], v14 offset:36864
    ds_read_b64_tr_b16 v[126:127], v15 offset:36864
    ds_read_b64_tr_b16 a[184:185], v16 offset:24576
    ds_read_b64_tr_b16 a[186:187], v17 offset:24576
    ds_read_b64_tr_b16 a[188:189], v16 offset:36864
    ds_read_b64_tr_b16 a[190:191], v17 offset:36864
    s_waitcnt lgkmcnt(0)
    s_waitcnt vmcnt(12)
    s_barrier
    s_add_u32 m0, s17, 0
    s_nop 0
    global_load_lds_dwordx4 v4, s[50:51] offset:0
    s_add_u32 m0, s17, 896
    s_nop 0
    global_load_lds_dwordx4 v4, s[50:51] offset:128
    s_add_u32 m0, s17, 1792
    s_nop 0
    global_load_lds_dwordx4 v4, s[50:51] offset:256
    s_add_u32 s50, s50, 98304
    s_addc_u32 s51, s51, 0
    s_add_u32 m0, s17, 3072
    s_nop 0
    global_load_lds_dwordx4 v5, s[50:51] offset:0
    s_add_u32 m0, s17, 3968
    s_nop 0
    global_load_lds_dwordx4 v5, s[50:51] offset:128
    s_add_u32 m0, s17, 4864
    s_nop 0
    global_load_lds_dwordx4 v5, s[50:51] offset:256
    s_add_u32 s50, s50, 98304
    s_addc_u32 s51, s51, 0
    s_add_u32 m0, s17, 6144
    s_nop 0
    global_load_lds_dwordx4 v4, s[50:51] offset:0
    s_add_u32 m0, s17, 7040
    s_nop 0
    global_load_lds_dwordx4 v4, s[50:51] offset:128
    s_add_u32 m0, s17, 7936
    s_nop 0
    global_load_lds_dwordx4 v4, s[50:51] offset:256
    s_add_u32 s50, s50, 98304
    s_addc_u32 s51, s51, 0
    s_add_u32 m0, s17, 9216
    s_nop 0
    global_load_lds_dwordx4 v5, s[50:51] offset:0
    s_add_u32 m0, s17, 10112
    s_nop 0
    global_load_lds_dwordx4 v5, s[50:51] offset:128
    s_add_u32 m0, s17, 11008
    s_nop 0
    global_load_lds_dwordx4 v5, s[50:51] offset:256
    s_add_u32 s50, s50, 1277952
    s_addc_u32 s51, s51, 0
    v_add_u32 v12, 49152, v12
    v_add_u32 v13, 49152, v13
    v_add_u32 v14, 49152, v14
    v_add_u32 v15, 49152, v15
    v_add_u32 v16, 49152, v16
    v_add_u32 v17, 49152, v17
    ds_read_b64_tr_b16 a[192:193], v12 offset:0
    ds_read_b64_tr_b16 a[194:195], v13 offset:0
    ds_read_b64_tr_b16 a[196:197], v12 offset:12288
    ds_read_b64_tr_b16 a[198:199], v13 offset:12288
    ds_read_b64_tr_b16 a[200:201], v14 offset:0
    ds_read_b64_tr_b16 a[202:203], v15 offset:0
    ds_read_b64_tr_b16 a[204:205], v14 offset:12288
    ds_read_b64_tr_b16 a[206:207], v15 offset:12288
    ds_read_b64_tr_b16 a[208:209], v16 offset:0
    ds_read_b64_tr_b16 a[210:211], v17 offset:0
    ds_read_b64_tr_b16 a[212:213], v16 offset:12288
    ds_read_b64_tr_b16 a[214:215], v17 offset:12288
    ds_read_b64_tr_b16 a[216:217], v12 offset:24576
    ds_read_b64_tr_b16 a[218:219], v13 offset:24576
    ds_read_b64_tr_b16 a[220:221], v12 offset:36864
    ds_read_b64_tr_b16 a[222:223], v13 offset:36864
    ds_read_b64_tr_b16 a[224:225], v14 offset:24576
    ds_read_b64_tr_b16 a[226:227], v15 offset:24576
    ds_read_b64_tr_b16 a[228:229], v14 offset:36864
    ds_read_b64_tr_b16 a[230:231], v15 offset:36864
    ds_read_b64_tr_b16 a[232:233], v16 offset:24576
    ds_read_b64_tr_b16 a[234:235], v17 offset:24576
    ds_read_b64_tr_b16 a[236:237], v16 offset:36864
    ds_read_b64_tr_b16 a[238:239], v17 offset:36864
    s_waitcnt lgkmcnt(0)
    s_waitcnt vmcnt(12)
    s_barrier
    s_add_u32 m0, s17, 49152
    s_nop 0
    global_load_lds_dwordx4 v4, s[50:51] offset:0
    s_add_u32 m0, s17, 50048
    s_nop 0
    global_load_lds_dwordx4 v4, s[50:51] offset:128
    s_add_u32 m0, s17, 50944
    s_nop 0
    global_load_lds_dwordx4 v4, s[50:51] offset:256
    s_add_u32 s50, s50, 98304
    s_addc_u32 s51, s51, 0
    s_add_u32 m0, s17, 52224
    s_nop 0
    global_load_lds_dwordx4 v5, s[50:51] offset:0
    s_add_u32 m0, s17, 53120
    s_nop 0
    global_load_lds_dwordx4 v5, s[50:51] offset:128
    s_add_u32 m0, s17, 54016
    s_nop 0
    global_load_lds_dwordx4 v5, s[50:51] offset:256
    s_add_u32 s50, s50, 98304
    s_addc_u32 s51, s51, 0
    s_add_u32 m0, s17, 55296
    s_nop 0
    global_load_lds_dwordx4 v4, s[50:51] offset:0
    s_add_u32 m0, s17, 56192
    s_nop 0
    global_load_lds_dwordx4 v4, s[50:51] offset:128
    s_add_u32 m0, s17, 57088
    s_nop 0
    global_load_lds_dwordx4 v4, s[50:51] offset:256
    s_add_u32 s50, s50, 98304
    s_addc_u32 s51, s51, 0
    s_add_u32 m0, s17, 58368
    s_nop 0
    global_load_lds_dwordx4 v5, s[50:51] offset:0
    s_add_u32 m0, s17, 59264
    s_nop 0
    global_load_lds_dwordx4 v5, s[50:51] offset:128
    s_add_u32 m0, s17, 60160
    s_nop 0
    global_load_lds_dwordx4 v5, s[50:51] offset:256
    s_add_u32 s50, s50, 1277952
    s_addc_u32 s51, s51, 0
    v_add_u32 v12, 49152, v12
    v_add_u32 v13, 49152, v13
    v_add_u32 v14, 49152, v14
    v_add_u32 v15, 49152, v15
    v_add_u32 v16, 49152, v16
    v_add_u32 v17, 49152, v17
    ds_read_b64_tr_b16 a[240:241], v12 offset:0
    ds_read_b64_tr_b16 a[242:243], v13 offset:0
    ds_read_b64_tr_b16 a[244:245], v12 offset:12288
    ds_read_b64_tr_b16 a[246:247], v13 offset:12288
    ds_read_b64_tr_b16 a[248:249], v14 offset:0
    ds_read_b64_tr_b16 a[250:251], v15 offset:0
    ds_read_b64_tr_b16 a[252:253], v14 offset:12288
    ds_read_b64_tr_b16 a[254:255], v15 offset:12288
    ds_read_b64_tr_b16 v[128:129], v16 offset:0
    ds_read_b64_tr_b16 v[130:131], v17 offset:0
    ds_read_b64_tr_b16 v[132:133], v16 offset:12288
    ds_read_b64_tr_b16 v[134:135], v17 offset:12288
    ds_read_b64_tr_b16 v[136:137], v12 offset:24576
    ds_read_b64_tr_b16 v[138:139], v13 offset:24576
    ds_read_b64_tr_b16 v[140:141], v12 offset:36864
    ds_read_b64_tr_b16 v[142:143], v13 offset:36864
    ds_read_b64_tr_b16 v[144:145], v14 offset:24576
    ds_read_b64_tr_b16 v[146:147], v15 offset:24576
    ds_read_b64_tr_b16 v[148:149], v14 offset:36864
    ds_read_b64_tr_b16 v[150:151], v15 offset:36864
    ds_read_b64_tr_b16 v[152:153], v16 offset:24576
    ds_read_b64_tr_b16 v[154:155], v17 offset:24576
    ds_read_b64_tr_b16 v[156:157], v16 offset:36864
    ds_read_b64_tr_b16 v[158:159], v17 offset:36864
    s_waitcnt lgkmcnt(0)
    s_waitcnt vmcnt(12)
    s_barrier
    v_add_u32 v12, 4294868992, v12
    v_add_u32 v13, 4294868992, v13
    v_add_u32 v14, 4294868992, v14
    v_add_u32 v15, 4294868992, v15
    v_add_u32 v16, 4294868992, v16
    v_add_u32 v17, 4294868992, v17
    ds_read_b64_tr_b16 v[160:161], v12 offset:0
    ds_read_b64_tr_b16 v[162:163], v13 offset:0
    ds_read_b64_tr_b16 v[164:165], v12 offset:12288
    ds_read_b64_tr_b16 v[166:167], v13 offset:12288
    ds_read_b64_tr_b16 v[168:169], v14 offset:0
    ds_read_b64_tr_b16 v[170:171], v15 offset:0
    ds_read_b64_tr_b16 v[172:173], v14 offset:12288
    ds_read_b64_tr_b16 v[174:175], v15 offset:12288
    ds_read_b64_tr_b16 v[176:177], v16 offset:0
    ds_read_b64_tr_b16 v[178:179], v17 offset:0
    ds_read_b64_tr_b16 v[180:181], v16 offset:12288
    ds_read_b64_tr_b16 v[182:183], v17 offset:12288
    ds_read_b64_tr_b16 v[184:185], v12 offset:24576
    ds_read_b64_tr_b16 v[186:187], v13 offset:24576
    ds_read_b64_tr_b16 v[188:189], v12 offset:36864
    ds_read_b64_tr_b16 v[190:191], v13 offset:36864
    ds_read_b64_tr_b16 v[208:209], v14 offset:24576
    ds_read_b64_tr_b16 v[210:211], v15 offset:24576
    ds_read_b64_tr_b16 v[212:213], v14 offset:36864
    ds_read_b64_tr_b16 v[214:215], v15 offset:36864
    ds_read_b64_tr_b16 v[232:233], v16 offset:24576
    ds_read_b64_tr_b16 v[234:235], v17 offset:24576
    ds_read_b64_tr_b16 v[236:237], v16 offset:36864
    ds_read_b64_tr_b16 v[238:239], v17 offset:36864
    s_waitcnt lgkmcnt(0)
    s_waitcnt vmcnt(0)
    s_barrier
    v_add_u32 v12, 49152, v12
    v_add_u32 v13, 49152, v13
    v_add_u32 v14, 49152, v14
    v_add_u32 v15, 49152, v15
    v_add_u32 v16, 49152, v16
    v_add_u32 v17, 49152, v17
    ds_read_b64_tr_b16 v[192:193], v12 offset:0
    ds_read_b64_tr_b16 v[194:195], v13 offset:0
    ds_read_b64_tr_b16 v[196:197], v12 offset:12288
    ds_read_b64_tr_b16 v[198:199], v13 offset:12288
    ds_read_b64_tr_b16 v[216:217], v14 offset:0
    ds_read_b64_tr_b16 v[218:219], v15 offset:0
    ds_read_b64_tr_b16 v[220:221], v14 offset:12288
    ds_read_b64_tr_b16 v[222:223], v15 offset:12288
    ds_read_b64_tr_b16 v[240:241], v16 offset:0
    ds_read_b64_tr_b16 v[242:243], v17 offset:0
    ds_read_b64_tr_b16 v[244:245], v16 offset:12288
    ds_read_b64_tr_b16 v[246:247], v17 offset:12288
    ds_read_b64_tr_b16 v[200:201], v12 offset:24576
    ds_read_b64_tr_b16 v[202:203], v13 offset:24576
    ds_read_b64_tr_b16 v[204:205], v12 offset:36864
    ds_read_b64_tr_b16 v[206:207], v13 offset:36864
    ds_read_b64_tr_b16 v[224:225], v14 offset:24576
    ds_read_b64_tr_b16 v[226:227], v15 offset:24576
    ds_read_b64_tr_b16 v[228:229], v14 offset:36864
    ds_read_b64_tr_b16 v[230:231], v15 offset:36864
    ds_read_b64_tr_b16 v[248:249], v16 offset:24576
    ds_read_b64_tr_b16 v[250:251], v17 offset:24576
    ds_read_b64_tr_b16 v[252:253], v16 offset:36864
    ds_read_b64_tr_b16 v[254:255], v17 offset:36864
    s_waitcnt lgkmcnt(0)
    s_barrier
    v_lshlrev_b32 v2, 4, v1
    s_mul_i32 s15, s12, 24576
    v_add_u32 v2, s15, v2
    ds_write_b128 v2, v[32:35] offset:0
    ds_write_b128 v2, v[36:39] offset:1024
    ds_write_b128 v2, v[40:43] offset:2048
    ds_write_b128 v2, v[44:47] offset:3072
    ds_write_b128 v2, v[48:51] offset:4096
    ds_write_b128 v2, v[52:55] offset:5120
    ds_write_b128 v2, v[56:59] offset:6144
    ds_write_b128 v2, v[60:63] offset:7168
    ds_write_b128 v2, v[64:67] offset:8192
    ds_write_b128 v2, v[68:71] offset:9216
    ds_write_b128 v2, v[72:75] offset:10240
    ds_write_b128 v2, v[76:79] offset:11264
    ds_write_b128 v2, v[80:83] offset:12288
    ds_write_b128 v2, v[84:87] offset:13312
    ds_write_b128 v2, v[88:91] offset:14336
    ds_write_b128 v2, v[92:95] offset:15360
    ds_write_b128 v2, v[96:99] offset:16384
    ds_write_b128 v2, v[100:103] offset:17408
    ds_write_b128 v2, v[104:107] offset:18432
    ds_write_b128 v2, v[108:111] offset:19456
    ds_write_b128 v2, v[112:115] offset:20480
    ds_write_b128 v2, v[116:119] offset:21504
    ds_write_b128 v2, v[120:123] offset:22528
    ds_write_b128 v2, v[124:127] offset:23552
    s_waitcnt lgkmcnt(0)
    s_mul_i32 s22, s12, 16384
    s_add_u32 s22, s22, 5120
    v_lshlrev_b32 v4, 4, v1
    v_add_u32 v4, s22, v4
    v_lshlrev_b32 v5, 3, v1
    v_add_u32 v5, s22, v5
    v_add_u32 v5, 2048, v5
    s_mul_i32 s23, s12, 2560
    s_add_u32 s23, s23, 98304
    v_lshlrev_b32 v6, 4, v1
    v_add_u32 v6, s23, v6
    v_lshlrev_b32 v7, 3, v1
    v_add_u32 v7, s23, v7
    v_add_u32 v7, 2048, v7
    v_lshrrev_b32 v2, 4, v1
    v_lshlrev_b32 v2, 8, v2
    v_and_b32 v3, 1, v1
    v_lshlrev_b32 v3, 7, v3
    v_add_u32 v2, v2, v3
    v_bfe_u32 v3, v1, 1, 3
    v_lshlrev_b32 v3, 4, v3
    v_add_u32 v2, v2, v3
    v_add_u32 v8, 98304, v2
    v_and_b32 v3, 1, v1
    v_cmp_eq_u32 vcc, 1, v3
    v_mov_b32 v9, 0x4444
    v_mov_b32 v3, 0xeeee
    v_cndmask_b32 v9, v9, v3, vcc
    v_lshlrev_b32 v10, 4, v1
    s_mul_i32 s15, s12, 24576
    v_add_u32 v10, s15, v10
    s_mov_b32 s38, 0
    s_load_dwordx2 s[42:43], s[0:1], 8
    v_and_b32 v2, 7, v0
    v_mul_u32_u24 v2, 1280, v2
    v_lshrrev_b32 v3, 3, v0
    v_lshlrev_b32 v3, 4, v3
    v_add_u32 v2, v2, v3
    v_lshlrev_b32 v3, 4, v0
    s_waitcnt lgkmcnt(0)
    global_load_dwordx4 v[32:35], v2, s[42:43]
    global_load_dwordx4 v[36:39], v2, s[42:43] offset:512
    s_cmp_ge_u32 s12, 2
    s_cbranch_scc1 .m0_102
    global_load_dwordx4 v[40:43], v2, s[42:43] offset:1024
    s_waitcnt vmcnt(0)
    v_add_u32 v2, 106496, v3
    ds_write_b128 v2, v[40:43]
.m0_102:
    s_waitcnt vmcnt(0)
    v_add_u32 v2, 98304, v3
    ds_write_b128 v2, v[32:35]
    ds_write_b128 v2, v[36:39] offset:4096
    s_waitcnt lgkmcnt(0)
    v_and_b32 v2, 15, v1
    v_lshrrev_b32 v3, 3, v2
    v_lshlrev_b32 v32, 8, v3
    v_bfe_u32 v3, v2, 1, 1
    v_lshlrev_b32 v3, 4, v3
    v_add_u32 v32, v32, v3
    v_bfe_u32 v3, v2, 2, 1
    v_lshlrev_b32 v3, 3, v3
    v_add_u32 v32, v32, v3
    v_and_b32 v3, 1, v2
    v_lshlrev_b32 v3, 1, v3
    v_add_u32 v32, v32, v3
    v_lshrrev_b32 v3, 4, v1
    v_lshlrev_b32 v34, 6, v3
    v_add_u32 v32, v32, v34
    v_lshrrev_b32 v33, 2, v2
    v_lshlrev_b32 v33, 7, v33
    v_lshlrev_b32 v34, 5, v3
    v_add_u32 v33, v33, v34
    v_and_b32 v3, 3, v2
    v_lshlrev_b32 v3, 1, v3
    v_add_u32 v33, v33, v3
    s_cmp_lg_u32 s12, 0
    s_cbranch_scc1 .qw_103
    v_add_u32 v21, 157696, v32
    v_add_u32 v24, 160768, v33
    v_add_u32 v22, 157700, v32
    v_add_u32 v25, 160776, v33
    v_add_u32 v23, 158208, v32
    v_add_u32 v26, 161280, v33
.qw_103:
    s_cmp_lg_u32 s12, 1
    s_cbranch_scc1 .qw_104
    v_add_u32 v21, 158212, v32
    v_add_u32 v24, 161288, v33
    v_add_u32 v22, 158720, v32
    v_add_u32 v25, 161792, v33
    v_add_u32 v23, 158724, v32
    v_add_u32 v26, 161800, v33
.qw_104:
    s_cmp_lg_u32 s12, 2
    s_cbranch_scc1 .qw_105
    v_add_u32 v21, 159232, v32
    v_add_u32 v24, 162304, v33
    v_add_u32 v22, 159236, v32
    v_add_u32 v25, 162312, v33
    v_add_u32 v23, 159744, v32
    v_add_u32 v26, 162816, v33
.qw_105:
    s_cmp_lg_u32 s12, 3
    s_cbranch_scc1 .qw_106
    v_add_u32 v21, 159748, v32
    v_add_u32 v24, 162824, v33
    v_add_u32 v22, 160256, v32
    v_add_u32 v25, 163328, v33
    v_add_u32 v23, 160260, v32
    v_add_u32 v26, 163336, v33
.qw_106:
    v_lshlrev_b32 v27, 4, v1
    v_and_b32 v2, 15, v1
    v_lshrrev_b32 v3, 2, v2
    v_lshlrev_b32 v3, 2, v3
    v_and_b32 v32, 1, v2
    v_lshlrev_b32 v32, 1, v32
    v_add_u32 v3, v3, v32
    v_and_b32 v32, 48, v1
    v_add_u32 v3, v3, v32
    v_bfe_u32 v32, v2, 1, 1
    v_mul_u32_u24 v32, 6144, v32
    v_lshlrev_b32 v28, 4, v3
    v_add_u32 v28, v28, v32
    v_lshlrev_b32 v29, 3, v3
    v_add_u32 v29, v29, v32
    v_add_u32 v29, 112640, v29
    v_add_u32 v28, 108544, v28
    s_mov_b32 s57, 12288
    s_lshr_b32 s25, s18, 3
    s_mul_i32 s25, s25, 16384
    s_and_b32 s23, s18, 7
    s_mul_i32 s23, s23, 640
    s_add_u32 s25, s25, s23
    s_and_b32 s23, s12, 1
    s_lshl_b32 s23, s23, 2
    v_lshrrev_b32 v3, 4, v1
    v_add_u32 v3, s23, v3
    v_lshrrev_b32 v32, 3, v2
    v_lshlrev_b32 v32, 8, v32
    v_lshlrev_b32 v33, 5, v3
    v_add_u32 v32, v32, v33
    v_and_b32 v33, 1, v2
    v_lshlrev_b32 v33, 4, v33
    v_add_u32 v32, v32, v33
    v_bfe_u32 v33, v2, 1, 2
    v_lshlrev_b32 v33, 2, v33
    v_add_u32 v32, v32, v33
    v_add_u32 v30, s25, v32
    v_lshlrev_b32 v32, 4, v3
    v_bfe_u32 v33, v2, 1, 1
    v_lshlrev_b32 v33, 3, v33
    v_add_u32 v32, v32, v33
    v_bfe_u32 v33, v2, 2, 1
    v_lshlrev_b32 v33, 2, v33
    v_add_u32 v32, v32, v33
    v_add_u32 v32, 512, v32
    v_add_u32 v31, s25, v32
    v_and_b32 v3, 9, v1
    v_cmp_eq_u32 vcc, 0, v3
    s_mov_b64 s[62:63], vcc
    v_cmp_gt_u32 vcc, 8, v2
    s_mov_b64 s[64:65], vcc
    s_mul_i32 s25, s18, 12288
    s_add_u32 s23, s25, 182452224
    s_add_u32 s66, s4, s23
    s_addc_u32 s67, s5, 0
    s_add_u32 s23, s25, 157286400
    s_add_u32 s68, s4, s23
    s_addc_u32 s69, s5, 0
    s_mul_i32 s25, s18, 2560
    s_add_u32 s25, s25, 232783872
    s_add_u32 s70, s4, s25
    s_addc_u32 s71, s5, 0
    s_mul_i32 s72, s18, 3
    s_add_u32 s73, s72, 2
    s_lshr_b32 s72, s72, 2
    s_lshr_b32 s73, s73, 2
    s_sub_u32 s73, s73, s72
    s_lshl_b32 s73, s73, 7
    v_and_b32 v17, 1, v1
    v_mul_lo_u32 v17, v17, s73
    s_lshl_b32 s72, s72, 7
    s_add_u32 s72, s72, 10240
    s_add_u32 s72, s10, s72
    s_addc_u32 s73, s11, 0
    s_lshl_b32 s47, s18, 7
    s_add_u32 s47, s47, 24576
    s_mov_b32 s74, 0
    s_mov_b32 s75, 108544
    s_mov_b32 s76, 108544
    s_and_b32 s77, s12, 1
    s_mul_i32 s77, s77, 6144
    v_lshrrev_b32 v2, 4, v1
    v_lshlrev_b32 v2, 7, v2
    v_and_b32 v3, 7, v1
    v_lshlrev_b32 v3, 4, v3
    v_add_u32 v0, v2, v3
    v_add_u32 v0, 160768, v0
    s_mov_b32 s58, 0
    s_mov_b32 s59, 0
    v_add_u32 v11, 157696, v27
    v_and_b32 v12, 3, v1
    v_lshlrev_b32 v12, 2, v12
    v_add_u32 v12, 98304, v12
    s_lshl_b32 s25, s12, 2
    s_add_u32 s25, s25, 98304
    v_mov_b32 v13, s25
    v_add_u32 v14, 8, v29
    s_mul_i32 s22, s12, 0
    v_add_u32 v4, s22, v4
    v_add_u32 v5, s22, v5
    s_mul_i32 s22, s12, 0
    v_add_u32 v6, s22, v6
    v_add_u32 v7, s22, v7
    v_mov_b32 v2, 128
.iw_107:
    global_load_dword v3, v2, s[6:7] sc0 sc1
    s_waitcnt vmcnt(0)
    v_readfirstlane_b32 s15, v3
    s_nop 3
    s_cmp_ge_u32 s15, 64
    s_cbranch_scc1 .iwd_108
    s_sleep 4
    s_add_u32 s14, s14, 1
    s_cmp_gt_u32 s14, 400000
    s_cbranch_scc1 .Lend
    s_branch .iw_107
.iwd_108:
.detw_109:
    v_mov_b32 v2, 72
    global_load_dword v3, v2, s[6:7] sc0 sc1
    s_waitcnt vmcnt(0)
    v_readfirstlane_b32 s60, v3
    s_add_u32 s14, s14, 1
    s_cmp_gt_u32 s14, 400000
    s_cbranch_scc1 .Lend
    s_and_b32 s15, s60, 0xff
    s_cmp_lt_u32 s15, 8
    s_cbranch_scc1 .detw_109
    s_cmp_ge_u32 s60, 0x500
    s_cselect_b32 s15, 8192, 0
    s_add_u32 s15, s15, 0
    s_add_u32 s34, s4, s15
    s_addc_u32 s35, s5, 0
    s_add_u32 s54, s34, 720896
    s_addc_u32 s55, s35, 0
    s_cmp_eq_u32 s18, 0
    s_cselect_b32 s56, s12, 99
    s_mov_b32 s53, 0
    s_mov_b32 s52, 0
    s_mov_b32 s33, 1
    s_cmp_ge_u32 s74, s33
    s_cbranch_scc1 .wkqd_111
    v_mov_b32 v2, 0
.wkq_110:
    global_load_dword v3, v17, s[72:73] offset:-2048 sc1
    global_load_dword v2, v17, s[72:73] offset:2048 sc1
    s_waitcnt vmcnt(0)
    v_min_u32 v3, v3, v2
    s_nop 0
    v_readlane_b32 s74, v3, 0
    v_readlane_b32 s15, v3, 1
    s_nop 3
    s_min_u32 s74, s74, s15
    s_cmp_ge_u32 s74, s33
    s_cbranch_scc1 .wkqd_111
    s_sleep 2
    s_add_u32 s14, s14, 1
    s_cmp_gt_u32 s14, 400000
    s_cbranch_scc1 .Lend
    s_branch .wkq_110
.wkqd_111:
    s_cmp_lt_u32 s12, 2
    s_cbranch_scc1 .ikq_112
    s_add_u32 m0, s77, 133120
    v_add_u32 v3, s77, v27
    global_load_lds_dwordx4 v3, s[68:69] offset:0 sc1
    global_load_lds_dwordx4 v3, s[68:69] offset:1024 sc1
    global_load_lds_dwordx4 v3, s[68:69] offset:2048 sc1
    global_load_lds_dwordx4 v3, s[68:69] offset:3072 sc1
    s_add_u32 m0, m0, 4096
    v_add_u32 v3, 4096, v3
    global_load_lds_dwordx4 v3, s[68:69] offset:0 sc1
    global_load_lds_dwordx4 v3, s[68:69] offset:1024 sc1
    s_add_u32 s68, s68, 393216
    s_addc_u32 s69, s69, 0
    s_add_u32 m0, s76, s77
    v_add_u32 v3, s77, v27
    global_load_lds_dwordx4 v3, s[66:67] offset:0 sc1
    global_load_lds_dwordx4 v3, s[66:67] offset:1024 sc1
    global_load_lds_dwordx4 v3, s[66:67] offset:2048 sc1
    global_load_lds_dwordx4 v3, s[66:67] offset:3072 sc1
    s_add_u32 m0, m0, 4096
    v_add_u32 v3, 4096, v3
    global_load_lds_dwordx4 v3, s[66:67] offset:0 sc1
    global_load_lds_dwordx4 v3, s[66:67] offset:1024 sc1
    s_add_u32 s66, s66, 393216
    s_addc_u32 s67, s67, 0
    s_xor_b32 s76, s76, 28672
    s_sub_u32 s66, s66, 393216
    s_subb_u32 s67, s67, 0
    s_sub_u32 s68, s68, 393216
    s_subb_u32 s69, s69, 0
.ikq_112:
    s_waitcnt vmcnt(0)
    v_mov_b32 v32, 0
    v_mov_b32 v33, 0
    v_mov_b32 v34, 0
    v_mov_b32 v35, 0
    v_mov_b32 v36, 0
    v_mov_b32 v37, 0
    v_mov_b32 v38, 0
    v_mov_b32 v39, 0
    v_mov_b32 v40, 0
    v_mov_b32 v41, 0
    v_mov_b32 v42, 0
    v_mov_b32 v43, 0
    v_mov_b32 v44, 0
    v_mov_b32 v45, 0
    v_mov_b32 v46, 0
    v_mov_b32 v47, 0
    v_mov_b32 v48, 0
    v_mov_b32 v49, 0
    v_mov_b32 v50, 0
    v_mov_b32 v51, 0
    v_mov_b32 v52, 0
    v_mov_b32 v53, 0
    v_mov_b32 v54, 0
    v_mov_b32 v55, 0
    v_mov_b32 v112, 0
    v_mov_b32 v113, 0
    v_mov_b32 v114, 0
    v_mov_b32 v115, 0
    v_mov_b32 v116, 0
    v_mov_b32 v117, 0
    v_mov_b32 v118, 0
    v_mov_b32 v119, 0
    ds_read_b128 v[120:123], v10 offset:0
    ds_read_b128 v[124:127], v10 offset:1024
    ds_read_b128 v[96:99], v10 offset:2048
    ds_read_b128 v[100:103], v10 offset:3072
    ds_read_b128 v[104:107], v10 offset:4096
    ds_read_b128 v[108:111], v10 offset:5120
    s_add_u32 s58, s58, 1
    v_mov_b32 v15, s58
    s_waitcnt lgkmcnt(0)
    s_branch .LS_go
.LS_step:
    global_load_dwordx4 v[56:59], v4, s[34:35] sc1
    global_load_dwordx4 v[60:63], v4, s[34:35] offset:1024 sc1
    global_load_dwordx2 v[64:65], v5, s[34:35] sc1
.Le1S0:
    s_waitcnt vmcnt(0)
    ds_write_b128 v6, v[56:59]
    ds_write_b128 v6, v[60:63] offset:1024
    ds_write_b64 v7, v[64:65]
    v_max3_u32 v2, v56, v57, v58
    v_max3_u32 v3, v59, v60, v61
    v_max3_u32 v2, v2, v62, v63
    v_max3_u32 v3, v3, v64, v65
    v_max_u32 v2, v2, v3
    v_cmp_eq_u32 vcc, -1, v2
    s_waitcnt lgkmcnt(0)
    s_cbranch_vccz .Le1okS
    global_load_dwordx4 v[56:59], v4, s[34:35] sc1
    global_load_dwordx4 v[60:63], v4, s[34:35] offset:1024 sc1
    global_load_dwordx2 v[64:65], v5, s[34:35] sc1
    s_add_u32 s14, s14, 1
    s_cmp_gt_u32 s14, 400000
    s_cbranch_scc1 .Lend
    s_branch .Le1S0
.Le1okS:
.LS_go:
    s_barrier
    s_cmp_ge_u32 s12, 2
    s_cbranch_scc1 .LS_projB
    s_cmp_eq_u32 s12, 1
    s_cbranch_scc1 .LS_projA1
.LS_projA0:
    ds_read_b128 v[56:59], v8 offset:0
    ds_read_b128 v[60:63], v8 offset:1024
    ds_read_b128 v[64:67], v8 offset:2048
    ds_read_b128 v[68:71], v8 offset:3072
    ds_read_b128 v[72:75], v8 offset:4096
    ds_read_b128 v[76:79], v8 offset:5120
    ds_read_b128 v[80:83], v8 offset:6144
    ds_read_b128 v[84:87], v8 offset:7168
    ds_read_b128 v[88:91], v8 offset:8192
    ds_read_b128 v[92:95], v8 offset:9216
    s_waitcnt lgkmcnt(9)
    v_smfmac_f32_16x16x64_bf16 v[32:35], v[56:59], a[0:7], v9
    v_smfmac_f32_16x16x64_bf16 v[36:39], v[56:59], v[120:127], v9
    ds_read_b128 v[120:123], v10 offset:6144
    ds_read_b128 v[124:127], v10 offset:7168
    v_smfmac_f32_16x16x64_bf16 v[40:43], v[56:59], a[8:15], v9
    s_waitcnt lgkmcnt(10)
    v_smfmac_f32_16x16x64_bf16 v[32:35], v[60:63], a[16:23], v9
    v_smfmac_f32_16x16x64_bf16 v[36:39], v[60:63], v[96:103], v9
    ds_read_b128 v[96:99], v10 offset:8192
    ds_read_b128 v[100:103], v10 offset:9216
    v_smfmac_f32_16x16x64_bf16 v[40:43], v[60:63], a[24:31], v9
    s_waitcnt lgkmcnt(11)
    v_smfmac_f32_16x16x64_bf16 v[32:35], v[64:67], a[32:39], v9
    v_smfmac_f32_16x16x64_bf16 v[36:39], v[64:67], v[104:111], v9
    ds_read_b128 v[104:107], v10 offset:10240
    ds_read_b128 v[108:111], v10 offset:11264
    v_smfmac_f32_16x16x64_bf16 v[40:43], v[64:67], a[40:47], v9
    s_waitcnt lgkmcnt(12)
    v_smfmac_f32_16x16x64_bf16 v[32:35], v[68:71], a[48:55], v9
    s_waitcnt lgkmcnt(4)
    v_smfmac_f32_16x16x64_bf16 v[36:39], v[68:71], v[120:127], v9
    ds_read_b128 v[120:123], v10 offset:12288
    ds_read_b128 v[124:127], v10 offset:13312
    v_smfmac_f32_16x16x64_bf16 v[40:43], v[68:71], a[56:63], v9
    v_smfmac_f32_16x16x64_bf16 v[32:35], v[72:75], a[64:71], v9
    s_waitcnt lgkmcnt(4)
    v_smfmac_f32_16x16x64_bf16 v[36:39], v[72:75], v[96:103], v9
    ds_read_b128 v[96:99], v10 offset:14336
    ds_read_b128 v[100:103], v10 offset:15360
    v_smfmac_f32_16x16x64_bf16 v[40:43], v[72:75], a[72:79], v9
    v_smfmac_f32_16x16x64_bf16 v[32:35], v[76:79], a[80:87], v9
    s_waitcnt lgkmcnt(4)
    v_smfmac_f32_16x16x64_bf16 v[36:39], v[76:79], v[104:111], v9
    ds_read_b128 v[104:107], v10 offset:16384
    ds_read_b128 v[108:111], v10 offset:17408
    v_smfmac_f32_16x16x64_bf16 v[40:43], v[76:79], a[88:95], v9
    v_smfmac_f32_16x16x64_bf16 v[32:35], v[80:83], a[96:103], v9
    s_waitcnt lgkmcnt(4)
    v_smfmac_f32_16x16x64_bf16 v[36:39], v[80:83], v[120:127], v9
    ds_read_b128 v[120:123], v10 offset:18432
    ds_read_b128 v[124:127], v10 offset:19456
    v_smfmac_f32_16x16x64_bf16 v[40:43], v[80:83], a[104:111], v9
    v_smfmac_f32_16x16x64_bf16 v[32:35], v[84:87], a[112:119], v9
    s_waitcnt lgkmcnt(4)
    v_smfmac_f32_16x16x64_bf16 v[32:35], v[88:91], v[96:103], v9
    ds_read_b128 v[96:99], v10 offset:20480
    ds_read_b128 v[100:103], v10 offset:21504
    v_smfmac_f32_16x16x64_bf16 v[32:35], v[92:95], a[120:127], v9
    v_smfmac_f32_16x16x64_bf16 v[36:39], v[84:87], a[128:135], v9
    s_waitcnt lgkmcnt(4)
    v_smfmac_f32_16x16x64_bf16 v[36:39], v[88:91], v[104:111], v9
    ds_read_b128 v[104:107], v10 offset:22528
    ds_read_b128 v[108:111], v10 offset:23552
    v_smfmac_f32_16x16x64_bf16 v[36:39], v[92:95], a[136:143], v9
    v_add_f32 v32, v32, v33
    v_add_f32 v34, v34, v35
    v_smfmac_f32_16x16x64_bf16 v[40:43], v[84:87], a[144:151], v9
    v_cvt_pk_bf16_f32 v32, v32, v34
    ds_write_b16 v21, v32
    s_waitcnt lgkmcnt(5)
    v_smfmac_f32_16x16x64_bf16 v[40:43], v[88:91], v[120:127], v9
    ds_write_b16_d16_hi v21, v32 offset:32
    ds_read_b128 v[120:123], v28 offset:0
    v_smfmac_f32_16x16x64_bf16 v[40:43], v[92:95], a[152:159], v9
    v_add_f32 v36, v36, v37
    ds_read_b128 v[124:127], v28 offset:1024
    v_smfmac_f32_16x16x64_bf16 v[44:47], v[56:59], a[160:167], v9
    v_add_f32 v38, v38, v39
    v_cvt_pk_bf16_f32 v36, v36, v38
    s_waitcnt lgkmcnt(6)
    v_smfmac_f32_16x16x64_bf16 v[48:51], v[56:59], v[96:103], v9
    ds_write_b16 v22, v36
    ds_read_b128 v[96:99], v28 offset:16
    v_smfmac_f32_16x16x64_bf16 v[52:55], v[56:59], a[168:175], v9
    ds_write_b16_d16_hi v22, v36 offset:32
    ds_read_b128 v[100:103], v28 offset:1040
    v_smfmac_f32_16x16x64_bf16 v[44:47], v[60:63], a[176:183], v9
    v_add_f32 v40, v40, v41
    v_add_f32 v42, v42, v43
    s_waitcnt lgkmcnt(8)
    v_smfmac_f32_16x16x64_bf16 v[48:51], v[60:63], v[104:111], v9
    v_cvt_pk_bf16_f32 v40, v40, v42
    ds_read_b128 v[104:107], v28 offset:2048
    v_smfmac_f32_16x16x64_bf16 v[52:55], v[60:63], a[184:191], v9
    ds_write_b16 v23, v40
    ds_read_b128 v[108:111], v28 offset:3072
    v_smfmac_f32_16x16x64_bf16 v[44:47], v[64:67], a[192:199], v9
    ds_write_b16_d16_hi v23, v40 offset:32
    ds_read_b128 v[56:59], v28 offset:2064
    v_smfmac_f32_16x16x64_bf16 v[48:51], v[64:67], a[200:207], v9
    ds_read_b128 v[60:63], v28 offset:3088
    v_smfmac_f32_16x16x64_bf16 v[52:55], v[64:67], a[208:215], v9
    v_smfmac_f32_16x16x64_bf16 v[44:47], v[68:71], a[216:223], v9
    v_smfmac_f32_16x16x64_bf16 v[48:51], v[68:71], a[224:231], v9
    s_waitcnt lgkmcnt(2)
    s_barrier
    ds_read_b128 v[32:35], v11 offset:0
    v_smfmac_f32_16x16x64_bf16 v[52:55], v[68:71], a[232:239], v9
    ds_read_b128 v[36:39], v11 offset:1024
    ds_read_b128 v[64:67], v28 offset:4096
    v_smfmac_f32_16x16x64_bf16 v[44:47], v[72:75], a[240:247], v9
    ds_read_b128 v[40:43], v11 offset:2048
    ds_read_b128 v[68:71], v28 offset:5120
    v_smfmac_f32_16x16x64_bf16 v[48:51], v[72:75], a[248:255], v9
    v_smfmac_f32_16x16x64_bf16 v[52:55], v[72:75], v[128:135], v9
    v_smfmac_f32_16x16x64_bf16 v[44:47], v[76:79], v[136:143], v9
    s_waitcnt lgkmcnt(4)
    v_smfmac_f32_16x16x64_bf16 v[112:115], v[32:35], v[120:127], v9
    v_smfmac_f32_16x16x64_bf16 v[116:119], v[32:35], v[96:103], v9
    ds_read_b128 v[96:99], v28 offset:4112
    s_waitcnt lgkmcnt(4)
    v_smfmac_f32_16x16x64_bf16 v[112:115], v[36:39], v[104:111], v9
    ds_read_b128 v[100:103], v28 offset:5136
    v_smfmac_f32_16x16x64_bf16 v[116:119], v[36:39], v[56:63], v9
    s_waitcnt lgkmcnt(3)
    s_waitcnt lgkmcnt(2)
    v_smfmac_f32_16x16x64_bf16 v[112:115], v[40:43], v[64:71], v9
    v_smfmac_f32_16x16x64_bf16 v[48:51], v[76:79], v[144:151], v9
    v_smfmac_f32_16x16x64_bf16 v[52:55], v[76:79], v[152:159], v9
    v_smfmac_f32_16x16x64_bf16 v[44:47], v[80:83], v[160:167], v9
    v_smfmac_f32_16x16x64_bf16 v[48:51], v[80:83], v[168:175], v9
    s_waitcnt lgkmcnt(0)
    v_smfmac_f32_16x16x64_bf16 v[116:119], v[40:43], v[96:103], v9
    v_add_f32 v120, v112, v113
    v_mov_b32 v124, 0x3dd53b95
    v_smfmac_f32_16x16x64_bf16 v[52:55], v[80:83], v[176:183], v9
    v_smfmac_f32_16x16x64_bf16 v[44:47], v[84:87], v[184:191], v9
    v_add_f32 v121, v116, v117
    v_max_f32 v122, v120, v121
    v_smfmac_f32_16x16x64_bf16 v[44:47], v[88:91], v[192:199], v9
    v_smfmac_f32_16x16x64_bf16 v[44:47], v[92:95], v[200:207], v9
    v_max_f32_dpp v122, v122, v122 row_ror:8 row_mask:0xf bank_mask:0xf
    v_smfmac_f32_16x16x64_bf16 v[48:51], v[84:87], v[208:215], v9
    v_smfmac_f32_16x16x64_bf16 v[48:51], v[88:91], v[216:223], v9
    v_add_f32 v44, v44, v45
    v_max_f32_dpp v122, v122, v122 row_ror:4 row_mask:0xf bank_mask:0xf
    v_smfmac_f32_16x16x64_bf16 v[48:51], v[92:95], v[224:231], v9
    v_add_f32 v46, v46, v47
    v_max_f32_dpp v122, v122, v122 row_ror:2 row_mask:0xf bank_mask:0xf
    v_smfmac_f32_16x16x64_bf16 v[52:55], v[84:87], v[232:239], v9
    v_cvt_pk_bf16_f32 v44, v44, v46
    v_max_f32_dpp v122, v122, v122 row_ror:1 row_mask:0xf bank_mask:0xf
    v_smfmac_f32_16x16x64_bf16 v[52:55], v[88:91], v[240:247], v9
    ds_write_b16 v24, v44
    v_mul_f32 v122, v122, v124
    v_smfmac_f32_16x16x64_bf16 v[52:55], v[92:95], v[248:255], v9
    ds_write_b16_d16_hi v24, v44 offset:16
    v_fma_f32 v120, v120, v124, -v122
    v_add_f32 v48, v48, v49
    v_fma_f32 v121, v121, v124, -v122
    v_add_f32 v50, v50, v51
    v_exp_f32 v120, v120
    v_cvt_pk_bf16_f32 v48, v48, v50
    v_exp_f32 v121, v121
    ds_write_b16 v25, v48
    v_add_f32 v123, v120, v121
    ds_write_b16_d16_hi v25, v48 offset:16
    v_add_f32 v52, v52, v53
    v_add_f32_dpp v123, v123, v123 row_ror:8 row_mask:0xf bank_mask:0xf
    v_add_f32 v54, v54, v55
    v_cvt_pk_bf16_f32 v52, v52, v54
    v_add_f32_dpp v123, v123, v123 row_ror:4 row_mask:0xf bank_mask:0xf
    ds_write_b16 v26, v52
    ds_write_b16_d16_hi v26, v52 offset:16
    v_add_f32_dpp v123, v123, v123 row_ror:2 row_mask:0xf bank_mask:0xf
    s_waitcnt lgkmcnt(0)
    s_barrier
    v_add_f32_dpp v123, v123, v123 row_ror:1 row_mask:0xf bank_mask:0xf
    ds_read_b128 v[96:99], v0 offset:0
    ds_read_b128 v[100:103], v0 offset:512
    ds_read_b128 v[104:107], v0 offset:1024
    ds_read_b128 v[108:111], v0 offset:1536
    ds_read_b128 v[44:47], v0 offset:2048
    ds_read_b128 v[48:51], v0 offset:2560
    v_mov_b32 v52, 0
    v_mov_b32 v53, 0
    v_mov_b32 v54, 0
    v_mov_b32 v55, 0
    s_nop 0
    s_waitcnt lgkmcnt(4)
    v_smfmac_f32_16x16x64_bf16 v[52:55], v[32:35], v[96:103], v9
    s_waitcnt lgkmcnt(2)
    v_smfmac_f32_16x16x64_bf16 v[52:55], v[36:39], v[104:111], v9
    s_waitcnt lgkmcnt(0)
    v_smfmac_f32_16x16x64_bf16 v[52:55], v[40:43], v[44:51], v9
    s_nop 0
    s_nop 0
    s_nop 0
    s_nop 0
    s_nop 0
    s_nop 0
    s_cmp_ge_u32 s38, 63
    s_cbranch_scc1 .LS_fin
    v_add_f32 v125, v52, v53
    v_mul_f32 v125, v125, v124
    v_max_f32 v126, v125, v122
    s_nop 1
    v_max_f32_dpp v126, v126, v126 quad_perm:[1,0,3,2] row_mask:0xf bank_mask:0xf
    s_nop 1
    v_max_f32_dpp v126, v126, v126 quad_perm:[2,3,0,1] row_mask:0xf bank_mask:0xf
    s_nop 1
    v_max_f32_dpp v126, v126, v126 row_half_mirror row_mask:0xf bank_mask:0xf
    v_sub_f32 v125, v125, v126
    v_sub_f32 v127, v122, v126
    v_exp_f32 v125, v125
    v_exp_f32 v127, v127
    v_mov_b32 v56, v125
    s_nop 1
    v_add_f32_dpp v56, v56, v56 quad_perm:[1,0,3,2] row_mask:0xf bank_mask:0xf
    s_nop 1
    v_add_f32_dpp v56, v56, v56 quad_perm:[2,3,0,1] row_mask:0xf bank_mask:0xf
    s_nop 1
    v_add_f32_dpp v56, v56, v56 row_half_mirror row_mask:0xf bank_mask:0xf
    v_fmac_f32 v56, v123, v127
    v_rcp_f32 v56, v56
    s_nop 0
    v_mul_f32 v125, v125, v56
    v_mul_f32 v127, v127, v56
    v_mul_f32 v120, v120, v127
    v_mul_f32 v121, v121, v127
    v_mov_b32_dpp v126, v125 quad_perm:[1,0,3,2] row_mask:0xf bank_mask:0xf
    v_cvt_pk_bf16_f32 v120, v120, v121
    global_store_dword v30, v120, s[34:35] sc1
    v_cvt_pk_bf16_f32 v125, v125, v126
    s_mov_b64 exec, s[62:63]
    global_store_dword v31, v125, s[34:35] sc1
    s_mov_b64 exec, -1
    s_branch .LS_next
.LS_projA1:
    ds_read_b128 v[56:59], v8 offset:0
    ds_read_b128 v[60:63], v8 offset:1024
    ds_read_b128 v[64:67], v8 offset:2048
    ds_read_b128 v[68:71], v8 offset:3072
    ds_read_b128 v[72:75], v8 offset:4096
    ds_read_b128 v[76:79], v8 offset:5120
    ds_read_b128 v[80:83], v8 offset:6144
    ds_read_b128 v[84:87], v8 offset:7168
    ds_read_b128 v[88:91], v8 offset:8192
    ds_read_b128 v[92:95], v8 offset:9216
    s_waitcnt lgkmcnt(9)
    v_smfmac_f32_16x16x64_bf16 v[32:35], v[56:59], a[0:7], v9
    v_smfmac_f32_16x16x64_bf16 v[36:39], v[56:59], v[120:127], v9
    ds_read_b128 v[120:123], v10 offset:6144
    ds_read_b128 v[124:127], v10 offset:7168
    v_smfmac_f32_16x16x64_bf16 v[40:43], v[56:59], a[8:15], v9
    s_waitcnt lgkmcnt(10)
    v_smfmac_f32_16x16x64_bf16 v[32:35], v[60:63], a[16:23], v9
    v_smfmac_f32_16x16x64_bf16 v[36:39], v[60:63], v[96:103], v9
    ds_read_b128 v[96:99], v10 offset:8192
    ds_read_b128 v[100:103], v10 offset:9216
    v_smfmac_f32_16x16x64_bf16 v[40:43], v[60:63], a[24:31], v9
    s_waitcnt lgkmcnt(11)
    v_smfmac_f32_16x16x64_bf16 v[32:35], v[64:67], a[32:39], v9
    v_smfmac_f32_16x16x64_bf16 v[36:39], v[64:67], v[104:111], v9
    ds_read_b128 v[104:107], v10 offset:10240
    ds_read_b128 v[108:111], v10 offset:11264
    v_smfmac_f32_16x16x64_bf16 v[40:43], v[64:67], a[40:47], v9
    s_waitcnt lgkmcnt(12)
    v_smfmac_f32_16x16x64_bf16 v[32:35], v[68:71], a[48:55], v9
    s_waitcnt lgkmcnt(4)
    v_smfmac_f32_16x16x64_bf16 v[36:39], v[68:71], v[120:127], v9
    ds_read_b128 v[120:123], v10 offset:12288
    ds_read_b128 v[124:127], v10 offset:13312
    v_smfmac_f32_16x16x64_bf16 v[40:43], v[68:71], a[56:63], v9
    v_smfmac_f32_16x16x64_bf16 v[32:35], v[72:75], a[64:71], v9
    s_waitcnt lgkmcnt(4)
    v_smfmac_f32_16x16x64_bf16 v[36:39], v[72:75], v[96:103], v9
    ds_read_b128 v[96:99], v10 offset:14336
    ds_read_b128 v[100:103], v10 offset:15360
    v_smfmac_f32_16x16x64_bf16 v[40:43], v[72:75], a[72:79], v9
    v_smfmac_f32_16x16x64_bf16 v[32:35], v[76:79], a[80:87], v9
    s_waitcnt lgkmcnt(4)
    v_smfmac_f32_16x16x64_bf16 v[36:39], v[76:79], v[104:111], v9
    ds_read_b128 v[104:107], v10 offset:16384
    ds_read_b128 v[108:111], v10 offset:17408
    v_smfmac_f32_16x16x64_bf16 v[40:43], v[76:79], a[88:95], v9
    v_smfmac_f32_16x16x64_bf16 v[32:35], v[80:83], a[96:103], v9
    s_waitcnt lgkmcnt(4)
    v_smfmac_f32_16x16x64_bf16 v[36:39], v[80:83], v[120:127], v9
    ds_read_b128 v[120:123], v10 offset:18432
    ds_read_b128 v[124:127], v10 offset:19456
    v_smfmac_f32_16x16x64_bf16 v[40:43], v[80:83], a[104:111], v9
    v_smfmac_f32_16x16x64_bf16 v[32:35], v[84:87], a[112:119], v9
    s_waitcnt lgkmcnt(4)
    v_smfmac_f32_16x16x64_bf16 v[32:35], v[88:91], v[96:103], v9
    ds_read_b128 v[96:99], v10 offset:20480
    ds_read_b128 v[100:103], v10 offset:21504
    v_smfmac_f32_16x16x64_bf16 v[32:35], v[92:95], a[120:127], v9
    v_smfmac_f32_16x16x64_bf16 v[36:39], v[84:87], a[128:135], v9
    s_waitcnt lgkmcnt(4)
    v_smfmac_f32_16x16x64_bf16 v[36:39], v[88:91], v[104:111], v9
    ds_read_b128 v[104:107], v10 offset:22528
    ds_read_b128 v[108:111], v10 offset:23552
    v_smfmac_f32_16x16x64_bf16 v[36:39], v[92:95], a[136:143], v9
    v_add_f32 v32, v32, v33
    v_add_f32 v34, v34, v35
    v_smfmac_f32_16x16x64_bf16 v[40:43], v[84:87], a[144:151], v9
    v_cvt_pk_bf16_f32 v32, v32, v34
    ds_write_b16 v21, v32
    s_waitcnt lgkmcnt(5)
    v_smfmac_f32_16x16x64_bf16 v[40:43], v[88:91], v[120:127], v9
    ds_write_b16_d16_hi v21, v32 offset:32
    ds_read_b128 v[120:123], v28 offset:0
    v_smfmac_f32_16x16x64_bf16 v[40:43], v[92:95], a[152:159], v9
    v_add_f32 v36, v36, v37
    ds_read_b128 v[124:127], v28 offset:1024
    v_smfmac_f32_16x16x64_bf16 v[44:47], v[56:59], a[160:167], v9
    v_add_f32 v38, v38, v39
    v_cvt_pk_bf16_f32 v36, v36, v38
    s_waitcnt lgkmcnt(6)
    v_smfmac_f32_16x16x64_bf16 v[48:51], v[56:59], v[96:103], v9
    ds_write_b16 v22, v36
    ds_read_b128 v[96:99], v28 offset:16
    v_smfmac_f32_16x16x64_bf16 v[52:55], v[56:59], a[168:175], v9
    ds_write_b16_d16_hi v22, v36 offset:32
    ds_read_b128 v[100:103], v28 offset:1040
    v_smfmac_f32_16x16x64_bf16 v[44:47], v[60:63], a[176:183], v9
    v_add_f32 v40, v40, v41
    v_add_f32 v42, v42, v43
    s_waitcnt lgkmcnt(8)
    v_smfmac_f32_16x16x64_bf16 v[48:51], v[60:63], v[104:111], v9
    v_cvt_pk_bf16_f32 v40, v40, v42
    ds_read_b128 v[104:107], v28 offset:2048
    v_smfmac_f32_16x16x64_bf16 v[52:55], v[60:63], a[184:191], v9
    ds_write_b16 v23, v40
    ds_read_b128 v[108:111], v28 offset:3072
    v_smfmac_f32_16x16x64_bf16 v[44:47], v[64:67], a[192:199], v9
    ds_write_b16_d16_hi v23, v40 offset:32
    ds_read_b128 v[56:59], v28 offset:2064
    v_smfmac_f32_16x16x64_bf16 v[48:51], v[64:67], a[200:207], v9
    ds_read_b128 v[60:63], v28 offset:3088
    v_smfmac_f32_16x16x64_bf16 v[52:55], v[64:67], a[208:215], v9
    v_smfmac_f32_16x16x64_bf16 v[44:47], v[68:71], a[216:223], v9
    v_smfmac_f32_16x16x64_bf16 v[48:51], v[68:71], a[224:231], v9
    s_waitcnt lgkmcnt(2)
    s_barrier
    ds_read_b128 v[32:35], v11 offset:0
    v_smfmac_f32_16x16x64_bf16 v[52:55], v[68:71], a[232:239], v9
    ds_read_b128 v[36:39], v11 offset:1024
    ds_read_b128 v[64:67], v28 offset:4096
    v_smfmac_f32_16x16x64_bf16 v[44:47], v[72:75], a[240:247], v9
    ds_read_b128 v[40:43], v11 offset:2048
    ds_read_b128 v[68:71], v28 offset:5120
    v_smfmac_f32_16x16x64_bf16 v[48:51], v[72:75], a[248:255], v9
    v_smfmac_f32_16x16x64_bf16 v[52:55], v[72:75], v[128:135], v9
    v_smfmac_f32_16x16x64_bf16 v[44:47], v[76:79], v[136:143], v9
    s_waitcnt lgkmcnt(4)
    v_smfmac_f32_16x16x64_bf16 v[112:115], v[32:35], v[120:127], v9
    v_smfmac_f32_16x16x64_bf16 v[116:119], v[32:35], v[96:103], v9
    ds_read_b128 v[96:99], v28 offset:4112
    s_waitcnt lgkmcnt(4)
    v_smfmac_f32_16x16x64_bf16 v[112:115], v[36:39], v[104:111], v9
    ds_read_b128 v[100:103], v28 offset:5136
    v_smfmac_f32_16x16x64_bf16 v[116:119], v[36:39], v[56:63], v9
    s_waitcnt lgkmcnt(3)
    s_waitcnt lgkmcnt(2)
    v_smfmac_f32_16x16x64_bf16 v[112:115], v[40:43], v[64:71], v9
    v_smfmac_f32_16x16x64_bf16 v[48:51], v[76:79], v[144:151], v9
    v_smfmac_f32_16x16x64_bf16 v[52:55], v[76:79], v[152:159], v9
    v_smfmac_f32_16x16x64_bf16 v[44:47], v[80:83], v[160:167], v9
    v_smfmac_f32_16x16x64_bf16 v[48:51], v[80:83], v[168:175], v9
    s_waitcnt lgkmcnt(0)
    v_smfmac_f32_16x16x64_bf16 v[116:119], v[40:43], v[96:103], v9
    v_add_f32 v120, v114, v115
    v_mov_b32 v124, 0x3dd53b95
    v_smfmac_f32_16x16x64_bf16 v[52:55], v[80:83], v[176:183], v9
    v_smfmac_f32_16x16x64_bf16 v[44:47], v[84:87], v[184:191], v9
    v_add_f32 v121, v118, v119
    v_max_f32 v122, v120, v121
    v_smfmac_f32_16x16x64_bf16 v[44:47], v[88:91], v[192:199], v9
    v_smfmac_f32_16x16x64_bf16 v[44:47], v[92:95], v[200:207], v9
    v_max_f32_dpp v122, v122, v122 row_ror:8 row_mask:0xf bank_mask:0xf
    v_smfmac_f32_16x16x64_bf16 v[48:51], v[84:87], v[208:215], v9
    v_smfmac_f32_16x16x64_bf16 v[48:51], v[88:91], v[216:223], v9
    v_add_f32 v44, v44, v45
    v_max_f32_dpp v122, v122, v122 row_ror:4 row_mask:0xf bank_mask:0xf
    v_smfmac_f32_16x16x64_bf16 v[48:51], v[92:95], v[224:231], v9
    v_add_f32 v46, v46, v47
    v_max_f32_dpp v122, v122, v122 row_ror:2 row_mask:0xf bank_mask:0xf
    v_smfmac_f32_16x16x64_bf16 v[52:55], v[84:87], v[232:239], v9
    v_cvt_pk_bf16_f32 v44, v44, v46
    v_max_f32_dpp v122, v122, v122 row_ror:1 row_mask:0xf bank_mask:0xf
    v_smfmac_f32_16x16x64_bf16 v[52:55], v[88:91], v[240:247], v9
    ds_write_b16 v24, v44
    v_mul_f32 v122, v122, v124
    v_smfmac_f32_16x16x64_bf16 v[52:55], v[92:95], v[248:255], v9
    ds_write_b16_d16_hi v24, v44 offset:16
    v_fma_f32 v120, v120, v124, -v122
    v_add_f32 v48, v48, v49
    v_fma_f32 v121, v121, v124, -v122
    v_add_f32 v50, v50, v51
    v_exp_f32 v120, v120
    v_cvt_pk_bf16_f32 v48, v48, v50
    v_exp_f32 v121, v121
    ds_write_b16 v25, v48
    v_add_f32 v123, v120, v121
    ds_write_b16_d16_hi v25, v48 offset:16
    v_add_f32 v52, v52, v53
    v_add_f32_dpp v123, v123, v123 row_ror:8 row_mask:0xf bank_mask:0xf
    v_add_f32 v54, v54, v55
    v_cvt_pk_bf16_f32 v52, v52, v54
    v_add_f32_dpp v123, v123, v123 row_ror:4 row_mask:0xf bank_mask:0xf
    ds_write_b16 v26, v52
    ds_write_b16_d16_hi v26, v52 offset:16
    v_add_f32_dpp v123, v123, v123 row_ror:2 row_mask:0xf bank_mask:0xf
    s_waitcnt lgkmcnt(0)
    s_barrier
    v_add_f32_dpp v123, v123, v123 row_ror:1 row_mask:0xf bank_mask:0xf
    ds_read_b128 v[96:99], v0 offset:0
    ds_read_b128 v[100:103], v0 offset:512
    ds_read_b128 v[104:107], v0 offset:1024
    ds_read_b128 v[108:111], v0 offset:1536
    ds_read_b128 v[44:47], v0 offset:2048
    ds_read_b128 v[48:51], v0 offset:2560
    v_mov_b32 v52, 0
    v_mov_b32 v53, 0
    v_mov_b32 v54, 0
    v_mov_b32 v55, 0
    s_nop 0
    s_waitcnt lgkmcnt(4)
    v_smfmac_f32_16x16x64_bf16 v[52:55], v[32:35], v[96:103], v9
    s_waitcnt lgkmcnt(2)
    v_smfmac_f32_16x16x64_bf16 v[52:55], v[36:39], v[104:111], v9
    s_waitcnt lgkmcnt(0)
    v_smfmac_f32_16x16x64_bf16 v[52:55], v[40:43], v[44:51], v9
    s_nop 0
    s_nop 0
    s_nop 0
    s_nop 0
    s_nop 0
    s_nop 0
    s_cmp_ge_u32 s38, 63
    s_cbranch_scc1 .LS_fin
    v_add_f32 v125, v54, v55
    v_mul_f32 v125, v125, v124
    v_max_f32 v126, v125, v122
    s_nop 1
    v_max_f32_dpp v126, v126, v126 quad_perm:[1,0,3,2] row_mask:0xf bank_mask:0xf
    s_nop 1
    v_max_f32_dpp v126, v126, v126 quad_perm:[2,3,0,1] row_mask:0xf bank_mask:0xf
    s_nop 1
    v_max_f32_dpp v126, v126, v126 row_half_mirror row_mask:0xf bank_mask:0xf
    v_sub_f32 v125, v125, v126
    v_sub_f32 v127, v122, v126
    v_exp_f32 v125, v125
    v_exp_f32 v127, v127
    v_mov_b32 v56, v125
    s_nop 1
    v_add_f32_dpp v56, v56, v56 quad_perm:[1,0,3,2] row_mask:0xf bank_mask:0xf
    s_nop 1
    v_add_f32_dpp v56, v56, v56 quad_perm:[2,3,0,1] row_mask:0xf bank_mask:0xf
    s_nop 1
    v_add_f32_dpp v56, v56, v56 row_half_mirror row_mask:0xf bank_mask:0xf
    v_fmac_f32 v56, v123, v127
    v_rcp_f32 v56, v56
    s_nop 0
    v_mul_f32 v125, v125, v56
    v_mul_f32 v127, v127, v56
    v_mul_f32 v120, v120, v127
    v_mul_f32 v121, v121, v127
    v_mov_b32_dpp v126, v125 quad_perm:[1,0,3,2] row_mask:0xf bank_mask:0xf
    v_cvt_pk_bf16_f32 v120, v120, v121
    global_store_dword v30, v120, s[34:35] sc1
    v_cvt_pk_bf16_f32 v125, v125, v126
    s_mov_b64 exec, s[62:63]
    global_store_dword v31, v125, s[34:35] sc1
    s_mov_b64 exec, -1
    s_branch .LS_next
.LS_projB:
    ds_read_b128 v[56:59], v8 offset:0
    ds_read_b128 v[60:63], v8 offset:1024
    ds_read_b128 v[64:67], v8 offset:2048
    ds_read_b128 v[68:71], v8 offset:3072
    ds_read_b128 v[72:75], v8 offset:4096
    ds_read_b128 v[76:79], v8 offset:5120
    ds_read_b128 v[80:83], v8 offset:6144
    ds_read_b128 v[84:87], v8 offset:7168
    ds_read_b128 v[88:91], v8 offset:8192
    ds_read_b128 v[92:95], v8 offset:9216
    s_waitcnt lgkmcnt(9)
    v_smfmac_f32_16x16x64_bf16 v[32:35], v[56:59], a[0:7], v9
    s_add_u32 s25, s76, s77
    s_add_u32 m0, s25, 24576
    v_add_u32 v16, s77, v27
    v_smfmac_f32_16x16x64_bf16 v[36:39], v[56:59], v[120:127], v9
    ds_read_b128 v[120:123], v10 offset:6144
    ds_read_b128 v[124:127], v10 offset:7168
    v_smfmac_f32_16x16x64_bf16 v[40:43], v[56:59], a[8:15], v9
    global_load_lds_dwordx4 v16, s[68:69] offset:0 sc1
    s_waitcnt lgkmcnt(10)
    v_smfmac_f32_16x16x64_bf16 v[32:35], v[60:63], a[16:23], v9
    global_load_lds_dwordx4 v16, s[68:69] offset:1024 sc1
    v_smfmac_f32_16x16x64_bf16 v[36:39], v[60:63], v[96:103], v9
    ds_read_b128 v[96:99], v10 offset:8192
    ds_read_b128 v[100:103], v10 offset:9216
    v_smfmac_f32_16x16x64_bf16 v[40:43], v[60:63], a[24:31], v9
    s_waitcnt lgkmcnt(11)
    v_smfmac_f32_16x16x64_bf16 v[32:35], v[64:67], a[32:39], v9
    global_load_lds_dwordx4 v16, s[68:69] offset:2048 sc1
    v_smfmac_f32_16x16x64_bf16 v[36:39], v[64:67], v[104:111], v9
    ds_read_b128 v[104:107], v10 offset:10240
    ds_read_b128 v[108:111], v10 offset:11264
    v_smfmac_f32_16x16x64_bf16 v[40:43], v[64:67], a[40:47], v9
    s_waitcnt lgkmcnt(12)
    v_smfmac_f32_16x16x64_bf16 v[32:35], v[68:71], a[48:55], v9
    global_load_lds_dwordx4 v16, s[68:69] offset:3072 sc1
    s_waitcnt lgkmcnt(4)
    v_smfmac_f32_16x16x64_bf16 v[36:39], v[68:71], v[120:127], v9
    ds_read_b128 v[120:123], v10 offset:12288
    ds_read_b128 v[124:127], v10 offset:13312
    v_smfmac_f32_16x16x64_bf16 v[40:43], v[68:71], a[56:63], v9
    v_smfmac_f32_16x16x64_bf16 v[32:35], v[72:75], a[64:71], v9
    s_add_u32 m0, m0, 4096
    v_add_u32 v16, 4096, v16
    s_waitcnt lgkmcnt(4)
    v_smfmac_f32_16x16x64_bf16 v[36:39], v[72:75], v[96:103], v9
    ds_read_b128 v[96:99], v10 offset:14336
    ds_read_b128 v[100:103], v10 offset:15360
    v_smfmac_f32_16x16x64_bf16 v[40:43], v[72:75], a[72:79], v9
    global_load_lds_dwordx4 v16, s[68:69] offset:0 sc1
    v_smfmac_f32_16x16x64_bf16 v[32:35], v[76:79], a[80:87], v9
    global_load_lds_dwordx4 v16, s[68:69] offset:1024 sc1
    s_waitcnt lgkmcnt(4)
    v_smfmac_f32_16x16x64_bf16 v[36:39], v[76:79], v[104:111], v9
    ds_read_b128 v[104:107], v10 offset:16384
    ds_read_b128 v[108:111], v10 offset:17408
    v_smfmac_f32_16x16x64_bf16 v[40:43], v[76:79], a[88:95], v9
    v_smfmac_f32_16x16x64_bf16 v[32:35], v[80:83], a[96:103], v9
    s_add_u32 s68, s68, 393216
    s_addc_u32 s69, s69, 0
    s_add_u32 m0, s76, s77
    s_waitcnt lgkmcnt(4)
    v_smfmac_f32_16x16x64_bf16 v[36:39], v[80:83], v[120:127], v9
    ds_read_b128 v[120:123], v10 offset:18432
    ds_read_b128 v[124:127], v10 offset:19456
    v_smfmac_f32_16x16x64_bf16 v[40:43], v[80:83], a[104:111], v9
    v_add_u32 v16, s77, v27
    global_load_lds_dwordx4 v16, s[66:67] offset:0 sc1
    v_smfmac_f32_16x16x64_bf16 v[32:35], v[84:87], a[112:119], v9
    global_load_lds_dwordx4 v16, s[66:67] offset:1024 sc1
    s_waitcnt lgkmcnt(4)
    v_smfmac_f32_16x16x64_bf16 v[32:35], v[88:91], v[96:103], v9
    ds_read_b128 v[96:99], v10 offset:20480
    ds_read_b128 v[100:103], v10 offset:21504
    v_smfmac_f32_16x16x64_bf16 v[32:35], v[92:95], a[120:127], v9
    v_smfmac_f32_16x16x64_bf16 v[36:39], v[84:87], a[128:135], v9
    global_load_lds_dwordx4 v16, s[66:67] offset:2048 sc1
    s_waitcnt lgkmcnt(4)
    v_smfmac_f32_16x16x64_bf16 v[36:39], v[88:91], v[104:111], v9
    ds_read_b128 v[104:107], v10 offset:22528
    ds_read_b128 v[108:111], v10 offset:23552
    v_smfmac_f32_16x16x64_bf16 v[36:39], v[92:95], a[136:143], v9
    v_add_f32 v32, v32, v33
    v_add_f32 v34, v34, v35
    v_smfmac_f32_16x16x64_bf16 v[40:43], v[84:87], a[144:151], v9
    global_load_lds_dwordx4 v16, s[66:67] offset:3072 sc1
    v_cvt_pk_bf16_f32 v32, v32, v34
    s_waitcnt lgkmcnt(4)
    v_smfmac_f32_16x16x64_bf16 v[40:43], v[88:91], v[120:127], v9
    ds_write_b16 v21, v32
    ds_write_b16_d16_hi v21, v32 offset:32
    v_smfmac_f32_16x16x64_bf16 v[40:43], v[92:95], a[152:159], v9
    v_add_f32 v36, v36, v37
    v_add_f32 v38, v38, v39
    v_smfmac_f32_16x16x64_bf16 v[44:47], v[56:59], a[160:167], v9
    s_add_u32 m0, m0, 4096
    v_cvt_pk_bf16_f32 v36, v36, v38
    s_waitcnt lgkmcnt(4)
    v_smfmac_f32_16x16x64_bf16 v[48:51], v[56:59], v[96:103], v9
    v_add_u32 v16, 4096, v16
    ds_write_b16 v22, v36
    v_smfmac_f32_16x16x64_bf16 v[52:55], v[56:59], a[168:175], v9
    global_load_lds_dwordx4 v16, s[66:67] offset:0 sc1
    ds_write_b16_d16_hi v22, v36 offset:32
    v_smfmac_f32_16x16x64_bf16 v[44:47], v[60:63], a[176:183], v9
    global_load_lds_dwordx4 v16, s[66:67] offset:1024 sc1
    v_add_f32 v40, v40, v41
    s_waitcnt lgkmcnt(4)
    v_smfmac_f32_16x16x64_bf16 v[48:51], v[60:63], v[104:111], v9
    v_add_f32 v42, v42, v43
    v_cvt_pk_bf16_f32 v40, v40, v42
    v_smfmac_f32_16x16x64_bf16 v[52:55], v[60:63], a[184:191], v9
    ds_write_b16 v23, v40
    ds_write_b16_d16_hi v23, v40 offset:32
    v_smfmac_f32_16x16x64_bf16 v[44:47], v[64:67], a[192:199], v9
    s_add_u32 s66, s66, 393216
    s_addc_u32 s67, s67, 0
    s_xor_b32 s76, s76, 28672
    v_smfmac_f32_16x16x64_bf16 v[48:51], v[64:67], a[200:207], v9
    v_smfmac_f32_16x16x64_bf16 v[52:55], v[64:67], a[208:215], v9
    v_smfmac_f32_16x16x64_bf16 v[44:47], v[68:71], a[216:223], v9
    s_waitcnt lgkmcnt(0)
    s_barrier
    v_smfmac_f32_16x16x64_bf16 v[48:51], v[68:71], a[224:231], v9
    v_smfmac_f32_16x16x64_bf16 v[52:55], v[68:71], a[232:239], v9
    v_smfmac_f32_16x16x64_bf16 v[44:47], v[72:75], a[240:247], v9
    v_smfmac_f32_16x16x64_bf16 v[48:51], v[72:75], a[248:255], v9
    v_smfmac_f32_16x16x64_bf16 v[52:55], v[72:75], v[128:135], v9
    v_smfmac_f32_16x16x64_bf16 v[44:47], v[76:79], v[136:143], v9
    v_smfmac_f32_16x16x64_bf16 v[48:51], v[76:79], v[144:151], v9
    v_smfmac_f32_16x16x64_bf16 v[52:55], v[76:79], v[152:159], v9
    v_smfmac_f32_16x16x64_bf16 v[44:47], v[80:83], v[160:167], v9
    v_smfmac_f32_16x16x64_bf16 v[48:51], v[80:83], v[168:175], v9
    v_smfmac_f32_16x16x64_bf16 v[52:55], v[80:83], v[176:183], v9
    v_smfmac_f32_16x16x64_bf16 v[44:47], v[84:87], v[184:191], v9
    v_smfmac_f32_16x16x64_bf16 v[44:47], v[88:91], v[192:199], v9
    v_smfmac_f32_16x16x64_bf16 v[44:47], v[92:95], v[200:207], v9
    v_smfmac_f32_16x16x64_bf16 v[48:51], v[84:87], v[208:215], v9
    v_smfmac_f32_16x16x64_bf16 v[48:51], v[88:91], v[216:223], v9
    v_add_f32 v44, v44, v45
    v_add_f32 v46, v46, v47
    v_smfmac_f32_16x16x64_bf16 v[48:51], v[92:95], v[224:231], v9
    v_cvt_pk_bf16_f32 v44, v44, v46
    ds_write_b16 v24, v44
    v_smfmac_f32_16x16x64_bf16 v[52:55], v[84:87], v[232:239], v9
    ds_write_b16_d16_hi v24, v44 offset:16
    v_smfmac_f32_16x16x64_bf16 v[52:55], v[88:91], v[240:247], v9
    v_add_f32 v48, v48, v49
    v_add_f32 v50, v50, v51
    v_smfmac_f32_16x16x64_bf16 v[52:55], v[92:95], v[248:255], v9
    s_cmp_lg_u32 s56, 2
    s_cbranch_scc1 .hus_113
    s_add_u32 s33, s38, 1
    v_mov_b32 v2, s53
    v_mov_b32 v3, s33
    s_mov_b64 exec, 1
    global_store_dword v2, v3, s[54:55] offset:0 sc1
    s_mov_b64 exec, -1
.hus_113:
    v_cvt_pk_bf16_f32 v48, v48, v50
    ds_write_b16 v25, v48
    ds_write_b16_d16_hi v25, v48 offset:16
    s_nop 0
    s_nop 0
    s_nop 0
    v_add_f32 v52, v52, v53
    v_add_f32 v54, v54, v55
    v_cvt_pk_bf16_f32 v52, v52, v54
    ds_write_b16 v26, v52
    ds_write_b16_d16_hi v26, v52 offset:16
    s_waitcnt lgkmcnt(0)
    s_barrier
    s_cmp_lg_u32 s12, 3
    s_cbranch_scc1 .pub_114
    s_mov_b32 s33, s38
    v_mov_b32 v2, s47
    v_mov_b32 v3, s33
    s_mov_b64 exec, 1
    global_store_dword v2, v3, s[10:11] sc1
    s_mov_b64 exec, -1
.pub_114:
    s_add_u32 s25, s77, s75
    s_add_u32 s25, s25, 24576
    v_add_u32 v2, s75, v27
    v_lshrrev_b32 v3, 1, v27
    v_add_u32 v101, s25, v3
    v_add_u32 v3, s75, v3
    v_add_u32 v100, s25, v27
    ds_read_b128 v[32:35], v0 offset:0
    ds_read_b128 v[36:39], v2 offset:0
    ds_read_b128 v[40:43], v2 offset:6144
    ds_read_b128 v[44:47], v100 offset:0
    ds_read_b128 v[48:51], v0 offset:512
    ds_read_b128 v[52:55], v2 offset:1024
    ds_read_b128 v[56:59], v2 offset:7168
    ds_read_b128 v[60:63], v100 offset:1024
    ds_read_b128 v[64:67], v0 offset:1024
    ds_read_b128 v[68:71], v2 offset:2048
    ds_read_b128 v[72:75], v2 offset:8192
    ds_read_b128 v[76:79], v100 offset:2048
    s_waitcnt lgkmcnt(8)
    v_mfma_f32_16x16x32_bf16 v[88:91], v[32:35], v[44:47], 0
    v_mfma_f32_16x16x32_bf16 v[92:95], v[36:39], v[44:47], 0
    v_mfma_f32_16x16x32_bf16 v[96:99], v[40:43], v[44:47], 0
    ds_read_b128 v[32:35], v0 offset:1536
    ds_read_b128 v[36:39], v2 offset:3072
    ds_read_b128 v[40:43], v2 offset:9216
    ds_read_b128 v[44:47], v100 offset:3072
    s_waitcnt lgkmcnt(8)
    v_mfma_f32_16x16x32_bf16 v[88:91], v[48:51], v[60:63], v[88:91]
    v_mfma_f32_16x16x32_bf16 v[92:95], v[52:55], v[60:63], v[92:95]
    v_mfma_f32_16x16x32_bf16 v[96:99], v[56:59], v[60:63], v[96:99]
    ds_read_b128 v[48:51], v0 offset:2048
    ds_read_b128 v[52:55], v2 offset:4096
    ds_read_b128 v[56:59], v2 offset:10240
    ds_read_b128 v[60:63], v100 offset:4096
    s_waitcnt lgkmcnt(8)
    v_mfma_f32_16x16x32_bf16 v[88:91], v[64:67], v[76:79], v[88:91]
    v_mfma_f32_16x16x32_bf16 v[92:95], v[68:71], v[76:79], v[92:95]
    v_mfma_f32_16x16x32_bf16 v[96:99], v[72:75], v[76:79], v[96:99]
    ds_read_b128 v[64:67], v0 offset:2560
    ds_read_b128 v[68:71], v2 offset:5120
    ds_read_b128 v[72:75], v2 offset:11264
    ds_read_b128 v[76:79], v100 offset:5120
    s_waitcnt lgkmcnt(8)
    v_mfma_f32_16x16x32_bf16 v[88:91], v[32:35], v[44:47], v[88:91]
    v_mfma_f32_16x16x32_bf16 v[92:95], v[36:39], v[44:47], v[92:95]
    v_mfma_f32_16x16x32_bf16 v[96:99], v[40:43], v[44:47], v[96:99]
    s_waitcnt lgkmcnt(4)
    v_mfma_f32_16x16x32_bf16 v[88:91], v[48:51], v[60:63], v[88:91]
    v_mfma_f32_16x16x32_bf16 v[92:95], v[52:55], v[60:63], v[92:95]
    v_mfma_f32_16x16x32_bf16 v[96:99], v[56:59], v[60:63], v[96:99]
    s_waitcnt lgkmcnt(0)
    v_mfma_f32_16x16x32_bf16 v[88:91], v[64:67], v[76:79], v[88:91]
    v_mfma_f32_16x16x32_bf16 v[92:95], v[68:71], v[76:79], v[92:95]
    v_mfma_f32_16x16x32_bf16 v[96:99], v[72:75], v[76:79], v[96:99]
    s_sub_u32 s25, s12, 2
    s_lshl_b32 s25, s25, 4
    v_and_b32 v32, 15, v1
    v_add_u32 v32, s25, v32
    v_lshrrev_b32 v33, 4, v1
    v_lshlrev_b32 v33, 2, v33
    v_sub_u32 v32, v32, v33
    v_mov_b32 v34, 0xff800000
    v_cmp_gt_u32 vcc, 32, v1
    s_nop 1
    v_cndmask_b32 v88, v34, v88, vcc
    v_cndmask_b32 v89, v34, v89, vcc
    v_cndmask_b32 v90, v34, v90, vcc
    v_cndmask_b32 v91, v34, v91, vcc
    v_cmp_le_i32 vcc, 0, v32
    s_nop 1
    v_cndmask_b32 v92, v34, v92, vcc
    v_cmp_le_i32 vcc, 1, v32
    s_nop 1
    v_cndmask_b32 v93, v34, v93, vcc
    v_cmp_le_i32 vcc, 2, v32
    s_nop 1
    v_cndmask_b32 v94, v34, v94, vcc
    v_cmp_le_i32 vcc, 3, v32
    s_nop 1
    v_cndmask_b32 v95, v34, v95, vcc
    v_cmp_le_i32 vcc, 16, v32
    s_nop 1
    v_cndmask_b32 v96, v34, v96, vcc
    v_cmp_le_i32 vcc, 17, v32
    s_nop 1
    v_cndmask_b32 v97, v34, v97, vcc
    v_cmp_le_i32 vcc, 18, v32
    s_nop 1
    v_cndmask_b32 v98, v34, v98, vcc
    v_cmp_le_i32 vcc, 19, v32
    s_nop 1
    v_cndmask_b32 v99, v34, v99, vcc
    v_max3_f32 v35, v88, v89, v90
    v_max3_f32 v35, v35, v91, v92
    v_max3_f32 v35, v35, v93, v94
    v_max3_f32 v35, v35, v95, v96
    v_max3_f32 v35, v35, v97, v98
    v_max_f32 v35, v35, v99
    v_mov_b32 v36, v35
    s_nop 1
    v_permlane32_swap_b32 v35, v36
    s_nop 1
    v_max_f32 v35, v35, v36
    v_mov_b32 v36, v35
    s_nop 1
    v_permlane16_swap_b32 v35, v36
    s_nop 1
    v_max_f32 v35, v35, v36
    v_mul_f32 v35, 0x3dd53b95, v35
    v_mov_b32 v36, 0x3dd53b95
    v_fma_f32 v88, v88, v36, -v35
    v_fma_f32 v89, v89, v36, -v35
    v_fma_f32 v90, v90, v36, -v35
    v_fma_f32 v91, v91, v36, -v35
    v_fma_f32 v92, v92, v36, -v35
    v_fma_f32 v93, v93, v36, -v35
    v_fma_f32 v94, v94, v36, -v35
    v_fma_f32 v95, v95, v36, -v35
    v_fma_f32 v96, v96, v36, -v35
    v_fma_f32 v97, v97, v36, -v35
    v_fma_f32 v98, v98, v36, -v35
    v_fma_f32 v99, v99, v36, -v35
    v_exp_f32 v88, v88
    v_exp_f32 v89, v89
    v_exp_f32 v90, v90
    v_exp_f32 v91, v91
    v_exp_f32 v92, v92
    v_exp_f32 v93, v93
    v_exp_f32 v94, v94
    v_exp_f32 v95, v95
    v_exp_f32 v96, v96
    v_exp_f32 v97, v97
    v_exp_f32 v98, v98
    v_exp_f32 v99, v99
    s_nop 0
    v_add_f32 v35, v88, v89
    v_add_f32 v35, v35, v90
    v_add_f32 v35, v35, v91
    v_add_f32 v35, v35, v92
    v_add_f32 v35, v35, v93
    v_add_f32 v35, v35, v94
    v_add_f32 v35, v35, v95
    v_add_f32 v35, v35, v96
    v_add_f32 v35, v35, v97
    v_add_f32 v35, v35, v98
    v_add_f32 v35, v35, v99
    v_mov_b32 v36, v35
    s_nop 1
    v_permlane32_swap_b32 v35, v36
    s_nop 1
    v_add_f32 v35, v35, v36
    v_mov_b32 v36, v35
    s_nop 1
    v_permlane16_swap_b32 v35, v36
    s_nop 1
    v_add_f32 v35, v35, v36
    v_rcp_f32 v35, v35
    s_nop 0
    v_mul_f32 v88, v88, v35
    v_mul_f32 v89, v89, v35
    v_mul_f32 v90, v90, v35
    v_mul_f32 v91, v91, v35
    v_mul_f32 v92, v92, v35
    v_mul_f32 v93, v93, v35
    v_mul_f32 v94, v94, v35
    v_mul_f32 v95, v95, v35
    v_mul_f32 v96, v96, v35
    v_mul_f32 v97, v97, v35
    v_mul_f32 v98, v98, v35
    v_mul_f32 v99, v99, v35
    v_cvt_pk_bf16_f32 v120, v88, v89
    v_cvt_pk_bf16_f32 v121, v90, v91
    v_cvt_pk_bf16_f32 v122, v92, v93
    v_cvt_pk_bf16_f32 v123, v94, v95
    v_cvt_pk_bf16_f32 v124, v96, v97
    v_cvt_pk_bf16_f32 v125, v98, v99
    s_sub_u32 s25, s12, 2
    s_lshl_b32 s23, s25, 10
    v_add_u32 v2, s23, v27
    global_store_dwordx4 v2, v[122:125], s[70:71] sc1
    v_and_b32 v3, 15, v1
    v_lshlrev_b32 v3, 4, v3
    v_lshrrev_b32 v2, 4, v1
    v_lshlrev_b32 v2, 3, v2
    v_add_u32 v2, v2, v3
    s_lshl_b32 s23, s25, 8
    v_add_u32 v2, s23, v2
    s_mov_b32 exec_hi, 0
    global_store_dwordx2 v2, v[120:121], s[70:71] offset:2048 sc1
    s_mov_b64 exec, -1
    s_add_u32 s70, s70, 81920
    s_addc_u32 s71, s71, 0
    s_cmp_ge_u32 s38, 63
    s_cbranch_scc1 .LS_fin
    s_cmp_lg_u32 s38, 0
    s_cbranch_scc1 .s0f_115
    s_mov_b32 s33, 2
    s_cmp_ge_u32 s74, s33
    s_cbranch_scc1 .wkqd_117
    v_mov_b32 v2, 0
.wkq_116:
    global_load_dword v3, v17, s[72:73] offset:-2048 sc1
    global_load_dword v2, v17, s[72:73] offset:2048 sc1
    s_waitcnt vmcnt(0)
    v_min_u32 v3, v3, v2
    s_nop 0
    v_readlane_b32 s74, v3, 0
    v_readlane_b32 s15, v3, 1
    s_nop 3
    s_min_u32 s74, s74, s15
    s_cmp_ge_u32 s74, s33
    s_cbranch_scc1 .wkqd_117
    s_sleep 2
    s_add_u32 s14, s14, 1
    s_cmp_gt_u32 s14, 400000
    s_cbranch_scc1 .Lend
    s_branch .wkq_116
.wkqd_117:
    s_waitcnt vmcnt(0)
    s_xor_b32 s76, s76, 28672
    s_add_u32 s25, s76, s77
    s_add_u32 m0, s25, 24576
    v_add_u32 v3, s77, v27
    global_load_lds_dwordx4 v3, s[68:69] offset:0 sc1
    global_load_lds_dwordx4 v3, s[68:69] offset:1024 sc1
    global_load_lds_dwordx4 v3, s[68:69] offset:2048 sc1
    global_load_lds_dwordx4 v3, s[68:69] offset:3072 sc1
    s_add_u32 m0, m0, 4096
    v_add_u32 v3, 4096, v3
    global_load_lds_dwordx4 v3, s[68:69] offset:0 sc1
    global_load_lds_dwordx4 v3, s[68:69] offset:1024 sc1
    s_add_u32 s68, s68, 393216
    s_addc_u32 s69, s69, 0
    s_add_u32 m0, s76, s77
    v_add_u32 v3, s77, v27
    global_load_lds_dwordx4 v3, s[66:67] offset:0 sc1
    global_load_lds_dwordx4 v3, s[66:67] offset:1024 sc1
    global_load_lds_dwordx4 v3, s[66:67] offset:2048 sc1
    global_load_lds_dwordx4 v3, s[66:67] offset:3072 sc1
    s_add_u32 m0, m0, 4096
    v_add_u32 v3, 4096, v3
    global_load_lds_dwordx4 v3, s[66:67] offset:0 sc1
    global_load_lds_dwordx4 v3, s[66:67] offset:1024 sc1
    s_add_u32 s66, s66, 393216
    s_addc_u32 s67, s67, 0
    s_xor_b32 s76, s76, 28672
.s0f_115:
    s_add_u32 s33, s38, 3
    s_min_u32 s33, s33, 64
    s_cmp_ge_u32 s74, s33
    s_cbranch_scc1 .wkqd_119
    v_mov_b32 v2, 0
.wkq_118:
    global_load_dword v3, v17, s[72:73] offset:-2048 sc1
    global_load_dword v2, v17, s[72:73] offset:2048 sc1
    s_waitcnt vmcnt(0)
    v_min_u32 v3, v3, v2
    s_nop 0
    v_readlane_b32 s74, v3, 0
    v_readlane_b32 s15, v3, 1
    s_nop 3
    s_min_u32 s74, s74, s15
    s_cmp_ge_u32 s74, s33
    s_cbranch_scc1 .wkqd_119
    s_sleep 2
    s_add_u32 s14, s14, 1
    s_cmp_gt_u32 s14, 400000
    s_cbranch_scc1 .Lend
    s_branch .wkq_118
.wkqd_119:
.LS_next:
    s_xor_b32 s75, s75, 28672
    v_add_u32 v28, s57, v28
    v_add_u32 v29, s57, v29
    v_add_u32 v14, s57, v14
    s_sub_u32 s57, 0, s57
    s_add_u32 s34, s34, 1048576
    s_addc_u32 s35, s35, 0
    s_and_b32 s25, s38, 1
    s_lshl_b32 s25, s25, 13
    s_xor_b32 s34, s34, s25
    s_add_u32 s38, s38, 1
    v_mov_b32 v32, 0
    v_mov_b32 v33, 0
    v_mov_b32 v34, 0
    v_mov_b32 v35, 0
    v_mov_b32 v36, 0
    v_mov_b32 v37, 0
    v_mov_b32 v38, 0
    v_mov_b32 v39, 0
    v_mov_b32 v40, 0
    v_mov_b32 v41, 0
    v_mov_b32 v42, 0
    v_mov_b32 v43, 0
    v_mov_b32 v44, 0
    v_mov_b32 v45, 0
    v_mov_b32 v46, 0
    v_mov_b32 v47, 0
    v_mov_b32 v48, 0
    v_mov_b32 v49, 0
    v_mov_b32 v50, 0
    v_mov_b32 v51, 0
    v_mov_b32 v52, 0
    v_mov_b32 v53, 0
    v_mov_b32 v54, 0
    v_mov_b32 v55, 0
    v_mov_b32 v112, 0
    v_mov_b32 v113, 0
    v_mov_b32 v114, 0
    v_mov_b32 v115, 0
    v_mov_b32 v116, 0
    v_mov_b32 v117, 0
    v_mov_b32 v118, 0
    v_mov_b32 v119, 0
    ds_read_b128 v[120:123], v10 offset:0
    ds_read_b128 v[124:127], v10 offset:1024
    ds_read_b128 v[96:99], v10 offset:2048
    ds_read_b128 v[100:103], v10 offset:3072
    ds_read_b128 v[104:107], v10 offset:4096
    ds_read_b128 v[108:111], v10 offset:5120
    s_add_u32 s58, s58, 1
    v_mov_b32 v15, s58
    s_cmp_lg_u32 s12, 0
    s_cbranch_scc1 .husk_121
    s_mov_b32 s33, s38
    v_mov_b32 v3, s52
    s_mov_b64 exec, 1
.hu_120:
    global_load_dword v2, v3, s[54:55] offset:1024 sc1
    s_add_u32 s14, s14, 1
    s_cmp_gt_u32 s14, 400000
    s_cbranch_scc1 .Lend
    s_waitcnt vmcnt(0)
    v_cmp_gt_i32 vcc, s33, v2
    s_cbranch_vccnz .hu_120
    s_mov_b64 exec, -1
.husk_121:
    s_barrier
    s_branch .LS_step
.LS_fin:
    s_waitcnt vmcnt(0)
    s_barrier
    s_mov_b32 s38, 64
    s_cmp_lg_u32 s12, 0
    s_cbranch_scc1 .pub_122
    v_mov_b32 v2, s47
    v_mov_b32 v3, s38
    s_mov_b64 exec, 1
    global_store_dword v2, v3, s[10:11] sc1
    s_mov_b64 exec, -1
.pub_122:
    s_branch .Lend
.Lrole_V:
    s_load_dwordx4 s[48:51], s[0:1], 32
    s_lshr_b32 s18, s13, 1
    s_mul_i32 s16, s18, 384
    s_mul_i32 s17, s18, 245760
    s_waitcnt lgkmcnt(0)
    s_add_u32 s48, s48, s16
    s_addc_u32 s49, s49, 0
    s_add_u32 s50, s50, s17
    s_addc_u32 s51, s51, 0
    v_lshrrev_b32 v12, 5, v1
    v_lshlrev_b32 v12, 1, v12
    v_bfe_u32 v13, v1, 3, 1
    v_add_u32 v12, v12, v13
    v_mul_u32_u24 v12, 10240, v12
    v_bfe_u32 v14, v1, 4, 1
    v_lshlrev_b32 v15, 9, v14
    v_add_u32 v12, v12, v15
    v_bfe_u32 v15, v1, 2, 1
    v_lshlrev_b32 v15, 7, v15
    v_add_u32 v12, v12, v15
    v_and_b32 v15, 3, v1
    v_lshlrev_b32 v15, 3, v15
    v_add_u32 v12, v12, v15
    v_lshlrev_b32 v13, 1, v13
    v_or_b32 v13, v13, v14
    v_xor_b32 v14, 0, v13
    v_lshlrev_b32 v14, 5, v14
    v_add_u32 v8, v12, v14
    v_xor_b32 v14, 1, v13
    v_lshlrev_b32 v14, 5, v14
    v_add_u32 v9, v12, v14
    v_xor_b32 v14, 2, v13
    v_lshlrev_b32 v14, 5, v14
    v_add_u32 v10, v12, v14
    v_xor_b32 v14, 3, v13
    v_lshlrev_b32 v14, 5, v14
    v_add_u32 v11, v12, v14
    s_cmp_lg_u32 s12, 0
    s_cbranch_scc1 .sw_123
    v_add_u32 v12, 0, v8
    v_add_u32 v13, 256, v9
    v_add_u32 v14, 0, v9
    v_add_u32 v15, 256, v8
    v_add_u32 v16, 0, v10
    v_add_u32 v17, 256, v11
    v_add_u32 v18, 0, v11
    v_add_u32 v19, 256, v10
    v_add_u32 v20, 1024, v8
    v_add_u32 v21, 1280, v9
    v_add_u32 v22, 1024, v9
    v_add_u32 v23, 1280, v8
    v_add_u32 v24, 1024, v10
    v_add_u32 v25, 1280, v11
    v_add_u32 v26, 1024, v11
    v_add_u32 v27, 1280, v10
    v_add_u32 v28, 2048, v8
    v_add_u32 v29, 2304, v9
    v_add_u32 v30, 2048, v9
    v_add_u32 v31, 2304, v8
.sw_123:
    s_cmp_lg_u32 s12, 1
    s_cbranch_scc1 .sw_124
    v_add_u32 v12, 2048, v10
    v_add_u32 v13, 2304, v11
    v_add_u32 v14, 2048, v11
    v_add_u32 v15, 2304, v10
    v_add_u32 v16, 3072, v8
    v_add_u32 v17, 3328, v9
    v_add_u32 v18, 3072, v9
    v_add_u32 v19, 3328, v8
    v_add_u32 v20, 3072, v10
    v_add_u32 v21, 3328, v11
    v_add_u32 v22, 3072, v11
    v_add_u32 v23, 3328, v10
    v_add_u32 v24, 4096, v8
    v_add_u32 v25, 4352, v9
    v_add_u32 v26, 4096, v9
    v_add_u32 v27, 4352, v8
    v_add_u32 v28, 4096, v10
    v_add_u32 v29, 4352, v11
    v_add_u32 v30, 4096, v11
    v_add_u32 v31, 4352, v10
.sw_124:
    s_cmp_lg_u32 s12, 2
    s_cbranch_scc1 .sw_125
    v_add_u32 v12, 5120, v8
    v_add_u32 v13, 5376, v9
    v_add_u32 v14, 5120, v9
    v_add_u32 v15, 5376, v8
    v_add_u32 v16, 5120, v10
    v_add_u32 v17, 5376, v11
    v_add_u32 v18, 5120, v11
    v_add_u32 v19, 5376, v10
    v_add_u32 v20, 6144, v8
    v_add_u32 v21, 6400, v9
    v_add_u32 v22, 6144, v9
    v_add_u32 v23, 6400, v8
    v_add_u32 v24, 6144, v10
    v_add_u32 v25, 6400, v11
    v_add_u32 v26, 6144, v11
    v_add_u32 v27, 6400, v10
    v_add_u32 v28, 7168, v8
    v_add_u32 v29, 7424, v9
    v_add_u32 v30, 7168, v9
    v_add_u32 v31, 7424, v8
.sw_125:
    s_cmp_lg_u32 s12, 3
    s_cbranch_scc1 .sw_126
    v_add_u32 v12, 7168, v10
    v_add_u32 v13, 7424, v11
    v_add_u32 v14, 7168, v11
    v_add_u32 v15, 7424, v10
    v_add_u32 v16, 8192, v8
    v_add_u32 v17, 8448, v9
    v_add_u32 v18, 8192, v9
    v_add_u32 v19, 8448, v8
    v_add_u32 v20, 8192, v10
    v_add_u32 v21, 8448, v11
    v_add_u32 v22, 8192, v11
    v_add_u32 v23, 8448, v10
    v_add_u32 v24, 9216, v8
    v_add_u32 v25, 9472, v9
    v_add_u32 v26, 9216, v9
    v_add_u32 v27, 9472, v8
    v_add_u32 v28, 9216, v10
    v_add_u32 v29, 9472, v11
    v_add_u32 v30, 9216, v11
    v_add_u32 v31, 9472, v10
.sw_126:
    v_lshrrev_b32 v2, 3, v1
    v_mul_u32_u24 v3, 1280, v2
    v_lshrrev_b32 v4, 1, v2
    v_lshrrev_b32 v5, 2, v2
    v_xor_b32 v4, v4, v5
    v_and_b32 v4, 1, v4
    v_lshlrev_b32 v4, 1, v4
    v_and_b32 v5, 7, v1
    v_xor_b32 v4, v4, v5
    v_xor_b32 v5, 4, v4
    v_lshlrev_b32 v4, 4, v4
    v_lshlrev_b32 v5, 4, v5
    v_add_u32 v4, v4, v3
    v_add_u32 v5, v5, v3
    s_mul_i32 s15, s12, 20480
    s_add_u32 s50, s50, s15
    s_addc_u32 s51, s51, 0
    s_mul_i32 s17, s12, 20480
    s_add_u32 m0, s17, 0
    s_nop 0
    global_load_lds_dwordx4 v4, s[50:51] offset:0
    s_add_u32 m0, s17, 896
    s_nop 0
    global_load_lds_dwordx4 v4, s[50:51] offset:128
    s_add_u32 m0, s17, 1792
    s_nop 0
    global_load_lds_dwordx4 v4, s[50:51] offset:256
    s_add_u32 m0, s17, 2688
    s_nop 0
    global_load_lds_dwordx4 v4, s[50:51] offset:384
    s_add_u32 m0, s17, 3584
    s_nop 0
    global_load_lds_dwordx4 v4, s[50:51] offset:512
    s_add_u32 m0, s17, 4480
    s_nop 0
    global_load_lds_dwordx4 v4, s[50:51] offset:640
    s_add_u32 m0, s17, 5376
    s_nop 0
    global_load_lds_dwordx4 v4, s[50:51] offset:768
    s_add_u32 m0, s17, 6272
    s_nop 0
    global_load_lds_dwordx4 v4, s[50:51] offset:896
    s_add_u32 m0, s17, 7168
    s_nop 0
    global_load_lds_dwordx4 v4, s[50:51] offset:1024
    s_add_u32 m0, s17, 8064
    s_nop 0
    global_load_lds_dwordx4 v4, s[50:51] offset:1152
    s_add_u32 s50, s50, 10240
    s_addc_u32 s51, s51, 0
    s_add_u32 m0, s17, 10240
    s_nop 0
    global_load_lds_dwordx4 v5, s[50:51] offset:0
    s_add_u32 m0, s17, 11136
    s_nop 0
    global_load_lds_dwordx4 v5, s[50:51] offset:128
    s_add_u32 m0, s17, 12032
    s_nop 0
    global_load_lds_dwordx4 v5, s[50:51] offset:256
    s_add_u32 m0, s17, 12928
    s_nop 0
    global_load_lds_dwordx4 v5, s[50:51] offset:384
    s_add_u32 m0, s17, 13824
    s_nop 0
    global_load_lds_dwordx4 v5, s[50:51] offset:512
    s_add_u32 m0, s17, 14720
    s_nop 0
    global_load_lds_dwordx4 v5, s[50:51] offset:640
    s_add_u32 m0, s17, 15616
    s_nop 0
    global_load_lds_dwordx4 v5, s[50:51] offset:768
    s_add_u32 m0, s17, 16512
    s_nop 0
    global_load_lds_dwordx4 v5, s[50:51] offset:896
    s_add_u32 m0, s17, 17408
    s_nop 0
    global_load_lds_dwordx4 v5, s[50:51] offset:1024
    s_add_u32 m0, s17, 18304
    s_nop 0
    global_load_lds_dwordx4 v5, s[50:51] offset:1152
    s_add_u32 s50, s50, 71680
    s_addc_u32 s51, s51, 0
    s_waitcnt vmcnt(0)
    s_barrier
    s_add_u32 m0, s17, 81920
    s_nop 0
    global_load_lds_dwordx4 v4, s[50:51] offset:0
    s_add_u32 m0, s17, 82816
    s_nop 0
    global_load_lds_dwordx4 v4, s[50:51] offset:128
    s_add_u32 m0, s17, 83712
    s_nop 0
    global_load_lds_dwordx4 v4, s[50:51] offset:256
    s_add_u32 m0, s17, 84608
    s_nop 0
    global_load_lds_dwordx4 v4, s[50:51] offset:384
    s_add_u32 m0, s17, 85504
    s_nop 0
    global_load_lds_dwordx4 v4, s[50:51] offset:512
    s_add_u32 m0, s17, 86400
    s_nop 0
    global_load_lds_dwordx4 v4, s[50:51] offset:640
    s_add_u32 m0, s17, 87296
    s_nop 0
    global_load_lds_dwordx4 v4, s[50:51] offset:768
    s_add_u32 m0, s17, 88192
    s_nop 0
    global_load_lds_dwordx4 v4, s[50:51] offset:896
    s_add_u32 m0, s17, 89088
    s_nop 0
    global_load_lds_dwordx4 v4, s[50:51] offset:1024
    s_add_u32 m0, s17, 89984
    s_nop 0
    global_load_lds_dwordx4 v4, s[50:51] offset:1152
    s_add_u32 s50, s50, 10240
    s_addc_u32 s51, s51, 0
    s_add_u32 m0, s17, 92160
    s_nop 0
    global_load_lds_dwordx4 v5, s[50:51] offset:0
    s_add_u32 m0, s17, 93056
    s_nop 0
    global_load_lds_dwordx4 v5, s[50:51] offset:128
    s_add_u32 m0, s17, 93952
    s_nop 0
    global_load_lds_dwordx4 v5, s[50:51] offset:256
    s_add_u32 m0, s17, 94848
    s_nop 0
    global_load_lds_dwordx4 v5, s[50:51] offset:384
    s_add_u32 m0, s17, 95744
    s_nop 0
    global_load_lds_dwordx4 v5, s[50:51] offset:512
    s_add_u32 m0, s17, 96640
    s_nop 0
    global_load_lds_dwordx4 v5, s[50:51] offset:640
    s_add_u32 m0, s17, 97536
    s_nop 0
    global_load_lds_dwordx4 v5, s[50:51] offset:768
    s_add_u32 m0, s17, 98432
    s_nop 0
    global_load_lds_dwordx4 v5, s[50:51] offset:896
    s_add_u32 m0, s17, 99328
    s_nop 0
    global_load_lds_dwordx4 v5, s[50:51] offset:1024
    s_add_u32 m0, s17, 100224
    s_nop 0
    global_load_lds_dwordx4 v5, s[50:51] offset:1152
    s_add_u32 s50, s50, 71680
    s_addc_u32 s51, s51, 0
    ds_read_b64_tr_b16 a[192:193], v12 offset:0
    ds_read_b64_tr_b16 a[194:195], v13 offset:0
    ds_read_b64_tr_b16 a[196:197], v12 offset:40960
    ds_read_b64_tr_b16 a[198:199], v13 offset:40960
    ds_read_b64_tr_b16 v[80:81], v14 offset:0
    ds_read_b64_tr_b16 v[82:83], v15 offset:0
    ds_read_b64_tr_b16 v[84:85], v14 offset:40960
    ds_read_b64_tr_b16 v[86:87], v15 offset:40960
    ds_read_b64_tr_b16 a[232:233], v16 offset:0
    ds_read_b64_tr_b16 a[234:235], v17 offset:0
    ds_read_b64_tr_b16 a[236:237], v16 offset:40960
    ds_read_b64_tr_b16 a[238:239], v17 offset:40960
    ds_read_b64_tr_b16 a[248:249], v18 offset:0
    ds_read_b64_tr_b16 a[250:251], v19 offset:0
    ds_read_b64_tr_b16 a[252:253], v18 offset:40960
    ds_read_b64_tr_b16 a[254:255], v19 offset:40960
    ds_read_b64_tr_b16 v[144:145], v20 offset:0
    ds_read_b64_tr_b16 v[146:147], v21 offset:0
    ds_read_b64_tr_b16 v[148:149], v20 offset:40960
    ds_read_b64_tr_b16 v[150:151], v21 offset:40960
    ds_read_b64_tr_b16 v[160:161], v22 offset:0
    ds_read_b64_tr_b16 v[162:163], v23 offset:0
    ds_read_b64_tr_b16 v[164:165], v22 offset:40960
    ds_read_b64_tr_b16 v[166:167], v23 offset:40960
    ds_read_b64_tr_b16 v[104:105], v24 offset:0
    ds_read_b64_tr_b16 v[106:107], v25 offset:0
    ds_read_b64_tr_b16 v[108:109], v24 offset:40960
    ds_read_b64_tr_b16 v[110:111], v25 offset:40960
    ds_read_b64_tr_b16 v[200:201], v26 offset:0
    ds_read_b64_tr_b16 v[202:203], v27 offset:0
    ds_read_b64_tr_b16 v[204:205], v26 offset:40960
    ds_read_b64_tr_b16 v[206:207], v27 offset:40960
    ds_read_b64_tr_b16 v[216:217], v28 offset:0
    ds_read_b64_tr_b16 v[218:219], v29 offset:0
    ds_read_b64_tr_b16 v[220:221], v28 offset:40960
    ds_read_b64_tr_b16 v[222:223], v29 offset:40960
    ds_read_b64_tr_b16 v[240:241], v30 offset:0
    ds_read_b64_tr_b16 v[242:243], v31 offset:0
    ds_read_b64_tr_b16 v[244:245], v30 offset:40960
    ds_read_b64_tr_b16 v[246:247], v31 offset:40960
    s_waitcnt lgkmcnt(0)
    s_waitcnt vmcnt(0)
    s_barrier
    s_add_u32 m0, s17, 0
    s_nop 0
    global_load_lds_dwordx4 v4, s[50:51] offset:0
    s_add_u32 m0, s17, 896
    s_nop 0
    global_load_lds_dwordx4 v4, s[50:51] offset:128
    s_add_u32 m0, s17, 1792
    s_nop 0
    global_load_lds_dwordx4 v4, s[50:51] offset:256
    s_add_u32 m0, s17, 2688
    s_nop 0
    global_load_lds_dwordx4 v4, s[50:51] offset:384
    s_add_u32 m0, s17, 3584
    s_nop 0
    global_load_lds_dwordx4 v4, s[50:51] offset:512
    s_add_u32 m0, s17, 4480
    s_nop 0
    global_load_lds_dwordx4 v4, s[50:51] offset:640
    s_add_u32 m0, s17, 5376
    s_nop 0
    global_load_lds_dwordx4 v4, s[50:51] offset:768
    s_add_u32 m0, s17, 6272
    s_nop 0
    global_load_lds_dwordx4 v4, s[50:51] offset:896
    s_add_u32 m0, s17, 7168
    s_nop 0
    global_load_lds_dwordx4 v4, s[50:51] offset:1024
    s_add_u32 m0, s17, 8064
    s_nop 0
    global_load_lds_dwordx4 v4, s[50:51] offset:1152
    s_add_u32 s50, s50, 10240
    s_addc_u32 s51, s51, 0
    s_add_u32 m0, s17, 10240
    s_nop 0
    global_load_lds_dwordx4 v5, s[50:51] offset:0
    s_add_u32 m0, s17, 11136
    s_nop 0
    global_load_lds_dwordx4 v5, s[50:51] offset:128
    s_add_u32 m0, s17, 12032
    s_nop 0
    global_load_lds_dwordx4 v5, s[50:51] offset:256
    s_add_u32 m0, s17, 12928
    s_nop 0
    global_load_lds_dwordx4 v5, s[50:51] offset:384
    s_add_u32 m0, s17, 13824
    s_nop 0
    global_load_lds_dwordx4 v5, s[50:51] offset:512
    s_add_u32 m0, s17, 14720
    s_nop 0
    global_load_lds_dwordx4 v5, s[50:51] offset:640
    s_add_u32 m0, s17, 15616
    s_nop 0
    global_load_lds_dwordx4 v5, s[50:51] offset:768
    s_add_u32 m0, s17, 16512
    s_nop 0
    global_load_lds_dwordx4 v5, s[50:51] offset:896
    s_add_u32 m0, s17, 17408
    s_nop 0
    global_load_lds_dwordx4 v5, s[50:51] offset:1024
    s_add_u32 m0, s17, 18304
    s_nop 0
    global_load_lds_dwordx4 v5, s[50:51] offset:1152
    s_add_u32 s50, s50, 71680
    s_addc_u32 s51, s51, 0
    v_add_u32 v12, 81920, v12
    v_add_u32 v13, 81920, v13
    v_add_u32 v14, 81920, v14
    v_add_u32 v15, 81920, v15
    v_add_u32 v16, 81920, v16
    v_add_u32 v17, 81920, v17
    v_add_u32 v18, 81920, v18
    v_add_u32 v19, 81920, v19
    v_add_u32 v20, 81920, v20
    v_add_u32 v21, 81920, v21
    v_add_u32 v22, 81920, v22
    v_add_u32 v23, 81920, v23
    v_add_u32 v24, 81920, v24
    v_add_u32 v25, 81920, v25
    v_add_u32 v26, 81920, v26
    v_add_u32 v27, 81920, v27
    v_add_u32 v28, 81920, v28
    v_add_u32 v29, 81920, v29
    v_add_u32 v30, 81920, v30
    v_add_u32 v31, 81920, v31
    ds_read_b64_tr_b16 a[200:201], v12 offset:0
    ds_read_b64_tr_b16 a[202:203], v13 offset:0
    ds_read_b64_tr_b16 a[204:205], v12 offset:40960
    ds_read_b64_tr_b16 a[206:207], v13 offset:40960
    ds_read_b64_tr_b16 a[216:217], v14 offset:0
    ds_read_b64_tr_b16 a[218:219], v15 offset:0
    ds_read_b64_tr_b16 a[220:221], v14 offset:40960
    ds_read_b64_tr_b16 a[222:223], v15 offset:40960
    ds_read_b64_tr_b16 a[240:241], v16 offset:0
    ds_read_b64_tr_b16 a[242:243], v17 offset:0
    ds_read_b64_tr_b16 a[244:245], v16 offset:40960
    ds_read_b64_tr_b16 a[246:247], v17 offset:40960
    ds_read_b64_tr_b16 v[128:129], v18 offset:0
    ds_read_b64_tr_b16 v[130:131], v19 offset:0
    ds_read_b64_tr_b16 v[132:133], v18 offset:40960
    ds_read_b64_tr_b16 v[134:135], v19 offset:40960
    ds_read_b64_tr_b16 v[96:97], v20 offset:0
    ds_read_b64_tr_b16 v[98:99], v21 offset:0
    ds_read_b64_tr_b16 v[100:101], v20 offset:40960
    ds_read_b64_tr_b16 v[102:103], v21 offset:40960
    ds_read_b64_tr_b16 v[168:169], v22 offset:0
    ds_read_b64_tr_b16 v[170:171], v23 offset:0
    ds_read_b64_tr_b16 v[172:173], v22 offset:40960
    ds_read_b64_tr_b16 v[174:175], v23 offset:40960
    ds_read_b64_tr_b16 v[184:185], v24 offset:0
    ds_read_b64_tr_b16 v[186:187], v25 offset:0
    ds_read_b64_tr_b16 v[188:189], v24 offset:40960
    ds_read_b64_tr_b16 v[190:191], v25 offset:40960
    ds_read_b64_tr_b16 v[208:209], v26 offset:0
    ds_read_b64_tr_b16 v[210:211], v27 offset:0
    ds_read_b64_tr_b16 v[212:213], v26 offset:40960
    ds_read_b64_tr_b16 v[214:215], v27 offset:40960
    ds_read_b64_tr_b16 v[224:225], v28 offset:0
    ds_read_b64_tr_b16 v[226:227], v29 offset:0
    ds_read_b64_tr_b16 v[228:229], v28 offset:40960
    ds_read_b64_tr_b16 v[230:231], v29 offset:40960
    ds_read_b64_tr_b16 v[120:121], v30 offset:0
    ds_read_b64_tr_b16 v[122:123], v31 offset:0
    ds_read_b64_tr_b16 v[124:125], v30 offset:40960
    ds_read_b64_tr_b16 v[126:127], v31 offset:40960
    s_waitcnt lgkmcnt(0)
    s_waitcnt vmcnt(0)
    s_barrier
    v_add_u32 v12, 4294885376, v12
    v_add_u32 v13, 4294885376, v13
    v_add_u32 v14, 4294885376, v14
    v_add_u32 v15, 4294885376, v15
    v_add_u32 v16, 4294885376, v16
    v_add_u32 v17, 4294885376, v17
    v_add_u32 v18, 4294885376, v18
    v_add_u32 v19, 4294885376, v19
    v_add_u32 v20, 4294885376, v20
    v_add_u32 v21, 4294885376, v21
    v_add_u32 v22, 4294885376, v22
    v_add_u32 v23, 4294885376, v23
    v_add_u32 v24, 4294885376, v24
    v_add_u32 v25, 4294885376, v25
    v_add_u32 v26, 4294885376, v26
    v_add_u32 v27, 4294885376, v27
    v_add_u32 v28, 4294885376, v28
    v_add_u32 v29, 4294885376, v29
    v_add_u32 v30, 4294885376, v30
    v_add_u32 v31, 4294885376, v31
    ds_read_b64_tr_b16 a[208:209], v12 offset:0
    ds_read_b64_tr_b16 a[210:211], v13 offset:0
    ds_read_b64_tr_b16 a[212:213], v12 offset:40960
    ds_read_b64_tr_b16 a[214:215], v13 offset:40960
    ds_read_b64_tr_b16 a[224:225], v14 offset:0
    ds_read_b64_tr_b16 a[226:227], v15 offset:0
    ds_read_b64_tr_b16 a[228:229], v14 offset:40960
    ds_read_b64_tr_b16 a[230:231], v15 offset:40960
    ds_read_b64_tr_b16 v[88:89], v16 offset:0
    ds_read_b64_tr_b16 v[90:91], v17 offset:0
    ds_read_b64_tr_b16 v[92:93], v16 offset:40960
    ds_read_b64_tr_b16 v[94:95], v17 offset:40960
    ds_read_b64_tr_b16 v[136:137], v18 offset:0
    ds_read_b64_tr_b16 v[138:139], v19 offset:0
    ds_read_b64_tr_b16 v[140:141], v18 offset:40960
    ds_read_b64_tr_b16 v[142:143], v19 offset:40960
    ds_read_b64_tr_b16 v[152:153], v20 offset:0
    ds_read_b64_tr_b16 v[154:155], v21 offset:0
    ds_read_b64_tr_b16 v[156:157], v20 offset:40960
    ds_read_b64_tr_b16 v[158:159], v21 offset:40960
    ds_read_b64_tr_b16 v[176:177], v22 offset:0
    ds_read_b64_tr_b16 v[178:179], v23 offset:0
    ds_read_b64_tr_b16 v[180:181], v22 offset:40960
    ds_read_b64_tr_b16 v[182:183], v23 offset:40960
    ds_read_b64_tr_b16 v[192:193], v24 offset:0
    ds_read_b64_tr_b16 v[194:195], v25 offset:0
    ds_read_b64_tr_b16 v[196:197], v24 offset:40960
    ds_read_b64_tr_b16 v[198:199], v25 offset:40960
    ds_read_b64_tr_b16 v[112:113], v26 offset:0
    ds_read_b64_tr_b16 v[114:115], v27 offset:0
    ds_read_b64_tr_b16 v[116:117], v26 offset:40960
    ds_read_b64_tr_b16 v[118:119], v27 offset:40960
    ds_read_b64_tr_b16 v[232:233], v28 offset:0
    ds_read_b64_tr_b16 v[234:235], v29 offset:0
    ds_read_b64_tr_b16 v[236:237], v28 offset:40960
    ds_read_b64_tr_b16 v[238:239], v29 offset:40960
    ds_read_b64_tr_b16 v[248:249], v30 offset:0
    ds_read_b64_tr_b16 v[250:251], v31 offset:0
    ds_read_b64_tr_b16 v[252:253], v30 offset:40960
    ds_read_b64_tr_b16 v[254:255], v31 offset:40960
    s_waitcnt lgkmcnt(0)
    s_barrier
    v_lshrrev_b32 v12, 5, v1
    v_lshlrev_b32 v12, 1, v12
    v_bfe_u32 v13, v1, 3, 1
    v_add_u32 v12, v12, v13
    v_mul_u32_u24 v12, 3072, v12
    v_bfe_u32 v14, v1, 4, 1
    v_lshlrev_b32 v15, 9, v14
    v_add_u32 v12, v12, v15
    v_bfe_u32 v15, v1, 2, 1
    v_lshlrev_b32 v15, 7, v15
    v_add_u32 v12, v12, v15
    v_and_b32 v15, 3, v1
    v_lshlrev_b32 v15, 3, v15
    v_add_u32 v12, v12, v15
    v_lshlrev_b32 v13, 1, v13
    v_or_b32 v13, v13, v14
    v_xor_b32 v14, 0, v13
    v_lshlrev_b32 v14, 5, v14
    v_add_u32 v8, v12, v14
    v_xor_b32 v14, 1, v13
    v_lshlrev_b32 v14, 5, v14
    v_add_u32 v9, v12, v14
    v_xor_b32 v14, 2, v13
    v_lshlrev_b32 v14, 5, v14
    v_add_u32 v10, v12, v14
    v_xor_b32 v14, 3, v13
    v_lshlrev_b32 v14, 5, v14
    v_add_u32 v11, v12, v14
    s_cmp_lg_u32 s12, 0
    s_cbranch_scc1 .sw_127
    v_add_u32 v12, 0, v8
    v_add_u32 v13, 256, v9
    v_add_u32 v14, 0, v9
    v_add_u32 v15, 256, v8
    v_add_u32 v16, 0, v10
    v_add_u32 v17, 256, v11
.sw_127:
    s_cmp_lg_u32 s12, 1
    s_cbranch_scc1 .sw_128
    v_add_u32 v12, 0, v11
    v_add_u32 v13, 256, v10
    v_add_u32 v14, 1024, v8
    v_add_u32 v15, 1280, v9
    v_add_u32 v16, 1024, v9
    v_add_u32 v17, 1280, v8
.sw_128:
    s_cmp_lg_u32 s12, 2
    s_cbranch_scc1 .sw_129
    v_add_u32 v12, 1024, v10
    v_add_u32 v13, 1280, v11
    v_add_u32 v14, 1024, v11
    v_add_u32 v15, 1280, v10
    v_add_u32 v16, 2048, v8
    v_add_u32 v17, 2304, v9
.sw_129:
    s_cmp_lg_u32 s12, 3
    s_cbranch_scc1 .sw_130
    v_add_u32 v12, 2048, v9
    v_add_u32 v13, 2304, v8
    v_add_u32 v14, 2048, v10
    v_add_u32 v15, 2304, v11
    v_add_u32 v16, 2048, v11
    v_add_u32 v17, 2304, v10
.sw_130:
    v_lshrrev_b32 v2, 3, v1
    v_mul_u32_u24 v3, 12288, v2
    v_lshrrev_b32 v4, 1, v2
    v_lshrrev_b32 v5, 2, v2
    v_xor_b32 v4, v4, v5
    v_and_b32 v4, 1, v4
    v_lshlrev_b32 v4, 1, v4
    v_and_b32 v5, 7, v1
    v_xor_b32 v4, v4, v5
    v_xor_b32 v5, 4, v4
    v_lshlrev_b32 v4, 4, v4
    v_lshlrev_b32 v5, 4, v5
    v_add_u32 v4, v4, v3
    v_add_u32 v5, v5, v3
    s_mul_i32 s15, s12, 393216
    s_add_u32 s48, s48, s15
    s_addc_u32 s49, s49, 0
    s_mul_i32 s17, s12, 12288
    s_add_u32 m0, s17, 0
    s_nop 0
    global_load_lds_dwordx4 v4, s[48:49] offset:0
    s_add_u32 m0, s17, 896
    s_nop 0
    global_load_lds_dwordx4 v4, s[48:49] offset:128
    s_add_u32 m0, s17, 1792
    s_nop 0
    global_load_lds_dwordx4 v4, s[48:49] offset:256
    s_add_u32 s48, s48, 98304
    s_addc_u32 s49, s49, 0
    s_add_u32 m0, s17, 3072
    s_nop 0
    global_load_lds_dwordx4 v5, s[48:49] offset:0
    s_add_u32 m0, s17, 3968
    s_nop 0
    global_load_lds_dwordx4 v5, s[48:49] offset:128
    s_add_u32 m0, s17, 4864
    s_nop 0
    global_load_lds_dwordx4 v5, s[48:49] offset:256
    s_add_u32 s48, s48, 98304
    s_addc_u32 s49, s49, 0
    s_add_u32 m0, s17, 6144
    s_nop 0
    global_load_lds_dwordx4 v4, s[48:49] offset:0
    s_add_u32 m0, s17, 7040
    s_nop 0
    global_load_lds_dwordx4 v4, s[48:49] offset:128
    s_add_u32 m0, s17, 7936
    s_nop 0
    global_load_lds_dwordx4 v4, s[48:49] offset:256
    s_add_u32 s48, s48, 98304
    s_addc_u32 s49, s49, 0
    s_add_u32 m0, s17, 9216
    s_nop 0
    global_load_lds_dwordx4 v5, s[48:49] offset:0
    s_add_u32 m0, s17, 10112
    s_nop 0
    global_load_lds_dwordx4 v5, s[48:49] offset:128
    s_add_u32 m0, s17, 11008
    s_nop 0
    global_load_lds_dwordx4 v5, s[48:49] offset:256
    s_add_u32 s48, s48, 1277952
    s_addc_u32 s49, s49, 0
    s_add_u32 m0, s17, 49152
    s_nop 0
    global_load_lds_dwordx4 v4, s[48:49] offset:0
    s_add_u32 m0, s17, 50048
    s_nop 0
    global_load_lds_dwordx4 v4, s[48:49] offset:128
    s_add_u32 m0, s17, 50944
    s_nop 0
    global_load_lds_dwordx4 v4, s[48:49] offset:256
    s_add_u32 s48, s48, 98304
    s_addc_u32 s49, s49, 0
    s_add_u32 m0, s17, 52224
    s_nop 0
    global_load_lds_dwordx4 v5, s[48:49] offset:0
    s_add_u32 m0, s17, 53120
    s_nop 0
    global_load_lds_dwordx4 v5, s[48:49] offset:128
    s_add_u32 m0, s17, 54016
    s_nop 0
    global_load_lds_dwordx4 v5, s[48:49] offset:256
    s_add_u32 s48, s48, 98304
    s_addc_u32 s49, s49, 0
    s_add_u32 m0, s17, 55296
    s_nop 0
    global_load_lds_dwordx4 v4, s[48:49] offset:0
    s_add_u32 m0, s17, 56192
    s_nop 0
    global_load_lds_dwordx4 v4, s[48:49] offset:128
    s_add_u32 m0, s17, 57088
    s_nop 0
    global_load_lds_dwordx4 v4, s[48:49] offset:256
    s_add_u32 s48, s48, 98304
    s_addc_u32 s49, s49, 0
    s_add_u32 m0, s17, 58368
    s_nop 0
    global_load_lds_dwordx4 v5, s[48:49] offset:0
    s_add_u32 m0, s17, 59264
    s_nop 0
    global_load_lds_dwordx4 v5, s[48:49] offset:128
    s_add_u32 m0, s17, 60160
    s_nop 0
    global_load_lds_dwordx4 v5, s[48:49] offset:256
    s_add_u32 s48, s48, 1277952
    s_addc_u32 s49, s49, 0
    s_waitcnt vmcnt(12)
    s_barrier
    s_add_u32 m0, s17, 98304
    s_nop 0
    global_load_lds_dwordx4 v4, s[48:49] offset:0
    s_add_u32 m0, s17, 99200
    s_nop 0
    global_load_lds_dwordx4 v4, s[48:49] offset:128
    s_add_u32 m0, s17, 100096
    s_nop 0
    global_load_lds_dwordx4 v4, s[48:49] offset:256
    s_add_u32 s48, s48, 98304
    s_addc_u32 s49, s49, 0
    s_add_u32 m0, s17, 101376
    s_nop 0
    global_load_lds_dwordx4 v5, s[48:49] offset:0
    s_add_u32 m0, s17, 102272
    s_nop 0
    global_load_lds_dwordx4 v5, s[48:49] offset:128
    s_add_u32 m0, s17, 103168
    s_nop 0
    global_load_lds_dwordx4 v5, s[48:49] offset:256
    s_add_u32 s48, s48, 98304
    s_addc_u32 s49, s49, 0
    s_add_u32 m0, s17, 104448
    s_nop 0
    global_load_lds_dwordx4 v4, s[48:49] offset:0
    s_add_u32 m0, s17, 105344
    s_nop 0
    global_load_lds_dwordx4 v4, s[48:49] offset:128
    s_add_u32 m0, s17, 106240
    s_nop 0
    global_load_lds_dwordx4 v4, s[48:49] offset:256
    s_add_u32 s48, s48, 98304
    s_addc_u32 s49, s49, 0
    s_add_u32 m0, s17, 107520
    s_nop 0
    global_load_lds_dwordx4 v5, s[48:49] offset:0
    s_add_u32 m0, s17, 108416
    s_nop 0
    global_load_lds_dwordx4 v5, s[48:49] offset:128
    s_add_u32 m0, s17, 109312
    s_nop 0
    global_load_lds_dwordx4 v5, s[48:49] offset:256
    s_add_u32 s48, s48, 1277952
    s_addc_u32 s49, s49, 0
    ds_read_b64_tr_b16 a[0:1], v12 offset:0
    ds_read_b64_tr_b16 a[2:3], v13 offset:0
    ds_read_b64_tr_b16 a[4:5], v12 offset:12288
    ds_read_b64_tr_b16 a[6:7], v13 offset:12288
    ds_read_b64_tr_b16 a[8:9], v14 offset:0
    ds_read_b64_tr_b16 a[10:11], v15 offset:0
    ds_read_b64_tr_b16 a[12:13], v14 offset:12288
    ds_read_b64_tr_b16 a[14:15], v15 offset:12288
    ds_read_b64_tr_b16 a[16:17], v16 offset:0
    ds_read_b64_tr_b16 a[18:19], v17 offset:0
    ds_read_b64_tr_b16 a[20:21], v16 offset:12288
    ds_read_b64_tr_b16 a[22:23], v17 offset:12288
    ds_read_b64_tr_b16 v[32:33], v12 offset:24576
    ds_read_b64_tr_b16 v[34:35], v13 offset:24576
    ds_read_b64_tr_b16 v[36:37], v12 offset:36864
    ds_read_b64_tr_b16 v[38:39], v13 offset:36864
    ds_read_b64_tr_b16 a[24:25], v14 offset:24576
    ds_read_b64_tr_b16 a[26:27], v15 offset:24576
    ds_read_b64_tr_b16 a[28:29], v14 offset:36864
    ds_read_b64_tr_b16 a[30:31], v15 offset:36864
    ds_read_b64_tr_b16 a[32:33], v16 offset:24576
    ds_read_b64_tr_b16 a[34:35], v17 offset:24576
    ds_read_b64_tr_b16 a[36:37], v16 offset:36864
    ds_read_b64_tr_b16 a[38:39], v17 offset:36864
    s_waitcnt lgkmcnt(0)
    s_waitcnt vmcnt(12)
    s_barrier
    s_add_u32 m0, s17, 0
    s_nop 0
    global_load_lds_dwordx4 v4, s[48:49] offset:0
    s_add_u32 m0, s17, 896
    s_nop 0
    global_load_lds_dwordx4 v4, s[48:49] offset:128
    s_add_u32 m0, s17, 1792
    s_nop 0
    global_load_lds_dwordx4 v4, s[48:49] offset:256
    s_add_u32 s48, s48, 98304
    s_addc_u32 s49, s49, 0
    s_add_u32 m0, s17, 3072
    s_nop 0
    global_load_lds_dwordx4 v5, s[48:49] offset:0
    s_add_u32 m0, s17, 3968
    s_nop 0
    global_load_lds_dwordx4 v5, s[48:49] offset:128
    s_add_u32 m0, s17, 4864
    s_nop 0
    global_load_lds_dwordx4 v5, s[48:49] offset:256
    s_add_u32 s48, s48, 98304
    s_addc_u32 s49, s49, 0
    s_add_u32 m0, s17, 6144
    s_nop 0
    global_load_lds_dwordx4 v4, s[48:49] offset:0
    s_add_u32 m0, s17, 7040
    s_nop 0
    global_load_lds_dwordx4 v4, s[48:49] offset:128
    s_add_u32 m0, s17, 7936
    s_nop 0
    global_load_lds_dwordx4 v4, s[48:49] offset:256
    s_add_u32 s48, s48, 98304
    s_addc_u32 s49, s49, 0
    s_add_u32 m0, s17, 9216
    s_nop 0
    global_load_lds_dwordx4 v5, s[48:49] offset:0
    s_add_u32 m0, s17, 10112
    s_nop 0
    global_load_lds_dwordx4 v5, s[48:49] offset:128
    s_add_u32 m0, s17, 11008
    s_nop 0
    global_load_lds_dwordx4 v5, s[48:49] offset:256
    s_add_u32 s48, s48, 1277952
    s_addc_u32 s49, s49, 0
    v_add_u32 v12, 49152, v12
    v_add_u32 v13, 49152, v13
    v_add_u32 v14, 49152, v14
    v_add_u32 v15, 49152, v15
    v_add_u32 v16, 49152, v16
    v_add_u32 v17, 49152, v17
    ds_read_b64_tr_b16 a[40:41], v12 offset:0
    ds_read_b64_tr_b16 a[42:43], v13 offset:0
    ds_read_b64_tr_b16 a[44:45], v12 offset:12288
    ds_read_b64_tr_b16 a[46:47], v13 offset:12288
    ds_read_b64_tr_b16 a[48:49], v14 offset:0
    ds_read_b64_tr_b16 a[50:51], v15 offset:0
    ds_read_b64_tr_b16 a[52:53], v14 offset:12288
    ds_read_b64_tr_b16 a[54:55], v15 offset:12288
    ds_read_b64_tr_b16 v[40:41], v16 offset:0
    ds_read_b64_tr_b16 v[42:43], v17 offset:0
    ds_read_b64_tr_b16 v[44:45], v16 offset:12288
    ds_read_b64_tr_b16 v[46:47], v17 offset:12288
    ds_read_b64_tr_b16 a[56:57], v12 offset:24576
    ds_read_b64_tr_b16 a[58:59], v13 offset:24576
    ds_read_b64_tr_b16 a[60:61], v12 offset:36864
    ds_read_b64_tr_b16 a[62:63], v13 offset:36864
    ds_read_b64_tr_b16 a[64:65], v14 offset:24576
    ds_read_b64_tr_b16 a[66:67], v15 offset:24576
    ds_read_b64_tr_b16 a[68:69], v14 offset:36864
    ds_read_b64_tr_b16 a[70:71], v15 offset:36864
    ds_read_b64_tr_b16 a[72:73], v16 offset:24576
    ds_read_b64_tr_b16 a[74:75], v17 offset:24576
    ds_read_b64_tr_b16 a[76:77], v16 offset:36864
    ds_read_b64_tr_b16 a[78:79], v17 offset:36864
    s_waitcnt lgkmcnt(0)
    s_waitcnt vmcnt(12)
    s_barrier
    s_add_u32 m0, s17, 49152
    s_nop 0
    global_load_lds_dwordx4 v4, s[48:49] offset:0
    s_add_u32 m0, s17, 50048
    s_nop 0
    global_load_lds_dwordx4 v4, s[48:49] offset:128
    s_add_u32 m0, s17, 50944
    s_nop 0
    global_load_lds_dwordx4 v4, s[48:49] offset:256
    s_add_u32 s48, s48, 98304
    s_addc_u32 s49, s49, 0
    s_add_u32 m0, s17, 52224
    s_nop 0
    global_load_lds_dwordx4 v5, s[48:49] offset:0
    s_add_u32 m0, s17, 53120
    s_nop 0
    global_load_lds_dwordx4 v5, s[48:49] offset:128
    s_add_u32 m0, s17, 54016
    s_nop 0
    global_load_lds_dwordx4 v5, s[48:49] offset:256
    s_add_u32 s48, s48, 98304
    s_addc_u32 s49, s49, 0
    s_add_u32 m0, s17, 55296
    s_nop 0
    global_load_lds_dwordx4 v4, s[48:49] offset:0
    s_add_u32 m0, s17, 56192
    s_nop 0
    global_load_lds_dwordx4 v4, s[48:49] offset:128
    s_add_u32 m0, s17, 57088
    s_nop 0
    global_load_lds_dwordx4 v4, s[48:49] offset:256
    s_add_u32 s48, s48, 98304
    s_addc_u32 s49, s49, 0
    s_add_u32 m0, s17, 58368
    s_nop 0
    global_load_lds_dwordx4 v5, s[48:49] offset:0
    s_add_u32 m0, s17, 59264
    s_nop 0
    global_load_lds_dwordx4 v5, s[48:49] offset:128
    s_add_u32 m0, s17, 60160
    s_nop 0
    global_load_lds_dwordx4 v5, s[48:49] offset:256
    s_add_u32 s48, s48, 1277952
    s_addc_u32 s49, s49, 0
    v_add_u32 v12, 49152, v12
    v_add_u32 v13, 49152, v13
    v_add_u32 v14, 49152, v14
    v_add_u32 v15, 49152, v15
    v_add_u32 v16, 49152, v16
    v_add_u32 v17, 49152, v17
    ds_read_b64_tr_b16 a[80:81], v12 offset:0
    ds_read_b64_tr_b16 a[82:83], v13 offset:0
    ds_read_b64_tr_b16 a[84:85], v12 offset:12288
    ds_read_b64_tr_b16 a[86:87], v13 offset:12288
    ds_read_b64_tr_b16 v[48:49], v14 offset:0
    ds_read_b64_tr_b16 v[50:51], v15 offset:0
    ds_read_b64_tr_b16 v[52:53], v14 offset:12288
    ds_read_b64_tr_b16 v[54:55], v15 offset:12288
    ds_read_b64_tr_b16 a[88:89], v16 offset:0
    ds_read_b64_tr_b16 a[90:91], v17 offset:0
    ds_read_b64_tr_b16 a[92:93], v16 offset:12288
    ds_read_b64_tr_b16 a[94:95], v17 offset:12288
    ds_read_b64_tr_b16 a[96:97], v12 offset:24576
    ds_read_b64_tr_b16 a[98:99], v13 offset:24576
    ds_read_b64_tr_b16 a[100:101], v12 offset:36864
    ds_read_b64_tr_b16 a[102:103], v13 offset:36864
    ds_read_b64_tr_b16 a[104:105], v14 offset:24576
    ds_read_b64_tr_b16 a[106:107], v15 offset:24576
    ds_read_b64_tr_b16 a[108:109], v14 offset:36864
    ds_read_b64_tr_b16 a[110:111], v15 offset:36864
    ds_read_b64_tr_b16 a[112:113], v16 offset:24576
    ds_read_b64_tr_b16 a[114:115], v17 offset:24576
    ds_read_b64_tr_b16 a[116:117], v16 offset:36864
    ds_read_b64_tr_b16 a[118:119], v17 offset:36864
    s_waitcnt lgkmcnt(0)
    s_waitcnt vmcnt(12)
    s_barrier
    v_add_u32 v12, 4294868992, v12
    v_add_u32 v13, 4294868992, v13
    v_add_u32 v14, 4294868992, v14
    v_add_u32 v15, 4294868992, v15
    v_add_u32 v16, 4294868992, v16
    v_add_u32 v17, 4294868992, v17
    ds_read_b64_tr_b16 v[56:57], v12 offset:0
    ds_read_b64_tr_b16 v[58:59], v13 offset:0
    ds_read_b64_tr_b16 v[60:61], v12 offset:12288
    ds_read_b64_tr_b16 v[62:63], v13 offset:12288
    ds_read_b64_tr_b16 a[120:121], v14 offset:0
    ds_read_b64_tr_b16 a[122:123], v15 offset:0
    ds_read_b64_tr_b16 a[124:125], v14 offset:12288
    ds_read_b64_tr_b16 a[126:127], v15 offset:12288
    ds_read_b64_tr_b16 a[128:129], v16 offset:0
    ds_read_b64_tr_b16 a[130:131], v17 offset:0
    ds_read_b64_tr_b16 a[132:133], v16 offset:12288
    ds_read_b64_tr_b16 a[134:135], v17 offset:12288
    ds_read_b64_tr_b16 a[136:137], v12 offset:24576
    ds_read_b64_tr_b16 a[138:139], v13 offset:24576
    ds_read_b64_tr_b16 a[140:141], v12 offset:36864
    ds_read_b64_tr_b16 a[142:143], v13 offset:36864
    ds_read_b64_tr_b16 a[152:153], v14 offset:24576
    ds_read_b64_tr_b16 a[154:155], v15 offset:24576
    ds_read_b64_tr_b16 a[156:157], v14 offset:36864
    ds_read_b64_tr_b16 a[158:159], v15 offset:36864
    ds_read_b64_tr_b16 a[176:177], v16 offset:24576
    ds_read_b64_tr_b16 a[178:179], v17 offset:24576
    ds_read_b64_tr_b16 a[180:181], v16 offset:36864
    ds_read_b64_tr_b16 a[182:183], v17 offset:36864
    s_waitcnt lgkmcnt(0)
    s_waitcnt vmcnt(0)
    s_barrier
    v_add_u32 v12, 49152, v12
    v_add_u32 v13, 49152, v13
    v_add_u32 v14, 49152, v14
    v_add_u32 v15, 49152, v15
    v_add_u32 v16, 49152, v16
    v_add_u32 v17, 49152, v17
    ds_read_b64_tr_b16 a[144:145], v12 offset:0
    ds_read_b64_tr_b16 a[146:147], v13 offset:0
    ds_read_b64_tr_b16 a[148:149], v12 offset:12288
    ds_read_b64_tr_b16 a[150:151], v13 offset:12288
    ds_read_b64_tr_b16 a[160:161], v14 offset:0
    ds_read_b64_tr_b16 a[162:163], v15 offset:0
    ds_read_b64_tr_b16 a[164:165], v14 offset:12288
    ds_read_b64_tr_b16 a[166:167], v15 offset:12288
    ds_read_b64_tr_b16 v[72:73], v16 offset:0
    ds_read_b64_tr_b16 v[74:75], v17 offset:0
    ds_read_b64_tr_b16 v[76:77], v16 offset:12288
    ds_read_b64_tr_b16 v[78:79], v17 offset:12288
    ds_read_b64_tr_b16 v[64:65], v12 offset:24576
    ds_read_b64_tr_b16 v[66:67], v13 offset:24576
    ds_read_b64_tr_b16 v[68:69], v12 offset:36864
    ds_read_b64_tr_b16 v[70:71], v13 offset:36864
    ds_read_b64_tr_b16 a[168:169], v14 offset:24576
    ds_read_b64_tr_b16 a[170:171], v15 offset:24576
    ds_read_b64_tr_b16 a[172:173], v14 offset:36864
    ds_read_b64_tr_b16 a[174:175], v15 offset:36864
    ds_read_b64_tr_b16 a[184:185], v16 offset:24576
    ds_read_b64_tr_b16 a[186:187], v17 offset:24576
    ds_read_b64_tr_b16 a[188:189], v16 offset:36864
    ds_read_b64_tr_b16 a[190:191], v17 offset:36864
    s_waitcnt lgkmcnt(0)
    s_barrier
    v_lshlrev_b32 v2, 4, v1
    s_mul_i32 s15, s12, 24576
    v_add_u32 v2, s15, v2
    ds_write_b128 v2, v[32:35] offset:0
    ds_write_b128 v2, v[36:39] offset:1024
    ds_write_b128 v2, v[40:43] offset:2048
    ds_write_b128 v2, v[44:47] offset:3072
    ds_write_b128 v2, v[48:51] offset:4096
    ds_write_b128 v2, v[52:55] offset:5120
    ds_write_b128 v2, v[56:59] offset:6144
    ds_write_b128 v2, v[60:63] offset:7168
    ds_write_b128 v2, v[64:67] offset:8192
    ds_write_b128 v2, v[68:71] offset:9216
    ds_write_b128 v2, v[72:75] offset:10240
    ds_write_b128 v2, v[76:79] offset:11264
    ds_write_b128 v2, v[80:83] offset:12288
    ds_write_b128 v2, v[84:87] offset:13312
    ds_write_b128 v2, v[88:91] offset:14336
    ds_write_b128 v2, v[92:95] offset:15360
    ds_write_b128 v2, v[96:99] offset:16384
    ds_write_b128 v2, v[100:103] offset:17408
    ds_write_b128 v2, v[104:107] offset:18432
    ds_write_b128 v2, v[108:111] offset:19456
    ds_write_b128 v2, v[112:115] offset:20480
    ds_write_b128 v2, v[116:119] offset:21504
    ds_write_b128 v2, v[120:123] offset:22528
    ds_write_b128 v2, v[124:127] offset:23552
    s_waitcnt lgkmcnt(0)
    s_mul_i32 s22, s12, 16384
    s_add_u32 s22, s22, 5120
    v_lshlrev_b32 v4, 4, v1
    v_add_u32 v4, s22, v4
    v_lshlrev_b32 v5, 3, v1
    v_add_u32 v5, s22, v5
    v_add_u32 v5, 2048, v5
    s_mul_i32 s23, s12, 2560
    s_add_u32 s23, s23, 98304
    v_lshlrev_b32 v6, 4, v1
    v_add_u32 v6, s23, v6
    v_lshlrev_b32 v7, 3, v1
    v_add_u32 v7, s23, v7
    v_add_u32 v7, 2048, v7
    v_lshrrev_b32 v2, 4, v1
    v_lshlrev_b32 v2, 8, v2
    v_and_b32 v3, 1, v1
    v_lshlrev_b32 v3, 7, v3
    v_add_u32 v2, v2, v3
    v_bfe_u32 v3, v1, 1, 3
    v_lshlrev_b32 v3, 4, v3
    v_add_u32 v2, v2, v3
    v_add_u32 v8, 98304, v2
    v_and_b32 v3, 1, v1
    v_cmp_eq_u32 vcc, 1, v3
    v_mov_b32 v9, 0x4444
    v_mov_b32 v3, 0xeeee
    v_cndmask_b32 v9, v9, v3, vcc
    v_lshlrev_b32 v10, 4, v1
    s_mul_i32 s15, s12, 24576
    v_add_u32 v10, s15, v10
    s_mov_b32 s38, 0
    s_load_dwordx2 s[42:43], s[0:1], 8
    v_and_b32 v2, 7, v0
    v_mul_u32_u24 v2, 1280, v2
    v_lshrrev_b32 v3, 3, v0
    v_lshlrev_b32 v3, 4, v3
    v_add_u32 v2, v2, v3
    v_lshlrev_b32 v3, 4, v0
    s_waitcnt lgkmcnt(0)
    global_load_dwordx4 v[32:35], v2, s[42:43]
    global_load_dwordx4 v[36:39], v2, s[42:43] offset:512
    s_cmp_ge_u32 s12, 2
    s_cbranch_scc1 .m0_131
    global_load_dwordx4 v[40:43], v2, s[42:43] offset:1024
    s_waitcnt vmcnt(0)
    v_add_u32 v2, 106496, v3
    ds_write_b128 v2, v[40:43]
.m0_131:
    s_waitcnt vmcnt(0)
    v_add_u32 v2, 98304, v3
    ds_write_b128 v2, v[32:35]
    ds_write_b128 v2, v[36:39] offset:4096
    s_waitcnt lgkmcnt(0)
    v_and_b32 v2, 15, v1
    v_lshrrev_b32 v3, 3, v2
    v_lshlrev_b32 v3, 7, v3
    v_and_b32 v2, 7, v2
    v_lshlrev_b32 v2, 1, v2
    v_add_u32 v2, v2, v3
    v_lshrrev_b32 v3, 4, v1
    v_lshlrev_b32 v3, 5, v3
    v_add_u32 v2, v2, v3
    s_mul_i32 s25, s12, 768
    s_add_u32 s25, s25, 157696
    v_add_u32 v21, s25, v2
    v_add_u32 v22, 59392, v8
    s_lshl_b32 s47, s18, 7
    s_add_u32 s47, s47, 28672
    v_lshrrev_b32 v2, 4, v1
    v_lshlrev_b32 v2, 14, v2
    v_and_b32 v3, 15, v1
    v_lshlrev_b32 v3, 4, v3
    v_add_u32 v2, v2, v3
    s_mul_i32 s25, s12, 163840
    s_lshl_b32 s23, s18, 8
    s_add_u32 s25, s25, s23
    s_add_u32 s25, s25, 65536
    v_add_u32 v23, s25, v2
    v_add_u32 v24, 65536, v23
    v_add_u32 v25, 65536, v24
    v_mov_b32 v2, 128
.iw_132:
    global_load_dword v3, v2, s[6:7] sc0 sc1
    s_waitcnt vmcnt(0)
    v_readfirstlane_b32 s15, v3
    s_nop 3
    s_cmp_ge_u32 s15, 64
    s_cbranch_scc1 .iwd_133
    s_sleep 4
    s_add_u32 s14, s14, 1
    s_cmp_gt_u32 s14, 400000
    s_cbranch_scc1 .Lend
    s_branch .iw_132
.iwd_133:
.detw_134:
    v_mov_b32 v2, 72
    global_load_dword v3, v2, s[6:7] sc0 sc1
    s_waitcnt vmcnt(0)
    v_readfirstlane_b32 s60, v3
    s_add_u32 s14, s14, 1
    s_cmp_gt_u32 s14, 400000
    s_cbranch_scc1 .Lend
    s_and_b32 s15, s60, 0xff
    s_cmp_lt_u32 s15, 8
    s_cbranch_scc1 .detw_134
    s_cmp_ge_u32 s60, 0x500
    s_cselect_b32 s15, 8192, 0
    s_add_u32 s15, s15, 0
    s_add_u32 s34, s4, s15
    s_addc_u32 s35, s5, 0
    s_add_u32 s54, s34, 720896
    s_addc_u32 s55, s35, 0
    s_cmp_eq_u32 s18, 0
    s_cselect_b32 s56, s12, 99
    s_mov_b32 s53, 0
    s_mov_b32 s52, 0
    v_mov_b32 v32, 0
    v_mov_b32 v33, 0
    v_mov_b32 v34, 0
    v_mov_b32 v35, 0
    v_mov_b32 v36, 0
    v_mov_b32 v37, 0
    v_mov_b32 v38, 0
    v_mov_b32 v39, 0
    v_mov_b32 v40, 0
    v_mov_b32 v41, 0
    v_mov_b32 v42, 0
    v_mov_b32 v43, 0
    v_mov_b32 v44, 0
    v_mov_b32 v45, 0
    v_mov_b32 v46, 0
    v_mov_b32 v47, 0
    v_mov_b32 v48, 0
    v_mov_b32 v49, 0
    v_mov_b32 v50, 0
    v_mov_b32 v51, 0
    v_mov_b32 v52, 0
    v_mov_b32 v53, 0
    v_mov_b32 v54, 0
    v_mov_b32 v55, 0
    v_mov_b32 v56, 0
    v_mov_b32 v57, 0
    v_mov_b32 v58, 0
    v_mov_b32 v59, 0
    v_mov_b32 v60, 0
    v_mov_b32 v61, 0
    v_mov_b32 v62, 0
    v_mov_b32 v63, 0
    v_mov_b32 v64, 0
    v_mov_b32 v65, 0
    v_mov_b32 v66, 0
    v_mov_b32 v67, 0
    v_mov_b32 v68, 0
    v_mov_b32 v69, 0
    v_mov_b32 v70, 0
    v_mov_b32 v71, 0
    ds_read_b128 v[112:115], v10 offset:0
    ds_read_b128 v[116:119], v10 offset:1024
    ds_read_b128 v[120:123], v10 offset:2048
    ds_read_b128 v[124:127], v10 offset:3072
    s_waitcnt lgkmcnt(0)
    s_branch .LV_go
.LV_step:
    v_mov_b32 v32, 0
    v_mov_b32 v33, 0
    v_mov_b32 v34, 0
    v_mov_b32 v35, 0
    v_mov_b32 v36, 0
    v_mov_b32 v37, 0
    v_mov_b32 v38, 0
    v_mov_b32 v39, 0
    v_mov_b32 v40, 0
    v_mov_b32 v41, 0
    v_mov_b32 v42, 0
    v_mov_b32 v43, 0
    v_mov_b32 v44, 0
    v_mov_b32 v45, 0
    v_mov_b32 v46, 0
    v_mov_b32 v47, 0
    v_mov_b32 v48, 0
    v_mov_b32 v49, 0
    v_mov_b32 v50, 0
    v_mov_b32 v51, 0
    v_mov_b32 v52, 0
    v_mov_b32 v53, 0
    v_mov_b32 v54, 0
    v_mov_b32 v55, 0
    v_mov_b32 v56, 0
    v_mov_b32 v57, 0
    v_mov_b32 v58, 0
    v_mov_b32 v59, 0
    v_mov_b32 v60, 0
    v_mov_b32 v61, 0
    v_mov_b32 v62, 0
    v_mov_b32 v63, 0
    v_mov_b32 v64, 0
    v_mov_b32 v65, 0
    v_mov_b32 v66, 0
    v_mov_b32 v67, 0
    v_mov_b32 v68, 0
    v_mov_b32 v69, 0
    v_mov_b32 v70, 0
    v_mov_b32 v71, 0
    ds_read_b128 v[112:115], v10 offset:0
    ds_read_b128 v[116:119], v10 offset:1024
    ds_read_b128 v[120:123], v10 offset:2048
    ds_read_b128 v[124:127], v10 offset:3072
    s_cmp_lg_u32 s12, 0
    s_cbranch_scc1 .husk_136
    s_mov_b32 s33, s38
    v_mov_b32 v3, s52
    s_mov_b64 exec, 1
.hu_135:
    global_load_dword v2, v3, s[54:55] offset:1024 sc1
    s_add_u32 s14, s14, 1
    s_cmp_gt_u32 s14, 400000
    s_cbranch_scc1 .Lend
    s_waitcnt vmcnt(0)
    v_cmp_gt_i32 vcc, s33, v2
    s_cbranch_vccnz .hu_135
    s_mov_b64 exec, -1
.husk_136:
    s_barrier
    global_load_dwordx4 v[72:75], v4, s[34:35] sc1
    global_load_dwordx4 v[76:79], v4, s[34:35] offset:1024 sc1
    global_load_dwordx2 v[80:81], v5, s[34:35] sc1
.Le1V0:
    s_waitcnt vmcnt(0)
    ds_write_b128 v6, v[72:75]
    ds_write_b128 v6, v[76:79] offset:1024
    ds_write_b64 v7, v[80:81]
    v_max3_u32 v2, v72, v73, v74
    v_max3_u32 v3, v75, v76, v77
    v_max3_u32 v2, v2, v78, v79
    v_max3_u32 v3, v3, v80, v81
    v_max_u32 v2, v2, v3
    v_cmp_eq_u32 vcc, -1, v2
    s_waitcnt lgkmcnt(0)
    s_cbranch_vccz .Le1okV
    global_load_dwordx4 v[72:75], v4, s[34:35] sc1
    global_load_dwordx4 v[76:79], v4, s[34:35] offset:1024 sc1
    global_load_dwordx2 v[80:81], v5, s[34:35] sc1
    s_add_u32 s14, s14, 1
    s_cmp_gt_u32 s14, 400000
    s_cbranch_scc1 .Lend
    s_branch .Le1V0
.Le1okV:
.LV_go:
    s_barrier
    ds_read_b128 v[72:75], v8 offset:0
    ds_read_b128 v[76:79], v8 offset:1024
    ds_read_b128 v[80:83], v8 offset:2048
    ds_read_b128 v[84:87], v8 offset:3072
    ds_read_b128 v[88:91], v8 offset:4096
    ds_read_b128 v[92:95], v8 offset:5120
    ds_read_b128 v[96:99], v8 offset:6144
    ds_read_b128 v[100:103], v8 offset:7168
    ds_read_b128 v[104:107], v8 offset:8192
    ds_read_b128 v[108:111], v8 offset:9216
    s_waitcnt lgkmcnt(9)
    v_smfmac_f32_16x16x64_bf16 v[32:35], v[72:75], a[0:7], v9
    v_smfmac_f32_16x16x64_bf16 v[36:39], v[72:75], a[8:15], v9
    v_smfmac_f32_16x16x64_bf16 v[40:43], v[72:75], a[16:23], v9
    s_cmp_lg_u32 s12, 1
    s_cbranch_scc1 .pub_137
    s_mov_b32 s33, s38
    v_mov_b32 v2, s47
    v_mov_b32 v3, s33
    s_mov_b64 exec, 1
    global_store_dword v2, v3, s[10:11] sc1
    s_mov_b64 exec, -1
.pub_137:
    s_waitcnt lgkmcnt(8)
    v_smfmac_f32_16x16x64_bf16 v[32:35], v[76:79], v[112:119], v9
    ds_read_b128 v[112:115], v10 offset:4096
    ds_read_b128 v[116:119], v10 offset:5120
    v_smfmac_f32_16x16x64_bf16 v[36:39], v[76:79], a[24:31], v9
    v_smfmac_f32_16x16x64_bf16 v[40:43], v[76:79], a[32:39], v9
    s_waitcnt lgkmcnt(9)
    v_smfmac_f32_16x16x64_bf16 v[32:35], v[80:83], a[40:47], v9
    v_smfmac_f32_16x16x64_bf16 v[36:39], v[80:83], a[48:55], v9
    v_smfmac_f32_16x16x64_bf16 v[40:43], v[80:83], v[120:127], v9
    ds_read_b128 v[120:123], v10 offset:6144
    ds_read_b128 v[124:127], v10 offset:7168
    s_waitcnt lgkmcnt(10)
    v_smfmac_f32_16x16x64_bf16 v[32:35], v[84:87], a[56:63], v9
    v_smfmac_f32_16x16x64_bf16 v[36:39], v[84:87], a[64:71], v9
    v_smfmac_f32_16x16x64_bf16 v[40:43], v[84:87], a[72:79], v9
    s_waitcnt lgkmcnt(9)
    v_smfmac_f32_16x16x64_bf16 v[32:35], v[88:91], a[80:87], v9
    s_waitcnt lgkmcnt(2)
    v_smfmac_f32_16x16x64_bf16 v[36:39], v[88:91], v[112:119], v9
    ds_read_b128 v[112:115], v10 offset:8192
    ds_read_b128 v[116:119], v10 offset:9216
    v_smfmac_f32_16x16x64_bf16 v[40:43], v[88:91], a[88:95], v9
    v_smfmac_f32_16x16x64_bf16 v[32:35], v[92:95], a[96:103], v9
    v_smfmac_f32_16x16x64_bf16 v[36:39], v[92:95], a[104:111], v9
    v_smfmac_f32_16x16x64_bf16 v[40:43], v[92:95], a[112:119], v9
    s_waitcnt lgkmcnt(2)
    v_smfmac_f32_16x16x64_bf16 v[32:35], v[96:99], v[120:127], v9
    ds_read_b128 v[120:123], v10 offset:10240
    ds_read_b128 v[124:127], v10 offset:11264
    v_smfmac_f32_16x16x64_bf16 v[36:39], v[96:99], a[120:127], v9
    v_smfmac_f32_16x16x64_bf16 v[40:43], v[96:99], a[128:135], v9
    v_smfmac_f32_16x16x64_bf16 v[32:35], v[100:103], a[136:143], v9
    v_smfmac_f32_16x16x64_bf16 v[32:35], v[104:107], a[144:151], v9
    s_waitcnt lgkmcnt(2)
    v_smfmac_f32_16x16x64_bf16 v[32:35], v[108:111], v[112:119], v9
    v_smfmac_f32_16x16x64_bf16 v[36:39], v[100:103], a[152:159], v9
    v_smfmac_f32_16x16x64_bf16 v[36:39], v[104:107], a[160:167], v9
    v_add_f32 v32, v32, v33
    v_add_f32 v34, v34, v35
    v_smfmac_f32_16x16x64_bf16 v[36:39], v[108:111], a[168:175], v9
    v_cvt_pk_bf16_f32 v84, v32, v34
    ds_write_b16 v21, v84 offset:0
    v_smfmac_f32_16x16x64_bf16 v[40:43], v[100:103], a[176:183], v9
    ds_write_b16_d16_hi v21, v84 offset:16
    s_waitcnt lgkmcnt(0)
    v_smfmac_f32_16x16x64_bf16 v[40:43], v[104:107], v[120:127], v9
    v_add_f32 v36, v36, v37
    v_add_f32 v38, v38, v39
    v_smfmac_f32_16x16x64_bf16 v[40:43], v[108:111], a[184:191], v9
    ds_read_b128 v[112:115], v10 offset:12288
    ds_read_b128 v[116:119], v10 offset:13312
    ds_read_b128 v[120:123], v10 offset:14336
    ds_read_b128 v[124:127], v10 offset:15360
    v_cvt_pk_bf16_f32 v85, v36, v38
    ds_write_b16 v21, v85 offset:256
    ds_write_b16_d16_hi v21, v85 offset:272
    s_nop 0
    v_add_f32 v40, v40, v41
    v_add_f32 v42, v42, v43
    v_cvt_pk_bf16_f32 v86, v40, v42
    ds_write_b16 v21, v86 offset:512
    ds_write_b16_d16_hi v21, v86 offset:528
    v_mov_b32 v32, 0
    v_mov_b32 v33, 0
    v_mov_b32 v34, 0
    v_mov_b32 v35, 0
    v_mov_b32 v36, 0
    v_mov_b32 v37, 0
    v_mov_b32 v38, 0
    v_mov_b32 v39, 0
    v_mov_b32 v40, 0
    v_mov_b32 v41, 0
    v_mov_b32 v42, 0
    v_mov_b32 v43, 0
    s_waitcnt lgkmcnt(0)
    s_barrier
    ds_read_b128 v[72:75], v22 offset:0
    ds_read_b128 v[76:79], v22 offset:1024
    ds_read_b128 v[80:83], v22 offset:2048
    s_waitcnt lgkmcnt(2)
    v_smfmac_f32_16x16x64_bf16 v[32:35], v[72:75], a[192:199], v9
    s_waitcnt lgkmcnt(1)
    v_smfmac_f32_16x16x64_bf16 v[32:35], v[76:79], a[200:207], v9
    s_waitcnt lgkmcnt(0)
    v_smfmac_f32_16x16x64_bf16 v[32:35], v[80:83], a[208:215], v9
    v_smfmac_f32_16x16x64_bf16 v[36:39], v[72:75], v[112:119], v9
    ds_read_b128 v[112:115], v10 offset:16384
    ds_read_b128 v[116:119], v10 offset:17408
    v_smfmac_f32_16x16x64_bf16 v[36:39], v[76:79], a[216:223], v9
    v_add_f32 v33, v32, v33
    v_add_f32 v34, v34, v35
    v_smfmac_f32_16x16x64_bf16 v[36:39], v[80:83], a[224:231], v9
    v_cvt_pk_bf16_f32 v84, v33, v34
    v_smfmac_f32_16x16x64_bf16 v[40:43], v[72:75], a[232:239], v9
    v_smfmac_f32_16x16x64_bf16 v[40:43], v[76:79], a[240:247], v9
    v_add_f32 v37, v36, v37
    v_add_f32 v38, v38, v39
    v_smfmac_f32_16x16x64_bf16 v[40:43], v[80:83], v[120:127], v9
    ds_read_b128 v[120:123], v10 offset:18432
    ds_read_b128 v[124:127], v10 offset:19456
    v_smfmac_f32_16x16x64_bf16 v[44:47], v[72:75], a[248:255], v9
    v_cvt_pk_bf16_f32 v85, v37, v38
    v_smfmac_f32_16x16x64_bf16 v[44:47], v[76:79], v[128:135], v9
    v_add_f32 v41, v40, v41
    v_add_f32 v42, v42, v43
    v_smfmac_f32_16x16x64_bf16 v[44:47], v[80:83], v[136:143], v9
    v_cvt_pk_bf16_f32 v86, v41, v42
    v_smfmac_f32_16x16x64_bf16 v[48:51], v[72:75], v[144:151], v9
    s_waitcnt lgkmcnt(2)
    v_smfmac_f32_16x16x64_bf16 v[48:51], v[76:79], v[112:119], v9
    ds_read_b128 v[112:115], v10 offset:20480
    ds_read_b128 v[116:119], v10 offset:21504
    v_smfmac_f32_16x16x64_bf16 v[48:51], v[80:83], v[152:159], v9
    v_add_f32 v45, v44, v45
    v_add_f32 v46, v46, v47
    v_smfmac_f32_16x16x64_bf16 v[52:55], v[72:75], v[160:167], v9
    v_cvt_pk_bf16_f32 v87, v45, v46
    v_smfmac_f32_16x16x64_bf16 v[52:55], v[76:79], v[168:175], v9
    v_smfmac_f32_16x16x64_bf16 v[52:55], v[80:83], v[176:183], v9
    v_permlane32_swap_b32 v84, v86
    v_permlane32_swap_b32 v85, v87
    s_waitcnt lgkmcnt(2)
    v_smfmac_f32_16x16x64_bf16 v[56:59], v[72:75], v[120:127], v9
    ds_read_b128 v[120:123], v10 offset:22528
    ds_read_b128 v[124:127], v10 offset:23552
    v_smfmac_f32_16x16x64_bf16 v[56:59], v[76:79], v[184:191], v9
    v_permlane16_swap_b32 v84, v85
    v_permlane16_swap_b32 v86, v87
    v_smfmac_f32_16x16x64_bf16 v[56:59], v[80:83], v[192:199], v9
    global_store_dwordx4 v23, v[84:87], s[34:35] sc1
    v_add_f32 v49, v48, v49
    v_smfmac_f32_16x16x64_bf16 v[60:63], v[72:75], v[200:207], v9
    v_add_f32 v50, v50, v51
    v_cvt_pk_bf16_f32 v88, v49, v50
    v_smfmac_f32_16x16x64_bf16 v[60:63], v[76:79], v[208:215], v9
    v_add_f32 v53, v52, v53
    v_add_f32 v54, v54, v55
    s_waitcnt lgkmcnt(2)
    v_smfmac_f32_16x16x64_bf16 v[60:63], v[80:83], v[112:119], v9
    v_cvt_pk_bf16_f32 v89, v53, v54
    v_add_f32 v57, v56, v57
    v_smfmac_f32_16x16x64_bf16 v[64:67], v[72:75], v[216:223], v9
    v_add_f32 v58, v58, v59
    v_cvt_pk_bf16_f32 v90, v57, v58
    v_smfmac_f32_16x16x64_bf16 v[64:67], v[76:79], v[224:231], v9
    v_add_f32 v61, v60, v61
    v_add_f32 v62, v62, v63
    v_smfmac_f32_16x16x64_bf16 v[64:67], v[80:83], v[232:239], v9
    v_cvt_pk_bf16_f32 v91, v61, v62
    v_smfmac_f32_16x16x64_bf16 v[68:71], v[72:75], v[240:247], v9
    s_waitcnt lgkmcnt(0)
    v_smfmac_f32_16x16x64_bf16 v[68:71], v[76:79], v[120:127], v9
    v_permlane32_swap_b32 v88, v90
    v_permlane32_swap_b32 v89, v91
    v_smfmac_f32_16x16x64_bf16 v[68:71], v[80:83], v[248:255], v9
    s_nop 0
    v_permlane16_swap_b32 v88, v89
    v_permlane16_swap_b32 v90, v91
    global_store_dwordx4 v24, v[88:91], s[34:35] sc1
    v_add_f32 v65, v64, v65
    v_add_f32 v66, v66, v67
    v_cvt_pk_bf16_f32 v92, v65, v66
    s_nop 0
    v_add_f32 v69, v68, v69
    v_add_f32 v70, v70, v71
    v_cvt_pk_bf16_f32 v93, v69, v70
    s_nop 0
    s_nop 0
    v_permlane32_swap_b32 v92, v94
    v_permlane32_swap_b32 v93, v95
    s_nop 0
    s_nop 0
    v_permlane16_swap_b32 v92, v93
    v_permlane16_swap_b32 v94, v95
    s_mov_b32 exec_hi, 0
    global_store_dwordx4 v25, v[92:95], s[34:35] sc1
    s_mov_b64 exec, -1
    s_cmp_ge_u32 s38, 63
    s_cbranch_scc1 .LV_fin
    s_add_u32 s34, s34, 1048576
    s_addc_u32 s35, s35, 0
    s_and_b32 s25, s38, 1
    s_lshl_b32 s25, s25, 13
    s_xor_b32 s34, s34, s25
    s_add_u32 s38, s38, 1
    s_branch .LV_step
.LV_fin:
    s_waitcnt vmcnt(0)
    s_barrier
    s_mov_b32 s38, 64
    s_cmp_lg_u32 s12, 0
    s_cbranch_scc1 .pub_138
    v_mov_b32 v2, s47
    v_mov_b32 v3, s38
    s_mov_b64 exec, 1
    global_store_dword v2, v3, s[10:11] sc1
    s_mov_b64 exec, -1
.pub_138:
    s_branch .Lend
.Lrole_C:
    s_sub_u32 s18, s13, 64
    v_and_b32 v3, 1, v1
    v_cmp_eq_u32 vcc, 1, v3
    v_mov_b32 v9, 0x4444
    v_mov_b32 v3, 0xeeee
    v_cndmask_b32 v9, v9, v3, vcc
    v_lshrrev_b32 v2, 5, v1
    v_mul_u32_u24 v2, 640, v2
    v_and_b32 v3, 31, v1
    v_lshlrev_b32 v3, 4, v3
    v_add_u32 v2, v2, v3
    s_mul_i32 s23, s12, 16384
    v_add_u32 v11, s23, v2
    v_lshrrev_b32 v2, 4, v1
    v_mul_u32_u24 v2, 1280, v2
    v_and_b32 v3, 15, v1
    v_lshlrev_b32 v3, 3, v3
    v_add_u32 v2, v2, v3
    v_add_u32 v2, 512, v2
    v_add_u32 v12, s23, v2
    v_lshlrev_b32 v2, 4, v1
    s_lshl_b32 s25, s18, 14
    s_lshl_b32 s23, s12, 11
    s_add_u32 s25, s25, s23
    s_add_u32 s25, s25, 65536
    v_add_u32 v13, s25, v2
    v_add_u32 v14, 16384, v13
    v_and_b32 v3, 15, v1
    v_lshlrev_b32 v3, 6, v3
    v_lshrrev_b32 v2, 4, v1
    v_lshlrev_b32 v2, 4, v2
    v_add_u32 v2, v2, v3
    s_lshl_b32 s25, s18, 15
    s_lshl_b32 s23, s12, 13
    s_add_u32 s25, s25, s23
    v_add_u32 v15, s25, v2
    v_add_u32 v17, 4096, v15
    v_add_u32 v18, 32768, v15
    v_add_u32 v19, 32768, v17
    v_lshrrev_b32 v2, 4, v1
    v_lshlrev_b32 v2, 8, v2
    v_and_b32 v3, 15, v1
    v_lshlrev_b32 v3, 2, v3
    v_add_u32 v2, v2, v3
    s_lshl_b32 s25, s12, 10
    v_add_u32 v20, s25, v2
    v_lshrrev_b32 v2, 3, v1
    v_lshlrev_b32 v21, 7, v2
    v_and_b32 v3, 7, v1
    v_lshlrev_b32 v3, 3, v3
    v_add_u32 v21, v21, v3
    s_lshl_b32 s25, s12, 6
    v_add_u32 v21, s25, v21
    v_and_b32 v3, 3, v2
    v_lshlrev_b32 v3, 1, v3
    v_lshrrev_b32 v2, 2, v2
    v_add_u32 v2, v2, v3
    v_lshlrev_b32 v2, 4, v2
    v_bfe_u32 v3, v1, 2, 1
    v_lshlrev_b32 v3, 7, v3
    v_add_u32 v2, v2, v3
    v_and_b32 v3, 3, v1
    v_lshlrev_b32 v3, 2, v3
    v_add_u32 v2, v2, v3
    s_lshl_b32 s25, s18, 0
    s_and_b32 s23, s12, 0
    s_add_u32 s25, s25, s23
    s_lshl_b32 s25, s25, 8
    s_mul_i32 s23, s25, 1639
    s_lshr_b32 s23, s23, 22
    s_mul_i32 s23, s23, 13824
    s_add_u32 s25, s25, s23
    s_add_u32 s25, s25, 5120
    v_add_u32 v22, s25, v2
    v_and_b32 v23, 31, v1
    v_lshlrev_b32 v23, 7, v23
    v_add_u32 v24, 4096, v23
    s_add_u32 s40, s4, 69206016
    s_addc_u32 s41, s5, 0
    s_mov_b32 s46, 0
    s_mov_b32 s38, 0
    v_mov_b32 v2, 128
.iw_139:
    global_load_dword v3, v2, s[6:7] sc0 sc1
    s_waitcnt vmcnt(0)
    v_readfirstlane_b32 s15, v3
    s_nop 3
    s_cmp_ge_u32 s15, 64
    s_cbranch_scc1 .iwd_140
    s_sleep 4
    s_add_u32 s14, s14, 1
    s_cmp_gt_u32 s14, 400000
    s_cbranch_scc1 .Lend
    s_branch .iw_139
.iwd_140:
.detw_141:
    v_mov_b32 v2, 72
    global_load_dword v3, v2, s[6:7] sc0 sc1
    s_waitcnt vmcnt(0)
    v_readfirstlane_b32 s60, v3
    s_add_u32 s14, s14, 1
    s_cmp_gt_u32 s14, 400000
    s_cbranch_scc1 .Lend
    s_and_b32 s15, s60, 0xff
    s_cmp_lt_u32 s15, 8
    s_cbranch_scc1 .detw_141
    s_cmp_ge_u32 s60, 0x500
    s_cselect_b32 s15, 8192, 0
    s_add_u32 s15, s15, 0
    s_add_u32 s34, s4, s15
    s_addc_u32 s35, s5, 0
    s_add_u32 s54, s34, 720896
    s_addc_u32 s55, s35, 0
    s_cmp_eq_u32 s18, 0
    s_cselect_b32 s56, s12, 99
    s_mov_b32 s53, 0
    s_mov_b32 s52, 0
    v_lshlrev_b32 v23, 7, v1
    s_mov_b32 s45, 0
.LC_step:
    s_add_u32 s33, s38, 1
    s_cmp_ge_u32 s46, s33
    s_cbranch_scc1 .wpd_143
    v_and_b32 v2, 7, v1
    v_lshlrev_b32 v2, 7, v2
    v_add_u32 v2, 20480, v2
    s_lshl_b32 s15, s12, 10
    v_add_u32 v2, s15, v2
.wp_142:
    global_load_dword v3, v2, s[10:11] sc1
    s_waitcnt vmcnt(0)
    s_nop 1
    v_min_u32_dpp v3, v3, v3 row_ror:1 row_mask:0xf bank_mask:0xf
    s_nop 1
    v_min_u32_dpp v3, v3, v3 row_ror:2 row_mask:0xf bank_mask:0xf
    s_nop 1
    v_min_u32_dpp v3, v3, v3 row_ror:4 row_mask:0xf bank_mask:0xf
    s_nop 1
    v_readlane_b32 s46, v3, 0
    s_cmp_ge_u32 s46, s33
    s_cbranch_scc1 .wpd_143
    s_sleep 2
    s_add_u32 s14, s14, 1
    s_cmp_gt_u32 s14, 400000
    s_cbranch_scc1 .Lend
    s_branch .wp_142
.wpd_143:
    global_load_dwordx4 v[68:71], v15, s[40:41] offset:0 sc1
    global_load_dwordx4 v[72:75], v15, s[40:41] offset:1024 sc1
    global_load_dwordx4 v[76:79], v15, s[40:41] offset:2048 sc1
    global_load_dwordx4 v[80:83], v15, s[40:41] offset:3072 sc1
    global_load_dwordx4 v[84:87], v17, s[40:41] offset:0 sc1
    global_load_dwordx4 v[88:91], v17, s[40:41] offset:1024 sc1
    global_load_dwordx4 v[92:95], v17, s[40:41] offset:2048 sc1
    global_load_dwordx4 v[96:99], v17, s[40:41] offset:3072 sc1
    s_add_u32 s40, s40, 1310720
    s_addc_u32 s41, s41, 0
    s_cmp_lg_u32 s12, 2
    s_cbranch_scc1 .husk_145
    s_add_u32 s33, s38, 1
    v_mov_b32 v3, s52
    s_mov_b64 exec, 1
.hu_144:
    global_load_dword v2, v3, s[54:55] offset:0 sc1
    s_add_u32 s14, s14, 1
    s_cmp_gt_u32 s14, 400000
    s_cbranch_scc1 .Lend
    s_waitcnt vmcnt(0)
    v_cmp_gt_i32 vcc, s33, v2
    s_cbranch_vccnz .hu_144
    s_mov_b64 exec, -1
.husk_145:
    s_barrier
    global_load_dwordx4 v[52:55], v13, s[34:35] sc1
    global_load_dwordx4 v[56:59], v13, s[34:35] offset:1024 sc1
    s_waitcnt vmcnt(0)
    v_max3_u32 v2, v52, v53, v54
    v_max3_u32 v3, v55, v56, v57
    v_max3_u32 v2, v2, v58, v59
    v_max_u32 v2, v2, v3
    v_cmp_eq_u32 vcc, -1, v2
    s_cbranch_vccz .LC_yok
.LC_yc:
    global_load_dwordx4 v[52:55], v13, s[34:35] sc1
    global_load_dwordx4 v[56:59], v13, s[34:35] offset:1024 sc1
    s_add_u32 s14, s14, 1
    s_cmp_gt_u32 s14, 400000
    s_cbranch_scc1 .Lend
    s_waitcnt vmcnt(0)
    v_max3_u32 v2, v52, v53, v54
    v_max3_u32 v3, v55, v56, v57
    v_max3_u32 v2, v2, v58, v59
    v_max_u32 v2, v2, v3
    v_cmp_eq_u32 vcc, -1, v2
    s_cbranch_vccnz .LC_yc
.LC_yok:
    global_load_dwordx2 v[48:49], v12, s[34:35] sc1
    global_load_dwordx2 v[50:51], v12, s[34:35] offset:640 sc1
    global_load_dwordx4 v[32:35], v11, s[34:35] sc1
    global_load_dwordx4 v[36:39], v11, s[34:35] offset:1280 sc1
    global_load_dwordx4 v[40:43], v11, s[34:35] offset:2560 sc1
    global_load_dwordx4 v[44:47], v11, s[34:35] offset:3840 sc1
.LC_p0:
    v_mov_b32 v132, 0
    v_mov_b32 v133, 0
    v_mov_b32 v134, 0
    v_mov_b32 v135, 0
    s_nop 0
    s_waitcnt vmcnt(4)
    v_smfmac_f32_16x16x64_bf16 v[132:135], v[48:51], v[52:59], v9
    v_max_u32 v2, v48, v49
    v_max_u32 v3, v50, v51
    s_waitcnt vmcnt(3)
    v_smfmac_f32_16x16x64_bf16 v[132:135], v[32:35], v[68:75], v9
    v_max3_u32 v2, v2, v32, v33
    v_max3_u32 v3, v3, v34, v35
    s_waitcnt vmcnt(2)
    v_smfmac_f32_16x16x64_bf16 v[132:135], v[36:39], v[76:83], v9
    v_max3_u32 v2, v2, v36, v37
    v_max3_u32 v3, v3, v38, v39
    s_waitcnt vmcnt(1)
    v_smfmac_f32_16x16x64_bf16 v[132:135], v[40:43], v[84:91], v9
    v_max3_u32 v2, v2, v40, v41
    v_max3_u32 v3, v3, v42, v43
    s_waitcnt vmcnt(0)
    v_smfmac_f32_16x16x64_bf16 v[132:135], v[44:47], v[92:99], v9
    v_max3_u32 v2, v2, v44, v45
    v_max3_u32 v3, v3, v46, v47
    v_max_u32 v2, v2, v3
    v_cmp_eq_u32 vcc, -1, v2
    s_nop 3
    s_cbranch_vccz .LC_ok
    global_load_dwordx2 v[48:49], v12, s[34:35] sc1
    global_load_dwordx2 v[50:51], v12, s[34:35] offset:640 sc1
    global_load_dwordx4 v[32:35], v11, s[34:35] sc1
    global_load_dwordx4 v[36:39], v11, s[34:35] offset:1280 sc1
    global_load_dwordx4 v[40:43], v11, s[34:35] offset:2560 sc1
    global_load_dwordx4 v[44:47], v11, s[34:35] offset:3840 sc1
    s_add_u32 s14, s14, 1
    s_cmp_gt_u32 s14, 400000
    s_cbranch_scc1 .Lend
    s_branch .LC_p1
.LC_p1:
    v_mov_b32 v132, 0
    v_mov_b32 v133, 0
    v_mov_b32 v134, 0
    v_mov_b32 v135, 0
    s_nop 0
    s_waitcnt vmcnt(4)
    v_smfmac_f32_16x16x64_bf16 v[132:135], v[48:51], v[52:59], v9
    v_max_u32 v2, v48, v49
    v_max_u32 v3, v50, v51
    s_waitcnt vmcnt(3)
    v_smfmac_f32_16x16x64_bf16 v[132:135], v[32:35], v[68:75], v9
    v_max3_u32 v2, v2, v32, v33
    v_max3_u32 v3, v3, v34, v35
    s_waitcnt vmcnt(2)
    v_smfmac_f32_16x16x64_bf16 v[132:135], v[36:39], v[76:83], v9
    v_max3_u32 v2, v2, v36, v37
    v_max3_u32 v3, v3, v38, v39
    s_waitcnt vmcnt(1)
    v_smfmac_f32_16x16x64_bf16 v[132:135], v[40:43], v[84:91], v9
    v_max3_u32 v2, v2, v40, v41
    v_max3_u32 v3, v3, v42, v43
    s_waitcnt vmcnt(0)
    v_smfmac_f32_16x16x64_bf16 v[132:135], v[44:47], v[92:99], v9
    v_max3_u32 v2, v2, v44, v45
    v_max3_u32 v3, v3, v46, v47
    v_max_u32 v2, v2, v3
    v_cmp_eq_u32 vcc, -1, v2
    s_nop 3
    s_cbranch_vccz .LC_ok
    global_load_dwordx2 v[48:49], v12, s[34:35] sc1
    global_load_dwordx2 v[50:51], v12, s[34:35] offset:640 sc1
    global_load_dwordx4 v[32:35], v11, s[34:35] sc1
    global_load_dwordx4 v[36:39], v11, s[34:35] offset:1280 sc1
    global_load_dwordx4 v[40:43], v11, s[34:35] offset:2560 sc1
    global_load_dwordx4 v[44:47], v11, s[34:35] offset:3840 sc1
    s_add_u32 s14, s14, 1
    s_cmp_gt_u32 s14, 400000
    s_cbranch_scc1 .Lend
    s_branch .LC_p1
.LC_ok:
    s_cmp_lg_u32 s56, 3
    s_cbranch_scc1 .hus_146
    s_add_u32 s33, s38, 1
    v_mov_b32 v2, s53
    v_mov_b32 v3, s33
    s_mov_b64 exec, 1
    global_store_dword v2, v3, s[54:55] offset:1024 sc1
    s_mov_b64 exec, -1
.hus_146:
.LC_red:
    v_add_f32 v168, v132, v133
    v_add_f32 v169, v134, v135
    ds_write_b32 v20, v168
    ds_write_b32 v20, v169 offset:128
    s_add_u32 s34, s34, 1048576
    s_addc_u32 s35, s35, 0
    s_and_b32 s25, s38, 1
    s_lshl_b32 s25, s25, 13
    s_xor_b32 s34, s34, s25
    s_add_u32 s38, s38, 1
    s_cmp_gt_u32 s12, 0
    s_waitcnt lgkmcnt(0)
    s_barrier
    s_cbranch_scc1 .LmpC
    ds_read_b64 v[168:169], v21
    ds_read_b64 v[170:171], v21 offset:1024
    ds_read_b64 v[172:173], v21 offset:2048
    ds_read_b64 v[174:175], v21 offset:3072
    s_waitcnt lgkmcnt(2)
    v_add_f32 v168, v168, v170
    v_add_f32 v169, v169, v171
    s_waitcnt lgkmcnt(0)
    v_add_f32 v172, v172, v174
    v_add_f32 v173, v173, v175
    v_add_f32 v168, v168, v172
    v_add_f32 v169, v169, v173
    v_cvt_pk_bf16_f32 v168, v168, v169
    global_store_dword v22, v168, s[34:35] sc1
.LmpC:
    s_barrier
    s_cmp_lt_u32 s38, 63
    s_cbranch_scc1 .LC_step
    s_branch .Lend
.Lend:
    s_endpgm
.section .rodata,"a"
.p2align 6
.amdhsa_kernel adaLN_cond__memory_aug_recurrent_mem_tr__mixer_channel_mlp__prompt_kernel
  .amdhsa_next_free_vgpr 512
  .amdhsa_next_free_sgpr 102
  .amdhsa_accum_offset 256
  .amdhsa_group_segment_fixed_size 0
  .amdhsa_kernarg_size 136
  .amdhsa_user_sgpr_count 2
  .amdhsa_user_sgpr_kernarg_segment_ptr 1
  .amdhsa_system_sgpr_workgroup_id_x 1
  .amdhsa_float_denorm_mode_32 3
  .amdhsa_float_denorm_mode_16_64 3
.end_amdhsa_kernel
```
